```python
import torch

def _softmax(x, axis=-1):
    return torch.softmax(x, dim=axis)

def _gelu(x):
    return torch.nn.functional.gelu(x, approximate='tanh')

def _silu(x):
    return torch.nn.functional.silu(x)

def _sigmoid(x):
    return torch.sigmoid(x)

def _layernorm(x, axis=-1, eps=1e-05):
    m = x.mean(dim=axis, keepdim=True)
    v = x.var(dim=axis, keepdim=True, unbiased=False)
    return (x - m) / torch.sqrt(v + eps)

def _scatter_add(tgt, idx, src, axis=0):
    return tgt.clone().index_add_(axis, idx, src)

def _segment_sum(src, seg, n):
    out = torch.zeros((n,) + src.shape[1:], dtype=src.dtype)
    return out.index_add_(0, seg, src)

def _pad(x, pw):
    flat = tuple((v for pair in reversed(pw) for v in pair))
    return torch.nn.functional.pad(x, flat)
kernel_name = 'concat_heads__linear_kernel_hedgehog__memory_aug_recurrent_mem_tr__prompt'

def setup_inputs():

    _w = lambda a: (lambda t: t.to(torch.bfloat16) if t.is_floating_point() else t)(torch.as_tensor(a))

    def _A_setup():
        B, S, D, H = (1, 2048, 640, 32)
        Dh = D // H
        return {'x': _w((lambda *s: torch.randn(*s, dtype=torch.bfloat16) * 0.8)(B, S, D)), 'wqkv': _w((lambda *s: torch.randn(*s, dtype=torch.bfloat16) * 0.8)(D, 3 * D)), 'w_phi': _w((lambda *s: torch.randn(*s, dtype=torch.bfloat16) * 0.8)(H, Dh, Dh) * Dh ** (-0.5)), 'wo': _w((lambda *s: torch.randn(*s, dtype=torch.bfloat16) * 0.05)(D, D))}
    _A_in = _A_setup()

    def _B_setup():
        B, S, Dm = (1, 2048, 640)
        H, Dh = (32, 128)
        M, seg = (8, 32)
        seg = min(seg, S)
        S = S // seg * seg
        return {'x': _w((lambda *s: torch.randn(*s, dtype=torch.bfloat16) * 0.05)(B, S, Dm)), 'mem0': _w((lambda *s: torch.randn(*s, dtype=torch.bfloat16) * 1.6)(B, M, Dm)), 'Wq': _w((lambda *s: torch.randn(*s, dtype=torch.bfloat16) * 0.8)(Dm, H, Dh) * Dm ** (-0.5)), 'Wk': _w((lambda *s: torch.randn(*s, dtype=torch.bfloat16) * 0.8)(Dm, H, Dh) * Dm ** (-0.5)), 'Wv': _w((lambda *s: torch.randn(*s, dtype=torch.bfloat16) * 1.6)(Dm, H, Dh) * Dm ** (-0.5)), 'Wo': _w((lambda *s: torch.randn(*s, dtype=torch.bfloat16) * 1.6)(H, Dh, Dm) * (H * Dh) ** (-0.5)), 'seg_len': seg}
    _B_in = _B_setup()
    return {'A_x': _A_in['x'], 'A_wqkv': _A_in['wqkv'], 'A_w_phi': _A_in['w_phi'], 'A_wo': _A_in['wo'], 'B_x': _B_in['x'], 'B_mem0': _B_in['mem0'], 'B_Wq': _B_in['Wq'], 'B_Wk': _B_in['Wk'], 'B_Wv': _B_in['Wv'], 'B_Wo': _B_in['Wo'], 'B_seg_len': _B_in['seg_len']}

def reference(A_x, A_wqkv, A_w_phi, A_wo, B_x, B_mem0, B_Wq, B_Wk, B_Wv, B_Wo, B_seg_len):

    def _A_ref(x, wqkv, w_phi, wo):
        B, S, D = x.shape
        H = 32
        Dh = D // H
        qkv = (lambda x, *d: x.permute(*d))((x @ wqkv).reshape(B, S, 3, H, Dh), 2, 0, 3, 1, 4)
        q, k, v = (qkv[0], qkv[1], qkv[2])
        pq = torch.einsum('bhsd,hdf->bhsf', q, w_phi)
        pk = torch.einsum('bhsd,hdf->bhsf', k, w_phi)
        phi_q = torch.concatenate([_softmax(pq, axis=-1), _softmax(-pq, axis=-1)], axis=-1)
        phi_k = torch.concatenate([_softmax(pk, axis=-1), _softmax(-pk, axis=-1)], axis=-1)
        kv = torch.einsum('bhsf,bhsd->bhfd', phi_k, v)
        z = torch.einsum('bhsf->bhf', phi_k)
        num = torch.einsum('bhqf,bhfd->bhqd', phi_q, kv)
        den = torch.einsum('bhqf,bhf->bhq', phi_q, z)[..., None] + 1e-06
        o = num / den
        return (lambda x, *d: x.permute(*d))(o, 0, 2, 1, 3).reshape(B, S, D) @ wo

    def _B_ref(x, mem0, Wq, Wk, Wv, Wo, seg_len):
        B, S, Dm = x.shape
        H, Dh = (Wq.shape[1], Wq.shape[2])
        M = mem0.shape[1]
        scale = Dh ** (-0.5)
        n_seg = S // seg_len
        L = M + seg_len
        idx = torch.arange(L)
        mask = (idx[:, None] < M) | (idx[:, None] >= idx[None, :])
        mem = mem0
        outs = []
        for s in range(n_seg):
            xs = x[:, s * seg_len:(s + 1) * seg_len, :].clone()
            h = torch.concatenate([mem, xs], axis=1)
            q = torch.einsum('btd,dhe->bhte', h, Wq)
            k = torch.einsum('btd,dhe->bhte', h, Wk)
            v = torch.einsum('btd,dhe->bhte', h, Wv)
            scores = torch.einsum('bhqe,bhke->bhqk', q, k) * scale
            scores = torch.where(mask[None, None], scores, -1000000000.0)
            p = _softmax(scores, axis=-1)
            o = torch.einsum('bhqk,bhke->bhqe', p, v)
            o = torch.einsum('bhte,hed->btd', o, Wo)
            mem = o[:, :M, :].clone()
            outs.append(o[:, M:, :])
        return torch.concatenate(outs, axis=1)
    a = _A_ref(A_x, A_wqkv, A_w_phi, A_wo)
    b = _B_ref(B_x, B_mem0, B_Wq, B_Wk, B_Wv, B_Wo, B_seg_len)
    return torch.concatenate([a, b], axis=-1)
```

```asm
; @launch grid=(256,1,1) block=(256,1,1) lds=163840
.amdgcn_target "amdgcn-amd-amdhsa--gfx950"
.text
.globl concat_heads__linear_kernel_hedgehog__memory_aug_recurrent_mem_tr__prompt_kernel
.p2align 8
.type concat_heads__linear_kernel_hedgehog__memory_aug_recurrent_mem_tr__prompt_kernel,@function
concat_heads__linear_kernel_hedgehog__memory_aug_recurrent_mem_tr__prompt_kernel:
  s_cmp_ge_u32 s2, 256
  s_cbranch_scc1 L_end0
  s_load_dwordx16 s[64:79], s[0:1], 0
  s_load_dwordx8 s[80:87], s[0:1], 64
  s_load_dwordx4 s[88:91], s[0:1], 96
  s_getreg_b32 s29, hwreg(HW_REG_XCC_ID, 0, 4)
  v_lshrrev_b32 v1, 6, v0
  v_mov_b32 v9, v0
  v_and_b32 v0, 63, v0
  v_readfirstlane_b32 s28, v1
  s_lshr_b32 s30, s2, 3
  s_mov_b32 s31, 0
  s_waitcnt lgkmcnt(0)
  s_mov_b32 s4, s90
  s_and_b32 s5, s91, 0xffff
  s_mov_b32 s6, 0x10000000
  s_mov_b32 s7, 0x20000
  s_mov_b32 s8, s88
  s_and_b32 s9, s89, 0xffff
  s_mov_b32 s10, 0x100
  s_mov_b32 s11, 0x20000
  s_getpc_b64 s[12:13]
L_cp_1:
  s_lshl_b32 s52, s30, 12
  v_lshl_add_u32 v10, v9, 7, s52
  s_mov_b32 s16, L_end - L_cp_1
  v_cmp_gt_u32 vcc, 32, v9
  v_cmp_gt_u32 s[14:15], s16, v10
  s_nop 0
  s_and_b64 vcc, vcc, s[14:15]
  v_mov_b32 v13, s13
  v_add_co_u32 v12, s[14:15], s12, v10
  s_nop 1
  v_addc_co_u32 v13, s[14:15], 0, v13, s[14:15]
  s_nop 0
  s_and_saveexec_b64 s[14:15], vcc
  s_cbranch_execz L_cp_1x
  global_load_dword v255, v[12:13], off
L_cp_1x:
  s_mov_b64 exec, s[14:15]
  s_mov_b32 s27, 0
  v_mov_b64 v[4:5], -1
  v_mov_b64 v[6:7], -1
  v_mov_b32 v8, 0
  v_lshlrev_b32 v2, 4, v9
  v_lshlrev_b32 v3, 2, v9
  s_lshl_b32 s52, s2, 13
  s_add_u32 s53, s52, 0x4800000
  s_add_u32 s54, s52, 0x4a00000
  s_bfe_u32 s52, s2, 0x20005
  s_lshl_b32 s52, s52, 18
  s_and_b32 s55, s2, 31
  s_mul_i32 s55, s55, 5120
  s_add_u32 s52, s52, s55
  s_add_u32 s52, s52, 0x4b00000
  s_cmp_lt_u32 s2, 128
  s_cselect_b32 s54, s54, s52
  buffer_store_dwordx4 v[4:7], v2, s[4:7], s53 offen sc1
  s_add_u32 s53, s53, 4096
  buffer_store_dword v4, v3, s[4:7], s53 offen sc1
  buffer_store_dwordx4 v[4:7], v2, s[4:7], s54 offen sc1
  s_add_u32 s54, s54, 4096
  buffer_store_dword v4, v3, s[4:7], s54 offen sc1
  s_lshl_b32 s52, s2, 7
  s_add_u32 s52, s52, 0x4c00000
  v_and_b32 v3, 124, v3
  buffer_store_dword v8, v3, s[4:7], s52 offen sc1
  s_cmp_lt_u32 s29, 8
  s_cbranch_scc1 L_dispatch
L_fallback:
  s_waitcnt vmcnt(0) lgkmcnt(0)
  s_barrier
  s_or_b32 s52, s28, s27
  s_mov_b32 s27, 1
  s_cmp_lg_u32 s52, 0
  s_cbranch_scc1 L_cens_2
  s_lshl_b32 s52, 1, s30
  s_lshl_b32 s53, s29, 3
  s_cmp_lt_u32 s29, 8
  s_cselect_b32 s52, s52, 0
  s_cselect_b32 s53, s53, 0
  s_mov_b64 exec, 1
  v_mov_b32 v14, 1
  v_mov_b32 v15, s52
  buffer_atomic_add_x2 v[14:15], off, s[8:11], s53 sc1
  s_mov_b64 exec, -1
L_cens_2:
  s_mov_b32 s31, 1
  s_lshr_b32 s29, s2, 5
  s_and_b32 s30, s2, 31
L_dispatch:
  s_cmp_lt_u32 s29, 2
  s_cbranch_scc1 L_chain
  s_cmp_lg_u32 s29, 2
  s_cbranch_scc1 L_nocal_3
  s_or_b32 s52, s30, s28
  s_cmp_lg_u32 s52, 0
  s_cbranch_scc1 L_nocal_3
  s_mov_b64 exec, 1
  v_mov_b32 v1, 0
  s_mov_b32 s32, 0x4801800
  s_mov_b32 s33, 0x4803800
  s_mov_b32 s38, -1
  s_mov_b32 s39, -1
  buffer_store_dword v1, off, s[4:7], s32 sc1
  buffer_store_dword v1, off, s[4:7], s33 sc1
  s_waitcnt vmcnt(0)
  s_memtime s[36:37]
  buffer_store_dword v1, off, s[4:7], s32 offset:128 sc1
  s_waitcnt vmcnt(0) lgkmcnt(0)
  s_mov_b32 s35, s36
  s_memtime s[36:37]
  s_waitcnt lgkmcnt(0)
  s_sub_u32 s35, s36, s35
  s_min_u32 s38, s38, s35
  buffer_store_dword v1, off, s[4:7], s33 offset:128 sc1
  s_waitcnt vmcnt(0) lgkmcnt(0)
  s_mov_b32 s35, s36
  s_memtime s[36:37]
  s_waitcnt lgkmcnt(0)
  s_sub_u32 s35, s36, s35
  s_min_u32 s39, s39, s35
  buffer_store_dword v1, off, s[4:7], s32 offset:256 sc1
  s_waitcnt vmcnt(0) lgkmcnt(0)
  s_mov_b32 s35, s36
  s_memtime s[36:37]
  s_waitcnt lgkmcnt(0)
  s_sub_u32 s35, s36, s35
  s_min_u32 s38, s38, s35
  buffer_store_dword v1, off, s[4:7], s33 offset:256 sc1
  s_waitcnt vmcnt(0) lgkmcnt(0)
  s_mov_b32 s35, s36
  s_memtime s[36:37]
  s_waitcnt lgkmcnt(0)
  s_sub_u32 s35, s36, s35
  s_min_u32 s39, s39, s35
  buffer_store_dword v1, off, s[4:7], s32 offset:384 sc1
  s_waitcnt vmcnt(0) lgkmcnt(0)
  s_mov_b32 s35, s36
  s_memtime s[36:37]
  s_waitcnt lgkmcnt(0)
  s_sub_u32 s35, s36, s35
  s_min_u32 s38, s38, s35
  buffer_store_dword v1, off, s[4:7], s33 offset:384 sc1
  s_waitcnt vmcnt(0) lgkmcnt(0)
  s_mov_b32 s35, s36
  s_memtime s[36:37]
  s_waitcnt lgkmcnt(0)
  s_sub_u32 s35, s36, s35
  s_min_u32 s39, s39, s35
  buffer_store_dword v1, off, s[4:7], s32 offset:512 sc1
  s_waitcnt vmcnt(0) lgkmcnt(0)
  s_mov_b32 s35, s36
  s_memtime s[36:37]
  s_waitcnt lgkmcnt(0)
  s_sub_u32 s35, s36, s35
  s_min_u32 s38, s38, s35
  buffer_store_dword v1, off, s[4:7], s33 offset:512 sc1
  s_waitcnt vmcnt(0) lgkmcnt(0)
  s_mov_b32 s35, s36
  s_memtime s[36:37]
  s_waitcnt lgkmcnt(0)
  s_sub_u32 s35, s36, s35
  s_min_u32 s39, s39, s35
  s_sub_u32 s34, s38, s39
  s_lshl_b32 s35, s38, 16
  s_or_b32 s35, s35, s39
  v_mov_b32 v1, s35
  buffer_store_dword v1, off, s[8:11], 0 offset:72 sc1
  s_cmp_gt_i32 s34, 0
  s_cselect_b32 s34, 3, 2
  v_mov_b32 v1, s34
  buffer_store_dword v1, off, s[8:11], 0 offset:68 sc1
  s_mov_b64 exec, -1
L_nocal_3:
  s_sub_u32 s52, s29, 2
  s_lshl_b32 s32, s52, 5
  s_add_u32 s32, s32, s30
  s_mov_b32 s12, s72
  s_and_b32 s13, s73, 0xffff
  s_mov_b32 s14, 0x280000
  s_mov_b32 s15, 0x20000
  s_lshr_b32 s52, s28, 1
  s_and_b32 s53, s28, 1
  v_and_b32 v4, 31, v0
  v_lshrrev_b32 v5, 5, v0
  v_bfe_u32 v6, v0, 1, 3
  s_lshl_b32 s54, s52, 13
  v_add_u32 v7, 0, v5
  v_xor_b32 v7, v7, v6
  v_lshlrev_b32 v7, 4, v7
  v_lshl_add_u32 v7, v4, 7, v7
  v_add_u32 v80, s54, v7
  v_add_u32 v7, 2, v5
  v_xor_b32 v7, v7, v6
  v_lshlrev_b32 v7, 4, v7
  v_lshl_add_u32 v7, v4, 7, v7
  v_add_u32 v81, s54, v7
  v_add_u32 v7, 4, v5
  v_xor_b32 v7, v7, v6
  v_lshlrev_b32 v7, 4, v7
  v_lshl_add_u32 v7, v4, 7, v7
  v_add_u32 v82, s54, v7
  v_add_u32 v7, 6, v5
  v_xor_b32 v7, v7, v6
  v_lshlrev_b32 v7, 4, v7
  v_lshl_add_u32 v7, v4, 7, v7
  v_add_u32 v83, s54, v7
  v_bfe_u32 v4, v0, 2, 2
  v_lshl_add_u32 v5, v5, 3, v4
  v_lshlrev_b32 v5, 9, v5
  v_bfe_u32 v6, v0, 4, 1
  v_lshlrev_b32 v6, 5, v6
  v_add_u32 v5, v5, v6
  v_and_b32 v6, 3, v0
  v_lshl_add_u32 v5, v6, 3, v5
  s_lshl_b32 s54, s53, 8
  s_add_u32 s54, s54, 16384
  v_xor_b32 v7, 0, v4
  v_lshl_add_u32 v7, v7, 6, v5
  v_add_u32 v84, s54, v7
  v_xor_b32 v7, 1, v4
  v_lshl_add_u32 v7, v7, 6, v5
  v_add_u32 v85, s54, v7
  v_xor_b32 v7, 2, v4
  v_lshl_add_u32 v7, v7, 6, v5
  v_add_u32 v86, s54, v7
  v_xor_b32 v7, 3, v4
  v_lshl_add_u32 v7, v7, 6, v5
  v_add_u32 v87, s54, v7
  v_lshrrev_b32 v4, 3, v0
  v_mul_u32_u24 v4, 1280, v4
  v_and_b32 v5, 7, v0
  v_lshrrev_b32 v6, 4, v0
  v_add_u32 v7, 0, v6
  v_xor_b32 v7, v7, v5
  v_lshl_add_u32 v88, v7, 4, v4
  v_add_u32 v7, 4, v6
  v_xor_b32 v7, v7, v5
  v_lshl_add_u32 v89, v7, 4, v4
  v_lshrrev_b32 v4, 5, v0
  v_and_b32 v5, 31, v0
  v_add_u32 v7, 0, v4
  v_lshlrev_b32 v7, 2, v7
  v_xor_b32 v7, v7, v5
  v_lshlrev_b32 v7, 4, v7
  v_lshl_add_u32 v90, v4, 13, v7
  v_add_u32 v7, 2, v4
  v_lshlrev_b32 v7, 2, v7
  v_xor_b32 v7, v7, v5
  v_lshlrev_b32 v7, 4, v7
  v_lshl_add_u32 v91, v4, 13, v7
  v_and_b32 v5, 15, v0
  v_lshlrev_b32 v5, 4, v5
  v_lshl_add_u32 v5, v4, 8, v5
  v_bfe_u32 v6, v0, 4, 1
  v_lshl_add_u32 v92, v6, 12, v5
  v_lshl_add_u32 v93, v6, 10, v5
  s_mov_b32 s41, 0x80000
  s_mov_b32 s40, 0
  s_mov_b32 s48, 0
  v_mov_b32 v94, v92
L_b1round_4:
  s_cmp_ge_u32 s40, 2
  s_cbranch_scc1 L_b1r2_5
  s_mul_i32 s34, s32, 43691
  s_lshr_b32 s34, s34, 18
  s_mul_i32 s52, s34, 6
  s_sub_u32 s33, s32, s52
  s_mul_i32 s52, s40, 6
  s_add_u32 s33, s33, s52
  s_branch L_b1kv_7
L_b1r2_5:
  s_cmp_ge_u32 s40, 3
  s_cbranch_scc1 L_b1r3_6
  s_lshr_b32 s34, s32, 2
  s_and_b32 s33, s32, 3
  s_cmp_ge_u32 s32, 128
  s_cbranch_scc1 L_b1r3_6q
  s_add_u32 s33, s33, 12
L_b1kv_7:
  s_lshr_b32 s35, s34, 4
  s_and_b32 s34, s34, 15
  s_branch L_b1go_8
L_b1r3_6:
  s_mul_i32 s34, s32, 43691
  s_lshr_b32 s34, s34, 19
  s_mul_i32 s52, s34, 12
  s_sub_u32 s33, s32, s52
  s_add_u32 s33, s33, 4
L_b1r3_6q:
  s_and_b32 s34, s34, 15
  s_mov_b32 s35, 2
L_b1go_8:
  s_cmp_eq_u32 s35, 0
  s_cselect_b64 s[16:17], s[78:79], s[80:81]
  s_cmp_eq_u32 s35, 2
  s_cselect_b64 s[16:17], s[76:77], s[16:17]
  s_and_b32 s17, s17, 0xffff
  s_mov_b32 s18, 5242880
  s_mov_b32 s19, 0x20000
  s_lshl_b32 s39, s28, 12
  s_lshl_b32 s52, s33, 7
  s_lshl_b32 s53, s28, 5
  s_add_u32 s52, s52, s53
  s_mul_i32 s36, s52, 1280
  s_lshl_b32 s52, s28, 17
  s_lshl_b32 s53, s34, 9
  s_add_u32 s37, s52, s53
  s_mov_b32 s43, 0
  s_barrier
  s_add_u32 m0, s39, s43
  s_add_u32 s52, s36, 0
  buffer_load_dwordx4 v88, s[12:15], s52 offen offset:0 lds
  s_add_u32 s52, s36, 9216
  buffer_load_dwordx4 v89, s[12:15], s52 offen offset:1024 lds
  s_add_u32 s52, s36, 18432
  buffer_load_dwordx4 v88, s[12:15], s52 offen offset:2048 lds
  s_add_u32 s52, s36, 27648
  buffer_load_dwordx4 v89, s[12:15], s52 offen offset:3072 lds
  s_add_u32 m0, m0, s39
  s_add_u32 m0, m0, 16384
  s_add_u32 s52, s37, 0
  buffer_load_dwordx4 v90, s[16:19], s52 offen offset:0 lds
  s_add_u32 s52, s37, 15360
  buffer_load_dwordx4 v91, s[16:19], s52 offen offset:1024 lds
  s_add_u32 s52, s37, 30720
  buffer_load_dwordx4 v90, s[16:19], s52 offen offset:2048 lds
  s_add_u32 s52, s37, 46080
  buffer_load_dwordx4 v91, s[16:19], s52 offen offset:3072 lds
  s_add_u32 m0, m0, 4096
  s_add_u32 s52, s37, 65536
  buffer_load_dwordx4 v90, s[16:19], s52 offen offset:0 lds
  s_add_u32 s52, s37, 80896
  buffer_load_dwordx4 v91, s[16:19], s52 offen offset:1024 lds
  s_add_u32 s52, s37, 96256
  buffer_load_dwordx4 v90, s[16:19], s52 offen offset:2048 lds
  s_add_u32 s52, s37, 111616
  buffer_load_dwordx4 v91, s[16:19], s52 offen offset:3072 lds
  s_add_u32 s36, s36, 128
  s_add_u32 s37, s37, 0x80000
  s_add_u32 s43, s43, 49152
  s_cmp_eq_u32 s43, 147456
  s_cselect_b32 s43, 0, s43
  v_mov_b32 v72, v80
  v_mov_b32 v73, v81
  v_mov_b32 v74, v82
  v_mov_b32 v75, v83
  v_mov_b32 v76, v84
  v_mov_b32 v77, v85
  v_mov_b32 v78, v86
  v_mov_b32 v79, v87
  s_add_u32 m0, s39, s43
  s_add_u32 s52, s36, 0
  buffer_load_dwordx4 v88, s[12:15], s52 offen offset:0 lds
  s_add_u32 s52, s36, 9216
  buffer_load_dwordx4 v89, s[12:15], s52 offen offset:1024 lds
  s_add_u32 s52, s36, 18432
  buffer_load_dwordx4 v88, s[12:15], s52 offen offset:2048 lds
  s_add_u32 s52, s36, 27648
  buffer_load_dwordx4 v89, s[12:15], s52 offen offset:3072 lds
  s_add_u32 m0, m0, s39
  s_add_u32 m0, m0, 16384
  s_add_u32 s52, s37, 0
  buffer_load_dwordx4 v90, s[16:19], s52 offen offset:0 lds
  s_add_u32 s52, s37, 15360
  buffer_load_dwordx4 v91, s[16:19], s52 offen offset:1024 lds
  s_add_u32 s52, s37, 30720
  buffer_load_dwordx4 v90, s[16:19], s52 offen offset:2048 lds
  s_add_u32 s52, s37, 46080
  buffer_load_dwordx4 v91, s[16:19], s52 offen offset:3072 lds
  s_add_u32 m0, m0, 4096
  s_add_u32 s52, s37, 65536
  buffer_load_dwordx4 v90, s[16:19], s52 offen offset:0 lds
  s_add_u32 s52, s37, 80896
  buffer_load_dwordx4 v91, s[16:19], s52 offen offset:1024 lds
  s_add_u32 s52, s37, 96256
  buffer_load_dwordx4 v90, s[16:19], s52 offen offset:2048 lds
  s_add_u32 s52, s37, 111616
  buffer_load_dwordx4 v91, s[16:19], s52 offen offset:3072 lds
  s_add_u32 s36, s36, 128
  s_add_u32 s37, s37, 0x80000
  s_add_u32 s43, s43, 49152
  s_cmp_eq_u32 s43, 147456
  s_cselect_b32 s43, 0, s43
  s_cmp_eq_u32 s35, 1
  s_cbranch_scc1 L_b1v_9
  s_waitcnt vmcnt(12)
  s_barrier
  s_or_b32 s52, s28, s27
  s_mov_b32 s27, 1
  s_cmp_lg_u32 s52, 0
  s_cbranch_scc1 L_cens_11
  s_lshl_b32 s52, 1, s30
  s_lshl_b32 s53, s29, 3
  s_cmp_lt_u32 s29, 8
  s_cselect_b32 s52, s52, 0
  s_cselect_b32 s53, s53, 0
  s_mov_b64 exec, 1
  v_mov_b32 v14, 1
  v_mov_b32 v15, s52
  buffer_atomic_add_x2 v[14:15], off, s[8:11], s53 sc1
  s_mov_b64 exec, -1
L_cens_11:
  ds_read_b128 v[16:19], v72 offset:0
  ds_read_b64_tr_b16 v[32:33], v76 offset:0
  ds_read_b64_tr_b16 v[34:35], v76 offset:2048
  ds_read_b128 v[20:23], v72 offset:4096
  ds_read_b64_tr_b16 v[36:37], v77 offset:0
  ds_read_b64_tr_b16 v[38:39], v77 offset:2048
  ds_read_b64_tr_b16 v[40:41], v78 offset:0
  ds_read_b64_tr_b16 v[42:43], v78 offset:2048
  ds_read_b64_tr_b16 v[44:45], v79 offset:0
  ds_read_b64_tr_b16 v[46:47], v79 offset:2048
  s_waitcnt lgkmcnt(0)
  v_mfma_f32_32x32x16_bf16 a[0:15], v[32:35], v[16:19], 0
  ds_read_b128 v[24:27], v73 offset:0
  ds_read_b64_tr_b16 v[48:49], v76 offset:8192
  s_cmp_eq_u32 s48, 0
  s_cbranch_scc1 L_nps_12
  buffer_store_dwordx4 v[128:131], v94, s[4:7], s45 offen offset:0 sc1
  buffer_store_dwordx4 v[132:135], v94, s[4:7], s45 offen offset:512 sc1
  s_add_u32 s45, s45, s46
L_nps_12:
  v_mfma_f32_32x32x16_bf16 a[16:31], v[36:39], v[16:19], 0
  ds_read_b64_tr_b16 v[50:51], v76 offset:10240
  ds_read_b128 v[28:31], v73 offset:4096
  v_mfma_f32_32x32x16_bf16 a[32:47], v[40:43], v[16:19], 0
  ds_read_b64_tr_b16 v[52:53], v77 offset:8192
  ds_read_b64_tr_b16 v[54:55], v77 offset:10240
  s_add_u32 m0, s39, s43
  v_mfma_f32_32x32x16_bf16 a[48:63], v[44:47], v[16:19], 0
  ds_read_b64_tr_b16 v[56:57], v78 offset:8192
  ds_read_b64_tr_b16 v[58:59], v78 offset:10240
  s_add_u32 s52, s36, 0
  buffer_load_dwordx4 v88, s[12:15], s52 offen offset:0 lds
  v_mfma_f32_32x32x16_bf16 a[64:79], v[32:35], v[20:23], 0
  ds_read_b64_tr_b16 v[60:61], v79 offset:8192
  ds_read_b64_tr_b16 v[62:63], v79 offset:10240
  s_add_u32 s52, s36, 9216
  buffer_load_dwordx4 v89, s[12:15], s52 offen offset:1024 lds
  v_mfma_f32_32x32x16_bf16 a[80:95], v[36:39], v[20:23], 0
  s_add_u32 s52, s36, 18432
  buffer_load_dwordx4 v88, s[12:15], s52 offen offset:2048 lds
  v_mfma_f32_32x32x16_bf16 a[96:111], v[40:43], v[20:23], 0
  s_add_u32 s52, s36, 27648
  buffer_load_dwordx4 v89, s[12:15], s52 offen offset:3072 lds
  v_mfma_f32_32x32x16_bf16 a[112:127], v[44:47], v[20:23], 0
  s_add_u32 m0, m0, s39
  s_add_u32 m0, m0, 16384
  s_waitcnt lgkmcnt(0)
  v_mfma_f32_32x32x16_bf16 a[0:15], v[48:51], v[24:27], a[0:15]
  ds_read_b128 v[16:19], v74 offset:0
  ds_read_b64_tr_b16 v[32:33], v76 offset:16384
  v_mfma_f32_32x32x16_bf16 a[16:31], v[52:55], v[24:27], a[16:31]
  ds_read_b64_tr_b16 v[34:35], v76 offset:18432
  ds_read_b128 v[20:23], v74 offset:4096
  v_mfma_f32_32x32x16_bf16 a[32:47], v[56:59], v[24:27], a[32:47]
  ds_read_b64_tr_b16 v[36:37], v77 offset:16384
  ds_read_b64_tr_b16 v[38:39], v77 offset:18432
  s_add_u32 s52, s37, 0
  buffer_load_dwordx4 v90, s[16:19], s52 offen offset:0 lds
  v_mfma_f32_32x32x16_bf16 a[48:63], v[60:63], v[24:27], a[48:63]
  ds_read_b64_tr_b16 v[40:41], v78 offset:16384
  ds_read_b64_tr_b16 v[42:43], v78 offset:18432
  s_add_u32 s52, s37, 15360
  buffer_load_dwordx4 v91, s[16:19], s52 offen offset:1024 lds
  v_mfma_f32_32x32x16_bf16 a[64:79], v[48:51], v[28:31], a[64:79]
  ds_read_b64_tr_b16 v[44:45], v79 offset:16384
  ds_read_b64_tr_b16 v[46:47], v79 offset:18432
  s_add_u32 s52, s37, 30720
  buffer_load_dwordx4 v90, s[16:19], s52 offen offset:2048 lds
  v_mfma_f32_32x32x16_bf16 a[80:95], v[52:55], v[28:31], a[80:95]
  s_add_u32 s52, s37, 46080
  buffer_load_dwordx4 v91, s[16:19], s52 offen offset:3072 lds
  v_mfma_f32_32x32x16_bf16 a[96:111], v[56:59], v[28:31], a[96:111]
  s_add_u32 m0, m0, 4096
  v_mfma_f32_32x32x16_bf16 a[112:127], v[60:63], v[28:31], a[112:127]
  s_add_u32 s52, s37, 65536
  buffer_load_dwordx4 v90, s[16:19], s52 offen offset:0 lds
  s_waitcnt lgkmcnt(0)
  v_mfma_f32_32x32x16_bf16 a[0:15], v[32:35], v[16:19], a[0:15]
  ds_read_b128 v[24:27], v75 offset:0
  ds_read_b64_tr_b16 v[48:49], v76 offset:24576
  v_mfma_f32_32x32x16_bf16 a[16:31], v[36:39], v[16:19], a[16:31]
  ds_read_b64_tr_b16 v[50:51], v76 offset:26624
  ds_read_b128 v[28:31], v75 offset:4096
  v_mfma_f32_32x32x16_bf16 a[32:47], v[40:43], v[16:19], a[32:47]
  ds_read_b64_tr_b16 v[52:53], v77 offset:24576
  ds_read_b64_tr_b16 v[54:55], v77 offset:26624
  s_add_u32 s52, s37, 80896
  buffer_load_dwordx4 v91, s[16:19], s52 offen offset:1024 lds
  v_mfma_f32_32x32x16_bf16 a[48:63], v[44:47], v[16:19], a[48:63]
  ds_read_b64_tr_b16 v[56:57], v78 offset:24576
  ds_read_b64_tr_b16 v[58:59], v78 offset:26624
  s_add_u32 s52, s37, 96256
  buffer_load_dwordx4 v90, s[16:19], s52 offen offset:2048 lds
  v_mfma_f32_32x32x16_bf16 a[64:79], v[32:35], v[20:23], a[64:79]
  ds_read_b64_tr_b16 v[60:61], v79 offset:24576
  ds_read_b64_tr_b16 v[62:63], v79 offset:26624
  s_add_u32 s52, s37, 111616
  buffer_load_dwordx4 v91, s[16:19], s52 offen offset:3072 lds
  v_mfma_f32_32x32x16_bf16 a[80:95], v[36:39], v[20:23], a[80:95]
  s_add_u32 s36, s36, 128
  s_add_u32 s37, s37, 0x80000
  s_add_u32 s43, s43, 49152
  s_cmp_eq_u32 s43, 147456
  s_cselect_b32 s43, 0, s43
  v_mfma_f32_32x32x16_bf16 a[96:111], v[40:43], v[20:23], a[96:111]
  v_mfma_f32_32x32x16_bf16 a[112:127], v[44:47], v[20:23], a[112:127]
  s_waitcnt lgkmcnt(0)
  v_mfma_f32_32x32x16_bf16 a[0:15], v[48:51], v[24:27], a[0:15]
  v_add_u32 v72, 49152, v72
  v_add_u32 v73, 49152, v73
  v_add_u32 v74, 49152, v74
  v_add_u32 v75, 49152, v75
  v_mfma_f32_32x32x16_bf16 a[16:31], v[52:55], v[24:27], a[16:31]
  v_add_u32 v76, 49152, v76
  v_add_u32 v77, 49152, v77
  v_add_u32 v78, 49152, v78
  v_add_u32 v79, 49152, v79
  v_mfma_f32_32x32x16_bf16 a[32:47], v[56:59], v[24:27], a[32:47]
  v_mfma_f32_32x32x16_bf16 a[48:63], v[60:63], v[24:27], a[48:63]
  s_waitcnt vmcnt(12)
  s_barrier
  v_mfma_f32_32x32x16_bf16 a[64:79], v[48:51], v[28:31], a[64:79]
  ds_read_b128 v[16:19], v72 offset:0
  ds_read_b64_tr_b16 v[32:33], v76 offset:0
  ds_read_b64_tr_b16 v[34:35], v76 offset:2048
  v_mfma_f32_32x32x16_bf16 a[80:95], v[52:55], v[28:31], a[80:95]
  ds_read_b128 v[20:23], v72 offset:4096
  ds_read_b64_tr_b16 v[36:37], v77 offset:0
  ds_read_b64_tr_b16 v[38:39], v77 offset:2048
  v_mfma_f32_32x32x16_bf16 a[96:111], v[56:59], v[28:31], a[96:111]
  ds_read_b64_tr_b16 v[40:41], v78 offset:0
  ds_read_b64_tr_b16 v[42:43], v78 offset:2048
  ds_read_b64_tr_b16 v[44:45], v79 offset:0
  v_mfma_f32_32x32x16_bf16 a[112:127], v[60:63], v[28:31], a[112:127]
  ds_read_b64_tr_b16 v[46:47], v79 offset:2048
  s_waitcnt lgkmcnt(0)
  v_mfma_f32_32x32x16_bf16 a[0:15], v[32:35], v[16:19], a[0:15]
  ds_read_b128 v[24:27], v73 offset:0
  ds_read_b64_tr_b16 v[48:49], v76 offset:8192
  s_cmp_eq_u32 s48, 0
  s_cbranch_scc1 L_nps_13
  buffer_store_dwordx4 v[136:139], v94, s[4:7], s45 offen offset:0 sc1
  buffer_store_dwordx4 v[140:143], v94, s[4:7], s45 offen offset:512 sc1
  s_add_u32 s45, s45, s46
L_nps_13:
  v_mfma_f32_32x32x16_bf16 a[16:31], v[36:39], v[16:19], a[16:31]
  ds_read_b64_tr_b16 v[50:51], v76 offset:10240
  ds_read_b128 v[28:31], v73 offset:4096
  v_mfma_f32_32x32x16_bf16 a[32:47], v[40:43], v[16:19], a[32:47]
  ds_read_b64_tr_b16 v[52:53], v77 offset:8192
  ds_read_b64_tr_b16 v[54:55], v77 offset:10240
  s_add_u32 m0, s39, s43
  v_mfma_f32_32x32x16_bf16 a[48:63], v[44:47], v[16:19], a[48:63]
  ds_read_b64_tr_b16 v[56:57], v78 offset:8192
  ds_read_b64_tr_b16 v[58:59], v78 offset:10240
  s_add_u32 s52, s36, 0
  buffer_load_dwordx4 v88, s[12:15], s52 offen offset:0 lds
  v_mfma_f32_32x32x16_bf16 a[64:79], v[32:35], v[20:23], a[64:79]
  ds_read_b64_tr_b16 v[60:61], v79 offset:8192
  ds_read_b64_tr_b16 v[62:63], v79 offset:10240
  s_add_u32 s52, s36, 9216
  buffer_load_dwordx4 v89, s[12:15], s52 offen offset:1024 lds
  v_mfma_f32_32x32x16_bf16 a[80:95], v[36:39], v[20:23], a[80:95]
  s_add_u32 s52, s36, 18432
  buffer_load_dwordx4 v88, s[12:15], s52 offen offset:2048 lds
  v_mfma_f32_32x32x16_bf16 a[96:111], v[40:43], v[20:23], a[96:111]
  s_add_u32 s52, s36, 27648
  buffer_load_dwordx4 v89, s[12:15], s52 offen offset:3072 lds
  v_mfma_f32_32x32x16_bf16 a[112:127], v[44:47], v[20:23], a[112:127]
  s_add_u32 m0, m0, s39
  s_add_u32 m0, m0, 16384
  s_waitcnt lgkmcnt(0)
  v_mfma_f32_32x32x16_bf16 a[0:15], v[48:51], v[24:27], a[0:15]
  ds_read_b128 v[16:19], v74 offset:0
  ds_read_b64_tr_b16 v[32:33], v76 offset:16384
  v_mfma_f32_32x32x16_bf16 a[16:31], v[52:55], v[24:27], a[16:31]
  ds_read_b64_tr_b16 v[34:35], v76 offset:18432
  ds_read_b128 v[20:23], v74 offset:4096
  v_mfma_f32_32x32x16_bf16 a[32:47], v[56:59], v[24:27], a[32:47]
  ds_read_b64_tr_b16 v[36:37], v77 offset:16384
  ds_read_b64_tr_b16 v[38:39], v77 offset:18432
  s_add_u32 s52, s37, 0
  buffer_load_dwordx4 v90, s[16:19], s52 offen offset:0 lds
  v_mfma_f32_32x32x16_bf16 a[48:63], v[60:63], v[24:27], a[48:63]
  ds_read_b64_tr_b16 v[40:41], v78 offset:16384
  ds_read_b64_tr_b16 v[42:43], v78 offset:18432
  s_add_u32 s52, s37, 15360
  buffer_load_dwordx4 v91, s[16:19], s52 offen offset:1024 lds
  v_mfma_f32_32x32x16_bf16 a[64:79], v[48:51], v[28:31], a[64:79]
  ds_read_b64_tr_b16 v[44:45], v79 offset:16384
  ds_read_b64_tr_b16 v[46:47], v79 offset:18432
  s_add_u32 s52, s37, 30720
  buffer_load_dwordx4 v90, s[16:19], s52 offen offset:2048 lds
  v_mfma_f32_32x32x16_bf16 a[80:95], v[52:55], v[28:31], a[80:95]
  s_add_u32 s52, s37, 46080
  buffer_load_dwordx4 v91, s[16:19], s52 offen offset:3072 lds
  v_mfma_f32_32x32x16_bf16 a[96:111], v[56:59], v[28:31], a[96:111]
  s_add_u32 m0, m0, 4096
  v_mfma_f32_32x32x16_bf16 a[112:127], v[60:63], v[28:31], a[112:127]
  s_add_u32 s52, s37, 65536
  buffer_load_dwordx4 v90, s[16:19], s52 offen offset:0 lds
  s_waitcnt lgkmcnt(0)
  v_mfma_f32_32x32x16_bf16 a[0:15], v[32:35], v[16:19], a[0:15]
  ds_read_b128 v[24:27], v75 offset:0
  ds_read_b64_tr_b16 v[48:49], v76 offset:24576
  v_mfma_f32_32x32x16_bf16 a[16:31], v[36:39], v[16:19], a[16:31]
  ds_read_b64_tr_b16 v[50:51], v76 offset:26624
  ds_read_b128 v[28:31], v75 offset:4096
  v_mfma_f32_32x32x16_bf16 a[32:47], v[40:43], v[16:19], a[32:47]
  ds_read_b64_tr_b16 v[52:53], v77 offset:24576
  ds_read_b64_tr_b16 v[54:55], v77 offset:26624
  s_add_u32 s52, s37, 80896
  buffer_load_dwordx4 v91, s[16:19], s52 offen offset:1024 lds
  v_mfma_f32_32x32x16_bf16 a[48:63], v[44:47], v[16:19], a[48:63]
  ds_read_b64_tr_b16 v[56:57], v78 offset:24576
  ds_read_b64_tr_b16 v[58:59], v78 offset:26624
  s_add_u32 s52, s37, 96256
  buffer_load_dwordx4 v90, s[16:19], s52 offen offset:2048 lds
  v_mfma_f32_32x32x16_bf16 a[64:79], v[32:35], v[20:23], a[64:79]
  ds_read_b64_tr_b16 v[60:61], v79 offset:24576
  ds_read_b64_tr_b16 v[62:63], v79 offset:26624
  s_add_u32 s52, s37, 111616
  buffer_load_dwordx4 v91, s[16:19], s52 offen offset:3072 lds
  v_mfma_f32_32x32x16_bf16 a[80:95], v[36:39], v[20:23], a[80:95]
  s_add_u32 s36, s36, 128
  s_add_u32 s37, s37, 0x80000
  s_add_u32 s43, s43, 49152
  s_cmp_eq_u32 s43, 147456
  s_cselect_b32 s43, 0, s43
  v_mfma_f32_32x32x16_bf16 a[96:111], v[40:43], v[20:23], a[96:111]
  v_mfma_f32_32x32x16_bf16 a[112:127], v[44:47], v[20:23], a[112:127]
  s_waitcnt lgkmcnt(0)
  v_mfma_f32_32x32x16_bf16 a[0:15], v[48:51], v[24:27], a[0:15]
  v_add_u32 v72, 49152, v72
  v_add_u32 v73, 49152, v73
  v_add_u32 v74, 49152, v74
  v_add_u32 v75, 49152, v75
  v_mfma_f32_32x32x16_bf16 a[16:31], v[52:55], v[24:27], a[16:31]
  v_add_u32 v76, 49152, v76
  v_add_u32 v77, 49152, v77
  v_add_u32 v78, 49152, v78
  v_add_u32 v79, 49152, v79
  v_mfma_f32_32x32x16_bf16 a[32:47], v[56:59], v[24:27], a[32:47]
  v_mfma_f32_32x32x16_bf16 a[48:63], v[60:63], v[24:27], a[48:63]
  s_waitcnt vmcnt(12)
  s_barrier
  v_mfma_f32_32x32x16_bf16 a[64:79], v[48:51], v[28:31], a[64:79]
  ds_read_b128 v[16:19], v72 offset:0
  ds_read_b64_tr_b16 v[32:33], v76 offset:0
  ds_read_b64_tr_b16 v[34:35], v76 offset:2048
  v_mfma_f32_32x32x16_bf16 a[80:95], v[52:55], v[28:31], a[80:95]
  ds_read_b128 v[20:23], v72 offset:4096
  ds_read_b64_tr_b16 v[36:37], v77 offset:0
  ds_read_b64_tr_b16 v[38:39], v77 offset:2048
  v_mfma_f32_32x32x16_bf16 a[96:111], v[56:59], v[28:31], a[96:111]
  ds_read_b64_tr_b16 v[40:41], v78 offset:0
  ds_read_b64_tr_b16 v[42:43], v78 offset:2048
  ds_read_b64_tr_b16 v[44:45], v79 offset:0
  v_mfma_f32_32x32x16_bf16 a[112:127], v[60:63], v[28:31], a[112:127]
  ds_read_b64_tr_b16 v[46:47], v79 offset:2048
  s_waitcnt lgkmcnt(0)
  v_mfma_f32_32x32x16_bf16 a[0:15], v[32:35], v[16:19], a[0:15]
  ds_read_b128 v[24:27], v73 offset:0
  ds_read_b64_tr_b16 v[48:49], v76 offset:8192
  s_cmp_eq_u32 s48, 0
  s_cbranch_scc1 L_nps_14
  buffer_store_dwordx4 v[144:147], v94, s[4:7], s45 offen offset:0 sc1
  buffer_store_dwordx4 v[148:151], v94, s[4:7], s45 offen offset:512 sc1
  s_add_u32 s45, s45, s46
L_nps_14:
  v_mfma_f32_32x32x16_bf16 a[16:31], v[36:39], v[16:19], a[16:31]
  ds_read_b64_tr_b16 v[50:51], v76 offset:10240
  ds_read_b128 v[28:31], v73 offset:4096
  v_mfma_f32_32x32x16_bf16 a[32:47], v[40:43], v[16:19], a[32:47]
  ds_read_b64_tr_b16 v[52:53], v77 offset:8192
  ds_read_b64_tr_b16 v[54:55], v77 offset:10240
  s_add_u32 m0, s39, s43
  v_mfma_f32_32x32x16_bf16 a[48:63], v[44:47], v[16:19], a[48:63]
  ds_read_b64_tr_b16 v[56:57], v78 offset:8192
  ds_read_b64_tr_b16 v[58:59], v78 offset:10240
  s_add_u32 s52, s36, 0
  buffer_load_dwordx4 v88, s[12:15], s52 offen offset:0 lds
  v_mfma_f32_32x32x16_bf16 a[64:79], v[32:35], v[20:23], a[64:79]
  ds_read_b64_tr_b16 v[60:61], v79 offset:8192
  ds_read_b64_tr_b16 v[62:63], v79 offset:10240
  s_add_u32 s52, s36, 9216
  buffer_load_dwordx4 v89, s[12:15], s52 offen offset:1024 lds
  v_mfma_f32_32x32x16_bf16 a[80:95], v[36:39], v[20:23], a[80:95]
  s_add_u32 s52, s36, 18432
  buffer_load_dwordx4 v88, s[12:15], s52 offen offset:2048 lds
  v_mfma_f32_32x32x16_bf16 a[96:111], v[40:43], v[20:23], a[96:111]
  s_add_u32 s52, s36, 27648
  buffer_load_dwordx4 v89, s[12:15], s52 offen offset:3072 lds
  v_mfma_f32_32x32x16_bf16 a[112:127], v[44:47], v[20:23], a[112:127]
  s_add_u32 m0, m0, s39
  s_add_u32 m0, m0, 16384
  s_waitcnt lgkmcnt(0)
  v_mfma_f32_32x32x16_bf16 a[0:15], v[48:51], v[24:27], a[0:15]
  ds_read_b128 v[16:19], v74 offset:0
  ds_read_b64_tr_b16 v[32:33], v76 offset:16384
  v_mfma_f32_32x32x16_bf16 a[16:31], v[52:55], v[24:27], a[16:31]
  ds_read_b64_tr_b16 v[34:35], v76 offset:18432
  ds_read_b128 v[20:23], v74 offset:4096
  v_mfma_f32_32x32x16_bf16 a[32:47], v[56:59], v[24:27], a[32:47]
  ds_read_b64_tr_b16 v[36:37], v77 offset:16384
  ds_read_b64_tr_b16 v[38:39], v77 offset:18432
  s_add_u32 s52, s37, 0
  buffer_load_dwordx4 v90, s[16:19], s52 offen offset:0 lds
  v_mfma_f32_32x32x16_bf16 a[48:63], v[60:63], v[24:27], a[48:63]
  ds_read_b64_tr_b16 v[40:41], v78 offset:16384
  ds_read_b64_tr_b16 v[42:43], v78 offset:18432
  s_add_u32 s52, s37, 15360
  buffer_load_dwordx4 v91, s[16:19], s52 offen offset:1024 lds
  v_mfma_f32_32x32x16_bf16 a[64:79], v[48:51], v[28:31], a[64:79]
  ds_read_b64_tr_b16 v[44:45], v79 offset:16384
  ds_read_b64_tr_b16 v[46:47], v79 offset:18432
  s_add_u32 s52, s37, 30720
  buffer_load_dwordx4 v90, s[16:19], s52 offen offset:2048 lds
  v_mfma_f32_32x32x16_bf16 a[80:95], v[52:55], v[28:31], a[80:95]
  s_add_u32 s52, s37, 46080
  buffer_load_dwordx4 v91, s[16:19], s52 offen offset:3072 lds
  v_mfma_f32_32x32x16_bf16 a[96:111], v[56:59], v[28:31], a[96:111]
  s_add_u32 m0, m0, 4096
  v_mfma_f32_32x32x16_bf16 a[112:127], v[60:63], v[28:31], a[112:127]
  s_add_u32 s52, s37, 65536
  buffer_load_dwordx4 v90, s[16:19], s52 offen offset:0 lds
  s_waitcnt lgkmcnt(0)
  v_mfma_f32_32x32x16_bf16 a[0:15], v[32:35], v[16:19], a[0:15]
  ds_read_b128 v[24:27], v75 offset:0
  ds_read_b64_tr_b16 v[48:49], v76 offset:24576
  v_mfma_f32_32x32x16_bf16 a[16:31], v[36:39], v[16:19], a[16:31]
  ds_read_b64_tr_b16 v[50:51], v76 offset:26624
  ds_read_b128 v[28:31], v75 offset:4096
  v_mfma_f32_32x32x16_bf16 a[32:47], v[40:43], v[16:19], a[32:47]
  ds_read_b64_tr_b16 v[52:53], v77 offset:24576
  ds_read_b64_tr_b16 v[54:55], v77 offset:26624
  s_add_u32 s52, s37, 80896
  buffer_load_dwordx4 v91, s[16:19], s52 offen offset:1024 lds
  v_mfma_f32_32x32x16_bf16 a[48:63], v[44:47], v[16:19], a[48:63]
  ds_read_b64_tr_b16 v[56:57], v78 offset:24576
  ds_read_b64_tr_b16 v[58:59], v78 offset:26624
  s_add_u32 s52, s37, 96256
  buffer_load_dwordx4 v90, s[16:19], s52 offen offset:2048 lds
  v_mfma_f32_32x32x16_bf16 a[64:79], v[32:35], v[20:23], a[64:79]
  ds_read_b64_tr_b16 v[60:61], v79 offset:24576
  ds_read_b64_tr_b16 v[62:63], v79 offset:26624
  s_add_u32 s52, s37, 111616
  buffer_load_dwordx4 v91, s[16:19], s52 offen offset:3072 lds
  v_mfma_f32_32x32x16_bf16 a[80:95], v[36:39], v[20:23], a[80:95]
  s_add_u32 s36, s36, 128
  s_add_u32 s37, s37, 0x80000
  s_add_u32 s43, s43, 49152
  s_cmp_eq_u32 s43, 147456
  s_cselect_b32 s43, 0, s43
  v_mfma_f32_32x32x16_bf16 a[96:111], v[40:43], v[20:23], a[96:111]
  v_mfma_f32_32x32x16_bf16 a[112:127], v[44:47], v[20:23], a[112:127]
  s_waitcnt lgkmcnt(0)
  v_mfma_f32_32x32x16_bf16 a[0:15], v[48:51], v[24:27], a[0:15]
  v_subrev_u32 v72, 98304, v72
  v_subrev_u32 v73, 98304, v73
  v_subrev_u32 v74, 98304, v74
  v_subrev_u32 v75, 98304, v75
  v_mfma_f32_32x32x16_bf16 a[16:31], v[52:55], v[24:27], a[16:31]
  v_subrev_u32 v76, 98304, v76
  v_subrev_u32 v77, 98304, v77
  v_subrev_u32 v78, 98304, v78
  v_subrev_u32 v79, 98304, v79
  v_mfma_f32_32x32x16_bf16 a[32:47], v[56:59], v[24:27], a[32:47]
  v_mfma_f32_32x32x16_bf16 a[48:63], v[60:63], v[24:27], a[48:63]
  s_waitcnt vmcnt(12)
  s_barrier
  v_mfma_f32_32x32x16_bf16 a[64:79], v[48:51], v[28:31], a[64:79]
  ds_read_b128 v[16:19], v72 offset:0
  ds_read_b64_tr_b16 v[32:33], v76 offset:0
  ds_read_b64_tr_b16 v[34:35], v76 offset:2048
  v_mfma_f32_32x32x16_bf16 a[80:95], v[52:55], v[28:31], a[80:95]
  ds_read_b128 v[20:23], v72 offset:4096
  ds_read_b64_tr_b16 v[36:37], v77 offset:0
  ds_read_b64_tr_b16 v[38:39], v77 offset:2048
  v_mfma_f32_32x32x16_bf16 a[96:111], v[56:59], v[28:31], a[96:111]
  ds_read_b64_tr_b16 v[40:41], v78 offset:0
  ds_read_b64_tr_b16 v[42:43], v78 offset:2048
  ds_read_b64_tr_b16 v[44:45], v79 offset:0
  v_mfma_f32_32x32x16_bf16 a[112:127], v[60:63], v[28:31], a[112:127]
  ds_read_b64_tr_b16 v[46:47], v79 offset:2048
  s_waitcnt lgkmcnt(0)
  v_mfma_f32_32x32x16_bf16 a[0:15], v[32:35], v[16:19], a[0:15]
  ds_read_b128 v[24:27], v73 offset:0
  ds_read_b64_tr_b16 v[48:49], v76 offset:8192
  s_cmp_eq_u32 s48, 0
  s_cbranch_scc1 L_nps_15
  buffer_store_dwordx4 v[152:155], v94, s[4:7], s45 offen offset:0 sc1
  buffer_store_dwordx4 v[156:159], v94, s[4:7], s45 offen offset:512 sc1
  s_add_u32 s45, s45, s47
L_nps_15:
  v_mfma_f32_32x32x16_bf16 a[16:31], v[36:39], v[16:19], a[16:31]
  ds_read_b64_tr_b16 v[50:51], v76 offset:10240
  ds_read_b128 v[28:31], v73 offset:4096
  v_mfma_f32_32x32x16_bf16 a[32:47], v[40:43], v[16:19], a[32:47]
  ds_read_b64_tr_b16 v[52:53], v77 offset:8192
  ds_read_b64_tr_b16 v[54:55], v77 offset:10240
  s_add_u32 m0, s39, s43
  v_mfma_f32_32x32x16_bf16 a[48:63], v[44:47], v[16:19], a[48:63]
  ds_read_b64_tr_b16 v[56:57], v78 offset:8192
  ds_read_b64_tr_b16 v[58:59], v78 offset:10240
  s_add_u32 s52, s36, 0
  buffer_load_dwordx4 v88, s[12:15], s52 offen offset:0 lds
  v_mfma_f32_32x32x16_bf16 a[64:79], v[32:35], v[20:23], a[64:79]
  ds_read_b64_tr_b16 v[60:61], v79 offset:8192
  ds_read_b64_tr_b16 v[62:63], v79 offset:10240
  s_add_u32 s52, s36, 9216
  buffer_load_dwordx4 v89, s[12:15], s52 offen offset:1024 lds
  v_mfma_f32_32x32x16_bf16 a[80:95], v[36:39], v[20:23], a[80:95]
  s_add_u32 s52, s36, 18432
  buffer_load_dwordx4 v88, s[12:15], s52 offen offset:2048 lds
  v_mfma_f32_32x32x16_bf16 a[96:111], v[40:43], v[20:23], a[96:111]
  s_add_u32 s52, s36, 27648
  buffer_load_dwordx4 v89, s[12:15], s52 offen offset:3072 lds
  v_mfma_f32_32x32x16_bf16 a[112:127], v[44:47], v[20:23], a[112:127]
  s_add_u32 m0, m0, s39
  s_add_u32 m0, m0, 16384
  s_waitcnt lgkmcnt(0)
  v_mfma_f32_32x32x16_bf16 a[0:15], v[48:51], v[24:27], a[0:15]
  ds_read_b128 v[16:19], v74 offset:0
  ds_read_b64_tr_b16 v[32:33], v76 offset:16384
  v_mfma_f32_32x32x16_bf16 a[16:31], v[52:55], v[24:27], a[16:31]
  ds_read_b64_tr_b16 v[34:35], v76 offset:18432
  ds_read_b128 v[20:23], v74 offset:4096
  v_mfma_f32_32x32x16_bf16 a[32:47], v[56:59], v[24:27], a[32:47]
  ds_read_b64_tr_b16 v[36:37], v77 offset:16384
  ds_read_b64_tr_b16 v[38:39], v77 offset:18432
  s_add_u32 s52, s37, 0
  buffer_load_dwordx4 v90, s[16:19], s52 offen offset:0 lds
  v_mfma_f32_32x32x16_bf16 a[48:63], v[60:63], v[24:27], a[48:63]
  ds_read_b64_tr_b16 v[40:41], v78 offset:16384
  ds_read_b64_tr_b16 v[42:43], v78 offset:18432
  s_add_u32 s52, s37, 15360
  buffer_load_dwordx4 v91, s[16:19], s52 offen offset:1024 lds
  v_mfma_f32_32x32x16_bf16 a[64:79], v[48:51], v[28:31], a[64:79]
  ds_read_b64_tr_b16 v[44:45], v79 offset:16384
  ds_read_b64_tr_b16 v[46:47], v79 offset:18432
  s_add_u32 s52, s37, 30720
  buffer_load_dwordx4 v90, s[16:19], s52 offen offset:2048 lds
  v_mfma_f32_32x32x16_bf16 a[80:95], v[52:55], v[28:31], a[80:95]
  s_add_u32 s52, s37, 46080
  buffer_load_dwordx4 v91, s[16:19], s52 offen offset:3072 lds
  v_mfma_f32_32x32x16_bf16 a[96:111], v[56:59], v[28:31], a[96:111]
  s_add_u32 m0, m0, 4096
  v_mfma_f32_32x32x16_bf16 a[112:127], v[60:63], v[28:31], a[112:127]
  s_add_u32 s52, s37, 65536
  buffer_load_dwordx4 v90, s[16:19], s52 offen offset:0 lds
  s_waitcnt lgkmcnt(0)
  v_mfma_f32_32x32x16_bf16 a[0:15], v[32:35], v[16:19], a[0:15]
  ds_read_b128 v[24:27], v75 offset:0
  ds_read_b64_tr_b16 v[48:49], v76 offset:24576
  v_mfma_f32_32x32x16_bf16 a[16:31], v[36:39], v[16:19], a[16:31]
  ds_read_b64_tr_b16 v[50:51], v76 offset:26624
  ds_read_b128 v[28:31], v75 offset:4096
  v_mfma_f32_32x32x16_bf16 a[32:47], v[40:43], v[16:19], a[32:47]
  ds_read_b64_tr_b16 v[52:53], v77 offset:24576
  ds_read_b64_tr_b16 v[54:55], v77 offset:26624
  s_add_u32 s52, s37, 80896
  buffer_load_dwordx4 v91, s[16:19], s52 offen offset:1024 lds
  v_mfma_f32_32x32x16_bf16 a[48:63], v[44:47], v[16:19], a[48:63]
  ds_read_b64_tr_b16 v[56:57], v78 offset:24576
  ds_read_b64_tr_b16 v[58:59], v78 offset:26624
  s_add_u32 s52, s37, 96256
  buffer_load_dwordx4 v90, s[16:19], s52 offen offset:2048 lds
  v_mfma_f32_32x32x16_bf16 a[64:79], v[32:35], v[20:23], a[64:79]
  ds_read_b64_tr_b16 v[60:61], v79 offset:24576
  ds_read_b64_tr_b16 v[62:63], v79 offset:26624
  s_add_u32 s52, s37, 111616
  buffer_load_dwordx4 v91, s[16:19], s52 offen offset:3072 lds
  v_mfma_f32_32x32x16_bf16 a[80:95], v[36:39], v[20:23], a[80:95]
  s_add_u32 s36, s36, 128
  s_add_u32 s37, s37, 0x80000
  s_add_u32 s43, s43, 49152
  s_cmp_eq_u32 s43, 147456
  s_cselect_b32 s43, 0, s43
  v_mfma_f32_32x32x16_bf16 a[96:111], v[40:43], v[20:23], a[96:111]
  v_mfma_f32_32x32x16_bf16 a[112:127], v[44:47], v[20:23], a[112:127]
  s_waitcnt lgkmcnt(0)
  v_mfma_f32_32x32x16_bf16 a[0:15], v[48:51], v[24:27], a[0:15]
  v_add_u32 v72, 49152, v72
  v_add_u32 v73, 49152, v73
  v_add_u32 v74, 49152, v74
  v_add_u32 v75, 49152, v75
  v_mfma_f32_32x32x16_bf16 a[16:31], v[52:55], v[24:27], a[16:31]
  v_add_u32 v76, 49152, v76
  v_add_u32 v77, 49152, v77
  v_add_u32 v78, 49152, v78
  v_add_u32 v79, 49152, v79
  v_mfma_f32_32x32x16_bf16 a[32:47], v[56:59], v[24:27], a[32:47]
  v_mfma_f32_32x32x16_bf16 a[48:63], v[60:63], v[24:27], a[48:63]
  s_waitcnt vmcnt(12)
  s_barrier
  v_mfma_f32_32x32x16_bf16 a[64:79], v[48:51], v[28:31], a[64:79]
  ds_read_b128 v[16:19], v72 offset:0
  ds_read_b64_tr_b16 v[32:33], v76 offset:0
  ds_read_b64_tr_b16 v[34:35], v76 offset:2048
  v_mfma_f32_32x32x16_bf16 a[80:95], v[52:55], v[28:31], a[80:95]
  ds_read_b128 v[20:23], v72 offset:4096
  ds_read_b64_tr_b16 v[36:37], v77 offset:0
  ds_read_b64_tr_b16 v[38:39], v77 offset:2048
  v_mfma_f32_32x32x16_bf16 a[96:111], v[56:59], v[28:31], a[96:111]
  ds_read_b64_tr_b16 v[40:41], v78 offset:0
  ds_read_b64_tr_b16 v[42:43], v78 offset:2048
  ds_read_b64_tr_b16 v[44:45], v79 offset:0
  v_mfma_f32_32x32x16_bf16 a[112:127], v[60:63], v[28:31], a[112:127]
  ds_read_b64_tr_b16 v[46:47], v79 offset:2048
  s_waitcnt lgkmcnt(0)
  v_mfma_f32_32x32x16_bf16 a[0:15], v[32:35], v[16:19], a[0:15]
  ds_read_b128 v[24:27], v73 offset:0
  ds_read_b64_tr_b16 v[48:49], v76 offset:8192
  s_cmp_eq_u32 s48, 0
  s_cbranch_scc1 L_nps_16
  buffer_store_dwordx4 v[160:163], v94, s[4:7], s45 offen offset:0 sc1
  buffer_store_dwordx4 v[164:167], v94, s[4:7], s45 offen offset:512 sc1
  s_add_u32 s45, s45, s46
L_nps_16:
  v_mfma_f32_32x32x16_bf16 a[16:31], v[36:39], v[16:19], a[16:31]
  ds_read_b64_tr_b16 v[50:51], v76 offset:10240
  ds_read_b128 v[28:31], v73 offset:4096
  v_mfma_f32_32x32x16_bf16 a[32:47], v[40:43], v[16:19], a[32:47]
  ds_read_b64_tr_b16 v[52:53], v77 offset:8192
  ds_read_b64_tr_b16 v[54:55], v77 offset:10240
  s_add_u32 m0, s39, s43
  v_mfma_f32_32x32x16_bf16 a[48:63], v[44:47], v[16:19], a[48:63]
  ds_read_b64_tr_b16 v[56:57], v78 offset:8192
  ds_read_b64_tr_b16 v[58:59], v78 offset:10240
  s_add_u32 s52, s36, 0
  buffer_load_dwordx4 v88, s[12:15], s52 offen offset:0 lds
  v_mfma_f32_32x32x16_bf16 a[64:79], v[32:35], v[20:23], a[64:79]
  ds_read_b64_tr_b16 v[60:61], v79 offset:8192
  ds_read_b64_tr_b16 v[62:63], v79 offset:10240
  s_add_u32 s52, s36, 9216
  buffer_load_dwordx4 v89, s[12:15], s52 offen offset:1024 lds
  v_mfma_f32_32x32x16_bf16 a[80:95], v[36:39], v[20:23], a[80:95]
  s_add_u32 s52, s36, 18432
  buffer_load_dwordx4 v88, s[12:15], s52 offen offset:2048 lds
  v_mfma_f32_32x32x16_bf16 a[96:111], v[40:43], v[20:23], a[96:111]
  s_add_u32 s52, s36, 27648
  buffer_load_dwordx4 v89, s[12:15], s52 offen offset:3072 lds
  v_mfma_f32_32x32x16_bf16 a[112:127], v[44:47], v[20:23], a[112:127]
  s_add_u32 m0, m0, s39
  s_add_u32 m0, m0, 16384
  s_waitcnt lgkmcnt(0)
  v_mfma_f32_32x32x16_bf16 a[0:15], v[48:51], v[24:27], a[0:15]
  ds_read_b128 v[16:19], v74 offset:0
  ds_read_b64_tr_b16 v[32:33], v76 offset:16384
  v_mfma_f32_32x32x16_bf16 a[16:31], v[52:55], v[24:27], a[16:31]
  ds_read_b64_tr_b16 v[34:35], v76 offset:18432
  ds_read_b128 v[20:23], v74 offset:4096
  v_mfma_f32_32x32x16_bf16 a[32:47], v[56:59], v[24:27], a[32:47]
  ds_read_b64_tr_b16 v[36:37], v77 offset:16384
  ds_read_b64_tr_b16 v[38:39], v77 offset:18432
  s_add_u32 s52, s37, 0
  buffer_load_dwordx4 v90, s[16:19], s52 offen offset:0 lds
  v_mfma_f32_32x32x16_bf16 a[48:63], v[60:63], v[24:27], a[48:63]
  ds_read_b64_tr_b16 v[40:41], v78 offset:16384
  ds_read_b64_tr_b16 v[42:43], v78 offset:18432
  s_add_u32 s52, s37, 15360
  buffer_load_dwordx4 v91, s[16:19], s52 offen offset:1024 lds
  v_mfma_f32_32x32x16_bf16 a[64:79], v[48:51], v[28:31], a[64:79]
  ds_read_b64_tr_b16 v[44:45], v79 offset:16384
  ds_read_b64_tr_b16 v[46:47], v79 offset:18432
  s_add_u32 s52, s37, 30720
  buffer_load_dwordx4 v90, s[16:19], s52 offen offset:2048 lds
  v_mfma_f32_32x32x16_bf16 a[80:95], v[52:55], v[28:31], a[80:95]
  s_add_u32 s52, s37, 46080
  buffer_load_dwordx4 v91, s[16:19], s52 offen offset:3072 lds
  v_mfma_f32_32x32x16_bf16 a[96:111], v[56:59], v[28:31], a[96:111]
  s_add_u32 m0, m0, 4096
  v_mfma_f32_32x32x16_bf16 a[112:127], v[60:63], v[28:31], a[112:127]
  s_add_u32 s52, s37, 65536
  buffer_load_dwordx4 v90, s[16:19], s52 offen offset:0 lds
  s_waitcnt lgkmcnt(0)
  v_mfma_f32_32x32x16_bf16 a[0:15], v[32:35], v[16:19], a[0:15]
  ds_read_b128 v[24:27], v75 offset:0
  ds_read_b64_tr_b16 v[48:49], v76 offset:24576
  v_mfma_f32_32x32x16_bf16 a[16:31], v[36:39], v[16:19], a[16:31]
  ds_read_b64_tr_b16 v[50:51], v76 offset:26624
  ds_read_b128 v[28:31], v75 offset:4096
  v_mfma_f32_32x32x16_bf16 a[32:47], v[40:43], v[16:19], a[32:47]
  ds_read_b64_tr_b16 v[52:53], v77 offset:24576
  ds_read_b64_tr_b16 v[54:55], v77 offset:26624
  s_add_u32 s52, s37, 80896
  buffer_load_dwordx4 v91, s[16:19], s52 offen offset:1024 lds
  v_mfma_f32_32x32x16_bf16 a[48:63], v[44:47], v[16:19], a[48:63]
  ds_read_b64_tr_b16 v[56:57], v78 offset:24576
  ds_read_b64_tr_b16 v[58:59], v78 offset:26624
  s_add_u32 s52, s37, 96256
  buffer_load_dwordx4 v90, s[16:19], s52 offen offset:2048 lds
  v_mfma_f32_32x32x16_bf16 a[64:79], v[32:35], v[20:23], a[64:79]
  ds_read_b64_tr_b16 v[60:61], v79 offset:24576
  ds_read_b64_tr_b16 v[62:63], v79 offset:26624
  s_add_u32 s52, s37, 111616
  buffer_load_dwordx4 v91, s[16:19], s52 offen offset:3072 lds
  v_mfma_f32_32x32x16_bf16 a[80:95], v[36:39], v[20:23], a[80:95]
  s_add_u32 s36, s36, 128
  s_add_u32 s37, s37, 0x80000
  s_add_u32 s43, s43, 49152
  s_cmp_eq_u32 s43, 147456
  s_cselect_b32 s43, 0, s43
  v_mfma_f32_32x32x16_bf16 a[96:111], v[40:43], v[20:23], a[96:111]
  v_mfma_f32_32x32x16_bf16 a[112:127], v[44:47], v[20:23], a[112:127]
  s_waitcnt lgkmcnt(0)
  v_mfma_f32_32x32x16_bf16 a[0:15], v[48:51], v[24:27], a[0:15]
  v_add_u32 v72, 49152, v72
  v_add_u32 v73, 49152, v73
  v_add_u32 v74, 49152, v74
  v_add_u32 v75, 49152, v75
  v_mfma_f32_32x32x16_bf16 a[16:31], v[52:55], v[24:27], a[16:31]
  v_add_u32 v76, 49152, v76
  v_add_u32 v77, 49152, v77
  v_add_u32 v78, 49152, v78
  v_add_u32 v79, 49152, v79
  v_mfma_f32_32x32x16_bf16 a[32:47], v[56:59], v[24:27], a[32:47]
  v_mfma_f32_32x32x16_bf16 a[48:63], v[60:63], v[24:27], a[48:63]
  s_waitcnt vmcnt(12)
  s_barrier
  v_mfma_f32_32x32x16_bf16 a[64:79], v[48:51], v[28:31], a[64:79]
  ds_read_b128 v[16:19], v72 offset:0
  ds_read_b64_tr_b16 v[32:33], v76 offset:0
  ds_read_b64_tr_b16 v[34:35], v76 offset:2048
  v_mfma_f32_32x32x16_bf16 a[80:95], v[52:55], v[28:31], a[80:95]
  ds_read_b128 v[20:23], v72 offset:4096
  ds_read_b64_tr_b16 v[36:37], v77 offset:0
  ds_read_b64_tr_b16 v[38:39], v77 offset:2048
  v_mfma_f32_32x32x16_bf16 a[96:111], v[56:59], v[28:31], a[96:111]
  ds_read_b64_tr_b16 v[40:41], v78 offset:0
  ds_read_b64_tr_b16 v[42:43], v78 offset:2048
  ds_read_b64_tr_b16 v[44:45], v79 offset:0
  v_mfma_f32_32x32x16_bf16 a[112:127], v[60:63], v[28:31], a[112:127]
  ds_read_b64_tr_b16 v[46:47], v79 offset:2048
  s_waitcnt lgkmcnt(0)
  v_mfma_f32_32x32x16_bf16 a[0:15], v[32:35], v[16:19], a[0:15]
  ds_read_b128 v[24:27], v73 offset:0
  ds_read_b64_tr_b16 v[48:49], v76 offset:8192
  s_cmp_eq_u32 s48, 0
  s_cbranch_scc1 L_nps_17
  buffer_store_dwordx4 v[168:171], v94, s[4:7], s45 offen offset:0 sc1
  buffer_store_dwordx4 v[172:175], v94, s[4:7], s45 offen offset:512 sc1
  s_add_u32 s45, s45, s46
L_nps_17:
  v_mfma_f32_32x32x16_bf16 a[16:31], v[36:39], v[16:19], a[16:31]
  ds_read_b64_tr_b16 v[50:51], v76 offset:10240
  ds_read_b128 v[28:31], v73 offset:4096
  v_mfma_f32_32x32x16_bf16 a[32:47], v[40:43], v[16:19], a[32:47]
  ds_read_b64_tr_b16 v[52:53], v77 offset:8192
  ds_read_b64_tr_b16 v[54:55], v77 offset:10240
  s_add_u32 m0, s39, s43
  v_mfma_f32_32x32x16_bf16 a[48:63], v[44:47], v[16:19], a[48:63]
  ds_read_b64_tr_b16 v[56:57], v78 offset:8192
  ds_read_b64_tr_b16 v[58:59], v78 offset:10240
  s_add_u32 s52, s36, 0
  buffer_load_dwordx4 v88, s[12:15], s52 offen offset:0 lds
  v_mfma_f32_32x32x16_bf16 a[64:79], v[32:35], v[20:23], a[64:79]
  ds_read_b64_tr_b16 v[60:61], v79 offset:8192
  ds_read_b64_tr_b16 v[62:63], v79 offset:10240
  s_add_u32 s52, s36, 9216
  buffer_load_dwordx4 v89, s[12:15], s52 offen offset:1024 lds
  v_mfma_f32_32x32x16_bf16 a[80:95], v[36:39], v[20:23], a[80:95]
  s_add_u32 s52, s36, 18432
  buffer_load_dwordx4 v88, s[12:15], s52 offen offset:2048 lds
  v_mfma_f32_32x32x16_bf16 a[96:111], v[40:43], v[20:23], a[96:111]
  s_add_u32 s52, s36, 27648
  buffer_load_dwordx4 v89, s[12:15], s52 offen offset:3072 lds
  v_mfma_f32_32x32x16_bf16 a[112:127], v[44:47], v[20:23], a[112:127]
  s_add_u32 m0, m0, s39
  s_add_u32 m0, m0, 16384
  s_waitcnt lgkmcnt(0)
  v_mfma_f32_32x32x16_bf16 a[0:15], v[48:51], v[24:27], a[0:15]
  ds_read_b128 v[16:19], v74 offset:0
  ds_read_b64_tr_b16 v[32:33], v76 offset:16384
  v_mfma_f32_32x32x16_bf16 a[16:31], v[52:55], v[24:27], a[16:31]
  ds_read_b64_tr_b16 v[34:35], v76 offset:18432
  ds_read_b128 v[20:23], v74 offset:4096
  v_mfma_f32_32x32x16_bf16 a[32:47], v[56:59], v[24:27], a[32:47]
  ds_read_b64_tr_b16 v[36:37], v77 offset:16384
  ds_read_b64_tr_b16 v[38:39], v77 offset:18432
  s_add_u32 s52, s37, 0
  buffer_load_dwordx4 v90, s[16:19], s52 offen offset:0 lds
  v_mfma_f32_32x32x16_bf16 a[48:63], v[60:63], v[24:27], a[48:63]
  ds_read_b64_tr_b16 v[40:41], v78 offset:16384
  ds_read_b64_tr_b16 v[42:43], v78 offset:18432
  s_add_u32 s52, s37, 15360
  buffer_load_dwordx4 v91, s[16:19], s52 offen offset:1024 lds
  v_mfma_f32_32x32x16_bf16 a[64:79], v[48:51], v[28:31], a[64:79]
  ds_read_b64_tr_b16 v[44:45], v79 offset:16384
  ds_read_b64_tr_b16 v[46:47], v79 offset:18432
  s_add_u32 s52, s37, 30720
  buffer_load_dwordx4 v90, s[16:19], s52 offen offset:2048 lds
  v_mfma_f32_32x32x16_bf16 a[80:95], v[52:55], v[28:31], a[80:95]
  s_add_u32 s52, s37, 46080
  buffer_load_dwordx4 v91, s[16:19], s52 offen offset:3072 lds
  v_mfma_f32_32x32x16_bf16 a[96:111], v[56:59], v[28:31], a[96:111]
  s_add_u32 m0, m0, 4096
  v_mfma_f32_32x32x16_bf16 a[112:127], v[60:63], v[28:31], a[112:127]
  s_add_u32 s52, s37, 65536
  buffer_load_dwordx4 v90, s[16:19], s52 offen offset:0 lds
  s_waitcnt lgkmcnt(0)
  v_mfma_f32_32x32x16_bf16 a[0:15], v[32:35], v[16:19], a[0:15]
  ds_read_b128 v[24:27], v75 offset:0
  ds_read_b64_tr_b16 v[48:49], v76 offset:24576
  v_mfma_f32_32x32x16_bf16 a[16:31], v[36:39], v[16:19], a[16:31]
  ds_read_b64_tr_b16 v[50:51], v76 offset:26624
  ds_read_b128 v[28:31], v75 offset:4096
  v_mfma_f32_32x32x16_bf16 a[32:47], v[40:43], v[16:19], a[32:47]
  ds_read_b64_tr_b16 v[52:53], v77 offset:24576
  ds_read_b64_tr_b16 v[54:55], v77 offset:26624
  s_add_u32 s52, s37, 80896
  buffer_load_dwordx4 v91, s[16:19], s52 offen offset:1024 lds
  v_mfma_f32_32x32x16_bf16 a[48:63], v[44:47], v[16:19], a[48:63]
  ds_read_b64_tr_b16 v[56:57], v78 offset:24576
  ds_read_b64_tr_b16 v[58:59], v78 offset:26624
  s_add_u32 s52, s37, 96256
  buffer_load_dwordx4 v90, s[16:19], s52 offen offset:2048 lds
  v_mfma_f32_32x32x16_bf16 a[64:79], v[32:35], v[20:23], a[64:79]
  ds_read_b64_tr_b16 v[60:61], v79 offset:24576
  ds_read_b64_tr_b16 v[62:63], v79 offset:26624
  s_add_u32 s52, s37, 111616
  buffer_load_dwordx4 v91, s[16:19], s52 offen offset:3072 lds
  v_mfma_f32_32x32x16_bf16 a[80:95], v[36:39], v[20:23], a[80:95]
  s_add_u32 s36, s36, 128
  s_add_u32 s37, s37, 0x80000
  s_add_u32 s43, s43, 49152
  s_cmp_eq_u32 s43, 147456
  s_cselect_b32 s43, 0, s43
  v_mfma_f32_32x32x16_bf16 a[96:111], v[40:43], v[20:23], a[96:111]
  v_mfma_f32_32x32x16_bf16 a[112:127], v[44:47], v[20:23], a[112:127]
  s_waitcnt lgkmcnt(0)
  v_mfma_f32_32x32x16_bf16 a[0:15], v[48:51], v[24:27], a[0:15]
  v_subrev_u32 v72, 98304, v72
  v_subrev_u32 v73, 98304, v73
  v_subrev_u32 v74, 98304, v74
  v_subrev_u32 v75, 98304, v75
  v_mfma_f32_32x32x16_bf16 a[16:31], v[52:55], v[24:27], a[16:31]
  v_subrev_u32 v76, 98304, v76
  v_subrev_u32 v77, 98304, v77
  v_subrev_u32 v78, 98304, v78
  v_subrev_u32 v79, 98304, v79
  v_mfma_f32_32x32x16_bf16 a[32:47], v[56:59], v[24:27], a[32:47]
  v_mfma_f32_32x32x16_bf16 a[48:63], v[60:63], v[24:27], a[48:63]
  s_waitcnt vmcnt(12)
  s_barrier
  v_mfma_f32_32x32x16_bf16 a[64:79], v[48:51], v[28:31], a[64:79]
  ds_read_b128 v[16:19], v72 offset:0
  ds_read_b64_tr_b16 v[32:33], v76 offset:0
  ds_read_b64_tr_b16 v[34:35], v76 offset:2048
  v_mfma_f32_32x32x16_bf16 a[80:95], v[52:55], v[28:31], a[80:95]
  ds_read_b128 v[20:23], v72 offset:4096
  ds_read_b64_tr_b16 v[36:37], v77 offset:0
  ds_read_b64_tr_b16 v[38:39], v77 offset:2048
  v_mfma_f32_32x32x16_bf16 a[96:111], v[56:59], v[28:31], a[96:111]
  ds_read_b64_tr_b16 v[40:41], v78 offset:0
  ds_read_b64_tr_b16 v[42:43], v78 offset:2048
  ds_read_b64_tr_b16 v[44:45], v79 offset:0
  v_mfma_f32_32x32x16_bf16 a[112:127], v[60:63], v[28:31], a[112:127]
  ds_read_b64_tr_b16 v[46:47], v79 offset:2048
  s_waitcnt lgkmcnt(0)
  v_mfma_f32_32x32x16_bf16 a[0:15], v[32:35], v[16:19], a[0:15]
  ds_read_b128 v[24:27], v73 offset:0
  ds_read_b64_tr_b16 v[48:49], v76 offset:8192
  s_cmp_eq_u32 s48, 0
  s_cbranch_scc1 L_nps_18
  buffer_store_dwordx4 v[176:179], v94, s[4:7], s45 offen offset:0 sc1
  buffer_store_dwordx4 v[180:183], v94, s[4:7], s45 offen offset:512 sc1
  s_add_u32 s45, s45, s46
L_nps_18:
  v_mfma_f32_32x32x16_bf16 a[16:31], v[36:39], v[16:19], a[16:31]
  ds_read_b64_tr_b16 v[50:51], v76 offset:10240
  ds_read_b128 v[28:31], v73 offset:4096
  v_mfma_f32_32x32x16_bf16 a[32:47], v[40:43], v[16:19], a[32:47]
  ds_read_b64_tr_b16 v[52:53], v77 offset:8192
  ds_read_b64_tr_b16 v[54:55], v77 offset:10240
  s_add_u32 m0, s39, s43
  v_mfma_f32_32x32x16_bf16 a[48:63], v[44:47], v[16:19], a[48:63]
  ds_read_b64_tr_b16 v[56:57], v78 offset:8192
  ds_read_b64_tr_b16 v[58:59], v78 offset:10240
  s_add_u32 s52, s36, 0
  buffer_load_dwordx4 v88, s[12:15], s52 offen offset:0 lds
  v_mfma_f32_32x32x16_bf16 a[64:79], v[32:35], v[20:23], a[64:79]
  ds_read_b64_tr_b16 v[60:61], v79 offset:8192
  ds_read_b64_tr_b16 v[62:63], v79 offset:10240
  s_add_u32 s52, s36, 9216
  buffer_load_dwordx4 v89, s[12:15], s52 offen offset:1024 lds
  v_mfma_f32_32x32x16_bf16 a[80:95], v[36:39], v[20:23], a[80:95]
  s_add_u32 s52, s36, 18432
  buffer_load_dwordx4 v88, s[12:15], s52 offen offset:2048 lds
  v_mfma_f32_32x32x16_bf16 a[96:111], v[40:43], v[20:23], a[96:111]
  s_add_u32 s52, s36, 27648
  buffer_load_dwordx4 v89, s[12:15], s52 offen offset:3072 lds
  v_mfma_f32_32x32x16_bf16 a[112:127], v[44:47], v[20:23], a[112:127]
  s_add_u32 m0, m0, s39
  s_add_u32 m0, m0, 16384
  s_waitcnt lgkmcnt(0)
  v_mfma_f32_32x32x16_bf16 a[0:15], v[48:51], v[24:27], a[0:15]
  ds_read_b128 v[16:19], v74 offset:0
  ds_read_b64_tr_b16 v[32:33], v76 offset:16384
  v_mfma_f32_32x32x16_bf16 a[16:31], v[52:55], v[24:27], a[16:31]
  ds_read_b64_tr_b16 v[34:35], v76 offset:18432
  ds_read_b128 v[20:23], v74 offset:4096
  v_mfma_f32_32x32x16_bf16 a[32:47], v[56:59], v[24:27], a[32:47]
  ds_read_b64_tr_b16 v[36:37], v77 offset:16384
  ds_read_b64_tr_b16 v[38:39], v77 offset:18432
  s_add_u32 s52, s37, 0
  buffer_load_dwordx4 v90, s[16:19], s52 offen offset:0 lds
  v_mfma_f32_32x32x16_bf16 a[48:63], v[60:63], v[24:27], a[48:63]
  ds_read_b64_tr_b16 v[40:41], v78 offset:16384
  ds_read_b64_tr_b16 v[42:43], v78 offset:18432
  s_add_u32 s52, s37, 15360
  buffer_load_dwordx4 v91, s[16:19], s52 offen offset:1024 lds
  v_mfma_f32_32x32x16_bf16 a[64:79], v[48:51], v[28:31], a[64:79]
  ds_read_b64_tr_b16 v[44:45], v79 offset:16384
  ds_read_b64_tr_b16 v[46:47], v79 offset:18432
  s_add_u32 s52, s37, 30720
  buffer_load_dwordx4 v90, s[16:19], s52 offen offset:2048 lds
  v_mfma_f32_32x32x16_bf16 a[80:95], v[52:55], v[28:31], a[80:95]
  s_add_u32 s52, s37, 46080
  buffer_load_dwordx4 v91, s[16:19], s52 offen offset:3072 lds
  v_mfma_f32_32x32x16_bf16 a[96:111], v[56:59], v[28:31], a[96:111]
  s_add_u32 m0, m0, 4096
  v_mfma_f32_32x32x16_bf16 a[112:127], v[60:63], v[28:31], a[112:127]
  s_add_u32 s52, s37, 65536
  buffer_load_dwordx4 v90, s[16:19], s52 offen offset:0 lds
  s_waitcnt lgkmcnt(0)
  v_mfma_f32_32x32x16_bf16 a[0:15], v[32:35], v[16:19], a[0:15]
  ds_read_b128 v[24:27], v75 offset:0
  ds_read_b64_tr_b16 v[48:49], v76 offset:24576
  v_mfma_f32_32x32x16_bf16 a[16:31], v[36:39], v[16:19], a[16:31]
  ds_read_b64_tr_b16 v[50:51], v76 offset:26624
  ds_read_b128 v[28:31], v75 offset:4096
  v_mfma_f32_32x32x16_bf16 a[32:47], v[40:43], v[16:19], a[32:47]
  ds_read_b64_tr_b16 v[52:53], v77 offset:24576
  ds_read_b64_tr_b16 v[54:55], v77 offset:26624
  s_add_u32 s52, s37, 80896
  buffer_load_dwordx4 v91, s[16:19], s52 offen offset:1024 lds
  v_mfma_f32_32x32x16_bf16 a[48:63], v[44:47], v[16:19], a[48:63]
  ds_read_b64_tr_b16 v[56:57], v78 offset:24576
  ds_read_b64_tr_b16 v[58:59], v78 offset:26624
  s_add_u32 s52, s37, 96256
  buffer_load_dwordx4 v90, s[16:19], s52 offen offset:2048 lds
  v_mfma_f32_32x32x16_bf16 a[64:79], v[32:35], v[20:23], a[64:79]
  ds_read_b64_tr_b16 v[60:61], v79 offset:24576
  ds_read_b64_tr_b16 v[62:63], v79 offset:26624
  s_add_u32 s52, s37, 111616
  buffer_load_dwordx4 v91, s[16:19], s52 offen offset:3072 lds
  v_mfma_f32_32x32x16_bf16 a[80:95], v[36:39], v[20:23], a[80:95]
  s_add_u32 s36, s36, 128
  s_add_u32 s37, s37, 0x80000
  s_add_u32 s43, s43, 49152
  s_cmp_eq_u32 s43, 147456
  s_cselect_b32 s43, 0, s43
  v_mfma_f32_32x32x16_bf16 a[96:111], v[40:43], v[20:23], a[96:111]
  v_mfma_f32_32x32x16_bf16 a[112:127], v[44:47], v[20:23], a[112:127]
  s_waitcnt lgkmcnt(0)
  v_mfma_f32_32x32x16_bf16 a[0:15], v[48:51], v[24:27], a[0:15]
  v_add_u32 v72, 49152, v72
  v_add_u32 v73, 49152, v73
  v_add_u32 v74, 49152, v74
  v_add_u32 v75, 49152, v75
  v_mfma_f32_32x32x16_bf16 a[16:31], v[52:55], v[24:27], a[16:31]
  v_add_u32 v76, 49152, v76
  v_add_u32 v77, 49152, v77
  v_add_u32 v78, 49152, v78
  v_add_u32 v79, 49152, v79
  v_mfma_f32_32x32x16_bf16 a[32:47], v[56:59], v[24:27], a[32:47]
  v_mfma_f32_32x32x16_bf16 a[48:63], v[60:63], v[24:27], a[48:63]
  s_waitcnt vmcnt(12)
  s_barrier
  v_mfma_f32_32x32x16_bf16 a[64:79], v[48:51], v[28:31], a[64:79]
  ds_read_b128 v[16:19], v72 offset:0
  ds_read_b64_tr_b16 v[32:33], v76 offset:0
  ds_read_b64_tr_b16 v[34:35], v76 offset:2048
  v_mfma_f32_32x32x16_bf16 a[80:95], v[52:55], v[28:31], a[80:95]
  ds_read_b128 v[20:23], v72 offset:4096
  ds_read_b64_tr_b16 v[36:37], v77 offset:0
  ds_read_b64_tr_b16 v[38:39], v77 offset:2048
  v_mfma_f32_32x32x16_bf16 a[96:111], v[56:59], v[28:31], a[96:111]
  ds_read_b64_tr_b16 v[40:41], v78 offset:0
  ds_read_b64_tr_b16 v[42:43], v78 offset:2048
  ds_read_b64_tr_b16 v[44:45], v79 offset:0
  v_mfma_f32_32x32x16_bf16 a[112:127], v[60:63], v[28:31], a[112:127]
  ds_read_b64_tr_b16 v[46:47], v79 offset:2048
  s_waitcnt lgkmcnt(0)
  v_mfma_f32_32x32x16_bf16 a[0:15], v[32:35], v[16:19], a[0:15]
  ds_read_b128 v[24:27], v73 offset:0
  ds_read_b64_tr_b16 v[48:49], v76 offset:8192
  s_cmp_eq_u32 s48, 0
  s_cbranch_scc1 L_nps_19
  buffer_store_dwordx4 v[184:187], v94, s[4:7], s45 offen offset:0 sc1
  buffer_store_dwordx4 v[188:191], v94, s[4:7], s45 offen offset:512 sc1
  s_add_u32 s45, s45, s46
L_nps_19:
  v_mfma_f32_32x32x16_bf16 a[16:31], v[36:39], v[16:19], a[16:31]
  ds_read_b64_tr_b16 v[50:51], v76 offset:10240
  ds_read_b128 v[28:31], v73 offset:4096
  v_mfma_f32_32x32x16_bf16 a[32:47], v[40:43], v[16:19], a[32:47]
  ds_read_b64_tr_b16 v[52:53], v77 offset:8192
  ds_read_b64_tr_b16 v[54:55], v77 offset:10240
  s_add_u32 m0, s39, s43
  v_mfma_f32_32x32x16_bf16 a[48:63], v[44:47], v[16:19], a[48:63]
  ds_read_b64_tr_b16 v[56:57], v78 offset:8192
  ds_read_b64_tr_b16 v[58:59], v78 offset:10240
  s_add_u32 s52, s36, 0
  buffer_load_dwordx4 v88, s[12:15], s52 offen offset:0 lds
  v_mfma_f32_32x32x16_bf16 a[64:79], v[32:35], v[20:23], a[64:79]
  ds_read_b64_tr_b16 v[60:61], v79 offset:8192
  ds_read_b64_tr_b16 v[62:63], v79 offset:10240
  s_add_u32 s52, s36, 9216
  buffer_load_dwordx4 v89, s[12:15], s52 offen offset:1024 lds
  v_mfma_f32_32x32x16_bf16 a[80:95], v[36:39], v[20:23], a[80:95]
  s_add_u32 s52, s36, 18432
  buffer_load_dwordx4 v88, s[12:15], s52 offen offset:2048 lds
  v_mfma_f32_32x32x16_bf16 a[96:111], v[40:43], v[20:23], a[96:111]
  s_add_u32 s52, s36, 27648
  buffer_load_dwordx4 v89, s[12:15], s52 offen offset:3072 lds
  v_mfma_f32_32x32x16_bf16 a[112:127], v[44:47], v[20:23], a[112:127]
  s_add_u32 m0, m0, s39
  s_add_u32 m0, m0, 16384
  s_waitcnt lgkmcnt(0)
  v_mfma_f32_32x32x16_bf16 a[0:15], v[48:51], v[24:27], a[0:15]
  ds_read_b128 v[16:19], v74 offset:0
  ds_read_b64_tr_b16 v[32:33], v76 offset:16384
  v_mfma_f32_32x32x16_bf16 a[16:31], v[52:55], v[24:27], a[16:31]
  ds_read_b64_tr_b16 v[34:35], v76 offset:18432
  ds_read_b128 v[20:23], v74 offset:4096
  v_mfma_f32_32x32x16_bf16 a[32:47], v[56:59], v[24:27], a[32:47]
  ds_read_b64_tr_b16 v[36:37], v77 offset:16384
  ds_read_b64_tr_b16 v[38:39], v77 offset:18432
  s_add_u32 s52, s37, 0
  buffer_load_dwordx4 v90, s[16:19], s52 offen offset:0 lds
  v_mfma_f32_32x32x16_bf16 a[48:63], v[60:63], v[24:27], a[48:63]
  ds_read_b64_tr_b16 v[40:41], v78 offset:16384
  ds_read_b64_tr_b16 v[42:43], v78 offset:18432
  s_add_u32 s52, s37, 15360
  buffer_load_dwordx4 v91, s[16:19], s52 offen offset:1024 lds
  v_mfma_f32_32x32x16_bf16 a[64:79], v[48:51], v[28:31], a[64:79]
  ds_read_b64_tr_b16 v[44:45], v79 offset:16384
  ds_read_b64_tr_b16 v[46:47], v79 offset:18432
  s_add_u32 s52, s37, 30720
  buffer_load_dwordx4 v90, s[16:19], s52 offen offset:2048 lds
  v_mfma_f32_32x32x16_bf16 a[80:95], v[52:55], v[28:31], a[80:95]
  s_add_u32 s52, s37, 46080
  buffer_load_dwordx4 v91, s[16:19], s52 offen offset:3072 lds
  v_mfma_f32_32x32x16_bf16 a[96:111], v[56:59], v[28:31], a[96:111]
  s_add_u32 m0, m0, 4096
  v_mfma_f32_32x32x16_bf16 a[112:127], v[60:63], v[28:31], a[112:127]
  s_add_u32 s52, s37, 65536
  buffer_load_dwordx4 v90, s[16:19], s52 offen offset:0 lds
  s_waitcnt lgkmcnt(0)
  v_mfma_f32_32x32x16_bf16 a[0:15], v[32:35], v[16:19], a[0:15]
  ds_read_b128 v[24:27], v75 offset:0
  ds_read_b64_tr_b16 v[48:49], v76 offset:24576
  v_mfma_f32_32x32x16_bf16 a[16:31], v[36:39], v[16:19], a[16:31]
  ds_read_b64_tr_b16 v[50:51], v76 offset:26624
  ds_read_b128 v[28:31], v75 offset:4096
  v_mfma_f32_32x32x16_bf16 a[32:47], v[40:43], v[16:19], a[32:47]
  ds_read_b64_tr_b16 v[52:53], v77 offset:24576
  ds_read_b64_tr_b16 v[54:55], v77 offset:26624
  s_add_u32 s52, s37, 80896
  buffer_load_dwordx4 v91, s[16:19], s52 offen offset:1024 lds
  v_mfma_f32_32x32x16_bf16 a[48:63], v[44:47], v[16:19], a[48:63]
  ds_read_b64_tr_b16 v[56:57], v78 offset:24576
  ds_read_b64_tr_b16 v[58:59], v78 offset:26624
  s_add_u32 s52, s37, 96256
  buffer_load_dwordx4 v90, s[16:19], s52 offen offset:2048 lds
  v_mfma_f32_32x32x16_bf16 a[64:79], v[32:35], v[20:23], a[64:79]
  ds_read_b64_tr_b16 v[60:61], v79 offset:24576
  ds_read_b64_tr_b16 v[62:63], v79 offset:26624
  s_add_u32 s52, s37, 111616
  buffer_load_dwordx4 v91, s[16:19], s52 offen offset:3072 lds
  v_mfma_f32_32x32x16_bf16 a[80:95], v[36:39], v[20:23], a[80:95]
  s_add_u32 s36, s36, 128
  s_add_u32 s37, s37, 0x80000
  s_add_u32 s43, s43, 49152
  s_cmp_eq_u32 s43, 147456
  s_cselect_b32 s43, 0, s43
  v_mfma_f32_32x32x16_bf16 a[96:111], v[40:43], v[20:23], a[96:111]
  v_mfma_f32_32x32x16_bf16 a[112:127], v[44:47], v[20:23], a[112:127]
  s_waitcnt lgkmcnt(0)
  v_mfma_f32_32x32x16_bf16 a[0:15], v[48:51], v[24:27], a[0:15]
  v_add_u32 v72, 49152, v72
  v_add_u32 v73, 49152, v73
  v_add_u32 v74, 49152, v74
  v_add_u32 v75, 49152, v75
  v_mfma_f32_32x32x16_bf16 a[16:31], v[52:55], v[24:27], a[16:31]
  v_add_u32 v76, 49152, v76
  v_add_u32 v77, 49152, v77
  v_add_u32 v78, 49152, v78
  v_add_u32 v79, 49152, v79
  v_mfma_f32_32x32x16_bf16 a[32:47], v[56:59], v[24:27], a[32:47]
  v_mfma_f32_32x32x16_bf16 a[48:63], v[60:63], v[24:27], a[48:63]
  s_waitcnt vmcnt(12)
  s_barrier
  v_mfma_f32_32x32x16_bf16 a[64:79], v[48:51], v[28:31], a[64:79]
  ds_read_b128 v[16:19], v72 offset:0
  ds_read_b64_tr_b16 v[32:33], v76 offset:0
  ds_read_b64_tr_b16 v[34:35], v76 offset:2048
  v_mfma_f32_32x32x16_bf16 a[80:95], v[52:55], v[28:31], a[80:95]
  ds_read_b128 v[20:23], v72 offset:4096
  ds_read_b64_tr_b16 v[36:37], v77 offset:0
  ds_read_b64_tr_b16 v[38:39], v77 offset:2048
  v_mfma_f32_32x32x16_bf16 a[96:111], v[56:59], v[28:31], a[96:111]
  ds_read_b64_tr_b16 v[40:41], v78 offset:0
  ds_read_b64_tr_b16 v[42:43], v78 offset:2048
  ds_read_b64_tr_b16 v[44:45], v79 offset:0
  v_mfma_f32_32x32x16_bf16 a[112:127], v[60:63], v[28:31], a[112:127]
  ds_read_b64_tr_b16 v[46:47], v79 offset:2048
  s_waitcnt lgkmcnt(0)
  v_mfma_f32_32x32x16_bf16 a[0:15], v[32:35], v[16:19], a[0:15]
  ds_read_b128 v[24:27], v73 offset:0
  ds_read_b64_tr_b16 v[48:49], v76 offset:8192
  v_mfma_f32_32x32x16_bf16 a[16:31], v[36:39], v[16:19], a[16:31]
  ds_read_b64_tr_b16 v[50:51], v76 offset:10240
  ds_read_b128 v[28:31], v73 offset:4096
  v_mfma_f32_32x32x16_bf16 a[32:47], v[40:43], v[16:19], a[32:47]
  ds_read_b64_tr_b16 v[52:53], v77 offset:8192
  ds_read_b64_tr_b16 v[54:55], v77 offset:10240
  v_mfma_f32_32x32x16_bf16 a[48:63], v[44:47], v[16:19], a[48:63]
  ds_read_b64_tr_b16 v[56:57], v78 offset:8192
  ds_read_b64_tr_b16 v[58:59], v78 offset:10240
  v_mfma_f32_32x32x16_bf16 a[64:79], v[32:35], v[20:23], a[64:79]
  ds_read_b64_tr_b16 v[60:61], v79 offset:8192
  ds_read_b64_tr_b16 v[62:63], v79 offset:10240
  v_mfma_f32_32x32x16_bf16 a[80:95], v[36:39], v[20:23], a[80:95]
  v_mfma_f32_32x32x16_bf16 a[96:111], v[40:43], v[20:23], a[96:111]
  v_mfma_f32_32x32x16_bf16 a[112:127], v[44:47], v[20:23], a[112:127]
  s_waitcnt lgkmcnt(0)
  v_mfma_f32_32x32x16_bf16 a[0:15], v[48:51], v[24:27], a[0:15]
  ds_read_b128 v[16:19], v74 offset:0
  ds_read_b64_tr_b16 v[32:33], v76 offset:16384
  v_mfma_f32_32x32x16_bf16 a[16:31], v[52:55], v[24:27], a[16:31]
  ds_read_b64_tr_b16 v[34:35], v76 offset:18432
  ds_read_b128 v[20:23], v74 offset:4096
  v_mfma_f32_32x32x16_bf16 a[32:47], v[56:59], v[24:27], a[32:47]
  ds_read_b64_tr_b16 v[36:37], v77 offset:16384
  ds_read_b64_tr_b16 v[38:39], v77 offset:18432
  v_mfma_f32_32x32x16_bf16 a[48:63], v[60:63], v[24:27], a[48:63]
  ds_read_b64_tr_b16 v[40:41], v78 offset:16384
  ds_read_b64_tr_b16 v[42:43], v78 offset:18432
  v_mfma_f32_32x32x16_bf16 a[64:79], v[48:51], v[28:31], a[64:79]
  ds_read_b64_tr_b16 v[44:45], v79 offset:16384
  ds_read_b64_tr_b16 v[46:47], v79 offset:18432
  v_mfma_f32_32x32x16_bf16 a[80:95], v[52:55], v[28:31], a[80:95]
  v_mfma_f32_32x32x16_bf16 a[96:111], v[56:59], v[28:31], a[96:111]
  v_mfma_f32_32x32x16_bf16 a[112:127], v[60:63], v[28:31], a[112:127]
  s_waitcnt lgkmcnt(0)
  v_mfma_f32_32x32x16_bf16 a[0:15], v[32:35], v[16:19], a[0:15]
  ds_read_b128 v[24:27], v75 offset:0
  ds_read_b64_tr_b16 v[48:49], v76 offset:24576
  v_mfma_f32_32x32x16_bf16 a[16:31], v[36:39], v[16:19], a[16:31]
  ds_read_b64_tr_b16 v[50:51], v76 offset:26624
  ds_read_b128 v[28:31], v75 offset:4096
  v_mfma_f32_32x32x16_bf16 a[32:47], v[40:43], v[16:19], a[32:47]
  ds_read_b64_tr_b16 v[52:53], v77 offset:24576
  ds_read_b64_tr_b16 v[54:55], v77 offset:26624
  v_mfma_f32_32x32x16_bf16 a[48:63], v[44:47], v[16:19], a[48:63]
  ds_read_b64_tr_b16 v[56:57], v78 offset:24576
  ds_read_b64_tr_b16 v[58:59], v78 offset:26624
  v_mfma_f32_32x32x16_bf16 a[64:79], v[32:35], v[20:23], a[64:79]
  ds_read_b64_tr_b16 v[60:61], v79 offset:24576
  ds_read_b64_tr_b16 v[62:63], v79 offset:26624
  v_mfma_f32_32x32x16_bf16 a[80:95], v[36:39], v[20:23], a[80:95]
  v_mfma_f32_32x32x16_bf16 a[96:111], v[40:43], v[20:23], a[96:111]
  v_mfma_f32_32x32x16_bf16 a[112:127], v[44:47], v[20:23], a[112:127]
  s_waitcnt lgkmcnt(0)
  v_mfma_f32_32x32x16_bf16 a[0:15], v[48:51], v[24:27], a[0:15]
  v_subrev_u32 v72, 98304, v72
  v_subrev_u32 v73, 98304, v73
  v_subrev_u32 v74, 98304, v74
  v_subrev_u32 v75, 98304, v75
  v_mfma_f32_32x32x16_bf16 a[16:31], v[52:55], v[24:27], a[16:31]
  v_subrev_u32 v76, 98304, v76
  v_subrev_u32 v77, 98304, v77
  v_subrev_u32 v78, 98304, v78
  v_subrev_u32 v79, 98304, v79
  v_mfma_f32_32x32x16_bf16 a[32:47], v[56:59], v[24:27], a[32:47]
  v_mfma_f32_32x32x16_bf16 a[48:63], v[60:63], v[24:27], a[48:63]
  s_waitcnt vmcnt(0)
  s_barrier
  s_cmp_eq_u32 s48, 0
  s_cbranch_scc1 L_nsg_20
  s_cmp_lg_u32 s28, 0
  s_cbranch_scc1 L_sig_21
  s_mov_b64 exec, 1
  v_mov_b32 v2, s50
  buffer_atomic_add v2, off, s[8:11], s49 sc1
  s_mov_b64 exec, -1
L_sig_21:
L_nsg_20:
  v_mfma_f32_32x32x16_bf16 a[64:79], v[48:51], v[28:31], a[64:79]
  ds_read_b128 v[16:19], v72 offset:0
  ds_read_b64_tr_b16 v[32:33], v76 offset:0
  ds_read_b64_tr_b16 v[34:35], v76 offset:2048
  v_mfma_f32_32x32x16_bf16 a[80:95], v[52:55], v[28:31], a[80:95]
  ds_read_b128 v[20:23], v72 offset:4096
  ds_read_b64_tr_b16 v[36:37], v77 offset:0
  ds_read_b64_tr_b16 v[38:39], v77 offset:2048
  v_mfma_f32_32x32x16_bf16 a[96:111], v[56:59], v[28:31], a[96:111]
  ds_read_b64_tr_b16 v[40:41], v78 offset:0
  ds_read_b64_tr_b16 v[42:43], v78 offset:2048
  ds_read_b64_tr_b16 v[44:45], v79 offset:0
  v_mfma_f32_32x32x16_bf16 a[112:127], v[60:63], v[28:31], a[112:127]
  ds_read_b64_tr_b16 v[46:47], v79 offset:2048
  s_waitcnt lgkmcnt(0)
  v_mfma_f32_32x32x16_bf16 a[0:15], v[32:35], v[16:19], a[0:15]
  ds_read_b128 v[24:27], v73 offset:0
  ds_read_b64_tr_b16 v[48:49], v76 offset:8192
  v_mfma_f32_32x32x16_bf16 a[16:31], v[36:39], v[16:19], a[16:31]
  ds_read_b64_tr_b16 v[50:51], v76 offset:10240
  ds_read_b128 v[28:31], v73 offset:4096
  v_mfma_f32_32x32x16_bf16 a[32:47], v[40:43], v[16:19], a[32:47]
  ds_read_b64_tr_b16 v[52:53], v77 offset:8192
  ds_read_b64_tr_b16 v[54:55], v77 offset:10240
  v_mfma_f32_32x32x16_bf16 a[48:63], v[44:47], v[16:19], a[48:63]
  ds_read_b64_tr_b16 v[56:57], v78 offset:8192
  ds_read_b64_tr_b16 v[58:59], v78 offset:10240
  v_mfma_f32_32x32x16_bf16 a[64:79], v[32:35], v[20:23], a[64:79]
  ds_read_b64_tr_b16 v[60:61], v79 offset:8192
  ds_read_b64_tr_b16 v[62:63], v79 offset:10240
  v_mfma_f32_32x32x16_bf16 a[80:95], v[36:39], v[20:23], a[80:95]
  v_mfma_f32_32x32x16_bf16 a[96:111], v[40:43], v[20:23], a[96:111]
  v_mfma_f32_32x32x16_bf16 a[112:127], v[44:47], v[20:23], a[112:127]
  s_waitcnt lgkmcnt(0)
  v_mfma_f32_32x32x16_bf16 a[0:15], v[48:51], v[24:27], a[0:15]
  ds_read_b128 v[16:19], v74 offset:0
  ds_read_b64_tr_b16 v[32:33], v76 offset:16384
  v_mfma_f32_32x32x16_bf16 a[16:31], v[52:55], v[24:27], a[16:31]
  ds_read_b64_tr_b16 v[34:35], v76 offset:18432
  ds_read_b128 v[20:23], v74 offset:4096
  v_mfma_f32_32x32x16_bf16 a[32:47], v[56:59], v[24:27], a[32:47]
  ds_read_b64_tr_b16 v[36:37], v77 offset:16384
  ds_read_b64_tr_b16 v[38:39], v77 offset:18432
  v_mfma_f32_32x32x16_bf16 a[48:63], v[60:63], v[24:27], a[48:63]
  ds_read_b64_tr_b16 v[40:41], v78 offset:16384
  ds_read_b64_tr_b16 v[42:43], v78 offset:18432
  v_mfma_f32_32x32x16_bf16 a[64:79], v[48:51], v[28:31], a[64:79]
  ds_read_b64_tr_b16 v[44:45], v79 offset:16384
  ds_read_b64_tr_b16 v[46:47], v79 offset:18432
  v_mfma_f32_32x32x16_bf16 a[80:95], v[52:55], v[28:31], a[80:95]
  v_mfma_f32_32x32x16_bf16 a[96:111], v[56:59], v[28:31], a[96:111]
  v_mfma_f32_32x32x16_bf16 a[112:127], v[60:63], v[28:31], a[112:127]
  s_waitcnt lgkmcnt(0)
  v_mfma_f32_32x32x16_bf16 a[0:15], v[32:35], v[16:19], a[0:15]
  ds_read_b128 v[24:27], v75 offset:0
  ds_read_b64_tr_b16 v[48:49], v76 offset:24576
  v_mfma_f32_32x32x16_bf16 a[16:31], v[36:39], v[16:19], a[16:31]
  ds_read_b64_tr_b16 v[50:51], v76 offset:26624
  ds_read_b128 v[28:31], v75 offset:4096
  v_mfma_f32_32x32x16_bf16 a[32:47], v[40:43], v[16:19], a[32:47]
  ds_read_b64_tr_b16 v[52:53], v77 offset:24576
  ds_read_b64_tr_b16 v[54:55], v77 offset:26624
  v_mfma_f32_32x32x16_bf16 a[48:63], v[44:47], v[16:19], a[48:63]
  ds_read_b64_tr_b16 v[56:57], v78 offset:24576
  ds_read_b64_tr_b16 v[58:59], v78 offset:26624
  v_mfma_f32_32x32x16_bf16 a[64:79], v[32:35], v[20:23], a[64:79]
  ds_read_b64_tr_b16 v[60:61], v79 offset:24576
  ds_read_b64_tr_b16 v[62:63], v79 offset:26624
  v_mfma_f32_32x32x16_bf16 a[80:95], v[36:39], v[20:23], a[80:95]
  v_mfma_f32_32x32x16_bf16 a[96:111], v[40:43], v[20:23], a[96:111]
  v_mfma_f32_32x32x16_bf16 a[112:127], v[44:47], v[20:23], a[112:127]
  s_waitcnt lgkmcnt(0)
  v_mfma_f32_32x32x16_bf16 a[0:15], v[48:51], v[24:27], a[0:15]
  v_mfma_f32_32x32x16_bf16 a[16:31], v[52:55], v[24:27], a[16:31]
  v_mfma_f32_32x32x16_bf16 a[32:47], v[56:59], v[24:27], a[32:47]
  v_mfma_f32_32x32x16_bf16 a[48:63], v[60:63], v[24:27], a[48:63]
  v_mfma_f32_32x32x16_bf16 a[64:79], v[48:51], v[28:31], a[64:79]
  v_mfma_f32_32x32x16_bf16 a[80:95], v[52:55], v[28:31], a[80:95]
  v_mfma_f32_32x32x16_bf16 a[96:111], v[56:59], v[28:31], a[96:111]
  v_mfma_f32_32x32x16_bf16 a[112:127], v[60:63], v[28:31], a[112:127]
  s_lshr_b32 s52, s28, 1
  s_lshl_b32 s53, s33, 2
  s_lshl_b32 s52, s52, 1
  s_add_u32 s52, s52, s53
  s_lshl_b32 s52, s52, 5
  s_and_b32 s53, s28, 1
  s_add_u32 s52, s52, s53
  s_lshl_b32 s53, s34, 1
  s_add_u32 s52, s52, s53
  s_cmp_eq_u32 s35, 2
  s_cselect_b32 s53, 13, 14
  s_lshl_b32 s52, s52, s53
  s_cmp_eq_u32 s35, 2
  s_cselect_b32 s53, 0x2000000, 0
  s_add_u32 s45, s52, s53
  s_cmp_eq_u32 s35, 2
  s_cselect_b32 s47, 0x40000, s41
  s_sub_u32 s47, s47, 3072
  s_movk_i32 s46, 1024
  v_mov_b32 v94, v92
  v_accvgpr_read_b32 v16, a0
  v_accvgpr_read_b32 v17, a1
  v_accvgpr_read_b32 v18, a2
  v_accvgpr_read_b32 v19, a3
  v_accvgpr_read_b32 v20, a4
  v_accvgpr_read_b32 v21, a5
  v_accvgpr_read_b32 v22, a6
  v_accvgpr_read_b32 v23, a7
  v_cvt_pk_bf16_f32 v128, v16, v17
  v_cvt_pk_bf16_f32 v129, v18, v19
  v_cvt_pk_bf16_f32 v130, v20, v21
  v_cvt_pk_bf16_f32 v131, v22, v23
  v_accvgpr_read_b32 v24, a8
  v_accvgpr_read_b32 v25, a9
  v_accvgpr_read_b32 v26, a10
  v_accvgpr_read_b32 v27, a11
  v_accvgpr_read_b32 v28, a12
  v_accvgpr_read_b32 v29, a13
  v_accvgpr_read_b32 v30, a14
  v_accvgpr_read_b32 v31, a15
  v_cvt_pk_bf16_f32 v132, v24, v25
  v_cvt_pk_bf16_f32 v133, v26, v27
  v_cvt_pk_bf16_f32 v134, v28, v29
  v_cvt_pk_bf16_f32 v135, v30, v31
  v_accvgpr_read_b32 v16, a16
  v_accvgpr_read_b32 v17, a17
  v_accvgpr_read_b32 v18, a18
  v_accvgpr_read_b32 v19, a19
  v_accvgpr_read_b32 v20, a20
  v_accvgpr_read_b32 v21, a21
  v_accvgpr_read_b32 v22, a22
  v_accvgpr_read_b32 v23, a23
  v_cvt_pk_bf16_f32 v136, v16, v17
  v_cvt_pk_bf16_f32 v137, v18, v19
  v_cvt_pk_bf16_f32 v138, v20, v21
  v_cvt_pk_bf16_f32 v139, v22, v23
  v_accvgpr_read_b32 v24, a24
  v_accvgpr_read_b32 v25, a25
  v_accvgpr_read_b32 v26, a26
  v_accvgpr_read_b32 v27, a27
  v_accvgpr_read_b32 v28, a28
  v_accvgpr_read_b32 v29, a29
  v_accvgpr_read_b32 v30, a30
  v_accvgpr_read_b32 v31, a31
  v_cvt_pk_bf16_f32 v140, v24, v25
  v_cvt_pk_bf16_f32 v141, v26, v27
  v_cvt_pk_bf16_f32 v142, v28, v29
  v_cvt_pk_bf16_f32 v143, v30, v31
  v_accvgpr_read_b32 v16, a32
  v_accvgpr_read_b32 v17, a33
  v_accvgpr_read_b32 v18, a34
  v_accvgpr_read_b32 v19, a35
  v_accvgpr_read_b32 v20, a36
  v_accvgpr_read_b32 v21, a37
  v_accvgpr_read_b32 v22, a38
  v_accvgpr_read_b32 v23, a39
  v_cvt_pk_bf16_f32 v144, v16, v17
  v_cvt_pk_bf16_f32 v145, v18, v19
  v_cvt_pk_bf16_f32 v146, v20, v21
  v_cvt_pk_bf16_f32 v147, v22, v23
  v_accvgpr_read_b32 v24, a40
  v_accvgpr_read_b32 v25, a41
  v_accvgpr_read_b32 v26, a42
  v_accvgpr_read_b32 v27, a43
  v_accvgpr_read_b32 v28, a44
  v_accvgpr_read_b32 v29, a45
  v_accvgpr_read_b32 v30, a46
  v_accvgpr_read_b32 v31, a47
  v_cvt_pk_bf16_f32 v148, v24, v25
  v_cvt_pk_bf16_f32 v149, v26, v27
  v_cvt_pk_bf16_f32 v150, v28, v29
  v_cvt_pk_bf16_f32 v151, v30, v31
  v_accvgpr_read_b32 v16, a48
  v_accvgpr_read_b32 v17, a49
  v_accvgpr_read_b32 v18, a50
  v_accvgpr_read_b32 v19, a51
  v_accvgpr_read_b32 v20, a52
  v_accvgpr_read_b32 v21, a53
  v_accvgpr_read_b32 v22, a54
  v_accvgpr_read_b32 v23, a55
  v_cvt_pk_bf16_f32 v152, v16, v17
  v_cvt_pk_bf16_f32 v153, v18, v19
  v_cvt_pk_bf16_f32 v154, v20, v21
  v_cvt_pk_bf16_f32 v155, v22, v23
  v_accvgpr_read_b32 v24, a56
  v_accvgpr_read_b32 v25, a57
  v_accvgpr_read_b32 v26, a58
  v_accvgpr_read_b32 v27, a59
  v_accvgpr_read_b32 v28, a60
  v_accvgpr_read_b32 v29, a61
  v_accvgpr_read_b32 v30, a62
  v_accvgpr_read_b32 v31, a63
  v_cvt_pk_bf16_f32 v156, v24, v25
  v_cvt_pk_bf16_f32 v157, v26, v27
  v_cvt_pk_bf16_f32 v158, v28, v29
  v_cvt_pk_bf16_f32 v159, v30, v31
  v_accvgpr_read_b32 v16, a64
  v_accvgpr_read_b32 v17, a65
  v_accvgpr_read_b32 v18, a66
  v_accvgpr_read_b32 v19, a67
  v_accvgpr_read_b32 v20, a68
  v_accvgpr_read_b32 v21, a69
  v_accvgpr_read_b32 v22, a70
  v_accvgpr_read_b32 v23, a71
  v_cvt_pk_bf16_f32 v160, v16, v17
  v_cvt_pk_bf16_f32 v161, v18, v19
  v_cvt_pk_bf16_f32 v162, v20, v21
  v_cvt_pk_bf16_f32 v163, v22, v23
  v_accvgpr_read_b32 v24, a72
  v_accvgpr_read_b32 v25, a73
  v_accvgpr_read_b32 v26, a74
  v_accvgpr_read_b32 v27, a75
  v_accvgpr_read_b32 v28, a76
  v_accvgpr_read_b32 v29, a77
  v_accvgpr_read_b32 v30, a78
  v_accvgpr_read_b32 v31, a79
  v_cvt_pk_bf16_f32 v164, v24, v25
  v_cvt_pk_bf16_f32 v165, v26, v27
  v_cvt_pk_bf16_f32 v166, v28, v29
  v_cvt_pk_bf16_f32 v167, v30, v31
  v_accvgpr_read_b32 v16, a80
  v_accvgpr_read_b32 v17, a81
  v_accvgpr_read_b32 v18, a82
  v_accvgpr_read_b32 v19, a83
  v_accvgpr_read_b32 v20, a84
  v_accvgpr_read_b32 v21, a85
  v_accvgpr_read_b32 v22, a86
  v_accvgpr_read_b32 v23, a87
  v_cvt_pk_bf16_f32 v168, v16, v17
  v_cvt_pk_bf16_f32 v169, v18, v19
  v_cvt_pk_bf16_f32 v170, v20, v21
  v_cvt_pk_bf16_f32 v171, v22, v23
  v_accvgpr_read_b32 v24, a88
  v_accvgpr_read_b32 v25, a89
  v_accvgpr_read_b32 v26, a90
  v_accvgpr_read_b32 v27, a91
  v_accvgpr_read_b32 v28, a92
  v_accvgpr_read_b32 v29, a93
  v_accvgpr_read_b32 v30, a94
  v_accvgpr_read_b32 v31, a95
  v_cvt_pk_bf16_f32 v172, v24, v25
  v_cvt_pk_bf16_f32 v173, v26, v27
  v_cvt_pk_bf16_f32 v174, v28, v29
  v_cvt_pk_bf16_f32 v175, v30, v31
  v_accvgpr_read_b32 v16, a96
  v_accvgpr_read_b32 v17, a97
  v_accvgpr_read_b32 v18, a98
  v_accvgpr_read_b32 v19, a99
  v_accvgpr_read_b32 v20, a100
  v_accvgpr_read_b32 v21, a101
  v_accvgpr_read_b32 v22, a102
  v_accvgpr_read_b32 v23, a103
  v_cvt_pk_bf16_f32 v176, v16, v17
  v_cvt_pk_bf16_f32 v177, v18, v19
  v_cvt_pk_bf16_f32 v178, v20, v21
  v_cvt_pk_bf16_f32 v179, v22, v23
  v_accvgpr_read_b32 v24, a104
  v_accvgpr_read_b32 v25, a105
  v_accvgpr_read_b32 v26, a106
  v_accvgpr_read_b32 v27, a107
  v_accvgpr_read_b32 v28, a108
  v_accvgpr_read_b32 v29, a109
  v_accvgpr_read_b32 v30, a110
  v_accvgpr_read_b32 v31, a111
  v_cvt_pk_bf16_f32 v180, v24, v25
  v_cvt_pk_bf16_f32 v181, v26, v27
  v_cvt_pk_bf16_f32 v182, v28, v29
  v_cvt_pk_bf16_f32 v183, v30, v31
  v_accvgpr_read_b32 v16, a112
  v_accvgpr_read_b32 v17, a113
  v_accvgpr_read_b32 v18, a114
  v_accvgpr_read_b32 v19, a115
  v_accvgpr_read_b32 v20, a116
  v_accvgpr_read_b32 v21, a117
  v_accvgpr_read_b32 v22, a118
  v_accvgpr_read_b32 v23, a119
  v_cvt_pk_bf16_f32 v184, v16, v17
  v_cvt_pk_bf16_f32 v185, v18, v19
  v_cvt_pk_bf16_f32 v186, v20, v21
  v_cvt_pk_bf16_f32 v187, v22, v23
  v_accvgpr_read_b32 v24, a120
  v_accvgpr_read_b32 v25, a121
  v_accvgpr_read_b32 v26, a122
  v_accvgpr_read_b32 v27, a123
  v_accvgpr_read_b32 v28, a124
  v_accvgpr_read_b32 v29, a125
  v_accvgpr_read_b32 v30, a126
  v_accvgpr_read_b32 v31, a127
  v_cvt_pk_bf16_f32 v188, v24, v25
  v_cvt_pk_bf16_f32 v189, v26, v27
  v_cvt_pk_bf16_f32 v190, v28, v29
  v_cvt_pk_bf16_f32 v191, v30, v31
  s_branch L_b1done_10
L_b1v_9:
  s_waitcnt vmcnt(12)
  s_barrier
  s_or_b32 s52, s28, s27
  s_mov_b32 s27, 1
  s_cmp_lg_u32 s52, 0
  s_cbranch_scc1 L_cens_22
  s_lshl_b32 s52, 1, s30
  s_lshl_b32 s53, s29, 3
  s_cmp_lt_u32 s29, 8
  s_cselect_b32 s52, s52, 0
  s_cselect_b32 s53, s53, 0
  s_mov_b64 exec, 1
  v_mov_b32 v14, 1
  v_mov_b32 v15, s52
  buffer_atomic_add_x2 v[14:15], off, s[8:11], s53 sc1
  s_mov_b64 exec, -1
L_cens_22:
  ds_read_b128 v[16:19], v72 offset:0
  ds_read_b64_tr_b16 v[32:33], v76 offset:0
  ds_read_b64_tr_b16 v[34:35], v76 offset:2048
  ds_read_b128 v[20:23], v72 offset:4096
  ds_read_b64_tr_b16 v[36:37], v77 offset:0
  ds_read_b64_tr_b16 v[38:39], v77 offset:2048
  ds_read_b64_tr_b16 v[40:41], v78 offset:0
  ds_read_b64_tr_b16 v[42:43], v78 offset:2048
  ds_read_b64_tr_b16 v[44:45], v79 offset:0
  ds_read_b64_tr_b16 v[46:47], v79 offset:2048
  s_waitcnt lgkmcnt(0)
  v_mfma_f32_32x32x16_bf16 a[0:15], v[16:19], v[32:35], 0
  ds_read_b128 v[24:27], v73 offset:0
  ds_read_b64_tr_b16 v[48:49], v76 offset:8192
  s_cmp_eq_u32 s48, 0
  s_cbranch_scc1 L_nps_23
  buffer_store_dwordx4 v[128:131], v94, s[4:7], s45 offen offset:0 sc1
  buffer_store_dwordx4 v[132:135], v94, s[4:7], s45 offen offset:512 sc1
  s_add_u32 s45, s45, s46
L_nps_23:
  v_mfma_f32_32x32x16_bf16 a[16:31], v[16:19], v[36:39], 0
  ds_read_b64_tr_b16 v[50:51], v76 offset:10240
  ds_read_b128 v[28:31], v73 offset:4096
  v_mfma_f32_32x32x16_bf16 a[32:47], v[16:19], v[40:43], 0
  ds_read_b64_tr_b16 v[52:53], v77 offset:8192
  ds_read_b64_tr_b16 v[54:55], v77 offset:10240
  s_add_u32 m0, s39, s43
  v_mfma_f32_32x32x16_bf16 a[48:63], v[16:19], v[44:47], 0
  ds_read_b64_tr_b16 v[56:57], v78 offset:8192
  ds_read_b64_tr_b16 v[58:59], v78 offset:10240
  s_add_u32 s52, s36, 0
  buffer_load_dwordx4 v88, s[12:15], s52 offen offset:0 lds
  v_mfma_f32_32x32x16_bf16 a[64:79], v[20:23], v[32:35], 0
  ds_read_b64_tr_b16 v[60:61], v79 offset:8192
  ds_read_b64_tr_b16 v[62:63], v79 offset:10240
  s_add_u32 s52, s36, 9216
  buffer_load_dwordx4 v89, s[12:15], s52 offen offset:1024 lds
  v_mfma_f32_32x32x16_bf16 a[80:95], v[20:23], v[36:39], 0
  s_add_u32 s52, s36, 18432
  buffer_load_dwordx4 v88, s[12:15], s52 offen offset:2048 lds
  v_mfma_f32_32x32x16_bf16 a[96:111], v[20:23], v[40:43], 0
  s_add_u32 s52, s36, 27648
  buffer_load_dwordx4 v89, s[12:15], s52 offen offset:3072 lds
  v_mfma_f32_32x32x16_bf16 a[112:127], v[20:23], v[44:47], 0
  s_add_u32 m0, m0, s39
  s_add_u32 m0, m0, 16384
  s_waitcnt lgkmcnt(0)
  v_mfma_f32_32x32x16_bf16 a[0:15], v[24:27], v[48:51], a[0:15]
  ds_read_b128 v[16:19], v74 offset:0
  ds_read_b64_tr_b16 v[32:33], v76 offset:16384
  v_mfma_f32_32x32x16_bf16 a[16:31], v[24:27], v[52:55], a[16:31]
  ds_read_b64_tr_b16 v[34:35], v76 offset:18432
  ds_read_b128 v[20:23], v74 offset:4096
  v_mfma_f32_32x32x16_bf16 a[32:47], v[24:27], v[56:59], a[32:47]
  ds_read_b64_tr_b16 v[36:37], v77 offset:16384
  ds_read_b64_tr_b16 v[38:39], v77 offset:18432
  s_add_u32 s52, s37, 0
  buffer_load_dwordx4 v90, s[16:19], s52 offen offset:0 lds
  v_mfma_f32_32x32x16_bf16 a[48:63], v[24:27], v[60:63], a[48:63]
  ds_read_b64_tr_b16 v[40:41], v78 offset:16384
  ds_read_b64_tr_b16 v[42:43], v78 offset:18432
  s_add_u32 s52, s37, 15360
  buffer_load_dwordx4 v91, s[16:19], s52 offen offset:1024 lds
  v_mfma_f32_32x32x16_bf16 a[64:79], v[28:31], v[48:51], a[64:79]
  ds_read_b64_tr_b16 v[44:45], v79 offset:16384
  ds_read_b64_tr_b16 v[46:47], v79 offset:18432
  s_add_u32 s52, s37, 30720
  buffer_load_dwordx4 v90, s[16:19], s52 offen offset:2048 lds
  v_mfma_f32_32x32x16_bf16 a[80:95], v[28:31], v[52:55], a[80:95]
  s_add_u32 s52, s37, 46080
  buffer_load_dwordx4 v91, s[16:19], s52 offen offset:3072 lds
  v_mfma_f32_32x32x16_bf16 a[96:111], v[28:31], v[56:59], a[96:111]
  s_add_u32 m0, m0, 4096
  v_mfma_f32_32x32x16_bf16 a[112:127], v[28:31], v[60:63], a[112:127]
  s_add_u32 s52, s37, 65536
  buffer_load_dwordx4 v90, s[16:19], s52 offen offset:0 lds
  s_waitcnt lgkmcnt(0)
  v_mfma_f32_32x32x16_bf16 a[0:15], v[16:19], v[32:35], a[0:15]
  ds_read_b128 v[24:27], v75 offset:0
  ds_read_b64_tr_b16 v[48:49], v76 offset:24576
  v_mfma_f32_32x32x16_bf16 a[16:31], v[16:19], v[36:39], a[16:31]
  ds_read_b64_tr_b16 v[50:51], v76 offset:26624
  ds_read_b128 v[28:31], v75 offset:4096
  v_mfma_f32_32x32x16_bf16 a[32:47], v[16:19], v[40:43], a[32:47]
  ds_read_b64_tr_b16 v[52:53], v77 offset:24576
  ds_read_b64_tr_b16 v[54:55], v77 offset:26624
  s_add_u32 s52, s37, 80896
  buffer_load_dwordx4 v91, s[16:19], s52 offen offset:1024 lds
  v_mfma_f32_32x32x16_bf16 a[48:63], v[16:19], v[44:47], a[48:63]
  ds_read_b64_tr_b16 v[56:57], v78 offset:24576
  ds_read_b64_tr_b16 v[58:59], v78 offset:26624
  s_add_u32 s52, s37, 96256
  buffer_load_dwordx4 v90, s[16:19], s52 offen offset:2048 lds
  v_mfma_f32_32x32x16_bf16 a[64:79], v[20:23], v[32:35], a[64:79]
  ds_read_b64_tr_b16 v[60:61], v79 offset:24576
  ds_read_b64_tr_b16 v[62:63], v79 offset:26624
  s_add_u32 s52, s37, 111616
  buffer_load_dwordx4 v91, s[16:19], s52 offen offset:3072 lds
  v_mfma_f32_32x32x16_bf16 a[80:95], v[20:23], v[36:39], a[80:95]
  s_add_u32 s36, s36, 128
  s_add_u32 s37, s37, 0x80000
  s_add_u32 s43, s43, 49152
  s_cmp_eq_u32 s43, 147456
  s_cselect_b32 s43, 0, s43
  v_mfma_f32_32x32x16_bf16 a[96:111], v[20:23], v[40:43], a[96:111]
  v_mfma_f32_32x32x16_bf16 a[112:127], v[20:23], v[44:47], a[112:127]
  s_waitcnt lgkmcnt(0)
  v_mfma_f32_32x32x16_bf16 a[0:15], v[24:27], v[48:51], a[0:15]
  v_add_u32 v72, 49152, v72
  v_add_u32 v73, 49152, v73
  v_add_u32 v74, 49152, v74
  v_add_u32 v75, 49152, v75
  v_mfma_f32_32x32x16_bf16 a[16:31], v[24:27], v[52:55], a[16:31]
  v_add_u32 v76, 49152, v76
  v_add_u32 v77, 49152, v77
  v_add_u32 v78, 49152, v78
  v_add_u32 v79, 49152, v79
  v_mfma_f32_32x32x16_bf16 a[32:47], v[24:27], v[56:59], a[32:47]
  v_mfma_f32_32x32x16_bf16 a[48:63], v[24:27], v[60:63], a[48:63]
  s_waitcnt vmcnt(12)
  s_barrier
  v_mfma_f32_32x32x16_bf16 a[64:79], v[28:31], v[48:51], a[64:79]
  ds_read_b128 v[16:19], v72 offset:0
  ds_read_b64_tr_b16 v[32:33], v76 offset:0
  ds_read_b64_tr_b16 v[34:35], v76 offset:2048
  v_mfma_f32_32x32x16_bf16 a[80:95], v[28:31], v[52:55], a[80:95]
  ds_read_b128 v[20:23], v72 offset:4096
  ds_read_b64_tr_b16 v[36:37], v77 offset:0
  ds_read_b64_tr_b16 v[38:39], v77 offset:2048
  v_mfma_f32_32x32x16_bf16 a[96:111], v[28:31], v[56:59], a[96:111]
  ds_read_b64_tr_b16 v[40:41], v78 offset:0
  ds_read_b64_tr_b16 v[42:43], v78 offset:2048
  ds_read_b64_tr_b16 v[44:45], v79 offset:0
  v_mfma_f32_32x32x16_bf16 a[112:127], v[28:31], v[60:63], a[112:127]
  ds_read_b64_tr_b16 v[46:47], v79 offset:2048
  s_waitcnt lgkmcnt(0)
  v_mfma_f32_32x32x16_bf16 a[0:15], v[16:19], v[32:35], a[0:15]
  ds_read_b128 v[24:27], v73 offset:0
  ds_read_b64_tr_b16 v[48:49], v76 offset:8192
  s_cmp_eq_u32 s48, 0
  s_cbranch_scc1 L_nps_24
  buffer_store_dwordx4 v[136:139], v94, s[4:7], s45 offen offset:0 sc1
  buffer_store_dwordx4 v[140:143], v94, s[4:7], s45 offen offset:512 sc1
  s_add_u32 s45, s45, s46
L_nps_24:
  v_mfma_f32_32x32x16_bf16 a[16:31], v[16:19], v[36:39], a[16:31]
  ds_read_b64_tr_b16 v[50:51], v76 offset:10240
  ds_read_b128 v[28:31], v73 offset:4096
  v_mfma_f32_32x32x16_bf16 a[32:47], v[16:19], v[40:43], a[32:47]
  ds_read_b64_tr_b16 v[52:53], v77 offset:8192
  ds_read_b64_tr_b16 v[54:55], v77 offset:10240
  s_add_u32 m0, s39, s43
  v_mfma_f32_32x32x16_bf16 a[48:63], v[16:19], v[44:47], a[48:63]
  ds_read_b64_tr_b16 v[56:57], v78 offset:8192
  ds_read_b64_tr_b16 v[58:59], v78 offset:10240
  s_add_u32 s52, s36, 0
  buffer_load_dwordx4 v88, s[12:15], s52 offen offset:0 lds
  v_mfma_f32_32x32x16_bf16 a[64:79], v[20:23], v[32:35], a[64:79]
  ds_read_b64_tr_b16 v[60:61], v79 offset:8192
  ds_read_b64_tr_b16 v[62:63], v79 offset:10240
  s_add_u32 s52, s36, 9216
  buffer_load_dwordx4 v89, s[12:15], s52 offen offset:1024 lds
  v_mfma_f32_32x32x16_bf16 a[80:95], v[20:23], v[36:39], a[80:95]
  s_add_u32 s52, s36, 18432
  buffer_load_dwordx4 v88, s[12:15], s52 offen offset:2048 lds
  v_mfma_f32_32x32x16_bf16 a[96:111], v[20:23], v[40:43], a[96:111]
  s_add_u32 s52, s36, 27648
  buffer_load_dwordx4 v89, s[12:15], s52 offen offset:3072 lds
  v_mfma_f32_32x32x16_bf16 a[112:127], v[20:23], v[44:47], a[112:127]
  s_add_u32 m0, m0, s39
  s_add_u32 m0, m0, 16384
  s_waitcnt lgkmcnt(0)
  v_mfma_f32_32x32x16_bf16 a[0:15], v[24:27], v[48:51], a[0:15]
  ds_read_b128 v[16:19], v74 offset:0
  ds_read_b64_tr_b16 v[32:33], v76 offset:16384
  v_mfma_f32_32x32x16_bf16 a[16:31], v[24:27], v[52:55], a[16:31]
  ds_read_b64_tr_b16 v[34:35], v76 offset:18432
  ds_read_b128 v[20:23], v74 offset:4096
  v_mfma_f32_32x32x16_bf16 a[32:47], v[24:27], v[56:59], a[32:47]
  ds_read_b64_tr_b16 v[36:37], v77 offset:16384
  ds_read_b64_tr_b16 v[38:39], v77 offset:18432
  s_add_u32 s52, s37, 0
  buffer_load_dwordx4 v90, s[16:19], s52 offen offset:0 lds
  v_mfma_f32_32x32x16_bf16 a[48:63], v[24:27], v[60:63], a[48:63]
  ds_read_b64_tr_b16 v[40:41], v78 offset:16384
  ds_read_b64_tr_b16 v[42:43], v78 offset:18432
  s_add_u32 s52, s37, 15360
  buffer_load_dwordx4 v91, s[16:19], s52 offen offset:1024 lds
  v_mfma_f32_32x32x16_bf16 a[64:79], v[28:31], v[48:51], a[64:79]
  ds_read_b64_tr_b16 v[44:45], v79 offset:16384
  ds_read_b64_tr_b16 v[46:47], v79 offset:18432
  s_add_u32 s52, s37, 30720
  buffer_load_dwordx4 v90, s[16:19], s52 offen offset:2048 lds
  v_mfma_f32_32x32x16_bf16 a[80:95], v[28:31], v[52:55], a[80:95]
  s_add_u32 s52, s37, 46080
  buffer_load_dwordx4 v91, s[16:19], s52 offen offset:3072 lds
  v_mfma_f32_32x32x16_bf16 a[96:111], v[28:31], v[56:59], a[96:111]
  s_add_u32 m0, m0, 4096
  v_mfma_f32_32x32x16_bf16 a[112:127], v[28:31], v[60:63], a[112:127]
  s_add_u32 s52, s37, 65536
  buffer_load_dwordx4 v90, s[16:19], s52 offen offset:0 lds
  s_waitcnt lgkmcnt(0)
  v_mfma_f32_32x32x16_bf16 a[0:15], v[16:19], v[32:35], a[0:15]
  ds_read_b128 v[24:27], v75 offset:0
  ds_read_b64_tr_b16 v[48:49], v76 offset:24576
  v_mfma_f32_32x32x16_bf16 a[16:31], v[16:19], v[36:39], a[16:31]
  ds_read_b64_tr_b16 v[50:51], v76 offset:26624
  ds_read_b128 v[28:31], v75 offset:4096
  v_mfma_f32_32x32x16_bf16 a[32:47], v[16:19], v[40:43], a[32:47]
  ds_read_b64_tr_b16 v[52:53], v77 offset:24576
  ds_read_b64_tr_b16 v[54:55], v77 offset:26624
  s_add_u32 s52, s37, 80896
  buffer_load_dwordx4 v91, s[16:19], s52 offen offset:1024 lds
  v_mfma_f32_32x32x16_bf16 a[48:63], v[16:19], v[44:47], a[48:63]
  ds_read_b64_tr_b16 v[56:57], v78 offset:24576
  ds_read_b64_tr_b16 v[58:59], v78 offset:26624
  s_add_u32 s52, s37, 96256
  buffer_load_dwordx4 v90, s[16:19], s52 offen offset:2048 lds
  v_mfma_f32_32x32x16_bf16 a[64:79], v[20:23], v[32:35], a[64:79]
  ds_read_b64_tr_b16 v[60:61], v79 offset:24576
  ds_read_b64_tr_b16 v[62:63], v79 offset:26624
  s_add_u32 s52, s37, 111616
  buffer_load_dwordx4 v91, s[16:19], s52 offen offset:3072 lds
  v_mfma_f32_32x32x16_bf16 a[80:95], v[20:23], v[36:39], a[80:95]
  s_add_u32 s36, s36, 128
  s_add_u32 s37, s37, 0x80000
  s_add_u32 s43, s43, 49152
  s_cmp_eq_u32 s43, 147456
  s_cselect_b32 s43, 0, s43
  v_mfma_f32_32x32x16_bf16 a[96:111], v[20:23], v[40:43], a[96:111]
  v_mfma_f32_32x32x16_bf16 a[112:127], v[20:23], v[44:47], a[112:127]
  s_waitcnt lgkmcnt(0)
  v_mfma_f32_32x32x16_bf16 a[0:15], v[24:27], v[48:51], a[0:15]
  v_add_u32 v72, 49152, v72
  v_add_u32 v73, 49152, v73
  v_add_u32 v74, 49152, v74
  v_add_u32 v75, 49152, v75
  v_mfma_f32_32x32x16_bf16 a[16:31], v[24:27], v[52:55], a[16:31]
  v_add_u32 v76, 49152, v76
  v_add_u32 v77, 49152, v77
  v_add_u32 v78, 49152, v78
  v_add_u32 v79, 49152, v79
  v_mfma_f32_32x32x16_bf16 a[32:47], v[24:27], v[56:59], a[32:47]
  v_mfma_f32_32x32x16_bf16 a[48:63], v[24:27], v[60:63], a[48:63]
  s_waitcnt vmcnt(12)
  s_barrier
  v_mfma_f32_32x32x16_bf16 a[64:79], v[28:31], v[48:51], a[64:79]
  ds_read_b128 v[16:19], v72 offset:0
  ds_read_b64_tr_b16 v[32:33], v76 offset:0
  ds_read_b64_tr_b16 v[34:35], v76 offset:2048
  v_mfma_f32_32x32x16_bf16 a[80:95], v[28:31], v[52:55], a[80:95]
  ds_read_b128 v[20:23], v72 offset:4096
  ds_read_b64_tr_b16 v[36:37], v77 offset:0
  ds_read_b64_tr_b16 v[38:39], v77 offset:2048
  v_mfma_f32_32x32x16_bf16 a[96:111], v[28:31], v[56:59], a[96:111]
  ds_read_b64_tr_b16 v[40:41], v78 offset:0
  ds_read_b64_tr_b16 v[42:43], v78 offset:2048
  ds_read_b64_tr_b16 v[44:45], v79 offset:0
  v_mfma_f32_32x32x16_bf16 a[112:127], v[28:31], v[60:63], a[112:127]
  ds_read_b64_tr_b16 v[46:47], v79 offset:2048
  s_waitcnt lgkmcnt(0)
  v_mfma_f32_32x32x16_bf16 a[0:15], v[16:19], v[32:35], a[0:15]
  ds_read_b128 v[24:27], v73 offset:0
  ds_read_b64_tr_b16 v[48:49], v76 offset:8192
  s_cmp_eq_u32 s48, 0
  s_cbranch_scc1 L_nps_25
  buffer_store_dwordx4 v[144:147], v94, s[4:7], s45 offen offset:0 sc1
  buffer_store_dwordx4 v[148:151], v94, s[4:7], s45 offen offset:512 sc1
  s_add_u32 s45, s45, s46
L_nps_25:
  v_mfma_f32_32x32x16_bf16 a[16:31], v[16:19], v[36:39], a[16:31]
  ds_read_b64_tr_b16 v[50:51], v76 offset:10240
  ds_read_b128 v[28:31], v73 offset:4096
  v_mfma_f32_32x32x16_bf16 a[32:47], v[16:19], v[40:43], a[32:47]
  ds_read_b64_tr_b16 v[52:53], v77 offset:8192
  ds_read_b64_tr_b16 v[54:55], v77 offset:10240
  s_add_u32 m0, s39, s43
  v_mfma_f32_32x32x16_bf16 a[48:63], v[16:19], v[44:47], a[48:63]
  ds_read_b64_tr_b16 v[56:57], v78 offset:8192
  ds_read_b64_tr_b16 v[58:59], v78 offset:10240
  s_add_u32 s52, s36, 0
  buffer_load_dwordx4 v88, s[12:15], s52 offen offset:0 lds
  v_mfma_f32_32x32x16_bf16 a[64:79], v[20:23], v[32:35], a[64:79]
  ds_read_b64_tr_b16 v[60:61], v79 offset:8192
  ds_read_b64_tr_b16 v[62:63], v79 offset:10240
  s_add_u32 s52, s36, 9216
  buffer_load_dwordx4 v89, s[12:15], s52 offen offset:1024 lds
  v_mfma_f32_32x32x16_bf16 a[80:95], v[20:23], v[36:39], a[80:95]
  s_add_u32 s52, s36, 18432
  buffer_load_dwordx4 v88, s[12:15], s52 offen offset:2048 lds
  v_mfma_f32_32x32x16_bf16 a[96:111], v[20:23], v[40:43], a[96:111]
  s_add_u32 s52, s36, 27648
  buffer_load_dwordx4 v89, s[12:15], s52 offen offset:3072 lds
  v_mfma_f32_32x32x16_bf16 a[112:127], v[20:23], v[44:47], a[112:127]
  s_add_u32 m0, m0, s39
  s_add_u32 m0, m0, 16384
  s_waitcnt lgkmcnt(0)
  v_mfma_f32_32x32x16_bf16 a[0:15], v[24:27], v[48:51], a[0:15]
  ds_read_b128 v[16:19], v74 offset:0
  ds_read_b64_tr_b16 v[32:33], v76 offset:16384
  v_mfma_f32_32x32x16_bf16 a[16:31], v[24:27], v[52:55], a[16:31]
  ds_read_b64_tr_b16 v[34:35], v76 offset:18432
  ds_read_b128 v[20:23], v74 offset:4096
  v_mfma_f32_32x32x16_bf16 a[32:47], v[24:27], v[56:59], a[32:47]
  ds_read_b64_tr_b16 v[36:37], v77 offset:16384
  ds_read_b64_tr_b16 v[38:39], v77 offset:18432
  s_add_u32 s52, s37, 0
  buffer_load_dwordx4 v90, s[16:19], s52 offen offset:0 lds
  v_mfma_f32_32x32x16_bf16 a[48:63], v[24:27], v[60:63], a[48:63]
  ds_read_b64_tr_b16 v[40:41], v78 offset:16384
  ds_read_b64_tr_b16 v[42:43], v78 offset:18432
  s_add_u32 s52, s37, 15360
  buffer_load_dwordx4 v91, s[16:19], s52 offen offset:1024 lds
  v_mfma_f32_32x32x16_bf16 a[64:79], v[28:31], v[48:51], a[64:79]
  ds_read_b64_tr_b16 v[44:45], v79 offset:16384
  ds_read_b64_tr_b16 v[46:47], v79 offset:18432
  s_add_u32 s52, s37, 30720
  buffer_load_dwordx4 v90, s[16:19], s52 offen offset:2048 lds
  v_mfma_f32_32x32x16_bf16 a[80:95], v[28:31], v[52:55], a[80:95]
  s_add_u32 s52, s37, 46080
  buffer_load_dwordx4 v91, s[16:19], s52 offen offset:3072 lds
  v_mfma_f32_32x32x16_bf16 a[96:111], v[28:31], v[56:59], a[96:111]
  s_add_u32 m0, m0, 4096
  v_mfma_f32_32x32x16_bf16 a[112:127], v[28:31], v[60:63], a[112:127]
  s_add_u32 s52, s37, 65536
  buffer_load_dwordx4 v90, s[16:19], s52 offen offset:0 lds
  s_waitcnt lgkmcnt(0)
  v_mfma_f32_32x32x16_bf16 a[0:15], v[16:19], v[32:35], a[0:15]
  ds_read_b128 v[24:27], v75 offset:0
  ds_read_b64_tr_b16 v[48:49], v76 offset:24576
  v_mfma_f32_32x32x16_bf16 a[16:31], v[16:19], v[36:39], a[16:31]
  ds_read_b64_tr_b16 v[50:51], v76 offset:26624
  ds_read_b128 v[28:31], v75 offset:4096
  v_mfma_f32_32x32x16_bf16 a[32:47], v[16:19], v[40:43], a[32:47]
  ds_read_b64_tr_b16 v[52:53], v77 offset:24576
  ds_read_b64_tr_b16 v[54:55], v77 offset:26624
  s_add_u32 s52, s37, 80896
  buffer_load_dwordx4 v91, s[16:19], s52 offen offset:1024 lds
  v_mfma_f32_32x32x16_bf16 a[48:63], v[16:19], v[44:47], a[48:63]
  ds_read_b64_tr_b16 v[56:57], v78 offset:24576
  ds_read_b64_tr_b16 v[58:59], v78 offset:26624
  s_add_u32 s52, s37, 96256
  buffer_load_dwordx4 v90, s[16:19], s52 offen offset:2048 lds
  v_mfma_f32_32x32x16_bf16 a[64:79], v[20:23], v[32:35], a[64:79]
  ds_read_b64_tr_b16 v[60:61], v79 offset:24576
  ds_read_b64_tr_b16 v[62:63], v79 offset:26624
  s_add_u32 s52, s37, 111616
  buffer_load_dwordx4 v91, s[16:19], s52 offen offset:3072 lds
  v_mfma_f32_32x32x16_bf16 a[80:95], v[20:23], v[36:39], a[80:95]
  s_add_u32 s36, s36, 128
  s_add_u32 s37, s37, 0x80000
  s_add_u32 s43, s43, 49152
  s_cmp_eq_u32 s43, 147456
  s_cselect_b32 s43, 0, s43
  v_mfma_f32_32x32x16_bf16 a[96:111], v[20:23], v[40:43], a[96:111]
  v_mfma_f32_32x32x16_bf16 a[112:127], v[20:23], v[44:47], a[112:127]
  s_waitcnt lgkmcnt(0)
  v_mfma_f32_32x32x16_bf16 a[0:15], v[24:27], v[48:51], a[0:15]
  v_subrev_u32 v72, 98304, v72
  v_subrev_u32 v73, 98304, v73
  v_subrev_u32 v74, 98304, v74
  v_subrev_u32 v75, 98304, v75
  v_mfma_f32_32x32x16_bf16 a[16:31], v[24:27], v[52:55], a[16:31]
  v_subrev_u32 v76, 98304, v76
  v_subrev_u32 v77, 98304, v77
  v_subrev_u32 v78, 98304, v78
  v_subrev_u32 v79, 98304, v79
  v_mfma_f32_32x32x16_bf16 a[32:47], v[24:27], v[56:59], a[32:47]
  v_mfma_f32_32x32x16_bf16 a[48:63], v[24:27], v[60:63], a[48:63]
  s_waitcnt vmcnt(12)
  s_barrier
  v_mfma_f32_32x32x16_bf16 a[64:79], v[28:31], v[48:51], a[64:79]
  ds_read_b128 v[16:19], v72 offset:0
  ds_read_b64_tr_b16 v[32:33], v76 offset:0
  ds_read_b64_tr_b16 v[34:35], v76 offset:2048
  v_mfma_f32_32x32x16_bf16 a[80:95], v[28:31], v[52:55], a[80:95]
  ds_read_b128 v[20:23], v72 offset:4096
  ds_read_b64_tr_b16 v[36:37], v77 offset:0
  ds_read_b64_tr_b16 v[38:39], v77 offset:2048
  v_mfma_f32_32x32x16_bf16 a[96:111], v[28:31], v[56:59], a[96:111]
  ds_read_b64_tr_b16 v[40:41], v78 offset:0
  ds_read_b64_tr_b16 v[42:43], v78 offset:2048
  ds_read_b64_tr_b16 v[44:45], v79 offset:0
  v_mfma_f32_32x32x16_bf16 a[112:127], v[28:31], v[60:63], a[112:127]
  ds_read_b64_tr_b16 v[46:47], v79 offset:2048
  s_waitcnt lgkmcnt(0)
  v_mfma_f32_32x32x16_bf16 a[0:15], v[16:19], v[32:35], a[0:15]
  ds_read_b128 v[24:27], v73 offset:0
  ds_read_b64_tr_b16 v[48:49], v76 offset:8192
  s_cmp_eq_u32 s48, 0
  s_cbranch_scc1 L_nps_26
  buffer_store_dwordx4 v[152:155], v94, s[4:7], s45 offen offset:0 sc1
  buffer_store_dwordx4 v[156:159], v94, s[4:7], s45 offen offset:512 sc1
  s_add_u32 s45, s45, s47
L_nps_26:
  v_mfma_f32_32x32x16_bf16 a[16:31], v[16:19], v[36:39], a[16:31]
  ds_read_b64_tr_b16 v[50:51], v76 offset:10240
  ds_read_b128 v[28:31], v73 offset:4096
  v_mfma_f32_32x32x16_bf16 a[32:47], v[16:19], v[40:43], a[32:47]
  ds_read_b64_tr_b16 v[52:53], v77 offset:8192
  ds_read_b64_tr_b16 v[54:55], v77 offset:10240
  s_add_u32 m0, s39, s43
  v_mfma_f32_32x32x16_bf16 a[48:63], v[16:19], v[44:47], a[48:63]
  ds_read_b64_tr_b16 v[56:57], v78 offset:8192
  ds_read_b64_tr_b16 v[58:59], v78 offset:10240
  s_add_u32 s52, s36, 0
  buffer_load_dwordx4 v88, s[12:15], s52 offen offset:0 lds
  v_mfma_f32_32x32x16_bf16 a[64:79], v[20:23], v[32:35], a[64:79]
  ds_read_b64_tr_b16 v[60:61], v79 offset:8192
  ds_read_b64_tr_b16 v[62:63], v79 offset:10240
  s_add_u32 s52, s36, 9216
  buffer_load_dwordx4 v89, s[12:15], s52 offen offset:1024 lds
  v_mfma_f32_32x32x16_bf16 a[80:95], v[20:23], v[36:39], a[80:95]
  s_add_u32 s52, s36, 18432
  buffer_load_dwordx4 v88, s[12:15], s52 offen offset:2048 lds
  v_mfma_f32_32x32x16_bf16 a[96:111], v[20:23], v[40:43], a[96:111]
  s_add_u32 s52, s36, 27648
  buffer_load_dwordx4 v89, s[12:15], s52 offen offset:3072 lds
  v_mfma_f32_32x32x16_bf16 a[112:127], v[20:23], v[44:47], a[112:127]
  s_add_u32 m0, m0, s39
  s_add_u32 m0, m0, 16384
  s_waitcnt lgkmcnt(0)
  v_mfma_f32_32x32x16_bf16 a[0:15], v[24:27], v[48:51], a[0:15]
  ds_read_b128 v[16:19], v74 offset:0
  ds_read_b64_tr_b16 v[32:33], v76 offset:16384
  v_mfma_f32_32x32x16_bf16 a[16:31], v[24:27], v[52:55], a[16:31]
  ds_read_b64_tr_b16 v[34:35], v76 offset:18432
  ds_read_b128 v[20:23], v74 offset:4096
  v_mfma_f32_32x32x16_bf16 a[32:47], v[24:27], v[56:59], a[32:47]
  ds_read_b64_tr_b16 v[36:37], v77 offset:16384
  ds_read_b64_tr_b16 v[38:39], v77 offset:18432
  s_add_u32 s52, s37, 0
  buffer_load_dwordx4 v90, s[16:19], s52 offen offset:0 lds
  v_mfma_f32_32x32x16_bf16 a[48:63], v[24:27], v[60:63], a[48:63]
  ds_read_b64_tr_b16 v[40:41], v78 offset:16384
  ds_read_b64_tr_b16 v[42:43], v78 offset:18432
  s_add_u32 s52, s37, 15360
  buffer_load_dwordx4 v91, s[16:19], s52 offen offset:1024 lds
  v_mfma_f32_32x32x16_bf16 a[64:79], v[28:31], v[48:51], a[64:79]
  ds_read_b64_tr_b16 v[44:45], v79 offset:16384
  ds_read_b64_tr_b16 v[46:47], v79 offset:18432
  s_add_u32 s52, s37, 30720
  buffer_load_dwordx4 v90, s[16:19], s52 offen offset:2048 lds
  v_mfma_f32_32x32x16_bf16 a[80:95], v[28:31], v[52:55], a[80:95]
  s_add_u32 s52, s37, 46080
  buffer_load_dwordx4 v91, s[16:19], s52 offen offset:3072 lds
  v_mfma_f32_32x32x16_bf16 a[96:111], v[28:31], v[56:59], a[96:111]
  s_add_u32 m0, m0, 4096
  v_mfma_f32_32x32x16_bf16 a[112:127], v[28:31], v[60:63], a[112:127]
  s_add_u32 s52, s37, 65536
  buffer_load_dwordx4 v90, s[16:19], s52 offen offset:0 lds
  s_waitcnt lgkmcnt(0)
  v_mfma_f32_32x32x16_bf16 a[0:15], v[16:19], v[32:35], a[0:15]
  ds_read_b128 v[24:27], v75 offset:0
  ds_read_b64_tr_b16 v[48:49], v76 offset:24576
  v_mfma_f32_32x32x16_bf16 a[16:31], v[16:19], v[36:39], a[16:31]
  ds_read_b64_tr_b16 v[50:51], v76 offset:26624
  ds_read_b128 v[28:31], v75 offset:4096
  v_mfma_f32_32x32x16_bf16 a[32:47], v[16:19], v[40:43], a[32:47]
  ds_read_b64_tr_b16 v[52:53], v77 offset:24576
  ds_read_b64_tr_b16 v[54:55], v77 offset:26624
  s_add_u32 s52, s37, 80896
  buffer_load_dwordx4 v91, s[16:19], s52 offen offset:1024 lds
  v_mfma_f32_32x32x16_bf16 a[48:63], v[16:19], v[44:47], a[48:63]
  ds_read_b64_tr_b16 v[56:57], v78 offset:24576
  ds_read_b64_tr_b16 v[58:59], v78 offset:26624
  s_add_u32 s52, s37, 96256
  buffer_load_dwordx4 v90, s[16:19], s52 offen offset:2048 lds
  v_mfma_f32_32x32x16_bf16 a[64:79], v[20:23], v[32:35], a[64:79]
  ds_read_b64_tr_b16 v[60:61], v79 offset:24576
  ds_read_b64_tr_b16 v[62:63], v79 offset:26624
  s_add_u32 s52, s37, 111616
  buffer_load_dwordx4 v91, s[16:19], s52 offen offset:3072 lds
  v_mfma_f32_32x32x16_bf16 a[80:95], v[20:23], v[36:39], a[80:95]
  s_add_u32 s36, s36, 128
  s_add_u32 s37, s37, 0x80000
  s_add_u32 s43, s43, 49152
  s_cmp_eq_u32 s43, 147456
  s_cselect_b32 s43, 0, s43
  v_mfma_f32_32x32x16_bf16 a[96:111], v[20:23], v[40:43], a[96:111]
  v_mfma_f32_32x32x16_bf16 a[112:127], v[20:23], v[44:47], a[112:127]
  s_waitcnt lgkmcnt(0)
  v_mfma_f32_32x32x16_bf16 a[0:15], v[24:27], v[48:51], a[0:15]
  v_add_u32 v72, 49152, v72
  v_add_u32 v73, 49152, v73
  v_add_u32 v74, 49152, v74
  v_add_u32 v75, 49152, v75
  v_mfma_f32_32x32x16_bf16 a[16:31], v[24:27], v[52:55], a[16:31]
  v_add_u32 v76, 49152, v76
  v_add_u32 v77, 49152, v77
  v_add_u32 v78, 49152, v78
  v_add_u32 v79, 49152, v79
  v_mfma_f32_32x32x16_bf16 a[32:47], v[24:27], v[56:59], a[32:47]
  v_mfma_f32_32x32x16_bf16 a[48:63], v[24:27], v[60:63], a[48:63]
  s_waitcnt vmcnt(12)
  s_barrier
  v_mfma_f32_32x32x16_bf16 a[64:79], v[28:31], v[48:51], a[64:79]
  ds_read_b128 v[16:19], v72 offset:0
  ds_read_b64_tr_b16 v[32:33], v76 offset:0
  ds_read_b64_tr_b16 v[34:35], v76 offset:2048
  v_mfma_f32_32x32x16_bf16 a[80:95], v[28:31], v[52:55], a[80:95]
  ds_read_b128 v[20:23], v72 offset:4096
  ds_read_b64_tr_b16 v[36:37], v77 offset:0
  ds_read_b64_tr_b16 v[38:39], v77 offset:2048
  v_mfma_f32_32x32x16_bf16 a[96:111], v[28:31], v[56:59], a[96:111]
  ds_read_b64_tr_b16 v[40:41], v78 offset:0
  ds_read_b64_tr_b16 v[42:43], v78 offset:2048
  ds_read_b64_tr_b16 v[44:45], v79 offset:0
  v_mfma_f32_32x32x16_bf16 a[112:127], v[28:31], v[60:63], a[112:127]
  ds_read_b64_tr_b16 v[46:47], v79 offset:2048
  s_waitcnt lgkmcnt(0)
  v_mfma_f32_32x32x16_bf16 a[0:15], v[16:19], v[32:35], a[0:15]
  ds_read_b128 v[24:27], v73 offset:0
  ds_read_b64_tr_b16 v[48:49], v76 offset:8192
  s_cmp_eq_u32 s48, 0
  s_cbranch_scc1 L_nps_27
  buffer_store_dwordx4 v[160:163], v94, s[4:7], s45 offen offset:0 sc1
  buffer_store_dwordx4 v[164:167], v94, s[4:7], s45 offen offset:512 sc1
  s_add_u32 s45, s45, s46
L_nps_27:
  v_mfma_f32_32x32x16_bf16 a[16:31], v[16:19], v[36:39], a[16:31]
  ds_read_b64_tr_b16 v[50:51], v76 offset:10240
  ds_read_b128 v[28:31], v73 offset:4096
  v_mfma_f32_32x32x16_bf16 a[32:47], v[16:19], v[40:43], a[32:47]
  ds_read_b64_tr_b16 v[52:53], v77 offset:8192
  ds_read_b64_tr_b16 v[54:55], v77 offset:10240
  s_add_u32 m0, s39, s43
  v_mfma_f32_32x32x16_bf16 a[48:63], v[16:19], v[44:47], a[48:63]
  ds_read_b64_tr_b16 v[56:57], v78 offset:8192
  ds_read_b64_tr_b16 v[58:59], v78 offset:10240
  s_add_u32 s52, s36, 0
  buffer_load_dwordx4 v88, s[12:15], s52 offen offset:0 lds
  v_mfma_f32_32x32x16_bf16 a[64:79], v[20:23], v[32:35], a[64:79]
  ds_read_b64_tr_b16 v[60:61], v79 offset:8192
  ds_read_b64_tr_b16 v[62:63], v79 offset:10240
  s_add_u32 s52, s36, 9216
  buffer_load_dwordx4 v89, s[12:15], s52 offen offset:1024 lds
  v_mfma_f32_32x32x16_bf16 a[80:95], v[20:23], v[36:39], a[80:95]
  s_add_u32 s52, s36, 18432
  buffer_load_dwordx4 v88, s[12:15], s52 offen offset:2048 lds
  v_mfma_f32_32x32x16_bf16 a[96:111], v[20:23], v[40:43], a[96:111]
  s_add_u32 s52, s36, 27648
  buffer_load_dwordx4 v89, s[12:15], s52 offen offset:3072 lds
  v_mfma_f32_32x32x16_bf16 a[112:127], v[20:23], v[44:47], a[112:127]
  s_add_u32 m0, m0, s39
  s_add_u32 m0, m0, 16384
  s_waitcnt lgkmcnt(0)
  v_mfma_f32_32x32x16_bf16 a[0:15], v[24:27], v[48:51], a[0:15]
  ds_read_b128 v[16:19], v74 offset:0
  ds_read_b64_tr_b16 v[32:33], v76 offset:16384
  v_mfma_f32_32x32x16_bf16 a[16:31], v[24:27], v[52:55], a[16:31]
  ds_read_b64_tr_b16 v[34:35], v76 offset:18432
  ds_read_b128 v[20:23], v74 offset:4096
  v_mfma_f32_32x32x16_bf16 a[32:47], v[24:27], v[56:59], a[32:47]
  ds_read_b64_tr_b16 v[36:37], v77 offset:16384
  ds_read_b64_tr_b16 v[38:39], v77 offset:18432
  s_add_u32 s52, s37, 0
  buffer_load_dwordx4 v90, s[16:19], s52 offen offset:0 lds
  v_mfma_f32_32x32x16_bf16 a[48:63], v[24:27], v[60:63], a[48:63]
  ds_read_b64_tr_b16 v[40:41], v78 offset:16384
  ds_read_b64_tr_b16 v[42:43], v78 offset:18432
  s_add_u32 s52, s37, 15360
  buffer_load_dwordx4 v91, s[16:19], s52 offen offset:1024 lds
  v_mfma_f32_32x32x16_bf16 a[64:79], v[28:31], v[48:51], a[64:79]
  ds_read_b64_tr_b16 v[44:45], v79 offset:16384
  ds_read_b64_tr_b16 v[46:47], v79 offset:18432
  s_add_u32 s52, s37, 30720
  buffer_load_dwordx4 v90, s[16:19], s52 offen offset:2048 lds
  v_mfma_f32_32x32x16_bf16 a[80:95], v[28:31], v[52:55], a[80:95]
  s_add_u32 s52, s37, 46080
  buffer_load_dwordx4 v91, s[16:19], s52 offen offset:3072 lds
  v_mfma_f32_32x32x16_bf16 a[96:111], v[28:31], v[56:59], a[96:111]
  s_add_u32 m0, m0, 4096
  v_mfma_f32_32x32x16_bf16 a[112:127], v[28:31], v[60:63], a[112:127]
  s_add_u32 s52, s37, 65536
  buffer_load_dwordx4 v90, s[16:19], s52 offen offset:0 lds
  s_waitcnt lgkmcnt(0)
  v_mfma_f32_32x32x16_bf16 a[0:15], v[16:19], v[32:35], a[0:15]
  ds_read_b128 v[24:27], v75 offset:0
  ds_read_b64_tr_b16 v[48:49], v76 offset:24576
  v_mfma_f32_32x32x16_bf16 a[16:31], v[16:19], v[36:39], a[16:31]
  ds_read_b64_tr_b16 v[50:51], v76 offset:26624
  ds_read_b128 v[28:31], v75 offset:4096
  v_mfma_f32_32x32x16_bf16 a[32:47], v[16:19], v[40:43], a[32:47]
  ds_read_b64_tr_b16 v[52:53], v77 offset:24576
  ds_read_b64_tr_b16 v[54:55], v77 offset:26624
  s_add_u32 s52, s37, 80896
  buffer_load_dwordx4 v91, s[16:19], s52 offen offset:1024 lds
  v_mfma_f32_32x32x16_bf16 a[48:63], v[16:19], v[44:47], a[48:63]
  ds_read_b64_tr_b16 v[56:57], v78 offset:24576
  ds_read_b64_tr_b16 v[58:59], v78 offset:26624
  s_add_u32 s52, s37, 96256
  buffer_load_dwordx4 v90, s[16:19], s52 offen offset:2048 lds
  v_mfma_f32_32x32x16_bf16 a[64:79], v[20:23], v[32:35], a[64:79]
  ds_read_b64_tr_b16 v[60:61], v79 offset:24576
  ds_read_b64_tr_b16 v[62:63], v79 offset:26624
  s_add_u32 s52, s37, 111616
  buffer_load_dwordx4 v91, s[16:19], s52 offen offset:3072 lds
  v_mfma_f32_32x32x16_bf16 a[80:95], v[20:23], v[36:39], a[80:95]
  s_add_u32 s36, s36, 128
  s_add_u32 s37, s37, 0x80000
  s_add_u32 s43, s43, 49152
  s_cmp_eq_u32 s43, 147456
  s_cselect_b32 s43, 0, s43
  v_mfma_f32_32x32x16_bf16 a[96:111], v[20:23], v[40:43], a[96:111]
  v_mfma_f32_32x32x16_bf16 a[112:127], v[20:23], v[44:47], a[112:127]
  s_waitcnt lgkmcnt(0)
  v_mfma_f32_32x32x16_bf16 a[0:15], v[24:27], v[48:51], a[0:15]
  v_add_u32 v72, 49152, v72
  v_add_u32 v73, 49152, v73
  v_add_u32 v74, 49152, v74
  v_add_u32 v75, 49152, v75
  v_mfma_f32_32x32x16_bf16 a[16:31], v[24:27], v[52:55], a[16:31]
  v_add_u32 v76, 49152, v76
  v_add_u32 v77, 49152, v77
  v_add_u32 v78, 49152, v78
  v_add_u32 v79, 49152, v79
  v_mfma_f32_32x32x16_bf16 a[32:47], v[24:27], v[56:59], a[32:47]
  v_mfma_f32_32x32x16_bf16 a[48:63], v[24:27], v[60:63], a[48:63]
  s_waitcnt vmcnt(12)
  s_barrier
  v_mfma_f32_32x32x16_bf16 a[64:79], v[28:31], v[48:51], a[64:79]
  ds_read_b128 v[16:19], v72 offset:0
  ds_read_b64_tr_b16 v[32:33], v76 offset:0
  ds_read_b64_tr_b16 v[34:35], v76 offset:2048
  v_mfma_f32_32x32x16_bf16 a[80:95], v[28:31], v[52:55], a[80:95]
  ds_read_b128 v[20:23], v72 offset:4096
  ds_read_b64_tr_b16 v[36:37], v77 offset:0
  ds_read_b64_tr_b16 v[38:39], v77 offset:2048
  v_mfma_f32_32x32x16_bf16 a[96:111], v[28:31], v[56:59], a[96:111]
  ds_read_b64_tr_b16 v[40:41], v78 offset:0
  ds_read_b64_tr_b16 v[42:43], v78 offset:2048
  ds_read_b64_tr_b16 v[44:45], v79 offset:0
  v_mfma_f32_32x32x16_bf16 a[112:127], v[28:31], v[60:63], a[112:127]
  ds_read_b64_tr_b16 v[46:47], v79 offset:2048
  s_waitcnt lgkmcnt(0)
  v_mfma_f32_32x32x16_bf16 a[0:15], v[16:19], v[32:35], a[0:15]
  ds_read_b128 v[24:27], v73 offset:0
  ds_read_b64_tr_b16 v[48:49], v76 offset:8192
  s_cmp_eq_u32 s48, 0
  s_cbranch_scc1 L_nps_28
  buffer_store_dwordx4 v[168:171], v94, s[4:7], s45 offen offset:0 sc1
  buffer_store_dwordx4 v[172:175], v94, s[4:7], s45 offen offset:512 sc1
  s_add_u32 s45, s45, s46
L_nps_28:
  v_mfma_f32_32x32x16_bf16 a[16:31], v[16:19], v[36:39], a[16:31]
  ds_read_b64_tr_b16 v[50:51], v76 offset:10240
  ds_read_b128 v[28:31], v73 offset:4096
  v_mfma_f32_32x32x16_bf16 a[32:47], v[16:19], v[40:43], a[32:47]
  ds_read_b64_tr_b16 v[52:53], v77 offset:8192
  ds_read_b64_tr_b16 v[54:55], v77 offset:10240
  s_add_u32 m0, s39, s43
  v_mfma_f32_32x32x16_bf16 a[48:63], v[16:19], v[44:47], a[48:63]
  ds_read_b64_tr_b16 v[56:57], v78 offset:8192
  ds_read_b64_tr_b16 v[58:59], v78 offset:10240
  s_add_u32 s52, s36, 0
  buffer_load_dwordx4 v88, s[12:15], s52 offen offset:0 lds
  v_mfma_f32_32x32x16_bf16 a[64:79], v[20:23], v[32:35], a[64:79]
  ds_read_b64_tr_b16 v[60:61], v79 offset:8192
  ds_read_b64_tr_b16 v[62:63], v79 offset:10240
  s_add_u32 s52, s36, 9216
  buffer_load_dwordx4 v89, s[12:15], s52 offen offset:1024 lds
  v_mfma_f32_32x32x16_bf16 a[80:95], v[20:23], v[36:39], a[80:95]
  s_add_u32 s52, s36, 18432
  buffer_load_dwordx4 v88, s[12:15], s52 offen offset:2048 lds
  v_mfma_f32_32x32x16_bf16 a[96:111], v[20:23], v[40:43], a[96:111]
  s_add_u32 s52, s36, 27648
  buffer_load_dwordx4 v89, s[12:15], s52 offen offset:3072 lds
  v_mfma_f32_32x32x16_bf16 a[112:127], v[20:23], v[44:47], a[112:127]
  s_add_u32 m0, m0, s39
  s_add_u32 m0, m0, 16384
  s_waitcnt lgkmcnt(0)
  v_mfma_f32_32x32x16_bf16 a[0:15], v[24:27], v[48:51], a[0:15]
  ds_read_b128 v[16:19], v74 offset:0
  ds_read_b64_tr_b16 v[32:33], v76 offset:16384
  v_mfma_f32_32x32x16_bf16 a[16:31], v[24:27], v[52:55], a[16:31]
  ds_read_b64_tr_b16 v[34:35], v76 offset:18432
  ds_read_b128 v[20:23], v74 offset:4096
  v_mfma_f32_32x32x16_bf16 a[32:47], v[24:27], v[56:59], a[32:47]
  ds_read_b64_tr_b16 v[36:37], v77 offset:16384
  ds_read_b64_tr_b16 v[38:39], v77 offset:18432
  s_add_u32 s52, s37, 0
  buffer_load_dwordx4 v90, s[16:19], s52 offen offset:0 lds
  v_mfma_f32_32x32x16_bf16 a[48:63], v[24:27], v[60:63], a[48:63]
  ds_read_b64_tr_b16 v[40:41], v78 offset:16384
  ds_read_b64_tr_b16 v[42:43], v78 offset:18432
  s_add_u32 s52, s37, 15360
  buffer_load_dwordx4 v91, s[16:19], s52 offen offset:1024 lds
  v_mfma_f32_32x32x16_bf16 a[64:79], v[28:31], v[48:51], a[64:79]
  ds_read_b64_tr_b16 v[44:45], v79 offset:16384
  ds_read_b64_tr_b16 v[46:47], v79 offset:18432
  s_add_u32 s52, s37, 30720
  buffer_load_dwordx4 v90, s[16:19], s52 offen offset:2048 lds
  v_mfma_f32_32x32x16_bf16 a[80:95], v[28:31], v[52:55], a[80:95]
  s_add_u32 s52, s37, 46080
  buffer_load_dwordx4 v91, s[16:19], s52 offen offset:3072 lds
  v_mfma_f32_32x32x16_bf16 a[96:111], v[28:31], v[56:59], a[96:111]
  s_add_u32 m0, m0, 4096
  v_mfma_f32_32x32x16_bf16 a[112:127], v[28:31], v[60:63], a[112:127]
  s_add_u32 s52, s37, 65536
  buffer_load_dwordx4 v90, s[16:19], s52 offen offset:0 lds
  s_waitcnt lgkmcnt(0)
  v_mfma_f32_32x32x16_bf16 a[0:15], v[16:19], v[32:35], a[0:15]
  ds_read_b128 v[24:27], v75 offset:0
  ds_read_b64_tr_b16 v[48:49], v76 offset:24576
  v_mfma_f32_32x32x16_bf16 a[16:31], v[16:19], v[36:39], a[16:31]
  ds_read_b64_tr_b16 v[50:51], v76 offset:26624
  ds_read_b128 v[28:31], v75 offset:4096
  v_mfma_f32_32x32x16_bf16 a[32:47], v[16:19], v[40:43], a[32:47]
  ds_read_b64_tr_b16 v[52:53], v77 offset:24576
  ds_read_b64_tr_b16 v[54:55], v77 offset:26624
  s_add_u32 s52, s37, 80896
  buffer_load_dwordx4 v91, s[16:19], s52 offen offset:1024 lds
  v_mfma_f32_32x32x16_bf16 a[48:63], v[16:19], v[44:47], a[48:63]
  ds_read_b64_tr_b16 v[56:57], v78 offset:24576
  ds_read_b64_tr_b16 v[58:59], v78 offset:26624
  s_add_u32 s52, s37, 96256
  buffer_load_dwordx4 v90, s[16:19], s52 offen offset:2048 lds
  v_mfma_f32_32x32x16_bf16 a[64:79], v[20:23], v[32:35], a[64:79]
  ds_read_b64_tr_b16 v[60:61], v79 offset:24576
  ds_read_b64_tr_b16 v[62:63], v79 offset:26624
  s_add_u32 s52, s37, 111616
  buffer_load_dwordx4 v91, s[16:19], s52 offen offset:3072 lds
  v_mfma_f32_32x32x16_bf16 a[80:95], v[20:23], v[36:39], a[80:95]
  s_add_u32 s36, s36, 128
  s_add_u32 s37, s37, 0x80000
  s_add_u32 s43, s43, 49152
  s_cmp_eq_u32 s43, 147456
  s_cselect_b32 s43, 0, s43
  v_mfma_f32_32x32x16_bf16 a[96:111], v[20:23], v[40:43], a[96:111]
  v_mfma_f32_32x32x16_bf16 a[112:127], v[20:23], v[44:47], a[112:127]
  s_waitcnt lgkmcnt(0)
  v_mfma_f32_32x32x16_bf16 a[0:15], v[24:27], v[48:51], a[0:15]
  v_subrev_u32 v72, 98304, v72
  v_subrev_u32 v73, 98304, v73
  v_subrev_u32 v74, 98304, v74
  v_subrev_u32 v75, 98304, v75
  v_mfma_f32_32x32x16_bf16 a[16:31], v[24:27], v[52:55], a[16:31]
  v_subrev_u32 v76, 98304, v76
  v_subrev_u32 v77, 98304, v77
  v_subrev_u32 v78, 98304, v78
  v_subrev_u32 v79, 98304, v79
  v_mfma_f32_32x32x16_bf16 a[32:47], v[24:27], v[56:59], a[32:47]
  v_mfma_f32_32x32x16_bf16 a[48:63], v[24:27], v[60:63], a[48:63]
  s_waitcnt vmcnt(12)
  s_barrier
  v_mfma_f32_32x32x16_bf16 a[64:79], v[28:31], v[48:51], a[64:79]
  ds_read_b128 v[16:19], v72 offset:0
  ds_read_b64_tr_b16 v[32:33], v76 offset:0
  ds_read_b64_tr_b16 v[34:35], v76 offset:2048
  v_mfma_f32_32x32x16_bf16 a[80:95], v[28:31], v[52:55], a[80:95]
  ds_read_b128 v[20:23], v72 offset:4096
  ds_read_b64_tr_b16 v[36:37], v77 offset:0
  ds_read_b64_tr_b16 v[38:39], v77 offset:2048
  v_mfma_f32_32x32x16_bf16 a[96:111], v[28:31], v[56:59], a[96:111]
  ds_read_b64_tr_b16 v[40:41], v78 offset:0
  ds_read_b64_tr_b16 v[42:43], v78 offset:2048
  ds_read_b64_tr_b16 v[44:45], v79 offset:0
  v_mfma_f32_32x32x16_bf16 a[112:127], v[28:31], v[60:63], a[112:127]
  ds_read_b64_tr_b16 v[46:47], v79 offset:2048
  s_waitcnt lgkmcnt(0)
  v_mfma_f32_32x32x16_bf16 a[0:15], v[16:19], v[32:35], a[0:15]
  ds_read_b128 v[24:27], v73 offset:0
  ds_read_b64_tr_b16 v[48:49], v76 offset:8192
  s_cmp_eq_u32 s48, 0
  s_cbranch_scc1 L_nps_29
  buffer_store_dwordx4 v[176:179], v94, s[4:7], s45 offen offset:0 sc1
  buffer_store_dwordx4 v[180:183], v94, s[4:7], s45 offen offset:512 sc1
  s_add_u32 s45, s45, s46
L_nps_29:
  v_mfma_f32_32x32x16_bf16 a[16:31], v[16:19], v[36:39], a[16:31]
  ds_read_b64_tr_b16 v[50:51], v76 offset:10240
  ds_read_b128 v[28:31], v73 offset:4096
  v_mfma_f32_32x32x16_bf16 a[32:47], v[16:19], v[40:43], a[32:47]
  ds_read_b64_tr_b16 v[52:53], v77 offset:8192
  ds_read_b64_tr_b16 v[54:55], v77 offset:10240
  s_add_u32 m0, s39, s43
  v_mfma_f32_32x32x16_bf16 a[48:63], v[16:19], v[44:47], a[48:63]
  ds_read_b64_tr_b16 v[56:57], v78 offset:8192
  ds_read_b64_tr_b16 v[58:59], v78 offset:10240
  s_add_u32 s52, s36, 0
  buffer_load_dwordx4 v88, s[12:15], s52 offen offset:0 lds
  v_mfma_f32_32x32x16_bf16 a[64:79], v[20:23], v[32:35], a[64:79]
  ds_read_b64_tr_b16 v[60:61], v79 offset:8192
  ds_read_b64_tr_b16 v[62:63], v79 offset:10240
  s_add_u32 s52, s36, 9216
  buffer_load_dwordx4 v89, s[12:15], s52 offen offset:1024 lds
  v_mfma_f32_32x32x16_bf16 a[80:95], v[20:23], v[36:39], a[80:95]
  s_add_u32 s52, s36, 18432
  buffer_load_dwordx4 v88, s[12:15], s52 offen offset:2048 lds
  v_mfma_f32_32x32x16_bf16 a[96:111], v[20:23], v[40:43], a[96:111]
  s_add_u32 s52, s36, 27648
  buffer_load_dwordx4 v89, s[12:15], s52 offen offset:3072 lds
  v_mfma_f32_32x32x16_bf16 a[112:127], v[20:23], v[44:47], a[112:127]
  s_add_u32 m0, m0, s39
  s_add_u32 m0, m0, 16384
  s_waitcnt lgkmcnt(0)
  v_mfma_f32_32x32x16_bf16 a[0:15], v[24:27], v[48:51], a[0:15]
  ds_read_b128 v[16:19], v74 offset:0
  ds_read_b64_tr_b16 v[32:33], v76 offset:16384
  v_mfma_f32_32x32x16_bf16 a[16:31], v[24:27], v[52:55], a[16:31]
  ds_read_b64_tr_b16 v[34:35], v76 offset:18432
  ds_read_b128 v[20:23], v74 offset:4096
  v_mfma_f32_32x32x16_bf16 a[32:47], v[24:27], v[56:59], a[32:47]
  ds_read_b64_tr_b16 v[36:37], v77 offset:16384
  ds_read_b64_tr_b16 v[38:39], v77 offset:18432
  s_add_u32 s52, s37, 0
  buffer_load_dwordx4 v90, s[16:19], s52 offen offset:0 lds
  v_mfma_f32_32x32x16_bf16 a[48:63], v[24:27], v[60:63], a[48:63]
  ds_read_b64_tr_b16 v[40:41], v78 offset:16384
  ds_read_b64_tr_b16 v[42:43], v78 offset:18432
  s_add_u32 s52, s37, 15360
  buffer_load_dwordx4 v91, s[16:19], s52 offen offset:1024 lds
  v_mfma_f32_32x32x16_bf16 a[64:79], v[28:31], v[48:51], a[64:79]
  ds_read_b64_tr_b16 v[44:45], v79 offset:16384
  ds_read_b64_tr_b16 v[46:47], v79 offset:18432
  s_add_u32 s52, s37, 30720
  buffer_load_dwordx4 v90, s[16:19], s52 offen offset:2048 lds
  v_mfma_f32_32x32x16_bf16 a[80:95], v[28:31], v[52:55], a[80:95]
  s_add_u32 s52, s37, 46080
  buffer_load_dwordx4 v91, s[16:19], s52 offen offset:3072 lds
  v_mfma_f32_32x32x16_bf16 a[96:111], v[28:31], v[56:59], a[96:111]
  s_add_u32 m0, m0, 4096
  v_mfma_f32_32x32x16_bf16 a[112:127], v[28:31], v[60:63], a[112:127]
  s_add_u32 s52, s37, 65536
  buffer_load_dwordx4 v90, s[16:19], s52 offen offset:0 lds
  s_waitcnt lgkmcnt(0)
  v_mfma_f32_32x32x16_bf16 a[0:15], v[16:19], v[32:35], a[0:15]
  ds_read_b128 v[24:27], v75 offset:0
  ds_read_b64_tr_b16 v[48:49], v76 offset:24576
  v_mfma_f32_32x32x16_bf16 a[16:31], v[16:19], v[36:39], a[16:31]
  ds_read_b64_tr_b16 v[50:51], v76 offset:26624
  ds_read_b128 v[28:31], v75 offset:4096
  v_mfma_f32_32x32x16_bf16 a[32:47], v[16:19], v[40:43], a[32:47]
  ds_read_b64_tr_b16 v[52:53], v77 offset:24576
  ds_read_b64_tr_b16 v[54:55], v77 offset:26624
  s_add_u32 s52, s37, 80896
  buffer_load_dwordx4 v91, s[16:19], s52 offen offset:1024 lds
  v_mfma_f32_32x32x16_bf16 a[48:63], v[16:19], v[44:47], a[48:63]
  ds_read_b64_tr_b16 v[56:57], v78 offset:24576
  ds_read_b64_tr_b16 v[58:59], v78 offset:26624
  s_add_u32 s52, s37, 96256
  buffer_load_dwordx4 v90, s[16:19], s52 offen offset:2048 lds
  v_mfma_f32_32x32x16_bf16 a[64:79], v[20:23], v[32:35], a[64:79]
  ds_read_b64_tr_b16 v[60:61], v79 offset:24576
  ds_read_b64_tr_b16 v[62:63], v79 offset:26624
  s_add_u32 s52, s37, 111616
  buffer_load_dwordx4 v91, s[16:19], s52 offen offset:3072 lds
  v_mfma_f32_32x32x16_bf16 a[80:95], v[20:23], v[36:39], a[80:95]
  s_add_u32 s36, s36, 128
  s_add_u32 s37, s37, 0x80000
  s_add_u32 s43, s43, 49152
  s_cmp_eq_u32 s43, 147456
  s_cselect_b32 s43, 0, s43
  v_mfma_f32_32x32x16_bf16 a[96:111], v[20:23], v[40:43], a[96:111]
  v_mfma_f32_32x32x16_bf16 a[112:127], v[20:23], v[44:47], a[112:127]
  s_waitcnt lgkmcnt(0)
  v_mfma_f32_32x32x16_bf16 a[0:15], v[24:27], v[48:51], a[0:15]
  v_add_u32 v72, 49152, v72
  v_add_u32 v73, 49152, v73
  v_add_u32 v74, 49152, v74
  v_add_u32 v75, 49152, v75
  v_mfma_f32_32x32x16_bf16 a[16:31], v[24:27], v[52:55], a[16:31]
  v_add_u32 v76, 49152, v76
  v_add_u32 v77, 49152, v77
  v_add_u32 v78, 49152, v78
  v_add_u32 v79, 49152, v79
  v_mfma_f32_32x32x16_bf16 a[32:47], v[24:27], v[56:59], a[32:47]
  v_mfma_f32_32x32x16_bf16 a[48:63], v[24:27], v[60:63], a[48:63]
  s_waitcnt vmcnt(12)
  s_barrier
  v_mfma_f32_32x32x16_bf16 a[64:79], v[28:31], v[48:51], a[64:79]
  ds_read_b128 v[16:19], v72 offset:0
  ds_read_b64_tr_b16 v[32:33], v76 offset:0
  ds_read_b64_tr_b16 v[34:35], v76 offset:2048
  v_mfma_f32_32x32x16_bf16 a[80:95], v[28:31], v[52:55], a[80:95]
  ds_read_b128 v[20:23], v72 offset:4096
  ds_read_b64_tr_b16 v[36:37], v77 offset:0
  ds_read_b64_tr_b16 v[38:39], v77 offset:2048
  v_mfma_f32_32x32x16_bf16 a[96:111], v[28:31], v[56:59], a[96:111]
  ds_read_b64_tr_b16 v[40:41], v78 offset:0
  ds_read_b64_tr_b16 v[42:43], v78 offset:2048
  ds_read_b64_tr_b16 v[44:45], v79 offset:0
  v_mfma_f32_32x32x16_bf16 a[112:127], v[28:31], v[60:63], a[112:127]
  ds_read_b64_tr_b16 v[46:47], v79 offset:2048
  s_waitcnt lgkmcnt(0)
  v_mfma_f32_32x32x16_bf16 a[0:15], v[16:19], v[32:35], a[0:15]
  ds_read_b128 v[24:27], v73 offset:0
  ds_read_b64_tr_b16 v[48:49], v76 offset:8192
  s_cmp_eq_u32 s48, 0
  s_cbranch_scc1 L_nps_30
  buffer_store_dwordx4 v[184:187], v94, s[4:7], s45 offen offset:0 sc1
  buffer_store_dwordx4 v[188:191], v94, s[4:7], s45 offen offset:512 sc1
  s_add_u32 s45, s45, s46
L_nps_30:
  v_mfma_f32_32x32x16_bf16 a[16:31], v[16:19], v[36:39], a[16:31]
  ds_read_b64_tr_b16 v[50:51], v76 offset:10240
  ds_read_b128 v[28:31], v73 offset:4096
  v_mfma_f32_32x32x16_bf16 a[32:47], v[16:19], v[40:43], a[32:47]
  ds_read_b64_tr_b16 v[52:53], v77 offset:8192
  ds_read_b64_tr_b16 v[54:55], v77 offset:10240
  s_add_u32 m0, s39, s43
  v_mfma_f32_32x32x16_bf16 a[48:63], v[16:19], v[44:47], a[48:63]
  ds_read_b64_tr_b16 v[56:57], v78 offset:8192
  ds_read_b64_tr_b16 v[58:59], v78 offset:10240
  s_add_u32 s52, s36, 0
  buffer_load_dwordx4 v88, s[12:15], s52 offen offset:0 lds
  v_mfma_f32_32x32x16_bf16 a[64:79], v[20:23], v[32:35], a[64:79]
  ds_read_b64_tr_b16 v[60:61], v79 offset:8192
  ds_read_b64_tr_b16 v[62:63], v79 offset:10240
  s_add_u32 s52, s36, 9216
  buffer_load_dwordx4 v89, s[12:15], s52 offen offset:1024 lds
  v_mfma_f32_32x32x16_bf16 a[80:95], v[20:23], v[36:39], a[80:95]
  s_add_u32 s52, s36, 18432
  buffer_load_dwordx4 v88, s[12:15], s52 offen offset:2048 lds
  v_mfma_f32_32x32x16_bf16 a[96:111], v[20:23], v[40:43], a[96:111]
  s_add_u32 s52, s36, 27648
  buffer_load_dwordx4 v89, s[12:15], s52 offen offset:3072 lds
  v_mfma_f32_32x32x16_bf16 a[112:127], v[20:23], v[44:47], a[112:127]
  s_add_u32 m0, m0, s39
  s_add_u32 m0, m0, 16384
  s_waitcnt lgkmcnt(0)
  v_mfma_f32_32x32x16_bf16 a[0:15], v[24:27], v[48:51], a[0:15]
  ds_read_b128 v[16:19], v74 offset:0
  ds_read_b64_tr_b16 v[32:33], v76 offset:16384
  v_mfma_f32_32x32x16_bf16 a[16:31], v[24:27], v[52:55], a[16:31]
  ds_read_b64_tr_b16 v[34:35], v76 offset:18432
  ds_read_b128 v[20:23], v74 offset:4096
  v_mfma_f32_32x32x16_bf16 a[32:47], v[24:27], v[56:59], a[32:47]
  ds_read_b64_tr_b16 v[36:37], v77 offset:16384
  ds_read_b64_tr_b16 v[38:39], v77 offset:18432
  s_add_u32 s52, s37, 0
  buffer_load_dwordx4 v90, s[16:19], s52 offen offset:0 lds
  v_mfma_f32_32x32x16_bf16 a[48:63], v[24:27], v[60:63], a[48:63]
  ds_read_b64_tr_b16 v[40:41], v78 offset:16384
  ds_read_b64_tr_b16 v[42:43], v78 offset:18432
  s_add_u32 s52, s37, 15360
  buffer_load_dwordx4 v91, s[16:19], s52 offen offset:1024 lds
  v_mfma_f32_32x32x16_bf16 a[64:79], v[28:31], v[48:51], a[64:79]
  ds_read_b64_tr_b16 v[44:45], v79 offset:16384
  ds_read_b64_tr_b16 v[46:47], v79 offset:18432
  s_add_u32 s52, s37, 30720
  buffer_load_dwordx4 v90, s[16:19], s52 offen offset:2048 lds
  v_mfma_f32_32x32x16_bf16 a[80:95], v[28:31], v[52:55], a[80:95]
  s_add_u32 s52, s37, 46080
  buffer_load_dwordx4 v91, s[16:19], s52 offen offset:3072 lds
  v_mfma_f32_32x32x16_bf16 a[96:111], v[28:31], v[56:59], a[96:111]
  s_add_u32 m0, m0, 4096
  v_mfma_f32_32x32x16_bf16 a[112:127], v[28:31], v[60:63], a[112:127]
  s_add_u32 s52, s37, 65536
  buffer_load_dwordx4 v90, s[16:19], s52 offen offset:0 lds
  s_waitcnt lgkmcnt(0)
  v_mfma_f32_32x32x16_bf16 a[0:15], v[16:19], v[32:35], a[0:15]
  ds_read_b128 v[24:27], v75 offset:0
  ds_read_b64_tr_b16 v[48:49], v76 offset:24576
  v_mfma_f32_32x32x16_bf16 a[16:31], v[16:19], v[36:39], a[16:31]
  ds_read_b64_tr_b16 v[50:51], v76 offset:26624
  ds_read_b128 v[28:31], v75 offset:4096
  v_mfma_f32_32x32x16_bf16 a[32:47], v[16:19], v[40:43], a[32:47]
  ds_read_b64_tr_b16 v[52:53], v77 offset:24576
  ds_read_b64_tr_b16 v[54:55], v77 offset:26624
  s_add_u32 s52, s37, 80896
  buffer_load_dwordx4 v91, s[16:19], s52 offen offset:1024 lds
  v_mfma_f32_32x32x16_bf16 a[48:63], v[16:19], v[44:47], a[48:63]
  ds_read_b64_tr_b16 v[56:57], v78 offset:24576
  ds_read_b64_tr_b16 v[58:59], v78 offset:26624
  s_add_u32 s52, s37, 96256
  buffer_load_dwordx4 v90, s[16:19], s52 offen offset:2048 lds
  v_mfma_f32_32x32x16_bf16 a[64:79], v[20:23], v[32:35], a[64:79]
  ds_read_b64_tr_b16 v[60:61], v79 offset:24576
  ds_read_b64_tr_b16 v[62:63], v79 offset:26624
  s_add_u32 s52, s37, 111616
  buffer_load_dwordx4 v91, s[16:19], s52 offen offset:3072 lds
  v_mfma_f32_32x32x16_bf16 a[80:95], v[20:23], v[36:39], a[80:95]
  s_add_u32 s36, s36, 128
  s_add_u32 s37, s37, 0x80000
  s_add_u32 s43, s43, 49152
  s_cmp_eq_u32 s43, 147456
  s_cselect_b32 s43, 0, s43
  v_mfma_f32_32x32x16_bf16 a[96:111], v[20:23], v[40:43], a[96:111]
  v_mfma_f32_32x32x16_bf16 a[112:127], v[20:23], v[44:47], a[112:127]
  s_waitcnt lgkmcnt(0)
  v_mfma_f32_32x32x16_bf16 a[0:15], v[24:27], v[48:51], a[0:15]
  v_add_u32 v72, 49152, v72
  v_add_u32 v73, 49152, v73
  v_add_u32 v74, 49152, v74
  v_add_u32 v75, 49152, v75
  v_mfma_f32_32x32x16_bf16 a[16:31], v[24:27], v[52:55], a[16:31]
  v_add_u32 v76, 49152, v76
  v_add_u32 v77, 49152, v77
  v_add_u32 v78, 49152, v78
  v_add_u32 v79, 49152, v79
  v_mfma_f32_32x32x16_bf16 a[32:47], v[24:27], v[56:59], a[32:47]
  v_mfma_f32_32x32x16_bf16 a[48:63], v[24:27], v[60:63], a[48:63]
  s_waitcnt vmcnt(12)
  s_barrier
  v_mfma_f32_32x32x16_bf16 a[64:79], v[28:31], v[48:51], a[64:79]
  ds_read_b128 v[16:19], v72 offset:0
  ds_read_b64_tr_b16 v[32:33], v76 offset:0
  ds_read_b64_tr_b16 v[34:35], v76 offset:2048
  v_mfma_f32_32x32x16_bf16 a[80:95], v[28:31], v[52:55], a[80:95]
  ds_read_b128 v[20:23], v72 offset:4096
  ds_read_b64_tr_b16 v[36:37], v77 offset:0
  ds_read_b64_tr_b16 v[38:39], v77 offset:2048
  v_mfma_f32_32x32x16_bf16 a[96:111], v[28:31], v[56:59], a[96:111]
  ds_read_b64_tr_b16 v[40:41], v78 offset:0
  ds_read_b64_tr_b16 v[42:43], v78 offset:2048
  ds_read_b64_tr_b16 v[44:45], v79 offset:0
  v_mfma_f32_32x32x16_bf16 a[112:127], v[28:31], v[60:63], a[112:127]
  ds_read_b64_tr_b16 v[46:47], v79 offset:2048
  s_waitcnt lgkmcnt(0)
  v_mfma_f32_32x32x16_bf16 a[0:15], v[16:19], v[32:35], a[0:15]
  ds_read_b128 v[24:27], v73 offset:0
  ds_read_b64_tr_b16 v[48:49], v76 offset:8192
  v_mfma_f32_32x32x16_bf16 a[16:31], v[16:19], v[36:39], a[16:31]
  ds_read_b64_tr_b16 v[50:51], v76 offset:10240
  ds_read_b128 v[28:31], v73 offset:4096
  v_mfma_f32_32x32x16_bf16 a[32:47], v[16:19], v[40:43], a[32:47]
  ds_read_b64_tr_b16 v[52:53], v77 offset:8192
  ds_read_b64_tr_b16 v[54:55], v77 offset:10240
  v_mfma_f32_32x32x16_bf16 a[48:63], v[16:19], v[44:47], a[48:63]
  ds_read_b64_tr_b16 v[56:57], v78 offset:8192
  ds_read_b64_tr_b16 v[58:59], v78 offset:10240
  v_mfma_f32_32x32x16_bf16 a[64:79], v[20:23], v[32:35], a[64:79]
  ds_read_b64_tr_b16 v[60:61], v79 offset:8192
  ds_read_b64_tr_b16 v[62:63], v79 offset:10240
  v_mfma_f32_32x32x16_bf16 a[80:95], v[20:23], v[36:39], a[80:95]
  v_mfma_f32_32x32x16_bf16 a[96:111], v[20:23], v[40:43], a[96:111]
  v_mfma_f32_32x32x16_bf16 a[112:127], v[20:23], v[44:47], a[112:127]
  s_waitcnt lgkmcnt(0)
  v_mfma_f32_32x32x16_bf16 a[0:15], v[24:27], v[48:51], a[0:15]
  ds_read_b128 v[16:19], v74 offset:0
  ds_read_b64_tr_b16 v[32:33], v76 offset:16384
  v_mfma_f32_32x32x16_bf16 a[16:31], v[24:27], v[52:55], a[16:31]
  ds_read_b64_tr_b16 v[34:35], v76 offset:18432
  ds_read_b128 v[20:23], v74 offset:4096
  v_mfma_f32_32x32x16_bf16 a[32:47], v[24:27], v[56:59], a[32:47]
  ds_read_b64_tr_b16 v[36:37], v77 offset:16384
  ds_read_b64_tr_b16 v[38:39], v77 offset:18432
  v_mfma_f32_32x32x16_bf16 a[48:63], v[24:27], v[60:63], a[48:63]
  ds_read_b64_tr_b16 v[40:41], v78 offset:16384
  ds_read_b64_tr_b16 v[42:43], v78 offset:18432
  v_mfma_f32_32x32x16_bf16 a[64:79], v[28:31], v[48:51], a[64:79]
  ds_read_b64_tr_b16 v[44:45], v79 offset:16384
  ds_read_b64_tr_b16 v[46:47], v79 offset:18432
  v_mfma_f32_32x32x16_bf16 a[80:95], v[28:31], v[52:55], a[80:95]
  v_mfma_f32_32x32x16_bf16 a[96:111], v[28:31], v[56:59], a[96:111]
  v_mfma_f32_32x32x16_bf16 a[112:127], v[28:31], v[60:63], a[112:127]
  s_waitcnt lgkmcnt(0)
  v_mfma_f32_32x32x16_bf16 a[0:15], v[16:19], v[32:35], a[0:15]
  ds_read_b128 v[24:27], v75 offset:0
  ds_read_b64_tr_b16 v[48:49], v76 offset:24576
  v_mfma_f32_32x32x16_bf16 a[16:31], v[16:19], v[36:39], a[16:31]
  ds_read_b64_tr_b16 v[50:51], v76 offset:26624
  ds_read_b128 v[28:31], v75 offset:4096
  v_mfma_f32_32x32x16_bf16 a[32:47], v[16:19], v[40:43], a[32:47]
  ds_read_b64_tr_b16 v[52:53], v77 offset:24576
  ds_read_b64_tr_b16 v[54:55], v77 offset:26624
  v_mfma_f32_32x32x16_bf16 a[48:63], v[16:19], v[44:47], a[48:63]
  ds_read_b64_tr_b16 v[56:57], v78 offset:24576
  ds_read_b64_tr_b16 v[58:59], v78 offset:26624
  v_mfma_f32_32x32x16_bf16 a[64:79], v[20:23], v[32:35], a[64:79]
  ds_read_b64_tr_b16 v[60:61], v79 offset:24576
  ds_read_b64_tr_b16 v[62:63], v79 offset:26624
  v_mfma_f32_32x32x16_bf16 a[80:95], v[20:23], v[36:39], a[80:95]
  v_mfma_f32_32x32x16_bf16 a[96:111], v[20:23], v[40:43], a[96:111]
  v_mfma_f32_32x32x16_bf16 a[112:127], v[20:23], v[44:47], a[112:127]
  s_waitcnt lgkmcnt(0)
  v_mfma_f32_32x32x16_bf16 a[0:15], v[24:27], v[48:51], a[0:15]
  v_subrev_u32 v72, 98304, v72
  v_subrev_u32 v73, 98304, v73
  v_subrev_u32 v74, 98304, v74
  v_subrev_u32 v75, 98304, v75
  v_mfma_f32_32x32x16_bf16 a[16:31], v[24:27], v[52:55], a[16:31]
  v_subrev_u32 v76, 98304, v76
  v_subrev_u32 v77, 98304, v77
  v_subrev_u32 v78, 98304, v78
  v_subrev_u32 v79, 98304, v79
  v_mfma_f32_32x32x16_bf16 a[32:47], v[24:27], v[56:59], a[32:47]
  v_mfma_f32_32x32x16_bf16 a[48:63], v[24:27], v[60:63], a[48:63]
  s_waitcnt vmcnt(0)
  s_barrier
  s_cmp_eq_u32 s48, 0
  s_cbranch_scc1 L_nsg_31
  s_cmp_lg_u32 s28, 0
  s_cbranch_scc1 L_sig_32
  s_mov_b64 exec, 1
  v_mov_b32 v2, s50
  buffer_atomic_add v2, off, s[8:11], s49 sc1
  s_mov_b64 exec, -1
L_sig_32:
L_nsg_31:
  v_mfma_f32_32x32x16_bf16 a[64:79], v[28:31], v[48:51], a[64:79]
  ds_read_b128 v[16:19], v72 offset:0
  ds_read_b64_tr_b16 v[32:33], v76 offset:0
  ds_read_b64_tr_b16 v[34:35], v76 offset:2048
  v_mfma_f32_32x32x16_bf16 a[80:95], v[28:31], v[52:55], a[80:95]
  ds_read_b128 v[20:23], v72 offset:4096
  ds_read_b64_tr_b16 v[36:37], v77 offset:0
  ds_read_b64_tr_b16 v[38:39], v77 offset:2048
  v_mfma_f32_32x32x16_bf16 a[96:111], v[28:31], v[56:59], a[96:111]
  ds_read_b64_tr_b16 v[40:41], v78 offset:0
  ds_read_b64_tr_b16 v[42:43], v78 offset:2048
  ds_read_b64_tr_b16 v[44:45], v79 offset:0
  v_mfma_f32_32x32x16_bf16 a[112:127], v[28:31], v[60:63], a[112:127]
  ds_read_b64_tr_b16 v[46:47], v79 offset:2048
  s_waitcnt lgkmcnt(0)
  v_mfma_f32_32x32x16_bf16 a[0:15], v[16:19], v[32:35], a[0:15]
  ds_read_b128 v[24:27], v73 offset:0
  ds_read_b64_tr_b16 v[48:49], v76 offset:8192
  v_mfma_f32_32x32x16_bf16 a[16:31], v[16:19], v[36:39], a[16:31]
  ds_read_b64_tr_b16 v[50:51], v76 offset:10240
  ds_read_b128 v[28:31], v73 offset:4096
  v_mfma_f32_32x32x16_bf16 a[32:47], v[16:19], v[40:43], a[32:47]
  ds_read_b64_tr_b16 v[52:53], v77 offset:8192
  ds_read_b64_tr_b16 v[54:55], v77 offset:10240
  v_mfma_f32_32x32x16_bf16 a[48:63], v[16:19], v[44:47], a[48:63]
  ds_read_b64_tr_b16 v[56:57], v78 offset:8192
  ds_read_b64_tr_b16 v[58:59], v78 offset:10240
  v_mfma_f32_32x32x16_bf16 a[64:79], v[20:23], v[32:35], a[64:79]
  ds_read_b64_tr_b16 v[60:61], v79 offset:8192
  ds_read_b64_tr_b16 v[62:63], v79 offset:10240
  v_mfma_f32_32x32x16_bf16 a[80:95], v[20:23], v[36:39], a[80:95]
  v_mfma_f32_32x32x16_bf16 a[96:111], v[20:23], v[40:43], a[96:111]
  v_mfma_f32_32x32x16_bf16 a[112:127], v[20:23], v[44:47], a[112:127]
  s_waitcnt lgkmcnt(0)
  v_mfma_f32_32x32x16_bf16 a[0:15], v[24:27], v[48:51], a[0:15]
  ds_read_b128 v[16:19], v74 offset:0
  ds_read_b64_tr_b16 v[32:33], v76 offset:16384
  v_mfma_f32_32x32x16_bf16 a[16:31], v[24:27], v[52:55], a[16:31]
  ds_read_b64_tr_b16 v[34:35], v76 offset:18432
  ds_read_b128 v[20:23], v74 offset:4096
  v_mfma_f32_32x32x16_bf16 a[32:47], v[24:27], v[56:59], a[32:47]
  ds_read_b64_tr_b16 v[36:37], v77 offset:16384
  ds_read_b64_tr_b16 v[38:39], v77 offset:18432
  v_mfma_f32_32x32x16_bf16 a[48:63], v[24:27], v[60:63], a[48:63]
  ds_read_b64_tr_b16 v[40:41], v78 offset:16384
  ds_read_b64_tr_b16 v[42:43], v78 offset:18432
  v_mfma_f32_32x32x16_bf16 a[64:79], v[28:31], v[48:51], a[64:79]
  ds_read_b64_tr_b16 v[44:45], v79 offset:16384
  ds_read_b64_tr_b16 v[46:47], v79 offset:18432
  v_mfma_f32_32x32x16_bf16 a[80:95], v[28:31], v[52:55], a[80:95]
  v_mfma_f32_32x32x16_bf16 a[96:111], v[28:31], v[56:59], a[96:111]
  v_mfma_f32_32x32x16_bf16 a[112:127], v[28:31], v[60:63], a[112:127]
  s_waitcnt lgkmcnt(0)
  v_mfma_f32_32x32x16_bf16 a[0:15], v[16:19], v[32:35], a[0:15]
  ds_read_b128 v[24:27], v75 offset:0
  ds_read_b64_tr_b16 v[48:49], v76 offset:24576
  v_mfma_f32_32x32x16_bf16 a[16:31], v[16:19], v[36:39], a[16:31]
  ds_read_b64_tr_b16 v[50:51], v76 offset:26624
  ds_read_b128 v[28:31], v75 offset:4096
  v_mfma_f32_32x32x16_bf16 a[32:47], v[16:19], v[40:43], a[32:47]
  ds_read_b64_tr_b16 v[52:53], v77 offset:24576
  ds_read_b64_tr_b16 v[54:55], v77 offset:26624
  v_mfma_f32_32x32x16_bf16 a[48:63], v[16:19], v[44:47], a[48:63]
  ds_read_b64_tr_b16 v[56:57], v78 offset:24576
  ds_read_b64_tr_b16 v[58:59], v78 offset:26624
  v_mfma_f32_32x32x16_bf16 a[64:79], v[20:23], v[32:35], a[64:79]
  ds_read_b64_tr_b16 v[60:61], v79 offset:24576
  ds_read_b64_tr_b16 v[62:63], v79 offset:26624
  v_mfma_f32_32x32x16_bf16 a[80:95], v[20:23], v[36:39], a[80:95]
  v_mfma_f32_32x32x16_bf16 a[96:111], v[20:23], v[40:43], a[96:111]
  v_mfma_f32_32x32x16_bf16 a[112:127], v[20:23], v[44:47], a[112:127]
  s_waitcnt lgkmcnt(0)
  v_mfma_f32_32x32x16_bf16 a[0:15], v[24:27], v[48:51], a[0:15]
  v_mfma_f32_32x32x16_bf16 a[16:31], v[24:27], v[52:55], a[16:31]
  v_mfma_f32_32x32x16_bf16 a[32:47], v[24:27], v[56:59], a[32:47]
  v_mfma_f32_32x32x16_bf16 a[48:63], v[24:27], v[60:63], a[48:63]
  v_mfma_f32_32x32x16_bf16 a[64:79], v[28:31], v[48:51], a[64:79]
  v_mfma_f32_32x32x16_bf16 a[80:95], v[28:31], v[52:55], a[80:95]
  v_mfma_f32_32x32x16_bf16 a[96:111], v[28:31], v[56:59], a[96:111]
  v_mfma_f32_32x32x16_bf16 a[112:127], v[28:31], v[60:63], a[112:127]
  s_lshr_b32 s52, s28, 1
  s_lshl_b32 s53, s33, 2
  s_lshl_b32 s52, s52, 1
  s_add_u32 s52, s52, s53
  s_lshl_b32 s52, s52, 5
  s_and_b32 s53, s28, 1
  s_add_u32 s52, s52, s53
  s_lshl_b32 s53, s34, 1
  s_add_u32 s52, s52, s53
  s_lshl_b32 s52, s52, 14
  s_add_u32 s45, s52, 0x2000
  s_movk_i32 s46, 2048
  s_mov_b32 s47, 0x7e800
  v_mov_b32 v94, v93
  v_accvgpr_read_b32 v16, a0
  v_accvgpr_read_b32 v17, a1
  v_accvgpr_read_b32 v18, a2
  v_accvgpr_read_b32 v19, a3
  v_accvgpr_read_b32 v20, a8
  v_accvgpr_read_b32 v21, a9
  v_accvgpr_read_b32 v22, a10
  v_accvgpr_read_b32 v23, a11
  v_cvt_pk_bf16_f32 v128, v16, v17
  v_cvt_pk_bf16_f32 v129, v18, v19
  v_cvt_pk_bf16_f32 v130, v20, v21
  v_cvt_pk_bf16_f32 v131, v22, v23
  v_accvgpr_read_b32 v24, a4
  v_accvgpr_read_b32 v25, a5
  v_accvgpr_read_b32 v26, a6
  v_accvgpr_read_b32 v27, a7
  v_accvgpr_read_b32 v28, a12
  v_accvgpr_read_b32 v29, a13
  v_accvgpr_read_b32 v30, a14
  v_accvgpr_read_b32 v31, a15
  v_cvt_pk_bf16_f32 v132, v24, v25
  v_cvt_pk_bf16_f32 v133, v26, v27
  v_cvt_pk_bf16_f32 v134, v28, v29
  v_cvt_pk_bf16_f32 v135, v30, v31
  v_accvgpr_read_b32 v16, a16
  v_accvgpr_read_b32 v17, a17
  v_accvgpr_read_b32 v18, a18
  v_accvgpr_read_b32 v19, a19
  v_accvgpr_read_b32 v20, a24
  v_accvgpr_read_b32 v21, a25
  v_accvgpr_read_b32 v22, a26
  v_accvgpr_read_b32 v23, a27
  v_cvt_pk_bf16_f32 v136, v16, v17
  v_cvt_pk_bf16_f32 v137, v18, v19
  v_cvt_pk_bf16_f32 v138, v20, v21
  v_cvt_pk_bf16_f32 v139, v22, v23
  v_accvgpr_read_b32 v24, a20
  v_accvgpr_read_b32 v25, a21
  v_accvgpr_read_b32 v26, a22
  v_accvgpr_read_b32 v27, a23
  v_accvgpr_read_b32 v28, a28
  v_accvgpr_read_b32 v29, a29
  v_accvgpr_read_b32 v30, a30
  v_accvgpr_read_b32 v31, a31
  v_cvt_pk_bf16_f32 v140, v24, v25
  v_cvt_pk_bf16_f32 v141, v26, v27
  v_cvt_pk_bf16_f32 v142, v28, v29
  v_cvt_pk_bf16_f32 v143, v30, v31
  v_accvgpr_read_b32 v16, a32
  v_accvgpr_read_b32 v17, a33
  v_accvgpr_read_b32 v18, a34
  v_accvgpr_read_b32 v19, a35
  v_accvgpr_read_b32 v20, a40
  v_accvgpr_read_b32 v21, a41
  v_accvgpr_read_b32 v22, a42
  v_accvgpr_read_b32 v23, a43
  v_cvt_pk_bf16_f32 v144, v16, v17
  v_cvt_pk_bf16_f32 v145, v18, v19
  v_cvt_pk_bf16_f32 v146, v20, v21
  v_cvt_pk_bf16_f32 v147, v22, v23
  v_accvgpr_read_b32 v24, a36
  v_accvgpr_read_b32 v25, a37
  v_accvgpr_read_b32 v26, a38
  v_accvgpr_read_b32 v27, a39
  v_accvgpr_read_b32 v28, a44
  v_accvgpr_read_b32 v29, a45
  v_accvgpr_read_b32 v30, a46
  v_accvgpr_read_b32 v31, a47
  v_cvt_pk_bf16_f32 v148, v24, v25
  v_cvt_pk_bf16_f32 v149, v26, v27
  v_cvt_pk_bf16_f32 v150, v28, v29
  v_cvt_pk_bf16_f32 v151, v30, v31
  v_accvgpr_read_b32 v16, a48
  v_accvgpr_read_b32 v17, a49
  v_accvgpr_read_b32 v18, a50
  v_accvgpr_read_b32 v19, a51
  v_accvgpr_read_b32 v20, a56
  v_accvgpr_read_b32 v21, a57
  v_accvgpr_read_b32 v22, a58
  v_accvgpr_read_b32 v23, a59
  v_cvt_pk_bf16_f32 v152, v16, v17
  v_cvt_pk_bf16_f32 v153, v18, v19
  v_cvt_pk_bf16_f32 v154, v20, v21
  v_cvt_pk_bf16_f32 v155, v22, v23
  v_accvgpr_read_b32 v24, a52
  v_accvgpr_read_b32 v25, a53
  v_accvgpr_read_b32 v26, a54
  v_accvgpr_read_b32 v27, a55
  v_accvgpr_read_b32 v28, a60
  v_accvgpr_read_b32 v29, a61
  v_accvgpr_read_b32 v30, a62
  v_accvgpr_read_b32 v31, a63
  v_cvt_pk_bf16_f32 v156, v24, v25
  v_cvt_pk_bf16_f32 v157, v26, v27
  v_cvt_pk_bf16_f32 v158, v28, v29
  v_cvt_pk_bf16_f32 v159, v30, v31
  v_accvgpr_read_b32 v16, a64
  v_accvgpr_read_b32 v17, a65
  v_accvgpr_read_b32 v18, a66
  v_accvgpr_read_b32 v19, a67
  v_accvgpr_read_b32 v20, a72
  v_accvgpr_read_b32 v21, a73
  v_accvgpr_read_b32 v22, a74
  v_accvgpr_read_b32 v23, a75
  v_cvt_pk_bf16_f32 v160, v16, v17
  v_cvt_pk_bf16_f32 v161, v18, v19
  v_cvt_pk_bf16_f32 v162, v20, v21
  v_cvt_pk_bf16_f32 v163, v22, v23
  v_accvgpr_read_b32 v24, a68
  v_accvgpr_read_b32 v25, a69
  v_accvgpr_read_b32 v26, a70
  v_accvgpr_read_b32 v27, a71
  v_accvgpr_read_b32 v28, a76
  v_accvgpr_read_b32 v29, a77
  v_accvgpr_read_b32 v30, a78
  v_accvgpr_read_b32 v31, a79
  v_cvt_pk_bf16_f32 v164, v24, v25
  v_cvt_pk_bf16_f32 v165, v26, v27
  v_cvt_pk_bf16_f32 v166, v28, v29
  v_cvt_pk_bf16_f32 v167, v30, v31
  v_accvgpr_read_b32 v16, a80
  v_accvgpr_read_b32 v17, a81
  v_accvgpr_read_b32 v18, a82
  v_accvgpr_read_b32 v19, a83
  v_accvgpr_read_b32 v20, a88
  v_accvgpr_read_b32 v21, a89
  v_accvgpr_read_b32 v22, a90
  v_accvgpr_read_b32 v23, a91
  v_cvt_pk_bf16_f32 v168, v16, v17
  v_cvt_pk_bf16_f32 v169, v18, v19
  v_cvt_pk_bf16_f32 v170, v20, v21
  v_cvt_pk_bf16_f32 v171, v22, v23
  v_accvgpr_read_b32 v24, a84
  v_accvgpr_read_b32 v25, a85
  v_accvgpr_read_b32 v26, a86
  v_accvgpr_read_b32 v27, a87
  v_accvgpr_read_b32 v28, a92
  v_accvgpr_read_b32 v29, a93
  v_accvgpr_read_b32 v30, a94
  v_accvgpr_read_b32 v31, a95
  v_cvt_pk_bf16_f32 v172, v24, v25
  v_cvt_pk_bf16_f32 v173, v26, v27
  v_cvt_pk_bf16_f32 v174, v28, v29
  v_cvt_pk_bf16_f32 v175, v30, v31
  v_accvgpr_read_b32 v16, a96
  v_accvgpr_read_b32 v17, a97
  v_accvgpr_read_b32 v18, a98
  v_accvgpr_read_b32 v19, a99
  v_accvgpr_read_b32 v20, a104
  v_accvgpr_read_b32 v21, a105
  v_accvgpr_read_b32 v22, a106
  v_accvgpr_read_b32 v23, a107
  v_cvt_pk_bf16_f32 v176, v16, v17
  v_cvt_pk_bf16_f32 v177, v18, v19
  v_cvt_pk_bf16_f32 v178, v20, v21
  v_cvt_pk_bf16_f32 v179, v22, v23
  v_accvgpr_read_b32 v24, a100
  v_accvgpr_read_b32 v25, a101
  v_accvgpr_read_b32 v26, a102
  v_accvgpr_read_b32 v27, a103
  v_accvgpr_read_b32 v28, a108
  v_accvgpr_read_b32 v29, a109
  v_accvgpr_read_b32 v30, a110
  v_accvgpr_read_b32 v31, a111
  v_cvt_pk_bf16_f32 v180, v24, v25
  v_cvt_pk_bf16_f32 v181, v26, v27
  v_cvt_pk_bf16_f32 v182, v28, v29
  v_cvt_pk_bf16_f32 v183, v30, v31
  v_accvgpr_read_b32 v16, a112
  v_accvgpr_read_b32 v17, a113
  v_accvgpr_read_b32 v18, a114
  v_accvgpr_read_b32 v19, a115
  v_accvgpr_read_b32 v20, a120
  v_accvgpr_read_b32 v21, a121
  v_accvgpr_read_b32 v22, a122
  v_accvgpr_read_b32 v23, a123
  v_cvt_pk_bf16_f32 v184, v16, v17
  v_cvt_pk_bf16_f32 v185, v18, v19
  v_cvt_pk_bf16_f32 v186, v20, v21
  v_cvt_pk_bf16_f32 v187, v22, v23
  v_accvgpr_read_b32 v24, a116
  v_accvgpr_read_b32 v25, a117
  v_accvgpr_read_b32 v26, a118
  v_accvgpr_read_b32 v27, a119
  v_accvgpr_read_b32 v28, a124
  v_accvgpr_read_b32 v29, a125
  v_accvgpr_read_b32 v30, a126
  v_accvgpr_read_b32 v31, a127
  v_cvt_pk_bf16_f32 v188, v24, v25
  v_cvt_pk_bf16_f32 v189, v26, v27
  v_cvt_pk_bf16_f32 v190, v28, v29
  v_cvt_pk_bf16_f32 v191, v30, v31
  s_branch L_b1done_10
L_b1done_10:
  s_cmp_eq_u32 s35, 2
  s_cselect_b32 s53, 16, 0
  s_add_u32 s53, s53, 128
  s_and_b32 s54, s33, 12
  s_add_u32 s49, s53, s54
  s_and_b32 s54, s33, 3
  s_lshl_b32 s54, s54, 3
  s_lshl_b32 s50, 1, s54
  s_cmp_lg_u32 s40, 0
  s_cbranch_scc1 L_vp_33
  v_lshlrev_b32 v2, 2, v0
  buffer_load_dword v2, v2, s[8:11], 0 offen sc1
  s_waitcnt vmcnt(0)
  s_mov_b32 s51, 0
L_vagain_35:
  v_cmp_eq_u32 vcc, -1, v2
  s_and_b32 s52, vcc_lo, 0xaaaa
  s_cmp_eq_u32 s52, 0xaaaa
  s_cbranch_scc1 L_vok_34
  s_mov_b32 s52, 0
  v_readlane_b32 s53, v2, 0
  s_nop 0
  s_add_u32 s52, s52, s53
  v_readlane_b32 s53, v2, 2
  s_nop 0
  s_add_u32 s52, s52, s53
  v_readlane_b32 s53, v2, 4
  s_nop 0
  s_add_u32 s52, s52, s53
  v_readlane_b32 s53, v2, 6
  s_nop 0
  s_add_u32 s52, s52, s53
  v_readlane_b32 s53, v2, 8
  s_nop 0
  s_add_u32 s52, s52, s53
  v_readlane_b32 s53, v2, 10
  s_nop 0
  s_add_u32 s52, s52, s53
  v_readlane_b32 s53, v2, 12
  s_nop 0
  s_add_u32 s52, s52, s53
  v_readlane_b32 s53, v2, 14
  s_nop 0
  s_add_u32 s52, s52, s53
  s_cmp_lt_u32 s52, 256
  s_cbranch_scc1 L_vagain_35w
  s_cmp_lg_u32 s31, 0
  s_cbranch_scc1 L_vok_34
  s_branch L_fallback
L_vagain_35w:
  s_add_u32 s51, s51, 1
  s_cmp_gt_u32 s51, 131072
  s_cbranch_scc1 L_end
  v_lshlrev_b32 v2, 2, v0
  buffer_load_dword v2, v2, s[8:11], 0 offen sc1
  s_waitcnt vmcnt(0)
  s_branch L_vagain_35
L_vok_34:
L_vp_33:
  s_mov_b32 s48, 1
  s_add_u32 s40, s40, 1
  s_cmp_eq_u32 s40, 1
  s_cbranch_scc1 L_b1now_36
  s_cmp_lt_u32 s40, 4
  s_cbranch_scc1 L_b1round_4
L_b1now_36:
  buffer_store_dwordx4 v[128:131], v94, s[4:7], s45 offen offset:0 sc1
  buffer_store_dwordx4 v[132:135], v94, s[4:7], s45 offen offset:512 sc1
  s_add_u32 s45, s45, s46
  buffer_store_dwordx4 v[136:139], v94, s[4:7], s45 offen offset:0 sc1
  buffer_store_dwordx4 v[140:143], v94, s[4:7], s45 offen offset:512 sc1
  s_add_u32 s45, s45, s46
  buffer_store_dwordx4 v[144:147], v94, s[4:7], s45 offen offset:0 sc1
  buffer_store_dwordx4 v[148:151], v94, s[4:7], s45 offen offset:512 sc1
  s_add_u32 s45, s45, s46
  buffer_store_dwordx4 v[152:155], v94, s[4:7], s45 offen offset:0 sc1
  buffer_store_dwordx4 v[156:159], v94, s[4:7], s45 offen offset:512 sc1
  s_add_u32 s45, s45, s47
  buffer_store_dwordx4 v[160:163], v94, s[4:7], s45 offen offset:0 sc1
  buffer_store_dwordx4 v[164:167], v94, s[4:7], s45 offen offset:512 sc1
  s_add_u32 s45, s45, s46
  buffer_store_dwordx4 v[168:171], v94, s[4:7], s45 offen offset:0 sc1
  buffer_store_dwordx4 v[172:175], v94, s[4:7], s45 offen offset:512 sc1
  s_add_u32 s45, s45, s46
  buffer_store_dwordx4 v[176:179], v94, s[4:7], s45 offen offset:0 sc1
  buffer_store_dwordx4 v[180:183], v94, s[4:7], s45 offen offset:512 sc1
  s_add_u32 s45, s45, s46
  buffer_store_dwordx4 v[184:187], v94, s[4:7], s45 offen offset:0 sc1
  buffer_store_dwordx4 v[188:191], v94, s[4:7], s45 offen offset:512 sc1
  s_add_u32 s45, s45, s46
  s_waitcnt vmcnt(0)
  s_barrier
  s_cmp_lg_u32 s28, 0
  s_cbranch_scc1 L_sig_37
  s_mov_b64 exec, 1
  v_mov_b32 v2, s50
  buffer_atomic_add v2, off, s[8:11], s49 sc1
  s_mov_b64 exec, -1
L_sig_37:
  s_mov_b32 s48, 0
  s_cmp_lt_u32 s40, 4
  s_cbranch_scc1 L_b1round_4
  s_cmp_ge_u32 s29, 6
  s_cbranch_scc1 L_parta
  s_cmp_ge_u32 s30, 20
  s_cbranch_scc1 L_b2
L_b3:
  s_mov_b32 s12, s82
  s_and_b32 s13, s83, 0xffff
  s_mov_b32 s14, 0x500000
  s_mov_b32 s15, 0x20000
  s_mov_b32 s16, s86
  s_and_b32 s17, s87, 0xffff
  s_mov_b32 s18, 0x500000
  s_mov_b32 s19, 0x20000
  v_lshrrev_b32 v4, 2, v0
  v_mul_u32_u24 v4, 1280, v4
  v_and_b32 v5, 3, v0
  v_lshl_add_u32 v4, v5, 4, v4
  s_mul_i32 s54, s28, 1310720
  s_lshl_b32 s53, s30, 6
  s_add_u32 s54, s54, s53
  s_lshl_b32 s35, s28, 15
  s_add_u32 m0, s35, 0
  s_add_u32 s52, s54, 0x0
  buffer_load_dwordx4 v4, s[12:15], s52 offen offset:0 lds
  s_add_u32 s52, s54, 0x4c00
  buffer_load_dwordx4 v4, s[12:15], s52 offen offset:1024 lds
  s_add_u32 s52, s54, 0x9800
  buffer_load_dwordx4 v4, s[12:15], s52 offen offset:2048 lds
  s_add_u32 s52, s54, 0xe400
  buffer_load_dwordx4 v4, s[12:15], s52 offen offset:3072 lds
  s_add_u32 m0, s35, 4096
  s_add_u32 s52, s54, 0x14000
  buffer_load_dwordx4 v4, s[12:15], s52 offen offset:0 lds
  s_add_u32 s52, s54, 0x18c00
  buffer_load_dwordx4 v4, s[12:15], s52 offen offset:1024 lds
  s_add_u32 s52, s54, 0x1d800
  buffer_load_dwordx4 v4, s[12:15], s52 offen offset:2048 lds
  s_add_u32 s52, s54, 0x22400
  buffer_load_dwordx4 v4, s[12:15], s52 offen offset:3072 lds
  s_add_u32 m0, s35, 8192
  s_add_u32 s52, s54, 0x28000
  buffer_load_dwordx4 v4, s[12:15], s52 offen offset:0 lds
  s_add_u32 s52, s54, 0x2cc00
  buffer_load_dwordx4 v4, s[12:15], s52 offen offset:1024 lds
  s_add_u32 s52, s54, 0x31800
  buffer_load_dwordx4 v4, s[12:15], s52 offen offset:2048 lds
  s_add_u32 s52, s54, 0x36400
  buffer_load_dwordx4 v4, s[12:15], s52 offen offset:3072 lds
  s_add_u32 m0, s35, 12288
  s_add_u32 s52, s54, 0x3c000
  buffer_load_dwordx4 v4, s[12:15], s52 offen offset:0 lds
  s_add_u32 s52, s54, 0x40c00
  buffer_load_dwordx4 v4, s[12:15], s52 offen offset:1024 lds
  s_add_u32 s52, s54, 0x45800
  buffer_load_dwordx4 v4, s[12:15], s52 offen offset:2048 lds
  s_add_u32 s52, s54, 0x4a400
  buffer_load_dwordx4 v4, s[12:15], s52 offen offset:3072 lds
  s_add_u32 m0, s35, 16384
  s_add_u32 s52, s54, 0x50000
  buffer_load_dwordx4 v4, s[12:15], s52 offen offset:0 lds
  s_add_u32 s52, s54, 0x54c00
  buffer_load_dwordx4 v4, s[12:15], s52 offen offset:1024 lds
  s_add_u32 s52, s54, 0x59800
  buffer_load_dwordx4 v4, s[12:15], s52 offen offset:2048 lds
  s_add_u32 s52, s54, 0x5e400
  buffer_load_dwordx4 v4, s[12:15], s52 offen offset:3072 lds
  s_add_u32 m0, s35, 20480
  s_add_u32 s52, s54, 0x64000
  buffer_load_dwordx4 v4, s[12:15], s52 offen offset:0 lds
  s_add_u32 s52, s54, 0x68c00
  buffer_load_dwordx4 v4, s[12:15], s52 offen offset:1024 lds
  s_add_u32 s52, s54, 0x6d800
  buffer_load_dwordx4 v4, s[12:15], s52 offen offset:2048 lds
  s_add_u32 s52, s54, 0x72400
  buffer_load_dwordx4 v4, s[12:15], s52 offen offset:3072 lds
  s_add_u32 m0, s35, 24576
  s_add_u32 s52, s54, 0x78000
  buffer_load_dwordx4 v4, s[12:15], s52 offen offset:0 lds
  s_add_u32 s52, s54, 0x7cc00
  buffer_load_dwordx4 v4, s[12:15], s52 offen offset:1024 lds
  s_add_u32 s52, s54, 0x81800
  buffer_load_dwordx4 v4, s[12:15], s52 offen offset:2048 lds
  s_add_u32 s52, s54, 0x86400
  buffer_load_dwordx4 v4, s[12:15], s52 offen offset:3072 lds
  s_add_u32 m0, s35, 28672
  s_add_u32 s52, s54, 0x8c000
  buffer_load_dwordx4 v4, s[12:15], s52 offen offset:0 lds
  s_add_u32 s52, s54, 0x90c00
  buffer_load_dwordx4 v4, s[12:15], s52 offen offset:1024 lds
  s_add_u32 s52, s54, 0x95800
  buffer_load_dwordx4 v4, s[12:15], s52 offen offset:2048 lds
  s_add_u32 s52, s54, 0x9a400
  buffer_load_dwordx4 v4, s[12:15], s52 offen offset:3072 lds
  v_lshrrev_b32 v6, 2, v0
  v_lshlrev_b32 v6, 6, v6
  v_lshl_add_u32 v6, v5, 4, v6
  v_add_u32 v6, s35, v6
  v_lshlrev_b32 v1, 4, v0
  s_waitcnt vmcnt(28)
  ds_read_b64_tr_b16 a[0:1], v6 offset:0
  ds_read_b64_tr_b16 a[2:3], v6 offset:1024
  ds_read_b64_tr_b16 a[4:5], v6 offset:8
  ds_read_b64_tr_b16 a[6:7], v6 offset:1032
  ds_read_b64_tr_b16 a[8:9], v6 offset:2048
  ds_read_b64_tr_b16 a[10:11], v6 offset:3072
  ds_read_b64_tr_b16 a[12:13], v6 offset:2056
  ds_read_b64_tr_b16 a[14:15], v6 offset:3080
  s_waitcnt lgkmcnt(0)
  s_add_u32 m0, s35, 0
  s_add_u32 s52, s54, 0xa0000
  buffer_load_dwordx4 v4, s[12:15], s52 offen offset:0 lds
  s_add_u32 s52, s54, 0xa4c00
  buffer_load_dwordx4 v4, s[12:15], s52 offen offset:1024 lds
  s_add_u32 s52, s54, 0xa9800
  buffer_load_dwordx4 v4, s[12:15], s52 offen offset:2048 lds
  s_add_u32 s52, s54, 0xae400
  buffer_load_dwordx4 v4, s[12:15], s52 offen offset:3072 lds
  s_waitcnt vmcnt(28)
  ds_read_b64_tr_b16 a[16:17], v6 offset:4096
  ds_read_b64_tr_b16 a[18:19], v6 offset:5120
  ds_read_b64_tr_b16 a[20:21], v6 offset:4104
  ds_read_b64_tr_b16 a[22:23], v6 offset:5128
  ds_read_b64_tr_b16 a[24:25], v6 offset:6144
  ds_read_b64_tr_b16 a[26:27], v6 offset:7168
  ds_read_b64_tr_b16 a[28:29], v6 offset:6152
  ds_read_b64_tr_b16 a[30:31], v6 offset:7176
  s_waitcnt lgkmcnt(0)
  s_add_u32 m0, s35, 4096
  s_add_u32 s52, s54, 0xb4000
  buffer_load_dwordx4 v4, s[12:15], s52 offen offset:0 lds
  s_add_u32 s52, s54, 0xb8c00
  buffer_load_dwordx4 v4, s[12:15], s52 offen offset:1024 lds
  s_add_u32 s52, s54, 0xbd800
  buffer_load_dwordx4 v4, s[12:15], s52 offen offset:2048 lds
  s_add_u32 s52, s54, 0xc2400
  buffer_load_dwordx4 v4, s[12:15], s52 offen offset:3072 lds
  s_waitcnt vmcnt(28)
  ds_read_b64_tr_b16 a[32:33], v6 offset:8192
  ds_read_b64_tr_b16 a[34:35], v6 offset:9216
  ds_read_b64_tr_b16 a[36:37], v6 offset:8200
  ds_read_b64_tr_b16 a[38:39], v6 offset:9224
  ds_read_b64_tr_b16 a[40:41], v6 offset:10240
  ds_read_b64_tr_b16 a[42:43], v6 offset:11264
  ds_read_b64_tr_b16 a[44:45], v6 offset:10248
  ds_read_b64_tr_b16 a[46:47], v6 offset:11272
  s_waitcnt lgkmcnt(0)
  s_add_u32 m0, s35, 8192
  s_add_u32 s52, s54, 0xc8000
  buffer_load_dwordx4 v4, s[12:15], s52 offen offset:0 lds
  s_add_u32 s52, s54, 0xccc00
  buffer_load_dwordx4 v4, s[12:15], s52 offen offset:1024 lds
  s_add_u32 s52, s54, 0xd1800
  buffer_load_dwordx4 v4, s[12:15], s52 offen offset:2048 lds
  s_add_u32 s52, s54, 0xd6400
  buffer_load_dwordx4 v4, s[12:15], s52 offen offset:3072 lds
  s_waitcnt vmcnt(28)
  ds_read_b64_tr_b16 a[48:49], v6 offset:12288
  ds_read_b64_tr_b16 a[50:51], v6 offset:13312
  ds_read_b64_tr_b16 a[52:53], v6 offset:12296
  ds_read_b64_tr_b16 a[54:55], v6 offset:13320
  ds_read_b64_tr_b16 a[56:57], v6 offset:14336
  ds_read_b64_tr_b16 a[58:59], v6 offset:15360
  ds_read_b64_tr_b16 a[60:61], v6 offset:14344
  ds_read_b64_tr_b16 a[62:63], v6 offset:15368
  s_waitcnt lgkmcnt(0)
  s_add_u32 m0, s35, 12288
  s_add_u32 s52, s54, 0xdc000
  buffer_load_dwordx4 v4, s[12:15], s52 offen offset:0 lds
  s_add_u32 s52, s54, 0xe0c00
  buffer_load_dwordx4 v4, s[12:15], s52 offen offset:1024 lds
  s_add_u32 s52, s54, 0xe5800
  buffer_load_dwordx4 v4, s[12:15], s52 offen offset:2048 lds
  s_add_u32 s52, s54, 0xea400
  buffer_load_dwordx4 v4, s[12:15], s52 offen offset:3072 lds
  s_waitcnt vmcnt(28)
  ds_read_b64_tr_b16 a[64:65], v6 offset:16384
  ds_read_b64_tr_b16 a[66:67], v6 offset:17408
  ds_read_b64_tr_b16 a[68:69], v6 offset:16392
  ds_read_b64_tr_b16 a[70:71], v6 offset:17416
  ds_read_b64_tr_b16 a[72:73], v6 offset:18432
  ds_read_b64_tr_b16 a[74:75], v6 offset:19456
  ds_read_b64_tr_b16 a[76:77], v6 offset:18440
  ds_read_b64_tr_b16 a[78:79], v6 offset:19464
  s_waitcnt lgkmcnt(0)
  s_add_u32 m0, s35, 16384
  s_add_u32 s52, s54, 0xf0000
  buffer_load_dwordx4 v4, s[12:15], s52 offen offset:0 lds
  s_add_u32 s52, s54, 0xf4c00
  buffer_load_dwordx4 v4, s[12:15], s52 offen offset:1024 lds
  s_add_u32 s52, s54, 0xf9800
  buffer_load_dwordx4 v4, s[12:15], s52 offen offset:2048 lds
  s_add_u32 s52, s54, 0xfe400
  buffer_load_dwordx4 v4, s[12:15], s52 offen offset:3072 lds
  s_waitcnt vmcnt(28)
  ds_read_b64_tr_b16 a[80:81], v6 offset:20480
  ds_read_b64_tr_b16 a[82:83], v6 offset:21504
  ds_read_b64_tr_b16 a[84:85], v6 offset:20488
  ds_read_b64_tr_b16 a[86:87], v6 offset:21512
  ds_read_b64_tr_b16 a[88:89], v6 offset:22528
  ds_read_b64_tr_b16 a[90:91], v6 offset:23552
  ds_read_b64_tr_b16 a[92:93], v6 offset:22536
  ds_read_b64_tr_b16 a[94:95], v6 offset:23560
  s_waitcnt lgkmcnt(0)
  s_add_u32 m0, s35, 20480
  s_add_u32 s52, s54, 0x104000
  buffer_load_dwordx4 v4, s[12:15], s52 offen offset:0 lds
  s_add_u32 s52, s54, 0x108c00
  buffer_load_dwordx4 v4, s[12:15], s52 offen offset:1024 lds
  s_add_u32 s52, s54, 0x10d800
  buffer_load_dwordx4 v4, s[12:15], s52 offen offset:2048 lds
  s_add_u32 s52, s54, 0x112400
  buffer_load_dwordx4 v4, s[12:15], s52 offen offset:3072 lds
  s_waitcnt vmcnt(28)
  ds_read_b64_tr_b16 a[96:97], v6 offset:24576
  ds_read_b64_tr_b16 a[98:99], v6 offset:25600
  ds_read_b64_tr_b16 a[100:101], v6 offset:24584
  ds_read_b64_tr_b16 a[102:103], v6 offset:25608
  ds_read_b64_tr_b16 a[104:105], v6 offset:26624
  ds_read_b64_tr_b16 a[106:107], v6 offset:27648
  ds_read_b64_tr_b16 a[108:109], v6 offset:26632
  ds_read_b64_tr_b16 a[110:111], v6 offset:27656
  s_waitcnt lgkmcnt(0)
  s_add_u32 m0, s35, 24576
  s_add_u32 s52, s54, 0x118000
  buffer_load_dwordx4 v4, s[12:15], s52 offen offset:0 lds
  s_add_u32 s52, s54, 0x11cc00
  buffer_load_dwordx4 v4, s[12:15], s52 offen offset:1024 lds
  s_add_u32 s52, s54, 0x121800
  buffer_load_dwordx4 v4, s[12:15], s52 offen offset:2048 lds
  s_add_u32 s52, s54, 0x126400
  buffer_load_dwordx4 v4, s[12:15], s52 offen offset:3072 lds
  s_waitcnt vmcnt(28)
  ds_read_b64_tr_b16 a[112:113], v6 offset:28672
  ds_read_b64_tr_b16 a[114:115], v6 offset:29696
  ds_read_b64_tr_b16 a[116:117], v6 offset:28680
  ds_read_b64_tr_b16 a[118:119], v6 offset:29704
  ds_read_b64_tr_b16 a[120:121], v6 offset:30720
  ds_read_b64_tr_b16 a[122:123], v6 offset:31744
  ds_read_b64_tr_b16 a[124:125], v6 offset:30728
  ds_read_b64_tr_b16 a[126:127], v6 offset:31752
  s_waitcnt lgkmcnt(0)
  s_add_u32 m0, s35, 28672
  s_add_u32 s52, s54, 0x12c000
  buffer_load_dwordx4 v4, s[12:15], s52 offen offset:0 lds
  s_add_u32 s52, s54, 0x130c00
  buffer_load_dwordx4 v4, s[12:15], s52 offen offset:1024 lds
  s_add_u32 s52, s54, 0x135800
  buffer_load_dwordx4 v4, s[12:15], s52 offen offset:2048 lds
  s_add_u32 s52, s54, 0x13a400
  buffer_load_dwordx4 v4, s[12:15], s52 offen offset:3072 lds
  s_waitcnt vmcnt(28)
  ds_read_b64_tr_b16 a[128:129], v6 offset:0
  ds_read_b64_tr_b16 a[130:131], v6 offset:1024
  ds_read_b64_tr_b16 a[132:133], v6 offset:8
  ds_read_b64_tr_b16 a[134:135], v6 offset:1032
  ds_read_b64_tr_b16 a[136:137], v6 offset:2048
  ds_read_b64_tr_b16 a[138:139], v6 offset:3072
  ds_read_b64_tr_b16 a[140:141], v6 offset:2056
  ds_read_b64_tr_b16 a[142:143], v6 offset:3080
  s_waitcnt vmcnt(24) lgkmcnt(0)
  ds_read_b64_tr_b16 a[144:145], v6 offset:4096
  ds_read_b64_tr_b16 a[146:147], v6 offset:5120
  ds_read_b64_tr_b16 a[148:149], v6 offset:4104
  ds_read_b64_tr_b16 a[150:151], v6 offset:5128
  ds_read_b64_tr_b16 a[152:153], v6 offset:6144
  ds_read_b64_tr_b16 a[154:155], v6 offset:7168
  ds_read_b64_tr_b16 a[156:157], v6 offset:6152
  ds_read_b64_tr_b16 a[158:159], v6 offset:7176
  s_waitcnt vmcnt(20) lgkmcnt(0)
  ds_read_b64_tr_b16 a[160:161], v6 offset:8192
  ds_read_b64_tr_b16 a[162:163], v6 offset:9216
  ds_read_b64_tr_b16 a[164:165], v6 offset:8200
  ds_read_b64_tr_b16 a[166:167], v6 offset:9224
  ds_read_b64_tr_b16 a[168:169], v6 offset:10240
  ds_read_b64_tr_b16 a[170:171], v6 offset:11264
  ds_read_b64_tr_b16 a[172:173], v6 offset:10248
  ds_read_b64_tr_b16 a[174:175], v6 offset:11272
  s_waitcnt vmcnt(16) lgkmcnt(0)
  ds_read_b64_tr_b16 a[176:177], v6 offset:12288
  ds_read_b64_tr_b16 a[178:179], v6 offset:13312
  ds_read_b64_tr_b16 a[180:181], v6 offset:12296
  ds_read_b64_tr_b16 a[182:183], v6 offset:13320
  ds_read_b64_tr_b16 a[184:185], v6 offset:14336
  ds_read_b64_tr_b16 a[186:187], v6 offset:15360
  ds_read_b64_tr_b16 a[188:189], v6 offset:14344
  ds_read_b64_tr_b16 a[190:191], v6 offset:15368
  s_waitcnt vmcnt(12) lgkmcnt(0)
  ds_read_b64_tr_b16 a[192:193], v6 offset:16384
  ds_read_b64_tr_b16 a[194:195], v6 offset:17408
  ds_read_b64_tr_b16 a[196:197], v6 offset:16392
  ds_read_b64_tr_b16 a[198:199], v6 offset:17416
  ds_read_b64_tr_b16 a[200:201], v6 offset:18432
  ds_read_b64_tr_b16 a[202:203], v6 offset:19456
  ds_read_b64_tr_b16 a[204:205], v6 offset:18440
  ds_read_b64_tr_b16 a[206:207], v6 offset:19464
  s_waitcnt vmcnt(8) lgkmcnt(0)
  ds_read_b64_tr_b16 a[208:209], v6 offset:20480
  ds_read_b64_tr_b16 a[210:211], v6 offset:21504
  ds_read_b64_tr_b16 a[212:213], v6 offset:20488
  ds_read_b64_tr_b16 a[214:215], v6 offset:21512
  ds_read_b64_tr_b16 a[216:217], v6 offset:22528
  ds_read_b64_tr_b16 a[218:219], v6 offset:23552
  ds_read_b64_tr_b16 a[220:221], v6 offset:22536
  ds_read_b64_tr_b16 a[222:223], v6 offset:23560
  s_waitcnt vmcnt(4) lgkmcnt(0)
  ds_read_b64_tr_b16 a[224:225], v6 offset:24576
  ds_read_b64_tr_b16 a[226:227], v6 offset:25600
  ds_read_b64_tr_b16 a[228:229], v6 offset:24584
  ds_read_b64_tr_b16 a[230:231], v6 offset:25608
  ds_read_b64_tr_b16 a[232:233], v6 offset:26624
  ds_read_b64_tr_b16 a[234:235], v6 offset:27648
  ds_read_b64_tr_b16 a[236:237], v6 offset:26632
  ds_read_b64_tr_b16 a[238:239], v6 offset:27656
  s_waitcnt vmcnt(0) lgkmcnt(0)
  ds_read_b64_tr_b16 a[240:241], v6 offset:28672
  ds_read_b64_tr_b16 a[242:243], v6 offset:29696
  ds_read_b64_tr_b16 a[244:245], v6 offset:28680
  ds_read_b64_tr_b16 a[246:247], v6 offset:29704
  ds_read_b64_tr_b16 a[248:249], v6 offset:30720
  ds_read_b64_tr_b16 a[250:251], v6 offset:31744
  ds_read_b64_tr_b16 a[252:253], v6 offset:30728
  ds_read_b64_tr_b16 a[254:255], v6 offset:31752
  s_waitcnt lgkmcnt(0)
  v_and_b32 v7, 1, v0
  s_lshl_b32 s52, s28, 6
  v_lshl_add_u32 v7, v7, 5, s52
  v_and_b32 v8, 15, v0
  v_mul_u32_u24 v8, 2560, v8
  v_lshrrev_b32 v9, 4, v0
  v_lshl_add_u32 v8, v9, 4, v8
  s_lshl_b32 s52, s30, 6
  s_add_u32 s52, s52, 1280
  v_add_u32 v8, s52, v8
  s_lshl_b32 s52, s28, 11
  v_add_u32 v9, s52, v1
  s_sub_u32 s33, s29, 2
  s_barrier
  s_mov_b64 s[44:45], -1
L_b3loop_38:
  s_lshr_b32 s52, s33, 1
  s_lshl_b32 s52, s52, 8
  s_add_u32 s52, s52, 0x4c04000
  s_lshl_b32 s54, s33, 17
  s_lshl_b32 s53, s28, 15
  s_add_u32 s54, s54, s53
  s_add_u32 s54, s54, 0x3000000
  s_mov_b32 s51, 0
  s_branch L_pollf_42
L_poll_41:
  s_sleep 1
L_pollf_42:
  buffer_load_dword v2, v7, s[4:7], s52 offen sc1
  s_add_u32 s51, s51, 1
  s_cmp_gt_u32 s51, 131072
  s_cbranch_scc1 L_end
  s_waitcnt vmcnt(0)
  v_cmp_eq_u32 vcc, 0, v2
  s_nop 0
  s_cbranch_vccnz L_poll_41
  buffer_load_dwordx4 v[16:19], v1, s[4:7], s54 offen offset:0 sc1
  buffer_load_dwordx4 v[20:23], v1, s[4:7], s54 offen offset:1024 sc1
  buffer_load_dwordx4 v[24:27], v1, s[4:7], s54 offen offset:2048 sc1
  buffer_load_dwordx4 v[28:31], v1, s[4:7], s54 offen offset:3072 sc1
  s_add_u32 s54, s54, 4096
  buffer_load_dwordx4 v[32:35], v1, s[4:7], s54 offen offset:0 sc1
  buffer_load_dwordx4 v[36:39], v1, s[4:7], s54 offen offset:1024 sc1
  buffer_load_dwordx4 v[40:43], v1, s[4:7], s54 offen offset:2048 sc1
  buffer_load_dwordx4 v[44:47], v1, s[4:7], s54 offen offset:3072 sc1
  s_add_u32 s54, s54, 4096
  buffer_load_dwordx4 v[48:51], v1, s[4:7], s54 offen offset:0 sc1
  buffer_load_dwordx4 v[52:55], v1, s[4:7], s54 offen offset:1024 sc1
  buffer_load_dwordx4 v[56:59], v1, s[4:7], s54 offen offset:2048 sc1
  buffer_load_dwordx4 v[60:63], v1, s[4:7], s54 offen offset:3072 sc1
  s_add_u32 s54, s54, 4096
  buffer_load_dwordx4 v[64:67], v1, s[4:7], s54 offen offset:0 sc1
  buffer_load_dwordx4 v[68:71], v1, s[4:7], s54 offen offset:1024 sc1
  buffer_load_dwordx4 v[72:75], v1, s[4:7], s54 offen offset:2048 sc1
  buffer_load_dwordx4 v[76:79], v1, s[4:7], s54 offen offset:3072 sc1
  s_add_u32 s54, s54, 4096
  buffer_load_dwordx4 v[80:83], v1, s[4:7], s54 offen offset:0 sc1
  buffer_load_dwordx4 v[84:87], v1, s[4:7], s54 offen offset:1024 sc1
  buffer_load_dwordx4 v[88:91], v1, s[4:7], s54 offen offset:2048 sc1
  buffer_load_dwordx4 v[92:95], v1, s[4:7], s54 offen offset:3072 sc1
  s_add_u32 s54, s54, 4096
  buffer_load_dwordx4 v[96:99], v1, s[4:7], s54 offen offset:0 sc1
  buffer_load_dwordx4 v[100:103], v1, s[4:7], s54 offen offset:1024 sc1
  buffer_load_dwordx4 v[104:107], v1, s[4:7], s54 offen offset:2048 sc1
  buffer_load_dwordx4 v[108:111], v1, s[4:7], s54 offen offset:3072 sc1
  s_add_u32 s54, s54, 4096
  buffer_load_dwordx4 v[112:115], v1, s[4:7], s54 offen offset:0 sc1
  buffer_load_dwordx4 v[116:119], v1, s[4:7], s54 offen offset:1024 sc1
  buffer_load_dwordx4 v[120:123], v1, s[4:7], s54 offen offset:2048 sc1
  buffer_load_dwordx4 v[124:127], v1, s[4:7], s54 offen offset:3072 sc1
  s_add_u32 s54, s54, 4096
  buffer_load_dwordx4 v[128:131], v1, s[4:7], s54 offen offset:0 sc1
  buffer_load_dwordx4 v[132:135], v1, s[4:7], s54 offen offset:1024 sc1
  buffer_load_dwordx4 v[136:139], v1, s[4:7], s54 offen offset:2048 sc1
  buffer_load_dwordx4 v[140:143], v1, s[4:7], s54 offen offset:3072 sc1
  s_add_u32 s54, s54, 4096
  s_waitcnt vmcnt(31)
  v_mfma_f32_16x16x32_bf16 v[144:147], a[0:3], v[16:19], 0
  v_mfma_f32_16x16x32_bf16 v[148:151], a[4:7], v[16:19], 0
  s_waitcnt vmcnt(30)
  v_mfma_f32_16x16x32_bf16 v[144:147], a[8:11], v[20:23], v[144:147]
  v_mfma_f32_16x16x32_bf16 v[148:151], a[12:15], v[20:23], v[148:151]
  s_waitcnt vmcnt(29)
  v_mfma_f32_16x16x32_bf16 v[144:147], a[16:19], v[24:27], v[144:147]
  v_mfma_f32_16x16x32_bf16 v[148:151], a[20:23], v[24:27], v[148:151]
  s_waitcnt vmcnt(28)
  v_mfma_f32_16x16x32_bf16 v[144:147], a[24:27], v[28:31], v[144:147]
  v_mfma_f32_16x16x32_bf16 v[148:151], a[28:31], v[28:31], v[148:151]
  s_waitcnt vmcnt(27)
  v_mfma_f32_16x16x32_bf16 v[144:147], a[32:35], v[32:35], v[144:147]
  v_mfma_f32_16x16x32_bf16 v[148:151], a[36:39], v[32:35], v[148:151]
  s_waitcnt vmcnt(26)
  v_mfma_f32_16x16x32_bf16 v[144:147], a[40:43], v[36:39], v[144:147]
  v_mfma_f32_16x16x32_bf16 v[148:151], a[44:47], v[36:39], v[148:151]
  s_waitcnt vmcnt(25)
  v_mfma_f32_16x16x32_bf16 v[144:147], a[48:51], v[40:43], v[144:147]
  v_mfma_f32_16x16x32_bf16 v[148:151], a[52:55], v[40:43], v[148:151]
  s_waitcnt vmcnt(24)
  v_mfma_f32_16x16x32_bf16 v[144:147], a[56:59], v[44:47], v[144:147]
  v_mfma_f32_16x16x32_bf16 v[148:151], a[60:63], v[44:47], v[148:151]
  s_waitcnt vmcnt(23)
  v_mfma_f32_16x16x32_bf16 v[144:147], a[64:67], v[48:51], v[144:147]
  v_mfma_f32_16x16x32_bf16 v[148:151], a[68:71], v[48:51], v[148:151]
  s_waitcnt vmcnt(22)
  v_mfma_f32_16x16x32_bf16 v[144:147], a[72:75], v[52:55], v[144:147]
  v_mfma_f32_16x16x32_bf16 v[148:151], a[76:79], v[52:55], v[148:151]
  s_waitcnt vmcnt(21)
  v_mfma_f32_16x16x32_bf16 v[144:147], a[80:83], v[56:59], v[144:147]
  v_mfma_f32_16x16x32_bf16 v[148:151], a[84:87], v[56:59], v[148:151]
  s_waitcnt vmcnt(20)
  v_mfma_f32_16x16x32_bf16 v[144:147], a[88:91], v[60:63], v[144:147]
  v_mfma_f32_16x16x32_bf16 v[148:151], a[92:95], v[60:63], v[148:151]
  s_waitcnt vmcnt(19)
  v_mfma_f32_16x16x32_bf16 v[144:147], a[96:99], v[64:67], v[144:147]
  v_mfma_f32_16x16x32_bf16 v[148:151], a[100:103], v[64:67], v[148:151]
  s_waitcnt vmcnt(18)
  v_mfma_f32_16x16x32_bf16 v[144:147], a[104:107], v[68:71], v[144:147]
  v_mfma_f32_16x16x32_bf16 v[148:151], a[108:111], v[68:71], v[148:151]
  s_waitcnt vmcnt(17)
  v_mfma_f32_16x16x32_bf16 v[144:147], a[112:115], v[72:75], v[144:147]
  v_mfma_f32_16x16x32_bf16 v[148:151], a[116:119], v[72:75], v[148:151]
  s_waitcnt vmcnt(16)
  v_mfma_f32_16x16x32_bf16 v[144:147], a[120:123], v[76:79], v[144:147]
  v_mfma_f32_16x16x32_bf16 v[148:151], a[124:127], v[76:79], v[148:151]
  s_waitcnt vmcnt(15)
  v_mfma_f32_16x16x32_bf16 v[144:147], a[128:131], v[80:83], v[144:147]
  v_mfma_f32_16x16x32_bf16 v[148:151], a[132:135], v[80:83], v[148:151]
  s_waitcnt vmcnt(14)
  v_mfma_f32_16x16x32_bf16 v[144:147], a[136:139], v[84:87], v[144:147]
  v_mfma_f32_16x16x32_bf16 v[148:151], a[140:143], v[84:87], v[148:151]
  s_waitcnt vmcnt(13)
  v_mfma_f32_16x16x32_bf16 v[144:147], a[144:147], v[88:91], v[144:147]
  v_mfma_f32_16x16x32_bf16 v[148:151], a[148:151], v[88:91], v[148:151]
  s_waitcnt vmcnt(12)
  v_mfma_f32_16x16x32_bf16 v[144:147], a[152:155], v[92:95], v[144:147]
  v_mfma_f32_16x16x32_bf16 v[148:151], a[156:159], v[92:95], v[148:151]
  s_waitcnt vmcnt(11)
  v_mfma_f32_16x16x32_bf16 v[144:147], a[160:163], v[96:99], v[144:147]
  v_mfma_f32_16x16x32_bf16 v[148:151], a[164:167], v[96:99], v[148:151]
  s_waitcnt vmcnt(10)
  v_mfma_f32_16x16x32_bf16 v[144:147], a[168:171], v[100:103], v[144:147]
  v_mfma_f32_16x16x32_bf16 v[148:151], a[172:175], v[100:103], v[148:151]
  s_waitcnt vmcnt(9)
  v_mfma_f32_16x16x32_bf16 v[144:147], a[176:179], v[104:107], v[144:147]
  v_mfma_f32_16x16x32_bf16 v[148:151], a[180:183], v[104:107], v[148:151]
  s_waitcnt vmcnt(8)
  v_mfma_f32_16x16x32_bf16 v[144:147], a[184:187], v[108:111], v[144:147]
  v_mfma_f32_16x16x32_bf16 v[148:151], a[188:191], v[108:111], v[148:151]
  s_waitcnt vmcnt(7)
  v_mfma_f32_16x16x32_bf16 v[144:147], a[192:195], v[112:115], v[144:147]
  v_mfma_f32_16x16x32_bf16 v[148:151], a[196:199], v[112:115], v[148:151]
  s_waitcnt vmcnt(6)
  v_mfma_f32_16x16x32_bf16 v[144:147], a[200:203], v[116:119], v[144:147]
  v_mfma_f32_16x16x32_bf16 v[148:151], a[204:207], v[116:119], v[148:151]
  s_waitcnt vmcnt(5)
  v_mfma_f32_16x16x32_bf16 v[144:147], a[208:211], v[120:123], v[144:147]
  v_mfma_f32_16x16x32_bf16 v[148:151], a[212:215], v[120:123], v[148:151]
  s_waitcnt vmcnt(4)
  v_mfma_f32_16x16x32_bf16 v[144:147], a[216:219], v[124:127], v[144:147]
  v_mfma_f32_16x16x32_bf16 v[148:151], a[220:223], v[124:127], v[148:151]
  s_waitcnt vmcnt(3)
  v_mfma_f32_16x16x32_bf16 v[144:147], a[224:227], v[128:131], v[144:147]
  v_mfma_f32_16x16x32_bf16 v[148:151], a[228:231], v[128:131], v[148:151]
  s_waitcnt vmcnt(2)
  v_mfma_f32_16x16x32_bf16 v[144:147], a[232:235], v[132:135], v[144:147]
  v_mfma_f32_16x16x32_bf16 v[148:151], a[236:239], v[132:135], v[148:151]
  s_waitcnt vmcnt(1)
  v_mfma_f32_16x16x32_bf16 v[144:147], a[240:243], v[136:139], v[144:147]
  v_mfma_f32_16x16x32_bf16 v[148:151], a[244:247], v[136:139], v[148:151]
  s_waitcnt vmcnt(0)
  v_mfma_f32_16x16x32_bf16 v[144:147], a[248:251], v[140:143], v[144:147]
  v_mfma_f32_16x16x32_bf16 v[148:151], a[252:255], v[140:143], v[148:151]
  s_nop 7
L_b3red_40:
  s_mul_i32 s52, s33, 40960
  s_cmp_eq_u32 s28, 0
  s_cbranch_scc1 L_b3w0_43
  ds_write_b128 v9, v[144:147]
  ds_write_b128 v9, v[148:151] offset:1024
  s_waitcnt lgkmcnt(0)
  s_barrier
  s_branch L_b3nx_44
L_b3w0_43:
  s_barrier
  ds_read_b128 v[16:19], v9 offset:2048
  ds_read_b128 v[20:23], v9 offset:3072
  ds_read_b128 v[24:27], v9 offset:4096
  ds_read_b128 v[28:31], v9 offset:5120
  ds_read_b128 v[32:35], v9 offset:6144
  ds_read_b128 v[36:39], v9 offset:7168
  s_waitcnt lgkmcnt(4)
  v_add_f32 v144, v144, v16
  v_add_f32 v145, v145, v17
  v_add_f32 v146, v146, v18
  v_add_f32 v147, v147, v19
  v_add_f32 v148, v148, v20
  v_add_f32 v149, v149, v21
  v_add_f32 v150, v150, v22
  v_add_f32 v151, v151, v23
  s_waitcnt lgkmcnt(2)
  v_add_f32 v144, v144, v24
  v_add_f32 v145, v145, v25
  v_add_f32 v146, v146, v26
  v_add_f32 v147, v147, v27
  v_add_f32 v148, v148, v28
  v_add_f32 v149, v149, v29
  v_add_f32 v150, v150, v30
  v_add_f32 v151, v151, v31
  s_waitcnt lgkmcnt(0)
  v_add_f32 v144, v144, v32
  v_add_f32 v145, v145, v33
  v_add_f32 v146, v146, v34
  v_add_f32 v147, v147, v35
  v_add_f32 v148, v148, v36
  v_add_f32 v149, v149, v37
  v_add_f32 v150, v150, v38
  v_add_f32 v151, v151, v39
  v_cvt_pk_bf16_f32 v144, v144, v145
  v_cvt_pk_bf16_f32 v145, v146, v147
  v_cvt_pk_bf16_f32 v146, v148, v149
  v_cvt_pk_bf16_f32 v147, v150, v151
  s_mov_b64 exec, s[44:45]
  buffer_store_dwordx4 v[144:147], v8, s[16:19], s52 offen
  s_mov_b64 exec, -1
L_b3nx_44:
  v_xor_b32 v9, 0x2000, v9
  s_cmp_ge_u32 s33, 126
  s_cbranch_scc1 L_b3fin_45
  s_add_u32 s33, s33, 2
  s_cmp_lg_u32 s44, -1
  s_cbranch_scc1 L_b3q_39
  s_add_u32 s33, s33, 2
  s_cmp_lt_u32 s33, 124
  s_cbranch_scc1 L_b3loop_38
  s_sub_u32 s52, s29, 2
  s_lshr_b32 s33, s52, 1
  s_add_u32 s33, s33, 124
  s_and_b32 s52, s52, 1
  s_mov_b32 s44, 0x00ff00ff
  s_cmp_eq_u32 s52, 1
  s_cselect_b32 s44, 0xff00ff00, s44
  s_mov_b32 s45, s44
  s_lshl_b32 s52, s52, 7
  v_and_b32 v10, 0x370, v1
  v_add_u32 v10, s52, v10
  v_bfe_u32 v11, v0, 3, 1
  v_lshl_add_u32 v10, v11, 10, v10
L_b3q_39:
  s_lshr_b32 s52, s33, 1
  s_lshl_b32 s52, s52, 8
  s_add_u32 s52, s52, 0x4c04000
  s_lshl_b32 s54, s33, 17
  s_lshl_b32 s53, s28, 15
  s_add_u32 s54, s54, s53
  s_add_u32 s54, s54, 0x3000000
  s_mov_b32 s51, 0
  s_branch L_pollf_47
L_poll_46:
  s_sleep 1
L_pollf_47:
  buffer_load_dword v2, v7, s[4:7], s52 offen sc1
  s_add_u32 s51, s51, 1
  s_cmp_gt_u32 s51, 131072
  s_cbranch_scc1 L_end
  s_waitcnt vmcnt(0)
  v_cmp_eq_u32 vcc, 0, v2
  s_nop 0
  s_cbranch_vccnz L_poll_46
  buffer_load_dwordx4 v[16:19], v10, s[4:7], s54 offen offset:0 sc1
  buffer_load_dwordx4 v[20:23], v10, s[4:7], s54 offen offset:2048 sc1
  s_add_u32 s54, s54, 4096
  buffer_load_dwordx4 v[24:27], v10, s[4:7], s54 offen offset:0 sc1
  buffer_load_dwordx4 v[28:31], v10, s[4:7], s54 offen offset:2048 sc1
  s_add_u32 s54, s54, 4096
  buffer_load_dwordx4 v[32:35], v10, s[4:7], s54 offen offset:0 sc1
  buffer_load_dwordx4 v[36:39], v10, s[4:7], s54 offen offset:2048 sc1
  s_add_u32 s54, s54, 4096
  buffer_load_dwordx4 v[40:43], v10, s[4:7], s54 offen offset:0 sc1
  buffer_load_dwordx4 v[44:47], v10, s[4:7], s54 offen offset:2048 sc1
  s_add_u32 s54, s54, 4096
  buffer_load_dwordx4 v[48:51], v10, s[4:7], s54 offen offset:0 sc1
  buffer_load_dwordx4 v[52:55], v10, s[4:7], s54 offen offset:2048 sc1
  s_add_u32 s54, s54, 4096
  buffer_load_dwordx4 v[56:59], v10, s[4:7], s54 offen offset:0 sc1
  buffer_load_dwordx4 v[60:63], v10, s[4:7], s54 offen offset:2048 sc1
  s_add_u32 s54, s54, 4096
  buffer_load_dwordx4 v[64:67], v10, s[4:7], s54 offen offset:0 sc1
  buffer_load_dwordx4 v[68:71], v10, s[4:7], s54 offen offset:2048 sc1
  s_add_u32 s54, s54, 4096
  buffer_load_dwordx4 v[72:75], v10, s[4:7], s54 offen offset:0 sc1
  buffer_load_dwordx4 v[76:79], v10, s[4:7], s54 offen offset:2048 sc1
  s_add_u32 s54, s54, 4096
  s_waitcnt vmcnt(15)
  v_mfma_f32_16x16x32_bf16 v[144:147], a[0:3], v[16:19], 0
  v_mfma_f32_16x16x32_bf16 v[148:151], a[4:7], v[16:19], 0
  v_mfma_f32_16x16x32_bf16 v[152:155], a[8:11], v[16:19], 0
  v_mfma_f32_16x16x32_bf16 v[156:159], a[12:15], v[16:19], 0
  s_waitcnt vmcnt(14)
  v_mfma_f32_16x16x32_bf16 v[144:147], a[16:19], v[20:23], v[144:147]
  v_mfma_f32_16x16x32_bf16 v[148:151], a[20:23], v[20:23], v[148:151]
  v_mfma_f32_16x16x32_bf16 v[152:155], a[24:27], v[20:23], v[152:155]
  v_mfma_f32_16x16x32_bf16 v[156:159], a[28:31], v[20:23], v[156:159]
  s_waitcnt vmcnt(13)
  v_mfma_f32_16x16x32_bf16 v[144:147], a[32:35], v[24:27], v[144:147]
  v_mfma_f32_16x16x32_bf16 v[148:151], a[36:39], v[24:27], v[148:151]
  v_mfma_f32_16x16x32_bf16 v[152:155], a[40:43], v[24:27], v[152:155]
  v_mfma_f32_16x16x32_bf16 v[156:159], a[44:47], v[24:27], v[156:159]
  s_waitcnt vmcnt(12)
  v_mfma_f32_16x16x32_bf16 v[144:147], a[48:51], v[28:31], v[144:147]
  v_mfma_f32_16x16x32_bf16 v[148:151], a[52:55], v[28:31], v[148:151]
  v_mfma_f32_16x16x32_bf16 v[152:155], a[56:59], v[28:31], v[152:155]
  v_mfma_f32_16x16x32_bf16 v[156:159], a[60:63], v[28:31], v[156:159]
  s_waitcnt vmcnt(11)
  v_mfma_f32_16x16x32_bf16 v[144:147], a[64:67], v[32:35], v[144:147]
  v_mfma_f32_16x16x32_bf16 v[148:151], a[68:71], v[32:35], v[148:151]
  v_mfma_f32_16x16x32_bf16 v[152:155], a[72:75], v[32:35], v[152:155]
  v_mfma_f32_16x16x32_bf16 v[156:159], a[76:79], v[32:35], v[156:159]
  s_waitcnt vmcnt(10)
  v_mfma_f32_16x16x32_bf16 v[144:147], a[80:83], v[36:39], v[144:147]
  v_mfma_f32_16x16x32_bf16 v[148:151], a[84:87], v[36:39], v[148:151]
  v_mfma_f32_16x16x32_bf16 v[152:155], a[88:91], v[36:39], v[152:155]
  v_mfma_f32_16x16x32_bf16 v[156:159], a[92:95], v[36:39], v[156:159]
  s_waitcnt vmcnt(9)
  v_mfma_f32_16x16x32_bf16 v[144:147], a[96:99], v[40:43], v[144:147]
  v_mfma_f32_16x16x32_bf16 v[148:151], a[100:103], v[40:43], v[148:151]
  v_mfma_f32_16x16x32_bf16 v[152:155], a[104:107], v[40:43], v[152:155]
  v_mfma_f32_16x16x32_bf16 v[156:159], a[108:111], v[40:43], v[156:159]
  s_waitcnt vmcnt(8)
  v_mfma_f32_16x16x32_bf16 v[144:147], a[112:115], v[44:47], v[144:147]
  v_mfma_f32_16x16x32_bf16 v[148:151], a[116:119], v[44:47], v[148:151]
  v_mfma_f32_16x16x32_bf16 v[152:155], a[120:123], v[44:47], v[152:155]
  v_mfma_f32_16x16x32_bf16 v[156:159], a[124:127], v[44:47], v[156:159]
  s_waitcnt vmcnt(7)
  v_mfma_f32_16x16x32_bf16 v[144:147], a[128:131], v[48:51], v[144:147]
  v_mfma_f32_16x16x32_bf16 v[148:151], a[132:135], v[48:51], v[148:151]
  v_mfma_f32_16x16x32_bf16 v[152:155], a[136:139], v[48:51], v[152:155]
  v_mfma_f32_16x16x32_bf16 v[156:159], a[140:143], v[48:51], v[156:159]
  s_waitcnt vmcnt(6)
  v_mfma_f32_16x16x32_bf16 v[144:147], a[144:147], v[52:55], v[144:147]
  v_mfma_f32_16x16x32_bf16 v[148:151], a[148:151], v[52:55], v[148:151]
  v_mfma_f32_16x16x32_bf16 v[152:155], a[152:155], v[52:55], v[152:155]
  v_mfma_f32_16x16x32_bf16 v[156:159], a[156:159], v[52:55], v[156:159]
  s_waitcnt vmcnt(5)
  v_mfma_f32_16x16x32_bf16 v[144:147], a[160:163], v[56:59], v[144:147]
  v_mfma_f32_16x16x32_bf16 v[148:151], a[164:167], v[56:59], v[148:151]
  v_mfma_f32_16x16x32_bf16 v[152:155], a[168:171], v[56:59], v[152:155]
  v_mfma_f32_16x16x32_bf16 v[156:159], a[172:175], v[56:59], v[156:159]
  s_waitcnt vmcnt(4)
  v_mfma_f32_16x16x32_bf16 v[144:147], a[176:179], v[60:63], v[144:147]
  v_mfma_f32_16x16x32_bf16 v[148:151], a[180:183], v[60:63], v[148:151]
  v_mfma_f32_16x16x32_bf16 v[152:155], a[184:187], v[60:63], v[152:155]
  v_mfma_f32_16x16x32_bf16 v[156:159], a[188:191], v[60:63], v[156:159]
  s_waitcnt vmcnt(3)
  v_mfma_f32_16x16x32_bf16 v[144:147], a[192:195], v[64:67], v[144:147]
  v_mfma_f32_16x16x32_bf16 v[148:151], a[196:199], v[64:67], v[148:151]
  v_mfma_f32_16x16x32_bf16 v[152:155], a[200:203], v[64:67], v[152:155]
  v_mfma_f32_16x16x32_bf16 v[156:159], a[204:207], v[64:67], v[156:159]
  s_waitcnt vmcnt(2)
  v_mfma_f32_16x16x32_bf16 v[144:147], a[208:211], v[68:71], v[144:147]
  v_mfma_f32_16x16x32_bf16 v[148:151], a[212:215], v[68:71], v[148:151]
  v_mfma_f32_16x16x32_bf16 v[152:155], a[216:219], v[68:71], v[152:155]
  v_mfma_f32_16x16x32_bf16 v[156:159], a[220:223], v[68:71], v[156:159]
  s_waitcnt vmcnt(1)
  v_mfma_f32_16x16x32_bf16 v[144:147], a[224:227], v[72:75], v[144:147]
  v_mfma_f32_16x16x32_bf16 v[148:151], a[228:231], v[72:75], v[148:151]
  v_mfma_f32_16x16x32_bf16 v[152:155], a[232:235], v[72:75], v[152:155]
  v_mfma_f32_16x16x32_bf16 v[156:159], a[236:239], v[72:75], v[156:159]
  s_waitcnt vmcnt(0)
  v_mfma_f32_16x16x32_bf16 v[144:147], a[240:243], v[76:79], v[144:147]
  v_mfma_f32_16x16x32_bf16 v[148:151], a[244:247], v[76:79], v[148:151]
  v_mfma_f32_16x16x32_bf16 v[152:155], a[248:251], v[76:79], v[152:155]
  v_mfma_f32_16x16x32_bf16 v[156:159], a[252:255], v[76:79], v[156:159]
  s_mov_b32 s46, 0xff00ff00
  s_mov_b32 s47, 0xff00ff00
  s_nop 1
  v_cndmask_b32 v144, v144, v152, s[46:47]
  v_cndmask_b32 v145, v145, v153, s[46:47]
  v_cndmask_b32 v146, v146, v154, s[46:47]
  v_cndmask_b32 v147, v147, v155, s[46:47]
  v_cndmask_b32 v148, v148, v156, s[46:47]
  v_cndmask_b32 v149, v149, v157, s[46:47]
  v_cndmask_b32 v150, v150, v158, s[46:47]
  v_cndmask_b32 v151, v151, v159, s[46:47]
  v_add_f32_dpp v144, v144, v144 row_ror:8 row_mask:0xf bank_mask:0xf
  v_add_f32_dpp v145, v145, v145 row_ror:8 row_mask:0xf bank_mask:0xf
  v_add_f32_dpp v146, v146, v146 row_ror:8 row_mask:0xf bank_mask:0xf
  v_add_f32_dpp v147, v147, v147 row_ror:8 row_mask:0xf bank_mask:0xf
  v_add_f32_dpp v148, v148, v148 row_ror:8 row_mask:0xf bank_mask:0xf
  v_add_f32_dpp v149, v149, v149 row_ror:8 row_mask:0xf bank_mask:0xf
  v_add_f32_dpp v150, v150, v150 row_ror:8 row_mask:0xf bank_mask:0xf
  v_add_f32_dpp v151, v151, v151 row_ror:8 row_mask:0xf bank_mask:0xf
  s_branch L_b3red_40
L_b3fin_45:
  s_branch L_end
L_b2:
  s_sub_u32 s52, s29, 2
  s_mul_i32 s52, s52, 12
  s_add_u32 s52, s52, s30
  s_sub_u32 s52, s52, 20
  s_and_b32 s35, s52, 7
  s_lshr_b32 s33, s52, 3
  s_lshl_b32 s34, s35, 2
  s_add_u32 s34, s34, s28
  s_mov_b32 s36, 0x3e0293ee
  v_lshlrev_b32 v1, 4, v0
  v_lshrrev_b32 v4, 4, v0
  v_bfe_u32 v6, v0, 2, 2
  v_and_b32 v5, 1, v0
  v_lshl_add_u32 v5, v6, 1, v5
  v_lshl_add_u32 v5, v4, 3, v5
  v_lshlrev_b32 v5, 4, v5
  v_lshlrev_b32 v6, 3, v0
  v_and_b32 v7, 1, v0
  v_lshlrev_b32 v7, 12, v7
  v_and_b32 v8, 15, v0
  v_lshl_add_u32 v9, v4, 2, 0
  v_cmp_le_u32 s[56:57], v9, v8
  v_lshl_add_u32 v9, v4, 2, 1
  v_cmp_le_u32 s[58:59], v9, v8
  v_lshl_add_u32 v9, v4, 2, 2
  v_cmp_le_u32 s[60:61], v9, v8
  v_lshl_add_u32 v9, v4, 2, 3
  v_cmp_le_u32 s[62:63], v9, v8
  v_mov_b32 v10, 0xff800000
  v_mov_b32 v172, 0x3f803f80
  v_mov_b32 v173, 0x3f803f80
  v_mov_b32 v174, 0x3f803f80
  v_mov_b32 v175, 0x3f803f80
  v_mov_b32 v158, 0
  v_mov_b32 v159, 0
  v_mov_b32 v165, 0
  v_mov_b32 v166, 0
  v_mov_b32 v169, 0
  v_mov_b32 v170, 0
L_b2loop_48:
  s_lshr_b32 s54, s33, 4
  s_add_u32 s55, s54, 36
  s_add_u32 s54, s54, 32
  s_bfe_u32 s53, s33, 0x20002
  s_lshl_b32 s53, s53, 3
  s_or_b32 s53, s53, 0x80000
  s_mov_b32 s51, 0
  s_branch L_wd_49a
L_wd_49:
  s_sleep 8
L_wd_49a:
  v_lshlrev_b32 v2, 2, v0
  buffer_load_dword v2, v2, s[8:11], 0 offen sc1
  s_add_u32 s51, s51, 1
  s_cmp_gt_u32 s51, 131072
  s_cbranch_scc1 L_end
  s_waitcnt vmcnt(0)
  v_readlane_b32 s52, v2, s54
  s_nop 0
  s_bfe_u32 s52, s52, s53
  s_cmp_lg_u32 s52, 32
  s_cbranch_scc1 L_wd_49
  v_readlane_b32 s52, v2, s55
  s_nop 0
  s_bfe_u32 s52, s52, s53
  s_cmp_lg_u32 s52, 16
  s_cbranch_scc1 L_wd_49
  s_lshl_b32 s52, s33, 5
  s_add_u32 s52, s52, s34
  s_lshl_b32 s37, s52, 12
  s_add_u32 s37, s37, 0x4000000
  s_lshl_b32 s53, s52, 13
  s_add_u32 s53, s53, 0x2000000
  s_lshl_b32 s52, s52, 14
  buffer_load_dwordx4 v[48:51], v1, s[4:7], s52 offen offset:0 sc1
  buffer_load_dwordx4 v[52:55], v1, s[4:7], s52 offen offset:1024 sc1
  buffer_load_dwordx4 v[56:59], v1, s[4:7], s52 offen offset:2048 sc1
  buffer_load_dwordx4 v[60:63], v1, s[4:7], s52 offen offset:3072 sc1
  s_add_u32 s52, s52, 4096
  buffer_load_dwordx4 v[64:67], v1, s[4:7], s52 offen offset:0 sc1
  buffer_load_dwordx4 v[68:71], v1, s[4:7], s52 offen offset:1024 sc1
  buffer_load_dwordx4 v[72:75], v1, s[4:7], s52 offen offset:2048 sc1
  buffer_load_dwordx4 v[76:79], v1, s[4:7], s52 offen offset:3072 sc1
  s_add_u32 s52, s52, 4096
  buffer_load_dwordx4 v[16:19], v1, s[4:7], s53 offen offset:0 sc1
  buffer_load_dwordx4 v[20:23], v1, s[4:7], s53 offen offset:1024 sc1
  buffer_load_dwordx4 v[24:27], v1, s[4:7], s53 offen offset:2048 sc1
  buffer_load_dwordx4 v[28:31], v1, s[4:7], s53 offen offset:3072 sc1
  s_add_u32 s53, s53, 4096
  buffer_load_dwordx4 v[32:35], v1, s[4:7], s53 offen offset:0 sc1
  buffer_load_dwordx4 v[36:39], v1, s[4:7], s53 offen offset:1024 sc1
  buffer_load_dwordx4 v[40:43], v1, s[4:7], s53 offen offset:2048 sc1
  buffer_load_dwordx4 v[44:47], v1, s[4:7], s53 offen offset:3072 sc1
  s_add_u32 s53, s53, 4096
  buffer_load_dwordx4 v[80:83], v1, s[4:7], s52 offen offset:0 sc1
  buffer_load_dwordx4 v[84:87], v1, s[4:7], s52 offen offset:1024 sc1
  buffer_load_dwordx4 v[88:91], v1, s[4:7], s52 offen offset:2048 sc1
  buffer_load_dwordx4 v[92:95], v1, s[4:7], s52 offen offset:3072 sc1
  s_add_u32 s52, s52, 4096
  buffer_load_dwordx4 v[96:99], v1, s[4:7], s52 offen offset:0 sc1
  buffer_load_dwordx4 v[100:103], v1, s[4:7], s52 offen offset:1024 sc1
  buffer_load_dwordx4 v[104:107], v1, s[4:7], s52 offen offset:2048 sc1
  buffer_load_dwordx4 v[108:111], v1, s[4:7], s52 offen offset:3072 sc1
  s_add_u32 s52, s52, 4096
  s_waitcnt vmcnt(8)
  v_mfma_f32_16x16x32_bf16 v[136:139], v[48:51], v[16:19], 0
  v_mfma_f32_16x16x32_bf16 v[136:139], v[52:55], v[20:23], v[136:139]
  v_mfma_f32_16x16x32_bf16 v[136:139], v[56:59], v[24:27], v[136:139]
  v_mfma_f32_16x16x32_bf16 v[136:139], v[60:63], v[28:31], v[136:139]
  v_mfma_f32_16x16x32_bf16 v[140:143], v[48:51], v[32:35], 0
  v_mfma_f32_16x16x32_bf16 v[140:143], v[52:55], v[36:39], v[140:143]
  v_mfma_f32_16x16x32_bf16 v[140:143], v[56:59], v[40:43], v[140:143]
  v_mfma_f32_16x16x32_bf16 v[140:143], v[60:63], v[44:47], v[140:143]
  v_mfma_f32_16x16x32_bf16 v[144:147], v[64:67], v[32:35], 0
  v_mfma_f32_16x16x32_bf16 v[144:147], v[68:71], v[36:39], v[144:147]
  v_mfma_f32_16x16x32_bf16 v[144:147], v[72:75], v[40:43], v[144:147]
  v_mfma_f32_16x16x32_bf16 v[144:147], v[76:79], v[44:47], v[144:147]
  s_lshl_b32 s52, s34, 7
  s_add_u32 s52, s52, 0x4c00000
  v_cndmask_b32 v136, v10, v136, s[56:57]
  v_cndmask_b32 v137, v10, v137, s[58:59]
  v_cndmask_b32 v138, v10, v138, s[60:61]
  v_cndmask_b32 v139, v10, v139, s[62:63]
  s_nop 1
  v_cndmask_b32 v144, v10, v144, s[56:57]
  v_cndmask_b32 v145, v10, v145, s[58:59]
  v_cndmask_b32 v146, v10, v146, s[60:61]
  v_cndmask_b32 v147, v10, v147, s[62:63]
  v_max3_f32 v11, v136, v137, v138
  v_max_f32 v11, v11, v139
  v_max3_f32 v12, v140, v141, v142
  v_max3_f32 v12, v12, v143, v144
  v_max3_f32 v12, v12, v145, v146
  v_max_f32 v12, v12, v147
  s_mov_b32 s51, 0
  s_branch L_pollf_51
L_poll_50:
  s_sleep 1
L_pollf_51:
  buffer_load_dword v2, v7, s[4:7], s52 offen sc1
  s_add_u32 s51, s51, 1
  s_cmp_gt_u32 s51, 131072
  s_cbranch_scc1 L_end
  s_waitcnt vmcnt(0)
  v_cmp_ge_u32 vcc, s33, v2
  s_nop 0
  s_cbranch_vccnz L_poll_50
  buffer_load_dwordx4 v[112:115], v5, s[4:7], s37 offen offset:0 sc1
  buffer_load_dwordx4 v[116:119], v5, s[4:7], s37 offen offset:512 sc1
  buffer_load_dwordx4 v[120:123], v5, s[4:7], s37 offen offset:1024 sc1
  buffer_load_dwordx4 v[124:127], v5, s[4:7], s37 offen offset:1536 sc1
  buffer_load_dwordx2 v[128:129], v6, s[4:7], s37 offen offset:2048 sc1
  buffer_load_dwordx2 v[130:131], v6, s[4:7], s37 offen offset:2560 sc1
  buffer_load_dwordx2 v[132:133], v6, s[4:7], s37 offen offset:3072 sc1
  buffer_load_dwordx2 v[134:135], v6, s[4:7], s37 offen offset:3584 sc1
  s_waitcnt vmcnt(7)
  v_mfma_f32_16x16x32_bf16 v[148:151], v[112:115], v[16:19], 0
  v_mfma_f32_16x16x32_bf16 v[152:155], v[112:115], v[32:35], 0
  s_waitcnt vmcnt(6)
  v_mfma_f32_16x16x32_bf16 v[148:151], v[116:119], v[20:23], v[148:151]
  v_mfma_f32_16x16x32_bf16 v[152:155], v[116:119], v[36:39], v[152:155]
  s_waitcnt vmcnt(5)
  v_mfma_f32_16x16x32_bf16 v[148:151], v[120:123], v[24:27], v[148:151]
  v_mfma_f32_16x16x32_bf16 v[152:155], v[120:123], v[40:43], v[152:155]
  s_waitcnt vmcnt(4)
  v_mfma_f32_16x16x32_bf16 v[148:151], v[124:127], v[28:31], v[148:151]
  v_mfma_f32_16x16x32_bf16 v[152:155], v[124:127], v[44:47], v[152:155]
  s_lshl_b32 s52, s33, 18
  s_lshl_b32 s53, s34, 12
  s_add_u32 s52, s52, s53
  s_add_u32 s52, s52, 0x3000000
  s_add_u32 s53, s52, 0x20000
  v_max3_f32 v11, v11, v148, v149
  s_nop 1
  v_max3_f32 v12, v12, v152, v153
  v_mov_b32 v13, v11
  v_mov_b32 v14, v12
  s_nop 0
  v_permlane32_swap_b32 v11, v13
  v_permlane32_swap_b32 v12, v14
  v_max_f32 v11, v11, v13
  v_max_f32 v12, v12, v14
  v_mov_b32 v13, v11
  v_mov_b32 v14, v12
  s_nop 0
  v_permlane16_swap_b32 v11, v13
  v_permlane16_swap_b32 v12, v14
  v_max_f32 v11, v11, v13
  v_max_f32 v12, v12, v14
  v_mul_f32 v11, s36, v11
  v_mul_f32 v12, s36, v12
  v_fma_f32 v136, v136, s36, -v11
  v_fma_f32 v137, v137, s36, -v11
  v_fma_f32 v138, v138, s36, -v11
  v_fma_f32 v139, v139, s36, -v11
  v_fma_f32 v148, v148, s36, -v11
  v_fma_f32 v149, v149, s36, -v11
  v_fma_f32 v140, v140, s36, -v12
  v_fma_f32 v141, v141, s36, -v12
  v_fma_f32 v142, v142, s36, -v12
  v_fma_f32 v143, v143, s36, -v12
  v_fma_f32 v144, v144, s36, -v12
  v_fma_f32 v145, v145, s36, -v12
  v_fma_f32 v146, v146, s36, -v12
  v_fma_f32 v147, v147, s36, -v12
  v_fma_f32 v152, v152, s36, -v12
  v_fma_f32 v153, v153, s36, -v12
  v_exp_f32 v136, v136
  v_exp_f32 v137, v137
  v_exp_f32 v138, v138
  v_exp_f32 v139, v139
  v_exp_f32 v148, v148
  v_exp_f32 v149, v149
  v_exp_f32 v140, v140
  v_exp_f32 v141, v141
  v_exp_f32 v142, v142
  v_exp_f32 v143, v143
  v_exp_f32 v144, v144
  v_exp_f32 v145, v145
  v_exp_f32 v146, v146
  v_exp_f32 v147, v147
  v_exp_f32 v152, v152
  v_exp_f32 v153, v153
  v_cvt_pk_bf16_f32 v156, v136, v137
  v_cvt_pk_bf16_f32 v157, v138, v139
  v_cvt_pk_bf16_f32 v160, v140, v141
  v_cvt_pk_bf16_f32 v161, v142, v143
  v_cvt_pk_bf16_f32 v162, v144, v145
  v_cvt_pk_bf16_f32 v163, v146, v147
  v_cvt_pk_bf16_f32 v164, v148, v149
  v_cvt_pk_bf16_f32 v167, v148, v149
  v_cvt_pk_bf16_f32 v168, v152, v153
  v_cvt_pk_bf16_f32 v171, v152, v153
  s_waitcnt vmcnt(0)
  v_mfma_f32_16x16x32_bf16 v[176:179], v[172:175], v[156:159], 0
  v_mfma_f32_16x16x32_bf16 v[184:187], v[80:83], v[156:159], 0
  v_mfma_f32_16x16x32_bf16 v[188:191], v[84:87], v[156:159], 0
  v_mfma_f32_16x16x32_bf16 v[192:195], v[88:91], v[156:159], 0
  v_mfma_f32_16x16x32_bf16 v[196:199], v[92:95], v[156:159], 0
  v_mfma_f32_16x16x32_bf16 v[200:203], v[96:99], v[156:159], 0
  v_mfma_f32_16x16x32_bf16 v[204:207], v[100:103], v[156:159], 0
  v_mfma_f32_16x16x32_bf16 v[208:211], v[104:107], v[156:159], 0
  v_mfma_f32_16x16x32_bf16 v[212:215], v[108:111], v[156:159], 0
  v_mfma_f32_16x16x16_bf16 v[176:179], v[172:173], v[164:165], v[176:179]
  v_mfma_f32_16x16x16_bf16 v[184:187], v[128:129], v[164:165], v[184:187]
  v_mfma_f32_16x16x16_bf16 v[188:191], v[130:131], v[164:165], v[188:191]
  v_mfma_f32_16x16x16_bf16 v[192:195], v[132:133], v[164:165], v[192:195]
  v_mfma_f32_16x16x16_bf16 v[196:199], v[134:135], v[164:165], v[196:199]
  v_mfma_f32_16x16x16_bf16 v[200:203], v[128:129], v[166:167], v[200:203]
  v_mfma_f32_16x16x16_bf16 v[204:207], v[130:131], v[166:167], v[204:207]
  v_mfma_f32_16x16x16_bf16 v[208:211], v[132:133], v[166:167], v[208:211]
  v_mfma_f32_16x16x16_bf16 v[212:215], v[134:135], v[166:167], v[212:215]
  v_mfma_f32_16x16x32_bf16 v[180:183], v[172:175], v[160:163], 0
  v_mfma_f32_16x16x32_bf16 v[216:219], v[80:83], v[160:163], 0
  v_mfma_f32_16x16x32_bf16 v[220:223], v[84:87], v[160:163], 0
  v_mfma_f32_16x16x32_bf16 v[224:227], v[88:91], v[160:163], 0
  v_mfma_f32_16x16x32_bf16 v[228:231], v[92:95], v[160:163], 0
  v_mfma_f32_16x16x32_bf16 v[232:235], v[96:99], v[160:163], 0
  v_mfma_f32_16x16x32_bf16 v[236:239], v[100:103], v[160:163], 0
  v_mfma_f32_16x16x32_bf16 v[240:243], v[104:107], v[160:163], 0
  v_mfma_f32_16x16x32_bf16 v[244:247], v[108:111], v[160:163], 0
  v_mfma_f32_16x16x16_bf16 v[180:183], v[172:173], v[168:169], v[180:183]
  v_mfma_f32_16x16x16_bf16 v[216:219], v[128:129], v[168:169], v[216:219]
  v_mfma_f32_16x16x16_bf16 v[220:223], v[130:131], v[168:169], v[220:223]
  v_mfma_f32_16x16x16_bf16 v[224:227], v[132:133], v[168:169], v[224:227]
  v_mfma_f32_16x16x16_bf16 v[228:231], v[134:135], v[168:169], v[228:231]
  v_mfma_f32_16x16x16_bf16 v[232:235], v[128:129], v[170:171], v[232:235]
  v_mfma_f32_16x16x16_bf16 v[236:239], v[130:131], v[170:171], v[236:239]
  v_mfma_f32_16x16x16_bf16 v[240:243], v[132:133], v[170:171], v[240:243]
  v_mfma_f32_16x16x16_bf16 v[244:247], v[134:135], v[170:171], v[244:247]
  v_rcp_f32 v176, v176
  v_rcp_f32 v180, v180
  v_mul_f32 v184, v184, v176
  v_mul_f32 v185, v185, v176
  v_mul_f32 v186, v186, v176
  v_mul_f32 v187, v187, v176
  v_mul_f32 v188, v188, v176
  v_mul_f32 v189, v189, v176
  v_mul_f32 v190, v190, v176
  v_mul_f32 v191, v191, v176
  v_cvt_pk_bf16_f32 v184, v184, v185
  v_cvt_pk_bf16_f32 v185, v186, v187
  v_cvt_pk_bf16_f32 v186, v188, v189
  v_cvt_pk_bf16_f32 v187, v190, v191
  buffer_store_dwordx4 v[184:187], v1, s[4:7], s52 offen offset:0 sc1
  v_mul_f32 v192, v192, v176
  v_mul_f32 v193, v193, v176
  v_mul_f32 v194, v194, v176
  v_mul_f32 v195, v195, v176
  v_mul_f32 v196, v196, v176
  v_mul_f32 v197, v197, v176
  v_mul_f32 v198, v198, v176
  v_mul_f32 v199, v199, v176
  v_cvt_pk_bf16_f32 v192, v192, v193
  v_cvt_pk_bf16_f32 v193, v194, v195
  v_cvt_pk_bf16_f32 v194, v196, v197
  v_cvt_pk_bf16_f32 v195, v198, v199
  buffer_store_dwordx4 v[192:195], v1, s[4:7], s52 offen offset:1024 sc1
  v_mul_f32 v200, v200, v176
  v_mul_f32 v201, v201, v176
  v_mul_f32 v202, v202, v176
  v_mul_f32 v203, v203, v176
  v_mul_f32 v204, v204, v176
  v_mul_f32 v205, v205, v176
  v_mul_f32 v206, v206, v176
  v_mul_f32 v207, v207, v176
  v_cvt_pk_bf16_f32 v200, v200, v201
  v_cvt_pk_bf16_f32 v201, v202, v203
  v_cvt_pk_bf16_f32 v202, v204, v205
  v_cvt_pk_bf16_f32 v203, v206, v207
  buffer_store_dwordx4 v[200:203], v1, s[4:7], s52 offen offset:2048 sc1
  v_mul_f32 v208, v208, v176
  v_mul_f32 v209, v209, v176
  v_mul_f32 v210, v210, v176
  v_mul_f32 v211, v211, v176
  v_mul_f32 v212, v212, v176
  v_mul_f32 v213, v213, v176
  v_mul_f32 v214, v214, v176
  v_mul_f32 v215, v215, v176
  v_cvt_pk_bf16_f32 v208, v208, v209
  v_cvt_pk_bf16_f32 v209, v210, v211
  v_cvt_pk_bf16_f32 v210, v212, v213
  v_cvt_pk_bf16_f32 v211, v214, v215
  buffer_store_dwordx4 v[208:211], v1, s[4:7], s52 offen offset:3072 sc1
  v_mul_f32 v216, v216, v180
  v_mul_f32 v217, v217, v180
  v_mul_f32 v218, v218, v180
  v_mul_f32 v219, v219, v180
  v_mul_f32 v220, v220, v180
  v_mul_f32 v221, v221, v180
  v_mul_f32 v222, v222, v180
  v_mul_f32 v223, v223, v180
  v_cvt_pk_bf16_f32 v216, v216, v217
  v_cvt_pk_bf16_f32 v217, v218, v219
  v_cvt_pk_bf16_f32 v218, v220, v221
  v_cvt_pk_bf16_f32 v219, v222, v223
  buffer_store_dwordx4 v[216:219], v1, s[4:7], s53 offen offset:0 sc1
  v_mul_f32 v224, v224, v180
  v_mul_f32 v225, v225, v180
  v_mul_f32 v226, v226, v180
  v_mul_f32 v227, v227, v180
  v_mul_f32 v228, v228, v180
  v_mul_f32 v229, v229, v180
  v_mul_f32 v230, v230, v180
  v_mul_f32 v231, v231, v180
  v_cvt_pk_bf16_f32 v224, v224, v225
  v_cvt_pk_bf16_f32 v225, v226, v227
  v_cvt_pk_bf16_f32 v226, v228, v229
  v_cvt_pk_bf16_f32 v227, v230, v231
  buffer_store_dwordx4 v[224:227], v1, s[4:7], s53 offen offset:1024 sc1
  v_mul_f32 v232, v232, v180
  v_mul_f32 v233, v233, v180
  v_mul_f32 v234, v234, v180
  v_mul_f32 v235, v235, v180
  v_mul_f32 v236, v236, v180
  v_mul_f32 v237, v237, v180
  v_mul_f32 v238, v238, v180
  v_mul_f32 v239, v239, v180
  v_cvt_pk_bf16_f32 v232, v232, v233
  v_cvt_pk_bf16_f32 v233, v234, v235
  v_cvt_pk_bf16_f32 v234, v236, v237
  v_cvt_pk_bf16_f32 v235, v238, v239
  buffer_store_dwordx4 v[232:235], v1, s[4:7], s53 offen offset:2048 sc1
  v_mul_f32 v240, v240, v180
  v_mul_f32 v241, v241, v180
  v_mul_f32 v242, v242, v180
  v_mul_f32 v243, v243, v180
  v_mul_f32 v244, v244, v180
  v_mul_f32 v245, v245, v180
  v_mul_f32 v246, v246, v180
  v_mul_f32 v247, v247, v180
  v_cvt_pk_bf16_f32 v240, v240, v241
  v_cvt_pk_bf16_f32 v241, v242, v243
  v_cvt_pk_bf16_f32 v242, v244, v245
  v_cvt_pk_bf16_f32 v243, v246, v247
  buffer_store_dwordx4 v[240:243], v1, s[4:7], s53 offen offset:3072 sc1
  s_lshl_b32 s52, s33, 8
  s_lshl_b32 s53, s35, 5
  s_add_u32 s52, s52, s53
  s_add_u32 s52, s52, 0x4c04000
  s_waitcnt vmcnt(0)
  s_barrier
  s_cmp_lg_u32 s28, 0
  s_cbranch_scc1 L_b2nf_52
  buffer_store_dword v10, off, s[4:7], s52 sc1
L_b2nf_52:
  s_add_u32 s33, s33, 6
  s_cmp_lt_u32 s33, 64
  s_cbranch_scc1 L_b2loop_48
  s_branch L_end
L_parta:
  s_sub_u32 s52, s29, 6
  s_lshl_b32 s33, s52, 5
  s_add_u32 s33, s33, s30
  s_lshr_b32 s34, s33, 4
  s_and_b32 s35, s33, 15
  s_mov_b32 s41, 0x3fb8aa3b
  v_mov_b32 v2, 0x80000000
  s_lshr_b32 s36, s33, 4
  s_bfe_u32 s55, s33, 0x20002
  s_and_b32 s40, s33, 3
  s_mov_b32 s16, s68
  s_and_b32 s17, s69, 0xffff
  s_mov_b32 s18, 0x6400
  s_mov_b32 s19, 0x20000
  s_cmp_eq_u32 s36, 3
  s_cselect_b64 s[12:13], s[70:71], s[66:67]
  s_and_b32 s13, s13, 0xffff
  s_cmp_eq_u32 s36, 3
  s_mov_b32 s53, 819200
  s_cselect_b32 s14, s53, 2457600
  s_mov_b32 s15, 0x20000
  s_movk_i32 s53, 1280
  s_cselect_b32 s38, s53, 3840
  s_mul_i32 s53, s36, 1280
  s_cselect_b32 s53, 0, s53
  s_lshl_b32 s37, s55, 3
  s_lshl_b32 s54, s28, 1
  s_add_u32 s37, s37, s54
  s_mul_i32 s54, s37, 40
  s_add_u32 s53, s53, s54
  s_mul_i32 s54, s40, 160
  s_mul_i32 s54, s54, s38
  s_add_u32 s39, s53, s54
  v_and_b32 v4, 15, v0
  v_lshrrev_b32 v5, 4, v0
  v_mul_lo_u32 v6, v4, s38
  v_lshl_add_u32 v6, v5, 4, v6
  s_lshl_b32 s38, s38, 4
  buffer_load_dwordx4 v[64:67], v6, s[12:15], s39 offen offset:0
  buffer_load_dwordx4 v[104:107], v6, s[12:15], s39 offen offset:40
  s_add_u32 s39, s39, s38
  buffer_load_dwordx4 v[68:71], v6, s[12:15], s39 offen offset:0
  buffer_load_dwordx4 v[108:111], v6, s[12:15], s39 offen offset:40
  s_add_u32 s39, s39, s38
  buffer_load_dwordx4 v[72:75], v6, s[12:15], s39 offen offset:0
  buffer_load_dwordx4 v[112:115], v6, s[12:15], s39 offen offset:40
  s_add_u32 s39, s39, s38
  buffer_load_dwordx4 v[76:79], v6, s[12:15], s39 offen offset:0
  buffer_load_dwordx4 v[116:119], v6, s[12:15], s39 offen offset:40
  s_add_u32 s39, s39, s38
  buffer_load_dwordx4 v[80:83], v6, s[12:15], s39 offen offset:0
  buffer_load_dwordx4 v[120:123], v6, s[12:15], s39 offen offset:40
  s_add_u32 s39, s39, s38
  buffer_load_dwordx4 v[84:87], v6, s[12:15], s39 offen offset:0
  buffer_load_dwordx4 v[124:127], v6, s[12:15], s39 offen offset:40
  s_add_u32 s39, s39, s38
  buffer_load_dwordx4 v[88:91], v6, s[12:15], s39 offen offset:0
  buffer_load_dwordx4 v[128:131], v6, s[12:15], s39 offen offset:40
  s_add_u32 s39, s39, s38
  buffer_load_dwordx4 v[92:95], v6, s[12:15], s39 offen offset:0
  buffer_load_dwordx4 v[132:135], v6, s[12:15], s39 offen offset:40
  s_add_u32 s39, s39, s38
  buffer_load_dwordx4 v[96:99], v6, s[12:15], s39 offen offset:0
  buffer_load_dwordx4 v[136:139], v6, s[12:15], s39 offen offset:40
  s_add_u32 s39, s39, s38
  buffer_load_dwordx4 v[100:103], v6, s[12:15], s39 offen offset:0
  buffer_load_dwordx4 v[140:143], v6, s[12:15], s39 offen offset:40
  s_add_u32 s39, s39, s38
  s_mul_i32 s53, s37, 800
  s_cmp_ge_u32 s36, 2
  s_cbranch_scc1 L_a0id_53
  v_lshl_add_u32 v7, v5, 3, 0
  v_add_u32 v8, 0, v4
  v_max_u32 v9, v7, v8
  v_mul_u32_u24 v7, 40, v7
  v_lshl_add_u32 v7, v8, 1, v7
  v_cmp_gt_u32 vcc, 20, v9
  s_nop 1
  v_cndmask_b32 v7, v2, v7, vcc
  buffer_load_ushort v160, v7, s[16:19], s53 offen offset:0
  buffer_load_ushort v176, v7, s[16:19], s53 offen offset:800
  v_lshl_add_u32 v7, v5, 3, 1
  v_add_u32 v8, 0, v4
  v_max_u32 v9, v7, v8
  v_mul_u32_u24 v7, 40, v7
  v_lshl_add_u32 v7, v8, 1, v7
  v_cmp_gt_u32 vcc, 20, v9
  s_nop 1
  v_cndmask_b32 v7, v2, v7, vcc
  buffer_load_ushort v161, v7, s[16:19], s53 offen offset:0
  buffer_load_ushort v177, v7, s[16:19], s53 offen offset:800
  v_lshl_add_u32 v7, v5, 3, 2
  v_add_u32 v8, 0, v4
  v_max_u32 v9, v7, v8
  v_mul_u32_u24 v7, 40, v7
  v_lshl_add_u32 v7, v8, 1, v7
  v_cmp_gt_u32 vcc, 20, v9
  s_nop 1
  v_cndmask_b32 v7, v2, v7, vcc
  buffer_load_ushort v162, v7, s[16:19], s53 offen offset:0
  buffer_load_ushort v178, v7, s[16:19], s53 offen offset:800
  v_lshl_add_u32 v7, v5, 3, 3
  v_add_u32 v8, 0, v4
  v_max_u32 v9, v7, v8
  v_mul_u32_u24 v7, 40, v7
  v_lshl_add_u32 v7, v8, 1, v7
  v_cmp_gt_u32 vcc, 20, v9
  s_nop 1
  v_cndmask_b32 v7, v2, v7, vcc
  buffer_load_ushort v163, v7, s[16:19], s53 offen offset:0
  buffer_load_ushort v179, v7, s[16:19], s53 offen offset:800
  v_lshl_add_u32 v7, v5, 3, 4
  v_add_u32 v8, 0, v4
  v_max_u32 v9, v7, v8
  v_mul_u32_u24 v7, 40, v7
  v_lshl_add_u32 v7, v8, 1, v7
  v_cmp_gt_u32 vcc, 20, v9
  s_nop 1
  v_cndmask_b32 v7, v2, v7, vcc
  buffer_load_ushort v164, v7, s[16:19], s53 offen offset:0
  buffer_load_ushort v180, v7, s[16:19], s53 offen offset:800
  v_lshl_add_u32 v7, v5, 3, 5
  v_add_u32 v8, 0, v4
  v_max_u32 v9, v7, v8
  v_mul_u32_u24 v7, 40, v7
  v_lshl_add_u32 v7, v8, 1, v7
  v_cmp_gt_u32 vcc, 20, v9
  s_nop 1
  v_cndmask_b32 v7, v2, v7, vcc
  buffer_load_ushort v165, v7, s[16:19], s53 offen offset:0
  buffer_load_ushort v181, v7, s[16:19], s53 offen offset:800
  v_lshl_add_u32 v7, v5, 3, 6
  v_add_u32 v8, 0, v4
  v_max_u32 v9, v7, v8
  v_mul_u32_u24 v7, 40, v7
  v_lshl_add_u32 v7, v8, 1, v7
  v_cmp_gt_u32 vcc, 20, v9
  s_nop 1
  v_cndmask_b32 v7, v2, v7, vcc
  buffer_load_ushort v166, v7, s[16:19], s53 offen offset:0
  buffer_load_ushort v182, v7, s[16:19], s53 offen offset:800
  v_lshl_add_u32 v7, v5, 3, 7
  v_add_u32 v8, 0, v4
  v_max_u32 v9, v7, v8
  v_mul_u32_u24 v7, 40, v7
  v_lshl_add_u32 v7, v8, 1, v7
  v_cmp_gt_u32 vcc, 20, v9
  s_nop 1
  v_cndmask_b32 v7, v2, v7, vcc
  buffer_load_ushort v167, v7, s[16:19], s53 offen offset:0
  buffer_load_ushort v183, v7, s[16:19], s53 offen offset:800
  v_lshl_add_u32 v7, v5, 3, 0
  v_add_u32 v8, 16, v4
  v_max_u32 v9, v7, v8
  v_mul_u32_u24 v7, 40, v7
  v_lshl_add_u32 v7, v8, 1, v7
  v_cmp_gt_u32 vcc, 20, v9
  s_nop 1
  v_cndmask_b32 v7, v2, v7, vcc
  buffer_load_ushort v168, v7, s[16:19], s53 offen offset:0
  buffer_load_ushort v184, v7, s[16:19], s53 offen offset:800
  v_lshl_add_u32 v7, v5, 3, 1
  v_add_u32 v8, 16, v4
  v_max_u32 v9, v7, v8
  v_mul_u32_u24 v7, 40, v7
  v_lshl_add_u32 v7, v8, 1, v7
  v_cmp_gt_u32 vcc, 20, v9
  s_nop 1
  v_cndmask_b32 v7, v2, v7, vcc
  buffer_load_ushort v169, v7, s[16:19], s53 offen offset:0
  buffer_load_ushort v185, v7, s[16:19], s53 offen offset:800
  v_lshl_add_u32 v7, v5, 3, 2
  v_add_u32 v8, 16, v4
  v_max_u32 v9, v7, v8
  v_mul_u32_u24 v7, 40, v7
  v_lshl_add_u32 v7, v8, 1, v7
  v_cmp_gt_u32 vcc, 20, v9
  s_nop 1
  v_cndmask_b32 v7, v2, v7, vcc
  buffer_load_ushort v170, v7, s[16:19], s53 offen offset:0
  buffer_load_ushort v186, v7, s[16:19], s53 offen offset:800
  v_lshl_add_u32 v7, v5, 3, 3
  v_add_u32 v8, 16, v4
  v_max_u32 v9, v7, v8
  v_mul_u32_u24 v7, 40, v7
  v_lshl_add_u32 v7, v8, 1, v7
  v_cmp_gt_u32 vcc, 20, v9
  s_nop 1
  v_cndmask_b32 v7, v2, v7, vcc
  buffer_load_ushort v171, v7, s[16:19], s53 offen offset:0
  buffer_load_ushort v187, v7, s[16:19], s53 offen offset:800
  v_lshl_add_u32 v7, v5, 3, 4
  v_add_u32 v8, 16, v4
  v_max_u32 v9, v7, v8
  v_mul_u32_u24 v7, 40, v7
  v_lshl_add_u32 v7, v8, 1, v7
  v_cmp_gt_u32 vcc, 20, v9
  s_nop 1
  v_cndmask_b32 v7, v2, v7, vcc
  buffer_load_ushort v172, v7, s[16:19], s53 offen offset:0
  buffer_load_ushort v188, v7, s[16:19], s53 offen offset:800
  v_lshl_add_u32 v7, v5, 3, 5
  v_add_u32 v8, 16, v4
  v_max_u32 v9, v7, v8
  v_mul_u32_u24 v7, 40, v7
  v_lshl_add_u32 v7, v8, 1, v7
  v_cmp_gt_u32 vcc, 20, v9
  s_nop 1
  v_cndmask_b32 v7, v2, v7, vcc
  buffer_load_ushort v173, v7, s[16:19], s53 offen offset:0
  buffer_load_ushort v189, v7, s[16:19], s53 offen offset:800
  v_lshl_add_u32 v7, v5, 3, 6
  v_add_u32 v8, 16, v4
  v_max_u32 v9, v7, v8
  v_mul_u32_u24 v7, 40, v7
  v_lshl_add_u32 v7, v8, 1, v7
  v_cmp_gt_u32 vcc, 20, v9
  s_nop 1
  v_cndmask_b32 v7, v2, v7, vcc
  buffer_load_ushort v174, v7, s[16:19], s53 offen offset:0
  buffer_load_ushort v190, v7, s[16:19], s53 offen offset:800
  v_lshl_add_u32 v7, v5, 3, 7
  v_add_u32 v8, 16, v4
  v_max_u32 v9, v7, v8
  v_mul_u32_u24 v7, 40, v7
  v_lshl_add_u32 v7, v8, 1, v7
  v_cmp_gt_u32 vcc, 20, v9
  s_nop 1
  v_cndmask_b32 v7, v2, v7, vcc
  buffer_load_ushort v175, v7, s[16:19], s53 offen offset:0
  buffer_load_ushort v191, v7, s[16:19], s53 offen offset:800
  s_branch L_a0b_54
L_a0id_53:
  v_mov_b32 v9, 0x3f80
  v_lshl_add_u32 v7, v5, 3, 0
  v_add_u32 v8, 0, v4
  v_cmp_eq_u32 vcc, v7, v8
  s_nop 1
  v_cndmask_b32 v160, 0, v9, vcc
  v_cndmask_b32 v176, 0, v9, vcc
  v_lshl_add_u32 v7, v5, 3, 1
  v_add_u32 v8, 0, v4
  v_cmp_eq_u32 vcc, v7, v8
  s_nop 1
  v_cndmask_b32 v161, 0, v9, vcc
  v_cndmask_b32 v177, 0, v9, vcc
  v_lshl_add_u32 v7, v5, 3, 2
  v_add_u32 v8, 0, v4
  v_cmp_eq_u32 vcc, v7, v8
  s_nop 1
  v_cndmask_b32 v162, 0, v9, vcc
  v_cndmask_b32 v178, 0, v9, vcc
  v_lshl_add_u32 v7, v5, 3, 3
  v_add_u32 v8, 0, v4
  v_cmp_eq_u32 vcc, v7, v8
  s_nop 1
  v_cndmask_b32 v163, 0, v9, vcc
  v_cndmask_b32 v179, 0, v9, vcc
  v_lshl_add_u32 v7, v5, 3, 4
  v_add_u32 v8, 0, v4
  v_cmp_eq_u32 vcc, v7, v8
  s_nop 1
  v_cndmask_b32 v164, 0, v9, vcc
  v_cndmask_b32 v180, 0, v9, vcc
  v_lshl_add_u32 v7, v5, 3, 5
  v_add_u32 v8, 0, v4
  v_cmp_eq_u32 vcc, v7, v8
  s_nop 1
  v_cndmask_b32 v165, 0, v9, vcc
  v_cndmask_b32 v181, 0, v9, vcc
  v_lshl_add_u32 v7, v5, 3, 6
  v_add_u32 v8, 0, v4
  v_cmp_eq_u32 vcc, v7, v8
  s_nop 1
  v_cndmask_b32 v166, 0, v9, vcc
  v_cndmask_b32 v182, 0, v9, vcc
  v_lshl_add_u32 v7, v5, 3, 7
  v_add_u32 v8, 0, v4
  v_cmp_eq_u32 vcc, v7, v8
  s_nop 1
  v_cndmask_b32 v167, 0, v9, vcc
  v_cndmask_b32 v183, 0, v9, vcc
  v_lshl_add_u32 v7, v5, 3, 0
  v_add_u32 v8, 16, v4
  v_cmp_eq_u32 vcc, v7, v8
  s_nop 1
  v_cndmask_b32 v168, 0, v9, vcc
  v_cndmask_b32 v184, 0, v9, vcc
  v_lshl_add_u32 v7, v5, 3, 1
  v_add_u32 v8, 16, v4
  v_cmp_eq_u32 vcc, v7, v8
  s_nop 1
  v_cndmask_b32 v169, 0, v9, vcc
  v_cndmask_b32 v185, 0, v9, vcc
  v_lshl_add_u32 v7, v5, 3, 2
  v_add_u32 v8, 16, v4
  v_cmp_eq_u32 vcc, v7, v8
  s_nop 1
  v_cndmask_b32 v170, 0, v9, vcc
  v_cndmask_b32 v186, 0, v9, vcc
  v_lshl_add_u32 v7, v5, 3, 3
  v_add_u32 v8, 16, v4
  v_cmp_eq_u32 vcc, v7, v8
  s_nop 1
  v_cndmask_b32 v171, 0, v9, vcc
  v_cndmask_b32 v187, 0, v9, vcc
  v_lshl_add_u32 v7, v5, 3, 4
  v_add_u32 v8, 16, v4
  v_cmp_eq_u32 vcc, v7, v8
  s_nop 1
  v_cndmask_b32 v172, 0, v9, vcc
  v_cndmask_b32 v188, 0, v9, vcc
  v_lshl_add_u32 v7, v5, 3, 5
  v_add_u32 v8, 16, v4
  v_cmp_eq_u32 vcc, v7, v8
  s_nop 1
  v_cndmask_b32 v173, 0, v9, vcc
  v_cndmask_b32 v189, 0, v9, vcc
  v_lshl_add_u32 v7, v5, 3, 6
  v_add_u32 v8, 16, v4
  v_cmp_eq_u32 vcc, v7, v8
  s_nop 1
  v_cndmask_b32 v174, 0, v9, vcc
  v_cndmask_b32 v190, 0, v9, vcc
  v_lshl_add_u32 v7, v5, 3, 7
  v_add_u32 v8, 16, v4
  v_cmp_eq_u32 vcc, v7, v8
  s_nop 1
  v_cndmask_b32 v175, 0, v9, vcc
  v_cndmask_b32 v191, 0, v9, vcc
L_a0b_54:
  s_lshr_b32 s54, s28, 1
  s_lshl_b32 s54, s54, 6
  v_lshrrev_b32 v10, 1, v5
  v_mul_u32_u24 v10, 5120, v10
  v_and_b32 v11, 1, v5
  v_lshl_add_u32 v10, v11, 3, v10
  v_add_u32 v10, s54, v10
  s_and_b32 s53, s28, 1
  s_mul_i32 s53, s53, 40
  v_mov_b32 v3, 51200
  v_add_u32 v8, 0, v4
  v_add3_u32 v7, v8, s53, 0
  v_lshrrev_b32 v9, 4, v7
  v_lshl_add_u32 v9, v9, 10, v10
  v_bfe_u32 v11, v7, 2, 2
  v_lshl_add_u32 v9, v11, 7, v9
  v_and_b32 v11, 3, v7
  v_lshl_add_u32 v9, v11, 4, v9
  v_cmp_gt_u32 vcc, 20, v8
  s_nop 1
  v_cndmask_b32 v12, v3, v9, vcc
  v_add_u32 v8, 16, v4
  v_add3_u32 v7, v8, s53, 0
  v_lshrrev_b32 v9, 4, v7
  v_lshl_add_u32 v9, v9, 10, v10
  v_bfe_u32 v11, v7, 2, 2
  v_lshl_add_u32 v9, v11, 7, v9
  v_and_b32 v11, 3, v7
  v_lshl_add_u32 v9, v11, 4, v9
  v_cmp_gt_u32 vcc, 20, v8
  s_nop 1
  v_cndmask_b32 v13, v3, v9, vcc
  v_add_u32 v8, 0, v4
  v_add3_u32 v7, v8, s53, 20
  v_lshrrev_b32 v9, 4, v7
  v_lshl_add_u32 v9, v9, 10, v10
  v_bfe_u32 v11, v7, 2, 2
  v_lshl_add_u32 v9, v11, 7, v9
  v_and_b32 v11, 3, v7
  v_lshl_add_u32 v9, v11, 4, v9
  v_cmp_gt_u32 vcc, 20, v8
  s_nop 1
  v_cndmask_b32 v14, v3, v9, vcc
  v_add_u32 v8, 16, v4
  v_add3_u32 v7, v8, s53, 20
  v_lshrrev_b32 v9, 4, v7
  v_lshl_add_u32 v9, v9, 10, v10
  v_bfe_u32 v11, v7, 2, 2
  v_lshl_add_u32 v9, v11, 7, v9
  v_and_b32 v11, 3, v7
  v_lshl_add_u32 v9, v11, 4, v9
  v_cmp_gt_u32 vcc, 20, v8
  s_nop 1
  v_cndmask_b32 v15, v3, v9, vcc
  s_waitcnt vmcnt(0)
  v_lshl_or_b32 v16, v161, 16, v160
  v_lshl_or_b32 v17, v163, 16, v162
  v_lshl_or_b32 v18, v165, 16, v164
  v_lshl_or_b32 v19, v167, 16, v166
  v_lshl_or_b32 v20, v169, 16, v168
  v_lshl_or_b32 v21, v171, 16, v170
  v_lshl_or_b32 v22, v173, 16, v172
  v_lshl_or_b32 v23, v175, 16, v174
  v_lshl_or_b32 v24, v177, 16, v176
  v_lshl_or_b32 v25, v179, 16, v178
  v_lshl_or_b32 v26, v181, 16, v180
  v_lshl_or_b32 v27, v183, 16, v182
  v_lshl_or_b32 v28, v185, 16, v184
  v_lshl_or_b32 v29, v187, 16, v186
  v_lshl_or_b32 v30, v189, 16, v188
  v_lshl_or_b32 v31, v191, 16, v190
  v_mfma_f32_16x16x32_bf16 v[32:35], v[64:67], v[16:19], 0
  v_mfma_f32_16x16x32_bf16 v[36:39], v[64:67], v[20:23], 0
  v_mfma_f32_16x16x32_bf16 v[40:43], v[104:107], v[24:27], 0
  v_mfma_f32_16x16x32_bf16 v[44:47], v[104:107], v[28:31], 0
  v_cvt_pk_bf16_f32 v32, v32, v33
  v_cvt_pk_bf16_f32 v33, v34, v35
  v_cvt_pk_bf16_f32 v36, v36, v37
  v_cvt_pk_bf16_f32 v37, v38, v39
  v_cvt_pk_bf16_f32 v40, v40, v41
  v_cvt_pk_bf16_f32 v41, v42, v43
  s_nop 1
  v_cvt_pk_bf16_f32 v44, v44, v45
  v_cvt_pk_bf16_f32 v45, v46, v47
  ds_write_b64 v12, v[32:33] offset:0
  ds_write_b64 v13, v[36:37] offset:0
  ds_write_b64 v14, v[40:41] offset:0
  ds_write_b64 v15, v[44:45] offset:0
  v_mfma_f32_16x16x32_bf16 v[48:51], v[68:71], v[16:19], 0
  v_mfma_f32_16x16x32_bf16 v[52:55], v[68:71], v[20:23], 0
  v_mfma_f32_16x16x32_bf16 v[56:59], v[108:111], v[24:27], 0
  v_mfma_f32_16x16x32_bf16 v[60:63], v[108:111], v[28:31], 0
  v_cvt_pk_bf16_f32 v48, v48, v49
  v_cvt_pk_bf16_f32 v49, v50, v51
  v_cvt_pk_bf16_f32 v52, v52, v53
  v_cvt_pk_bf16_f32 v53, v54, v55
  v_cvt_pk_bf16_f32 v56, v56, v57
  v_cvt_pk_bf16_f32 v57, v58, v59
  s_nop 1
  v_cvt_pk_bf16_f32 v60, v60, v61
  v_cvt_pk_bf16_f32 v61, v62, v63
  ds_write_b64 v12, v[48:49] offset:10240
  ds_write_b64 v13, v[52:53] offset:10240
  ds_write_b64 v14, v[56:57] offset:10240
  ds_write_b64 v15, v[60:61] offset:10240
  v_mfma_f32_16x16x32_bf16 v[32:35], v[72:75], v[16:19], 0
  v_mfma_f32_16x16x32_bf16 v[36:39], v[72:75], v[20:23], 0
  v_mfma_f32_16x16x32_bf16 v[40:43], v[112:115], v[24:27], 0
  v_mfma_f32_16x16x32_bf16 v[44:47], v[112:115], v[28:31], 0
  v_cvt_pk_bf16_f32 v32, v32, v33
  v_cvt_pk_bf16_f32 v33, v34, v35
  v_cvt_pk_bf16_f32 v36, v36, v37
  v_cvt_pk_bf16_f32 v37, v38, v39
  v_cvt_pk_bf16_f32 v40, v40, v41
  v_cvt_pk_bf16_f32 v41, v42, v43
  s_nop 1
  v_cvt_pk_bf16_f32 v44, v44, v45
  v_cvt_pk_bf16_f32 v45, v46, v47
  ds_write_b64 v12, v[32:33] offset:20480
  ds_write_b64 v13, v[36:37] offset:20480
  ds_write_b64 v14, v[40:41] offset:20480
  ds_write_b64 v15, v[44:45] offset:20480
  v_mfma_f32_16x16x32_bf16 v[48:51], v[76:79], v[16:19], 0
  v_mfma_f32_16x16x32_bf16 v[52:55], v[76:79], v[20:23], 0
  v_mfma_f32_16x16x32_bf16 v[56:59], v[116:119], v[24:27], 0
  v_mfma_f32_16x16x32_bf16 v[60:63], v[116:119], v[28:31], 0
  v_cvt_pk_bf16_f32 v48, v48, v49
  v_cvt_pk_bf16_f32 v49, v50, v51
  v_cvt_pk_bf16_f32 v52, v52, v53
  v_cvt_pk_bf16_f32 v53, v54, v55
  v_cvt_pk_bf16_f32 v56, v56, v57
  v_cvt_pk_bf16_f32 v57, v58, v59
  s_nop 1
  v_cvt_pk_bf16_f32 v60, v60, v61
  v_cvt_pk_bf16_f32 v61, v62, v63
  ds_write_b64 v12, v[48:49] offset:30720
  ds_write_b64 v13, v[52:53] offset:30720
  ds_write_b64 v14, v[56:57] offset:30720
  ds_write_b64 v15, v[60:61] offset:30720
  v_mfma_f32_16x16x32_bf16 v[32:35], v[80:83], v[16:19], 0
  v_mfma_f32_16x16x32_bf16 v[36:39], v[80:83], v[20:23], 0
  v_mfma_f32_16x16x32_bf16 v[40:43], v[120:123], v[24:27], 0
  v_mfma_f32_16x16x32_bf16 v[44:47], v[120:123], v[28:31], 0
  v_cvt_pk_bf16_f32 v32, v32, v33
  v_cvt_pk_bf16_f32 v33, v34, v35
  v_cvt_pk_bf16_f32 v36, v36, v37
  v_cvt_pk_bf16_f32 v37, v38, v39
  v_cvt_pk_bf16_f32 v40, v40, v41
  v_cvt_pk_bf16_f32 v41, v42, v43
  s_nop 1
  v_cvt_pk_bf16_f32 v44, v44, v45
  v_cvt_pk_bf16_f32 v45, v46, v47
  ds_write_b64 v12, v[32:33] offset:40960
  ds_write_b64 v13, v[36:37] offset:40960
  ds_write_b64 v14, v[40:41] offset:40960
  ds_write_b64 v15, v[44:45] offset:40960
  v_mfma_f32_16x16x32_bf16 v[48:51], v[84:87], v[16:19], 0
  v_mfma_f32_16x16x32_bf16 v[52:55], v[84:87], v[20:23], 0
  v_mfma_f32_16x16x32_bf16 v[56:59], v[124:127], v[24:27], 0
  v_mfma_f32_16x16x32_bf16 v[60:63], v[124:127], v[28:31], 0
  v_cvt_pk_bf16_f32 v48, v48, v49
  v_cvt_pk_bf16_f32 v49, v50, v51
  v_cvt_pk_bf16_f32 v52, v52, v53
  v_cvt_pk_bf16_f32 v53, v54, v55
  v_cvt_pk_bf16_f32 v56, v56, v57
  v_cvt_pk_bf16_f32 v57, v58, v59
  s_nop 1
  v_cvt_pk_bf16_f32 v60, v60, v61
  v_cvt_pk_bf16_f32 v61, v62, v63
  ds_write_b64 v12, v[48:49] offset:512
  ds_write_b64 v13, v[52:53] offset:512
  ds_write_b64 v14, v[56:57] offset:512
  ds_write_b64 v15, v[60:61] offset:512
  v_mfma_f32_16x16x32_bf16 v[32:35], v[88:91], v[16:19], 0
  v_mfma_f32_16x16x32_bf16 v[36:39], v[88:91], v[20:23], 0
  v_mfma_f32_16x16x32_bf16 v[40:43], v[128:131], v[24:27], 0
  v_mfma_f32_16x16x32_bf16 v[44:47], v[128:131], v[28:31], 0
  v_cvt_pk_bf16_f32 v32, v32, v33
  v_cvt_pk_bf16_f32 v33, v34, v35
  v_cvt_pk_bf16_f32 v36, v36, v37
  v_cvt_pk_bf16_f32 v37, v38, v39
  v_cvt_pk_bf16_f32 v40, v40, v41
  v_cvt_pk_bf16_f32 v41, v42, v43
  s_nop 1
  v_cvt_pk_bf16_f32 v44, v44, v45
  v_cvt_pk_bf16_f32 v45, v46, v47
  ds_write_b64 v12, v[32:33] offset:10752
  ds_write_b64 v13, v[36:37] offset:10752
  ds_write_b64 v14, v[40:41] offset:10752
  ds_write_b64 v15, v[44:45] offset:10752
  v_mfma_f32_16x16x32_bf16 v[48:51], v[92:95], v[16:19], 0
  v_mfma_f32_16x16x32_bf16 v[52:55], v[92:95], v[20:23], 0
  v_mfma_f32_16x16x32_bf16 v[56:59], v[132:135], v[24:27], 0
  v_mfma_f32_16x16x32_bf16 v[60:63], v[132:135], v[28:31], 0
  v_cvt_pk_bf16_f32 v48, v48, v49
  v_cvt_pk_bf16_f32 v49, v50, v51
  v_cvt_pk_bf16_f32 v52, v52, v53
  v_cvt_pk_bf16_f32 v53, v54, v55
  v_cvt_pk_bf16_f32 v56, v56, v57
  v_cvt_pk_bf16_f32 v57, v58, v59
  s_nop 1
  v_cvt_pk_bf16_f32 v60, v60, v61
  v_cvt_pk_bf16_f32 v61, v62, v63
  ds_write_b64 v12, v[48:49] offset:20992
  ds_write_b64 v13, v[52:53] offset:20992
  ds_write_b64 v14, v[56:57] offset:20992
  ds_write_b64 v15, v[60:61] offset:20992
  v_mfma_f32_16x16x32_bf16 v[32:35], v[96:99], v[16:19], 0
  v_mfma_f32_16x16x32_bf16 v[36:39], v[96:99], v[20:23], 0
  v_mfma_f32_16x16x32_bf16 v[40:43], v[136:139], v[24:27], 0
  v_mfma_f32_16x16x32_bf16 v[44:47], v[136:139], v[28:31], 0
  v_cvt_pk_bf16_f32 v32, v32, v33
  v_cvt_pk_bf16_f32 v33, v34, v35
  v_cvt_pk_bf16_f32 v36, v36, v37
  v_cvt_pk_bf16_f32 v37, v38, v39
  v_cvt_pk_bf16_f32 v40, v40, v41
  v_cvt_pk_bf16_f32 v41, v42, v43
  s_nop 1
  v_cvt_pk_bf16_f32 v44, v44, v45
  v_cvt_pk_bf16_f32 v45, v46, v47
  ds_write_b64 v12, v[32:33] offset:31232
  ds_write_b64 v13, v[36:37] offset:31232
  ds_write_b64 v14, v[40:41] offset:31232
  ds_write_b64 v15, v[44:45] offset:31232
  v_mfma_f32_16x16x32_bf16 v[48:51], v[100:103], v[16:19], 0
  v_mfma_f32_16x16x32_bf16 v[52:55], v[100:103], v[20:23], 0
  v_mfma_f32_16x16x32_bf16 v[56:59], v[140:143], v[24:27], 0
  v_mfma_f32_16x16x32_bf16 v[60:63], v[140:143], v[28:31], 0
  v_cvt_pk_bf16_f32 v48, v48, v49
  v_cvt_pk_bf16_f32 v49, v50, v51
  v_cvt_pk_bf16_f32 v52, v52, v53
  v_cvt_pk_bf16_f32 v53, v54, v55
  v_cvt_pk_bf16_f32 v56, v56, v57
  v_cvt_pk_bf16_f32 v57, v58, v59
  s_nop 1
  v_cvt_pk_bf16_f32 v60, v60, v61
  v_cvt_pk_bf16_f32 v61, v62, v63
  ds_write_b64 v12, v[48:49] offset:41472
  ds_write_b64 v13, v[52:53] offset:41472
  ds_write_b64 v14, v[56:57] offset:41472
  ds_write_b64 v15, v[60:61] offset:41472
  s_cmp_eq_u32 s36, 3
  s_cselect_b32 s52, 5, 15
  s_lshl_b32 s38, s52, 10
  s_mul_i32 s53, s55, 4
  s_add_u32 s53, s53, s40
  s_mul_i32 s53, s53, 10
  s_mul_i32 s53, s53, s38
  s_mul_i32 s54, s36, 5120
  s_add_u32 s54, s54, 0x5000000
  s_cmp_eq_u32 s36, 3
  s_cselect_b32 s54, 0x5300000, s54
  s_add_u32 s39, s53, s54
  v_lshlrev_b32 v1, 4, v0
  s_lshl_b32 s52, s28, 10
  v_add_u32 v7, s52, v1
  s_waitcnt lgkmcnt(0)
  s_barrier
  ds_read_b128 v[64:67], v7 offset:0
  ds_read_b128 v[68:71], v7 offset:4096
  ds_read_b128 v[72:75], v7 offset:8192
  ds_read_b128 v[76:79], v7 offset:12288
  ds_read_b128 v[80:83], v7 offset:16384
  ds_read_b128 v[84:87], v7 offset:20480
  ds_read_b128 v[88:91], v7 offset:24576
  ds_read_b128 v[92:95], v7 offset:28672
  ds_read_b128 v[96:99], v7 offset:32768
  ds_read_b128 v[100:103], v7 offset:36864
  ds_read_b128 v[104:107], v7 offset:40960
  ds_read_b128 v[108:111], v7 offset:45056
  ds_read_b128 v[112:115], v7 offset:49152
  s_add_u32 s52, s28, 0
  s_mul_i32 s53, s52, 52
  s_lshr_b32 s53, s53, 8
  s_mul_i32 s54, s53, 5
  s_sub_u32 s54, s52, s54
  s_mul_i32 s53, s53, s38
  s_lshl_b32 s54, s54, 10
  s_add_u32 s53, s53, s54
  s_add_u32 s53, s53, s39
  s_waitcnt lgkmcnt(12)
  buffer_store_dwordx4 v[64:67], v1, s[4:7], s53 offen sc1
  s_add_u32 s52, s28, 4
  s_mul_i32 s53, s52, 52
  s_lshr_b32 s53, s53, 8
  s_mul_i32 s54, s53, 5
  s_sub_u32 s54, s52, s54
  s_mul_i32 s53, s53, s38
  s_lshl_b32 s54, s54, 10
  s_add_u32 s53, s53, s54
  s_add_u32 s53, s53, s39
  s_waitcnt lgkmcnt(11)
  buffer_store_dwordx4 v[68:71], v1, s[4:7], s53 offen sc1
  s_add_u32 s52, s28, 8
  s_mul_i32 s53, s52, 52
  s_lshr_b32 s53, s53, 8
  s_mul_i32 s54, s53, 5
  s_sub_u32 s54, s52, s54
  s_mul_i32 s53, s53, s38
  s_lshl_b32 s54, s54, 10
  s_add_u32 s53, s53, s54
  s_add_u32 s53, s53, s39
  s_waitcnt lgkmcnt(10)
  buffer_store_dwordx4 v[72:75], v1, s[4:7], s53 offen sc1
  s_add_u32 s52, s28, 12
  s_mul_i32 s53, s52, 52
  s_lshr_b32 s53, s53, 8
  s_mul_i32 s54, s53, 5
  s_sub_u32 s54, s52, s54
  s_mul_i32 s53, s53, s38
  s_lshl_b32 s54, s54, 10
  s_add_u32 s53, s53, s54
  s_add_u32 s53, s53, s39
  s_waitcnt lgkmcnt(9)
  buffer_store_dwordx4 v[76:79], v1, s[4:7], s53 offen sc1
  s_add_u32 s52, s28, 16
  s_mul_i32 s53, s52, 52
  s_lshr_b32 s53, s53, 8
  s_mul_i32 s54, s53, 5
  s_sub_u32 s54, s52, s54
  s_mul_i32 s53, s53, s38
  s_lshl_b32 s54, s54, 10
  s_add_u32 s53, s53, s54
  s_add_u32 s53, s53, s39
  s_waitcnt lgkmcnt(8)
  buffer_store_dwordx4 v[80:83], v1, s[4:7], s53 offen sc1
  s_add_u32 s52, s28, 20
  s_mul_i32 s53, s52, 52
  s_lshr_b32 s53, s53, 8
  s_mul_i32 s54, s53, 5
  s_sub_u32 s54, s52, s54
  s_mul_i32 s53, s53, s38
  s_lshl_b32 s54, s54, 10
  s_add_u32 s53, s53, s54
  s_add_u32 s53, s53, s39
  s_waitcnt lgkmcnt(7)
  buffer_store_dwordx4 v[84:87], v1, s[4:7], s53 offen sc1
  s_add_u32 s52, s28, 24
  s_mul_i32 s53, s52, 52
  s_lshr_b32 s53, s53, 8
  s_mul_i32 s54, s53, 5
  s_sub_u32 s54, s52, s54
  s_mul_i32 s53, s53, s38
  s_lshl_b32 s54, s54, 10
  s_add_u32 s53, s53, s54
  s_add_u32 s53, s53, s39
  s_waitcnt lgkmcnt(6)
  buffer_store_dwordx4 v[88:91], v1, s[4:7], s53 offen sc1
  s_add_u32 s52, s28, 28
  s_mul_i32 s53, s52, 52
  s_lshr_b32 s53, s53, 8
  s_mul_i32 s54, s53, 5
  s_sub_u32 s54, s52, s54
  s_mul_i32 s53, s53, s38
  s_lshl_b32 s54, s54, 10
  s_add_u32 s53, s53, s54
  s_add_u32 s53, s53, s39
  s_waitcnt lgkmcnt(5)
  buffer_store_dwordx4 v[92:95], v1, s[4:7], s53 offen sc1
  s_add_u32 s52, s28, 32
  s_mul_i32 s53, s52, 52
  s_lshr_b32 s53, s53, 8
  s_mul_i32 s54, s53, 5
  s_sub_u32 s54, s52, s54
  s_mul_i32 s53, s53, s38
  s_lshl_b32 s54, s54, 10
  s_add_u32 s53, s53, s54
  s_add_u32 s53, s53, s39
  s_waitcnt lgkmcnt(4)
  buffer_store_dwordx4 v[96:99], v1, s[4:7], s53 offen sc1
  s_add_u32 s52, s28, 36
  s_mul_i32 s53, s52, 52
  s_lshr_b32 s53, s53, 8
  s_mul_i32 s54, s53, 5
  s_sub_u32 s54, s52, s54
  s_mul_i32 s53, s53, s38
  s_lshl_b32 s54, s54, 10
  s_add_u32 s53, s53, s54
  s_add_u32 s53, s53, s39
  s_waitcnt lgkmcnt(3)
  buffer_store_dwordx4 v[100:103], v1, s[4:7], s53 offen sc1
  s_add_u32 s52, s28, 40
  s_mul_i32 s53, s52, 52
  s_lshr_b32 s53, s53, 8
  s_mul_i32 s54, s53, 5
  s_sub_u32 s54, s52, s54
  s_mul_i32 s53, s53, s38
  s_lshl_b32 s54, s54, 10
  s_add_u32 s53, s53, s54
  s_add_u32 s53, s53, s39
  s_waitcnt lgkmcnt(2)
  buffer_store_dwordx4 v[104:107], v1, s[4:7], s53 offen sc1
  s_add_u32 s52, s28, 44
  s_mul_i32 s53, s52, 52
  s_lshr_b32 s53, s53, 8
  s_mul_i32 s54, s53, 5
  s_sub_u32 s54, s52, s54
  s_mul_i32 s53, s53, s38
  s_lshl_b32 s54, s54, 10
  s_add_u32 s53, s53, s54
  s_add_u32 s53, s53, s39
  s_waitcnt lgkmcnt(1)
  buffer_store_dwordx4 v[108:111], v1, s[4:7], s53 offen sc1
  s_add_u32 s52, s28, 48
  s_mul_i32 s53, s52, 52
  s_lshr_b32 s53, s53, 8
  s_mul_i32 s54, s53, 5
  s_sub_u32 s54, s52, s54
  s_mul_i32 s53, s53, s38
  s_lshl_b32 s54, s54, 10
  s_add_u32 s53, s53, s54
  s_add_u32 s53, s53, s39
  s_cmp_lt_u32 s52, 50
  s_cselect_b32 s53, s53, 0x80000000
  s_waitcnt lgkmcnt(0)
  buffer_store_dwordx4 v[112:115], v1, s[4:7], s53 offen sc1
  s_waitcnt vmcnt(0)
  s_barrier
  s_cmp_lg_u32 s28, 0
  s_cbranch_scc1 L_sig_55
  s_mov_b64 exec, 1
  v_mov_b32 v2, 1
  buffer_atomic_add v2, off, s[8:11], 0 offset:192 sc1
  s_mov_b64 exec, -1
L_sig_55:
  s_mov_b32 s12, s64
  s_and_b32 s13, s65, 0xffff
  s_mov_b32 s14, 0x280000
  s_mov_b32 s15, 0x20000
  v_lshlrev_b32 v1, 4, v0
  v_and_b32 v4, 31, v0
  v_lshrrev_b32 v5, 5, v0
  v_mul_u32_u24 v6, 1280, v4
  v_mul_u32_u24 v7, 160, v5
  v_add_u32 v6, v6, v7
  s_lshl_b32 s52, s35, 2
  s_add_u32 s52, s52, s28
  s_mul_i32 s38, s52, 40960
  s_mov_b32 s39, 0
  s_mul_i32 s52, s34, 614400
  s_add_u32 s44, s52, 0x5000000
  s_mov_b32 s51, 0
  s_branch L_wd_56a
L_wd_56:
  s_sleep 8
L_wd_56a:
  v_lshlrev_b32 v2, 2, v0
  buffer_load_dword v2, v2, s[8:11], 0 offen sc1
  s_add_u32 s51, s51, 1
  s_cmp_gt_u32 s51, 131072
  s_cbranch_scc1 L_end
  s_waitcnt vmcnt(0)
  v_readlane_b32 s52, v2, 48
  s_nop 0
  s_cmp_lg_u32 s52, 64
  s_cbranch_scc1 L_wd_56
  s_mul_i32 s48, s28, 8192
  v_add_u32 v3, s48, v1
  v_mov_b32 v8, v1
  s_mov_b32 s47, 0
  s_mov_b32 s40, 0
  buffer_load_dwordx4 v[16:19], v6, s[12:15], s38 offen
  s_add_u32 s38, s38, 16
  s_add_u32 s39, s39, 1
  s_cmp_eq_u32 s39, 10
  s_cselect_b32 s52, 160, 0
  s_cselect_b32 s39, 0, s39
  s_add_u32 s38, s38, s52
  buffer_load_dwordx4 v[20:23], v6, s[12:15], s38 offen
  s_add_u32 s38, s38, 16
  s_add_u32 s39, s39, 1
  s_cmp_eq_u32 s39, 10
  s_cselect_b32 s52, 160, 0
  s_cselect_b32 s39, 0, s39
  s_add_u32 s38, s38, s52
  s_add_u32 m0, s48, s47
  s_add_u32 s53, s44, 0
  buffer_load_dwordx4 v3, s[4:7], s53 offen offset:0 sc1 lds
  buffer_load_dwordx4 v3, s[4:7], s53 offen offset:1024 sc1 lds
  buffer_load_dwordx4 v3, s[4:7], s53 offen offset:2048 sc1 lds
  buffer_load_dwordx4 v3, s[4:7], s53 offen offset:3072 sc1 lds
  s_add_u32 m0, m0, 4096
  s_add_u32 s53, s44, 4096
  buffer_load_dwordx4 v3, s[4:7], s53 offen offset:0 sc1 lds
  buffer_load_dwordx4 v3, s[4:7], s53 offen offset:1024 sc1 lds
  buffer_load_dwordx4 v3, s[4:7], s53 offen offset:2048 sc1 lds
  buffer_load_dwordx4 v3, s[4:7], s53 offen offset:3072 sc1 lds
  s_add_u32 s44, s44, 30720
  s_add_u32 s47, s47, 0x8000
  s_and_b32 s47, s47, 0x1ffff
  buffer_load_dwordx4 v[24:27], v6, s[12:15], s38 offen
  s_add_u32 s38, s38, 16
  s_add_u32 s39, s39, 1
  s_cmp_eq_u32 s39, 10
  s_cselect_b32 s52, 160, 0
  s_cselect_b32 s39, 0, s39
  s_add_u32 s38, s38, s52
  buffer_load_dwordx4 v[28:31], v6, s[12:15], s38 offen
  s_add_u32 s38, s38, 16
  s_add_u32 s39, s39, 1
  s_cmp_eq_u32 s39, 10
  s_cselect_b32 s52, 160, 0
  s_cselect_b32 s39, 0, s39
  s_add_u32 s38, s38, s52
  s_add_u32 m0, s48, s47
  s_add_u32 s53, s44, 0
  buffer_load_dwordx4 v3, s[4:7], s53 offen offset:0 sc1 lds
  buffer_load_dwordx4 v3, s[4:7], s53 offen offset:1024 sc1 lds
  buffer_load_dwordx4 v3, s[4:7], s53 offen offset:2048 sc1 lds
  buffer_load_dwordx4 v3, s[4:7], s53 offen offset:3072 sc1 lds
  s_add_u32 m0, m0, 4096
  s_add_u32 s53, s44, 4096
  buffer_load_dwordx4 v3, s[4:7], s53 offen offset:0 sc1 lds
  buffer_load_dwordx4 v3, s[4:7], s53 offen offset:1024 sc1 lds
  buffer_load_dwordx4 v3, s[4:7], s53 offen offset:2048 sc1 lds
  buffer_load_dwordx4 v3, s[4:7], s53 offen offset:3072 sc1 lds
  s_add_u32 s44, s44, 30720
  s_add_u32 s47, s47, 0x8000
  s_and_b32 s47, s47, 0x1ffff
  buffer_load_dwordx4 v[32:35], v6, s[12:15], s38 offen
  s_add_u32 s38, s38, 16
  s_add_u32 s39, s39, 1
  s_cmp_eq_u32 s39, 10
  s_cselect_b32 s52, 160, 0
  s_cselect_b32 s39, 0, s39
  s_add_u32 s38, s38, s52
  buffer_load_dwordx4 v[36:39], v6, s[12:15], s38 offen
  s_add_u32 s38, s38, 16
  s_add_u32 s39, s39, 1
  s_cmp_eq_u32 s39, 10
  s_cselect_b32 s52, 160, 0
  s_cselect_b32 s39, 0, s39
  s_add_u32 s38, s38, s52
  s_add_u32 m0, s48, s47
  s_add_u32 s53, s44, 0
  buffer_load_dwordx4 v3, s[4:7], s53 offen offset:0 sc1 lds
  buffer_load_dwordx4 v3, s[4:7], s53 offen offset:1024 sc1 lds
  buffer_load_dwordx4 v3, s[4:7], s53 offen offset:2048 sc1 lds
  buffer_load_dwordx4 v3, s[4:7], s53 offen offset:3072 sc1 lds
  s_add_u32 m0, m0, 4096
  s_add_u32 s53, s44, 4096
  buffer_load_dwordx4 v3, s[4:7], s53 offen offset:0 sc1 lds
  buffer_load_dwordx4 v3, s[4:7], s53 offen offset:1024 sc1 lds
  buffer_load_dwordx4 v3, s[4:7], s53 offen offset:2048 sc1 lds
  buffer_load_dwordx4 v3, s[4:7], s53 offen offset:3072 sc1 lds
  s_add_u32 s44, s44, 30720
  s_add_u32 s47, s47, 0x8000
  s_and_b32 s47, s47, 0x1ffff
  v_accvgpr_write_b32 a0, 0
  v_accvgpr_write_b32 a1, 0
  v_accvgpr_write_b32 a2, 0
  v_accvgpr_write_b32 a3, 0
  v_accvgpr_write_b32 a4, 0
  v_accvgpr_write_b32 a5, 0
  v_accvgpr_write_b32 a6, 0
  v_accvgpr_write_b32 a7, 0
  v_accvgpr_write_b32 a8, 0
  v_accvgpr_write_b32 a9, 0
  v_accvgpr_write_b32 a10, 0
  v_accvgpr_write_b32 a11, 0
  v_accvgpr_write_b32 a12, 0
  v_accvgpr_write_b32 a13, 0
  v_accvgpr_write_b32 a14, 0
  v_accvgpr_write_b32 a15, 0
  v_accvgpr_write_b32 a16, 0
  v_accvgpr_write_b32 a17, 0
  v_accvgpr_write_b32 a18, 0
  v_accvgpr_write_b32 a19, 0
  v_accvgpr_write_b32 a20, 0
  v_accvgpr_write_b32 a21, 0
  v_accvgpr_write_b32 a22, 0
  v_accvgpr_write_b32 a23, 0
  v_accvgpr_write_b32 a24, 0
  v_accvgpr_write_b32 a25, 0
  v_accvgpr_write_b32 a26, 0
  v_accvgpr_write_b32 a27, 0
  v_accvgpr_write_b32 a28, 0
  v_accvgpr_write_b32 a29, 0
  v_accvgpr_write_b32 a30, 0
  v_accvgpr_write_b32 a31, 0
  v_accvgpr_write_b32 a32, 0
  v_accvgpr_write_b32 a33, 0
  v_accvgpr_write_b32 a34, 0
  v_accvgpr_write_b32 a35, 0
  v_accvgpr_write_b32 a36, 0
  v_accvgpr_write_b32 a37, 0
  v_accvgpr_write_b32 a38, 0
  v_accvgpr_write_b32 a39, 0
  v_accvgpr_write_b32 a40, 0
  v_accvgpr_write_b32 a41, 0
  v_accvgpr_write_b32 a42, 0
  v_accvgpr_write_b32 a43, 0
  v_accvgpr_write_b32 a44, 0
  v_accvgpr_write_b32 a45, 0
  v_accvgpr_write_b32 a46, 0
  v_accvgpr_write_b32 a47, 0
  v_accvgpr_write_b32 a48, 0
  v_accvgpr_write_b32 a49, 0
  v_accvgpr_write_b32 a50, 0
  v_accvgpr_write_b32 a51, 0
  v_accvgpr_write_b32 a52, 0
  v_accvgpr_write_b32 a53, 0
  v_accvgpr_write_b32 a54, 0
  v_accvgpr_write_b32 a55, 0
  v_accvgpr_write_b32 a56, 0
  v_accvgpr_write_b32 a57, 0
  v_accvgpr_write_b32 a58, 0
  v_accvgpr_write_b32 a59, 0
  v_accvgpr_write_b32 a60, 0
  v_accvgpr_write_b32 a61, 0
  v_accvgpr_write_b32 a62, 0
  v_accvgpr_write_b32 a63, 0
  v_accvgpr_write_b32 a64, 0
  v_accvgpr_write_b32 a65, 0
  v_accvgpr_write_b32 a66, 0
  v_accvgpr_write_b32 a67, 0
  v_accvgpr_write_b32 a68, 0
  v_accvgpr_write_b32 a69, 0
  v_accvgpr_write_b32 a70, 0
  v_accvgpr_write_b32 a71, 0
  v_accvgpr_write_b32 a72, 0
  v_accvgpr_write_b32 a73, 0
  v_accvgpr_write_b32 a74, 0
  v_accvgpr_write_b32 a75, 0
  v_accvgpr_write_b32 a76, 0
  v_accvgpr_write_b32 a77, 0
  v_accvgpr_write_b32 a78, 0
  v_accvgpr_write_b32 a79, 0
  v_accvgpr_write_b32 a80, 0
  v_accvgpr_write_b32 a81, 0
  v_accvgpr_write_b32 a82, 0
  v_accvgpr_write_b32 a83, 0
  v_accvgpr_write_b32 a84, 0
  v_accvgpr_write_b32 a85, 0
  v_accvgpr_write_b32 a86, 0
  v_accvgpr_write_b32 a87, 0
  v_accvgpr_write_b32 a88, 0
  v_accvgpr_write_b32 a89, 0
  v_accvgpr_write_b32 a90, 0
  v_accvgpr_write_b32 a91, 0
  v_accvgpr_write_b32 a92, 0
  v_accvgpr_write_b32 a93, 0
  v_accvgpr_write_b32 a94, 0
  v_accvgpr_write_b32 a95, 0
  v_accvgpr_write_b32 a96, 0
  v_accvgpr_write_b32 a97, 0
  v_accvgpr_write_b32 a98, 0
  v_accvgpr_write_b32 a99, 0
  v_accvgpr_write_b32 a100, 0
  v_accvgpr_write_b32 a101, 0
  v_accvgpr_write_b32 a102, 0
  v_accvgpr_write_b32 a103, 0
  v_accvgpr_write_b32 a104, 0
  v_accvgpr_write_b32 a105, 0
  v_accvgpr_write_b32 a106, 0
  v_accvgpr_write_b32 a107, 0
  v_accvgpr_write_b32 a108, 0
  v_accvgpr_write_b32 a109, 0
  v_accvgpr_write_b32 a110, 0
  v_accvgpr_write_b32 a111, 0
  v_accvgpr_write_b32 a112, 0
  v_accvgpr_write_b32 a113, 0
  v_accvgpr_write_b32 a114, 0
  v_accvgpr_write_b32 a115, 0
  v_accvgpr_write_b32 a116, 0
  v_accvgpr_write_b32 a117, 0
  v_accvgpr_write_b32 a118, 0
  v_accvgpr_write_b32 a119, 0
  v_accvgpr_write_b32 a120, 0
  v_accvgpr_write_b32 a121, 0
  v_accvgpr_write_b32 a122, 0
  v_accvgpr_write_b32 a123, 0
  v_accvgpr_write_b32 a124, 0
  v_accvgpr_write_b32 a125, 0
  v_accvgpr_write_b32 a126, 0
  v_accvgpr_write_b32 a127, 0
  v_accvgpr_write_b32 a128, 0
  v_accvgpr_write_b32 a129, 0
  v_accvgpr_write_b32 a130, 0
  v_accvgpr_write_b32 a131, 0
  v_accvgpr_write_b32 a132, 0
  v_accvgpr_write_b32 a133, 0
  v_accvgpr_write_b32 a134, 0
  v_accvgpr_write_b32 a135, 0
  v_accvgpr_write_b32 a136, 0
  v_accvgpr_write_b32 a137, 0
  v_accvgpr_write_b32 a138, 0
  v_accvgpr_write_b32 a139, 0
  v_accvgpr_write_b32 a140, 0
  v_accvgpr_write_b32 a141, 0
  v_accvgpr_write_b32 a142, 0
  v_accvgpr_write_b32 a143, 0
  v_accvgpr_write_b32 a144, 0
  v_accvgpr_write_b32 a145, 0
  v_accvgpr_write_b32 a146, 0
  v_accvgpr_write_b32 a147, 0
  v_accvgpr_write_b32 a148, 0
  v_accvgpr_write_b32 a149, 0
  v_accvgpr_write_b32 a150, 0
  v_accvgpr_write_b32 a151, 0
  v_accvgpr_write_b32 a152, 0
  v_accvgpr_write_b32 a153, 0
  v_accvgpr_write_b32 a154, 0
  v_accvgpr_write_b32 a155, 0
  v_accvgpr_write_b32 a156, 0
  v_accvgpr_write_b32 a157, 0
  v_accvgpr_write_b32 a158, 0
  v_accvgpr_write_b32 a159, 0
  v_accvgpr_write_b32 a160, 0
  v_accvgpr_write_b32 a161, 0
  v_accvgpr_write_b32 a162, 0
  v_accvgpr_write_b32 a163, 0
  v_accvgpr_write_b32 a164, 0
  v_accvgpr_write_b32 a165, 0
  v_accvgpr_write_b32 a166, 0
  v_accvgpr_write_b32 a167, 0
  v_accvgpr_write_b32 a168, 0
  v_accvgpr_write_b32 a169, 0
  v_accvgpr_write_b32 a170, 0
  v_accvgpr_write_b32 a171, 0
  v_accvgpr_write_b32 a172, 0
  v_accvgpr_write_b32 a173, 0
  v_accvgpr_write_b32 a174, 0
  v_accvgpr_write_b32 a175, 0
  v_accvgpr_write_b32 a176, 0
  v_accvgpr_write_b32 a177, 0
  v_accvgpr_write_b32 a178, 0
  v_accvgpr_write_b32 a179, 0
  v_accvgpr_write_b32 a180, 0
  v_accvgpr_write_b32 a181, 0
  v_accvgpr_write_b32 a182, 0
  v_accvgpr_write_b32 a183, 0
  v_accvgpr_write_b32 a184, 0
  v_accvgpr_write_b32 a185, 0
  v_accvgpr_write_b32 a186, 0
  v_accvgpr_write_b32 a187, 0
  v_accvgpr_write_b32 a188, 0
  v_accvgpr_write_b32 a189, 0
  v_accvgpr_write_b32 a190, 0
  v_accvgpr_write_b32 a191, 0
  v_accvgpr_write_b32 a192, 0
  v_accvgpr_write_b32 a193, 0
  v_accvgpr_write_b32 a194, 0
  v_accvgpr_write_b32 a195, 0
  v_accvgpr_write_b32 a196, 0
  v_accvgpr_write_b32 a197, 0
  v_accvgpr_write_b32 a198, 0
  v_accvgpr_write_b32 a199, 0
  v_accvgpr_write_b32 a200, 0
  v_accvgpr_write_b32 a201, 0
  v_accvgpr_write_b32 a202, 0
  v_accvgpr_write_b32 a203, 0
  v_accvgpr_write_b32 a204, 0
  v_accvgpr_write_b32 a205, 0
  v_accvgpr_write_b32 a206, 0
  v_accvgpr_write_b32 a207, 0
  v_accvgpr_write_b32 a208, 0
  v_accvgpr_write_b32 a209, 0
  v_accvgpr_write_b32 a210, 0
  v_accvgpr_write_b32 a211, 0
  v_accvgpr_write_b32 a212, 0
  v_accvgpr_write_b32 a213, 0
  v_accvgpr_write_b32 a214, 0
  v_accvgpr_write_b32 a215, 0
  v_accvgpr_write_b32 a216, 0
  v_accvgpr_write_b32 a217, 0
  v_accvgpr_write_b32 a218, 0
  v_accvgpr_write_b32 a219, 0
  v_accvgpr_write_b32 a220, 0
  v_accvgpr_write_b32 a221, 0
  v_accvgpr_write_b32 a222, 0
  v_accvgpr_write_b32 a223, 0
  v_accvgpr_write_b32 a224, 0
  v_accvgpr_write_b32 a225, 0
  v_accvgpr_write_b32 a226, 0
  v_accvgpr_write_b32 a227, 0
  v_accvgpr_write_b32 a228, 0
  v_accvgpr_write_b32 a229, 0
  v_accvgpr_write_b32 a230, 0
  v_accvgpr_write_b32 a231, 0
  v_accvgpr_write_b32 a232, 0
  v_accvgpr_write_b32 a233, 0
  v_accvgpr_write_b32 a234, 0
  v_accvgpr_write_b32 a235, 0
  v_accvgpr_write_b32 a236, 0
  v_accvgpr_write_b32 a237, 0
  v_accvgpr_write_b32 a238, 0
  v_accvgpr_write_b32 a239, 0
  s_waitcnt vmcnt(20)
  s_barrier
  ds_read_b128 v[48:51], v8 offset:0
  ds_read_b128 v[52:55], v8 offset:1024
  ds_read_b128 v[56:59], v8 offset:2048
  ds_read_b128 v[60:63], v8 offset:3072
  ds_read_b128 v[64:67], v8 offset:4096
  ds_read_b128 v[68:71], v8 offset:5120
  ds_read_b128 v[72:75], v8 offset:6144
  ds_read_b128 v[76:79], v8 offset:7168
  ds_read_b128 v[80:83], v8 offset:8192
  ds_read_b128 v[84:87], v8 offset:9216
  ds_read_b128 v[88:91], v8 offset:10240
  ds_read_b128 v[92:95], v8 offset:11264
  ds_read_b128 v[96:99], v8 offset:12288
  ds_read_b128 v[100:103], v8 offset:13312
  ds_read_b128 v[104:107], v8 offset:14336
L_ag_57:
  s_waitcnt lgkmcnt(0)
  v_mfma_f32_32x32x16_bf16 a[0:15], v[48:51], v[16:19], a[0:15]
  ds_read_b128 v[108:111], v8 offset:15360
  buffer_load_dwordx4 v[40:43], v6, s[12:15], s38 offen
  s_add_u32 s38, s38, 16
  s_add_u32 s39, s39, 1
  s_cmp_eq_u32 s39, 10
  s_cselect_b32 s52, 160, 0
  s_cselect_b32 s39, 0, s39
  s_add_u32 s38, s38, s52
  v_mfma_f32_32x32x16_bf16 a[16:31], v[52:55], v[16:19], a[16:31]
  ds_read_b128 v[112:115], v8 offset:16384
  buffer_load_dwordx4 v[44:47], v6, s[12:15], s38 offen
  s_add_u32 s38, s38, 16
  s_add_u32 s39, s39, 1
  s_cmp_eq_u32 s39, 10
  s_cselect_b32 s52, 160, 0
  s_cselect_b32 s39, 0, s39
  s_add_u32 s38, s38, s52
  v_mfma_f32_32x32x16_bf16 a[32:47], v[56:59], v[16:19], a[32:47]
  ds_read_b128 v[116:119], v8 offset:17408
  s_add_u32 m0, s48, s47
  s_add_u32 s53, s44, 0
  v_mfma_f32_32x32x16_bf16 a[48:63], v[60:63], v[16:19], a[48:63]
  ds_read_b128 v[120:123], v8 offset:18432
  buffer_load_dwordx4 v3, s[4:7], s53 offen offset:0 sc1 lds
  v_mfma_f32_32x32x16_bf16 a[64:79], v[64:67], v[16:19], a[64:79]
  ds_read_b128 v[124:127], v8 offset:19456
  buffer_load_dwordx4 v3, s[4:7], s53 offen offset:1024 sc1 lds
  v_mfma_f32_32x32x16_bf16 a[80:95], v[68:71], v[16:19], a[80:95]
  ds_read_b128 v[128:131], v8 offset:20480
  buffer_load_dwordx4 v3, s[4:7], s53 offen offset:2048 sc1 lds
  v_mfma_f32_32x32x16_bf16 a[96:111], v[72:75], v[16:19], a[96:111]
  ds_read_b128 v[132:135], v8 offset:21504
  buffer_load_dwordx4 v3, s[4:7], s53 offen offset:3072 sc1 lds
  v_mfma_f32_32x32x16_bf16 a[112:127], v[76:79], v[16:19], a[112:127]
  ds_read_b128 v[136:139], v8 offset:22528
  s_add_u32 m0, m0, 4096
  s_add_u32 s53, s44, 4096
  v_mfma_f32_32x32x16_bf16 a[128:143], v[80:83], v[16:19], a[128:143]
  ds_read_b128 v[140:143], v8 offset:23552
  buffer_load_dwordx4 v3, s[4:7], s53 offen offset:0 sc1 lds
  v_mfma_f32_32x32x16_bf16 a[144:159], v[84:87], v[16:19], a[144:159]
  ds_read_b128 v[144:147], v8 offset:24576
  buffer_load_dwordx4 v3, s[4:7], s53 offen offset:1024 sc1 lds
  v_mfma_f32_32x32x16_bf16 a[160:175], v[88:91], v[16:19], a[160:175]
  ds_read_b128 v[148:151], v8 offset:25600
  buffer_load_dwordx4 v3, s[4:7], s53 offen offset:2048 sc1 lds
  v_mfma_f32_32x32x16_bf16 a[176:191], v[92:95], v[16:19], a[176:191]
  ds_read_b128 v[152:155], v8 offset:26624
  buffer_load_dwordx4 v3, s[4:7], s53 offen offset:3072 sc1 lds
  v_mfma_f32_32x32x16_bf16 a[192:207], v[96:99], v[16:19], a[192:207]
  ds_read_b128 v[156:159], v8 offset:27648
  s_add_u32 s44, s44, 30720
  s_add_u32 s47, s47, 0x8000
  s_and_b32 s47, s47, 0x1ffff
  v_mfma_f32_32x32x16_bf16 a[208:223], v[100:103], v[16:19], a[208:223]
  ds_read_b128 v[160:163], v8 offset:28672
  v_mfma_f32_32x32x16_bf16 a[224:239], v[104:107], v[16:19], a[224:239]
  ds_read_b128 v[164:167], v8 offset:29696
  s_waitcnt lgkmcnt(0)
  v_mfma_f32_32x32x16_bf16 a[0:15], v[108:111], v[20:23], a[0:15]
  v_add_u32 v8, 0x8000, v8
  v_and_b32 v8, 0x1ffff, v8
  s_waitcnt vmcnt(20)
  s_barrier
  ds_read_b128 v[48:51], v8 offset:0
  v_mfma_f32_32x32x16_bf16 a[16:31], v[112:115], v[20:23], a[16:31]
  ds_read_b128 v[52:55], v8 offset:1024
  v_mfma_f32_32x32x16_bf16 a[32:47], v[116:119], v[20:23], a[32:47]
  ds_read_b128 v[56:59], v8 offset:2048
  v_mfma_f32_32x32x16_bf16 a[48:63], v[120:123], v[20:23], a[48:63]
  ds_read_b128 v[60:63], v8 offset:3072
  v_mfma_f32_32x32x16_bf16 a[64:79], v[124:127], v[20:23], a[64:79]
  ds_read_b128 v[64:67], v8 offset:4096
  v_mfma_f32_32x32x16_bf16 a[80:95], v[128:131], v[20:23], a[80:95]
  ds_read_b128 v[68:71], v8 offset:5120
  v_mfma_f32_32x32x16_bf16 a[96:111], v[132:135], v[20:23], a[96:111]
  ds_read_b128 v[72:75], v8 offset:6144
  v_mfma_f32_32x32x16_bf16 a[112:127], v[136:139], v[20:23], a[112:127]
  ds_read_b128 v[76:79], v8 offset:7168
  v_mfma_f32_32x32x16_bf16 a[128:143], v[140:143], v[20:23], a[128:143]
  ds_read_b128 v[80:83], v8 offset:8192
  v_mfma_f32_32x32x16_bf16 a[144:159], v[144:147], v[20:23], a[144:159]
  ds_read_b128 v[84:87], v8 offset:9216
  v_mfma_f32_32x32x16_bf16 a[160:175], v[148:151], v[20:23], a[160:175]
  ds_read_b128 v[88:91], v8 offset:10240
  v_mfma_f32_32x32x16_bf16 a[176:191], v[152:155], v[20:23], a[176:191]
  ds_read_b128 v[92:95], v8 offset:11264
  v_mfma_f32_32x32x16_bf16 a[192:207], v[156:159], v[20:23], a[192:207]
  ds_read_b128 v[96:99], v8 offset:12288
  v_mfma_f32_32x32x16_bf16 a[208:223], v[160:163], v[20:23], a[208:223]
  ds_read_b128 v[100:103], v8 offset:13312
  v_mfma_f32_32x32x16_bf16 a[224:239], v[164:167], v[20:23], a[224:239]
  ds_read_b128 v[104:107], v8 offset:14336
  s_waitcnt lgkmcnt(0)
  v_mfma_f32_32x32x16_bf16 a[0:15], v[48:51], v[24:27], a[0:15]
  ds_read_b128 v[108:111], v8 offset:15360
  buffer_load_dwordx4 v[16:19], v6, s[12:15], s38 offen
  s_add_u32 s38, s38, 16
  s_add_u32 s39, s39, 1
  s_cmp_eq_u32 s39, 10
  s_cselect_b32 s52, 160, 0
  s_cselect_b32 s39, 0, s39
  s_add_u32 s38, s38, s52
  v_mfma_f32_32x32x16_bf16 a[16:31], v[52:55], v[24:27], a[16:31]
  ds_read_b128 v[112:115], v8 offset:16384
  buffer_load_dwordx4 v[20:23], v6, s[12:15], s38 offen
  s_add_u32 s38, s38, 16
  s_add_u32 s39, s39, 1
  s_cmp_eq_u32 s39, 10
  s_cselect_b32 s52, 160, 0
  s_cselect_b32 s39, 0, s39
  s_add_u32 s38, s38, s52
  v_mfma_f32_32x32x16_bf16 a[32:47], v[56:59], v[24:27], a[32:47]
  ds_read_b128 v[116:119], v8 offset:17408
  s_add_u32 m0, s48, s47
  s_add_u32 s53, s44, 0
  v_mfma_f32_32x32x16_bf16 a[48:63], v[60:63], v[24:27], a[48:63]
  ds_read_b128 v[120:123], v8 offset:18432
  buffer_load_dwordx4 v3, s[4:7], s53 offen offset:0 sc1 lds
  v_mfma_f32_32x32x16_bf16 a[64:79], v[64:67], v[24:27], a[64:79]
  ds_read_b128 v[124:127], v8 offset:19456
  buffer_load_dwordx4 v3, s[4:7], s53 offen offset:1024 sc1 lds
  v_mfma_f32_32x32x16_bf16 a[80:95], v[68:71], v[24:27], a[80:95]
  ds_read_b128 v[128:131], v8 offset:20480
  buffer_load_dwordx4 v3, s[4:7], s53 offen offset:2048 sc1 lds
  v_mfma_f32_32x32x16_bf16 a[96:111], v[72:75], v[24:27], a[96:111]
  ds_read_b128 v[132:135], v8 offset:21504
  buffer_load_dwordx4 v3, s[4:7], s53 offen offset:3072 sc1 lds
  v_mfma_f32_32x32x16_bf16 a[112:127], v[76:79], v[24:27], a[112:127]
  ds_read_b128 v[136:139], v8 offset:22528
  s_add_u32 m0, m0, 4096
  s_add_u32 s53, s44, 4096
  v_mfma_f32_32x32x16_bf16 a[128:143], v[80:83], v[24:27], a[128:143]
  ds_read_b128 v[140:143], v8 offset:23552
  buffer_load_dwordx4 v3, s[4:7], s53 offen offset:0 sc1 lds
  v_mfma_f32_32x32x16_bf16 a[144:159], v[84:87], v[24:27], a[144:159]
  ds_read_b128 v[144:147], v8 offset:24576
  buffer_load_dwordx4 v3, s[4:7], s53 offen offset:1024 sc1 lds
  v_mfma_f32_32x32x16_bf16 a[160:175], v[88:91], v[24:27], a[160:175]
  ds_read_b128 v[148:151], v8 offset:25600
  buffer_load_dwordx4 v3, s[4:7], s53 offen offset:2048 sc1 lds
  v_mfma_f32_32x32x16_bf16 a[176:191], v[92:95], v[24:27], a[176:191]
  ds_read_b128 v[152:155], v8 offset:26624
  buffer_load_dwordx4 v3, s[4:7], s53 offen offset:3072 sc1 lds
  v_mfma_f32_32x32x16_bf16 a[192:207], v[96:99], v[24:27], a[192:207]
  ds_read_b128 v[156:159], v8 offset:27648
  s_add_u32 s44, s44, 30720
  s_add_u32 s47, s47, 0x8000
  s_and_b32 s47, s47, 0x1ffff
  v_mfma_f32_32x32x16_bf16 a[208:223], v[100:103], v[24:27], a[208:223]
  ds_read_b128 v[160:163], v8 offset:28672
  v_mfma_f32_32x32x16_bf16 a[224:239], v[104:107], v[24:27], a[224:239]
  ds_read_b128 v[164:167], v8 offset:29696
  s_waitcnt lgkmcnt(0)
  v_mfma_f32_32x32x16_bf16 a[0:15], v[108:111], v[28:31], a[0:15]
  v_add_u32 v8, 0x8000, v8
  v_and_b32 v8, 0x1ffff, v8
  s_waitcnt vmcnt(20)
  s_barrier
  ds_read_b128 v[48:51], v8 offset:0
  v_mfma_f32_32x32x16_bf16 a[16:31], v[112:115], v[28:31], a[16:31]
  ds_read_b128 v[52:55], v8 offset:1024
  v_mfma_f32_32x32x16_bf16 a[32:47], v[116:119], v[28:31], a[32:47]
  ds_read_b128 v[56:59], v8 offset:2048
  v_mfma_f32_32x32x16_bf16 a[48:63], v[120:123], v[28:31], a[48:63]
  ds_read_b128 v[60:63], v8 offset:3072
  v_mfma_f32_32x32x16_bf16 a[64:79], v[124:127], v[28:31], a[64:79]
  ds_read_b128 v[64:67], v8 offset:4096
  v_mfma_f32_32x32x16_bf16 a[80:95], v[128:131], v[28:31], a[80:95]
  ds_read_b128 v[68:71], v8 offset:5120
  v_mfma_f32_32x32x16_bf16 a[96:111], v[132:135], v[28:31], a[96:111]
  ds_read_b128 v[72:75], v8 offset:6144
  v_mfma_f32_32x32x16_bf16 a[112:127], v[136:139], v[28:31], a[112:127]
  ds_read_b128 v[76:79], v8 offset:7168
  v_mfma_f32_32x32x16_bf16 a[128:143], v[140:143], v[28:31], a[128:143]
  ds_read_b128 v[80:83], v8 offset:8192
  v_mfma_f32_32x32x16_bf16 a[144:159], v[144:147], v[28:31], a[144:159]
  ds_read_b128 v[84:87], v8 offset:9216
  v_mfma_f32_32x32x16_bf16 a[160:175], v[148:151], v[28:31], a[160:175]
  ds_read_b128 v[88:91], v8 offset:10240
  v_mfma_f32_32x32x16_bf16 a[176:191], v[152:155], v[28:31], a[176:191]
  ds_read_b128 v[92:95], v8 offset:11264
  v_mfma_f32_32x32x16_bf16 a[192:207], v[156:159], v[28:31], a[192:207]
  ds_read_b128 v[96:99], v8 offset:12288
  v_mfma_f32_32x32x16_bf16 a[208:223], v[160:163], v[28:31], a[208:223]
  ds_read_b128 v[100:103], v8 offset:13312
  v_mfma_f32_32x32x16_bf16 a[224:239], v[164:167], v[28:31], a[224:239]
  ds_read_b128 v[104:107], v8 offset:14336
  s_waitcnt lgkmcnt(0)
  v_mfma_f32_32x32x16_bf16 a[0:15], v[48:51], v[32:35], a[0:15]
  ds_read_b128 v[108:111], v8 offset:15360
  buffer_load_dwordx4 v[24:27], v6, s[12:15], s38 offen
  s_add_u32 s38, s38, 16
  s_add_u32 s39, s39, 1
  s_cmp_eq_u32 s39, 10
  s_cselect_b32 s52, 160, 0
  s_cselect_b32 s39, 0, s39
  s_add_u32 s38, s38, s52
  v_mfma_f32_32x32x16_bf16 a[16:31], v[52:55], v[32:35], a[16:31]
  ds_read_b128 v[112:115], v8 offset:16384
  buffer_load_dwordx4 v[28:31], v6, s[12:15], s38 offen
  s_add_u32 s38, s38, 16
  s_add_u32 s39, s39, 1
  s_cmp_eq_u32 s39, 10
  s_cselect_b32 s52, 160, 0
  s_cselect_b32 s39, 0, s39
  s_add_u32 s38, s38, s52
  v_mfma_f32_32x32x16_bf16 a[32:47], v[56:59], v[32:35], a[32:47]
  ds_read_b128 v[116:119], v8 offset:17408
  s_add_u32 m0, s48, s47
  s_add_u32 s53, s44, 0
  v_mfma_f32_32x32x16_bf16 a[48:63], v[60:63], v[32:35], a[48:63]
  ds_read_b128 v[120:123], v8 offset:18432
  buffer_load_dwordx4 v3, s[4:7], s53 offen offset:0 sc1 lds
  v_mfma_f32_32x32x16_bf16 a[64:79], v[64:67], v[32:35], a[64:79]
  ds_read_b128 v[124:127], v8 offset:19456
  buffer_load_dwordx4 v3, s[4:7], s53 offen offset:1024 sc1 lds
  v_mfma_f32_32x32x16_bf16 a[80:95], v[68:71], v[32:35], a[80:95]
  ds_read_b128 v[128:131], v8 offset:20480
  buffer_load_dwordx4 v3, s[4:7], s53 offen offset:2048 sc1 lds
  v_mfma_f32_32x32x16_bf16 a[96:111], v[72:75], v[32:35], a[96:111]
  ds_read_b128 v[132:135], v8 offset:21504
  buffer_load_dwordx4 v3, s[4:7], s53 offen offset:3072 sc1 lds
  v_mfma_f32_32x32x16_bf16 a[112:127], v[76:79], v[32:35], a[112:127]
  ds_read_b128 v[136:139], v8 offset:22528
  s_add_u32 m0, m0, 4096
  s_add_u32 s53, s44, 4096
  v_mfma_f32_32x32x16_bf16 a[128:143], v[80:83], v[32:35], a[128:143]
  ds_read_b128 v[140:143], v8 offset:23552
  buffer_load_dwordx4 v3, s[4:7], s53 offen offset:0 sc1 lds
  v_mfma_f32_32x32x16_bf16 a[144:159], v[84:87], v[32:35], a[144:159]
  ds_read_b128 v[144:147], v8 offset:24576
  buffer_load_dwordx4 v3, s[4:7], s53 offen offset:1024 sc1 lds
  v_mfma_f32_32x32x16_bf16 a[160:175], v[88:91], v[32:35], a[160:175]
  ds_read_b128 v[148:151], v8 offset:25600
  buffer_load_dwordx4 v3, s[4:7], s53 offen offset:2048 sc1 lds
  v_mfma_f32_32x32x16_bf16 a[176:191], v[92:95], v[32:35], a[176:191]
  ds_read_b128 v[152:155], v8 offset:26624
  buffer_load_dwordx4 v3, s[4:7], s53 offen offset:3072 sc1 lds
  v_mfma_f32_32x32x16_bf16 a[192:207], v[96:99], v[32:35], a[192:207]
  ds_read_b128 v[156:159], v8 offset:27648
  s_add_u32 s44, s44, 30720
  s_add_u32 s47, s47, 0x8000
  s_and_b32 s47, s47, 0x1ffff
  v_mfma_f32_32x32x16_bf16 a[208:223], v[100:103], v[32:35], a[208:223]
  ds_read_b128 v[160:163], v8 offset:28672
  v_mfma_f32_32x32x16_bf16 a[224:239], v[104:107], v[32:35], a[224:239]
  ds_read_b128 v[164:167], v8 offset:29696
  s_waitcnt lgkmcnt(0)
  v_mfma_f32_32x32x16_bf16 a[0:15], v[108:111], v[36:39], a[0:15]
  v_add_u32 v8, 0x8000, v8
  v_and_b32 v8, 0x1ffff, v8
  s_waitcnt vmcnt(20)
  s_barrier
  ds_read_b128 v[48:51], v8 offset:0
  v_mfma_f32_32x32x16_bf16 a[16:31], v[112:115], v[36:39], a[16:31]
  ds_read_b128 v[52:55], v8 offset:1024
  v_mfma_f32_32x32x16_bf16 a[32:47], v[116:119], v[36:39], a[32:47]
  ds_read_b128 v[56:59], v8 offset:2048
  v_mfma_f32_32x32x16_bf16 a[48:63], v[120:123], v[36:39], a[48:63]
  ds_read_b128 v[60:63], v8 offset:3072
  v_mfma_f32_32x32x16_bf16 a[64:79], v[124:127], v[36:39], a[64:79]
  ds_read_b128 v[64:67], v8 offset:4096
  v_mfma_f32_32x32x16_bf16 a[80:95], v[128:131], v[36:39], a[80:95]
  ds_read_b128 v[68:71], v8 offset:5120
  v_mfma_f32_32x32x16_bf16 a[96:111], v[132:135], v[36:39], a[96:111]
  ds_read_b128 v[72:75], v8 offset:6144
  v_mfma_f32_32x32x16_bf16 a[112:127], v[136:139], v[36:39], a[112:127]
  ds_read_b128 v[76:79], v8 offset:7168
  v_mfma_f32_32x32x16_bf16 a[128:143], v[140:143], v[36:39], a[128:143]
  ds_read_b128 v[80:83], v8 offset:8192
  v_mfma_f32_32x32x16_bf16 a[144:159], v[144:147], v[36:39], a[144:159]
  ds_read_b128 v[84:87], v8 offset:9216
  v_mfma_f32_32x32x16_bf16 a[160:175], v[148:151], v[36:39], a[160:175]
  ds_read_b128 v[88:91], v8 offset:10240
  v_mfma_f32_32x32x16_bf16 a[176:191], v[152:155], v[36:39], a[176:191]
  ds_read_b128 v[92:95], v8 offset:11264
  v_mfma_f32_32x32x16_bf16 a[192:207], v[156:159], v[36:39], a[192:207]
  ds_read_b128 v[96:99], v8 offset:12288
  v_mfma_f32_32x32x16_bf16 a[208:223], v[160:163], v[36:39], a[208:223]
  ds_read_b128 v[100:103], v8 offset:13312
  v_mfma_f32_32x32x16_bf16 a[224:239], v[164:167], v[36:39], a[224:239]
  ds_read_b128 v[104:107], v8 offset:14336
  s_waitcnt lgkmcnt(0)
  v_mfma_f32_32x32x16_bf16 a[0:15], v[48:51], v[40:43], a[0:15]
  ds_read_b128 v[108:111], v8 offset:15360
  buffer_load_dwordx4 v[32:35], v6, s[12:15], s38 offen
  s_add_u32 s38, s38, 16
  s_add_u32 s39, s39, 1
  s_cmp_eq_u32 s39, 10
  s_cselect_b32 s52, 160, 0
  s_cselect_b32 s39, 0, s39
  s_add_u32 s38, s38, s52
  v_mfma_f32_32x32x16_bf16 a[16:31], v[52:55], v[40:43], a[16:31]
  ds_read_b128 v[112:115], v8 offset:16384
  buffer_load_dwordx4 v[36:39], v6, s[12:15], s38 offen
  s_add_u32 s38, s38, 16
  s_add_u32 s39, s39, 1
  s_cmp_eq_u32 s39, 10
  s_cselect_b32 s52, 160, 0
  s_cselect_b32 s39, 0, s39
  s_add_u32 s38, s38, s52
  v_mfma_f32_32x32x16_bf16 a[32:47], v[56:59], v[40:43], a[32:47]
  ds_read_b128 v[116:119], v8 offset:17408
  s_add_u32 m0, s48, s47
  s_add_u32 s53, s44, 0
  v_mfma_f32_32x32x16_bf16 a[48:63], v[60:63], v[40:43], a[48:63]
  ds_read_b128 v[120:123], v8 offset:18432
  buffer_load_dwordx4 v3, s[4:7], s53 offen offset:0 sc1 lds
  v_mfma_f32_32x32x16_bf16 a[64:79], v[64:67], v[40:43], a[64:79]
  ds_read_b128 v[124:127], v8 offset:19456
  buffer_load_dwordx4 v3, s[4:7], s53 offen offset:1024 sc1 lds
  v_mfma_f32_32x32x16_bf16 a[80:95], v[68:71], v[40:43], a[80:95]
  ds_read_b128 v[128:131], v8 offset:20480
  buffer_load_dwordx4 v3, s[4:7], s53 offen offset:2048 sc1 lds
  v_mfma_f32_32x32x16_bf16 a[96:111], v[72:75], v[40:43], a[96:111]
  ds_read_b128 v[132:135], v8 offset:21504
  buffer_load_dwordx4 v3, s[4:7], s53 offen offset:3072 sc1 lds
  v_mfma_f32_32x32x16_bf16 a[112:127], v[76:79], v[40:43], a[112:127]
  ds_read_b128 v[136:139], v8 offset:22528
  s_add_u32 m0, m0, 4096
  s_add_u32 s53, s44, 4096
  v_mfma_f32_32x32x16_bf16 a[128:143], v[80:83], v[40:43], a[128:143]
  ds_read_b128 v[140:143], v8 offset:23552
  buffer_load_dwordx4 v3, s[4:7], s53 offen offset:0 sc1 lds
  v_mfma_f32_32x32x16_bf16 a[144:159], v[84:87], v[40:43], a[144:159]
  ds_read_b128 v[144:147], v8 offset:24576
  buffer_load_dwordx4 v3, s[4:7], s53 offen offset:1024 sc1 lds
  v_mfma_f32_32x32x16_bf16 a[160:175], v[88:91], v[40:43], a[160:175]
  ds_read_b128 v[148:151], v8 offset:25600
  buffer_load_dwordx4 v3, s[4:7], s53 offen offset:2048 sc1 lds
  v_mfma_f32_32x32x16_bf16 a[176:191], v[92:95], v[40:43], a[176:191]
  ds_read_b128 v[152:155], v8 offset:26624
  buffer_load_dwordx4 v3, s[4:7], s53 offen offset:3072 sc1 lds
  v_mfma_f32_32x32x16_bf16 a[192:207], v[96:99], v[40:43], a[192:207]
  ds_read_b128 v[156:159], v8 offset:27648
  s_add_u32 s44, s44, 30720
  s_add_u32 s47, s47, 0x8000
  s_and_b32 s47, s47, 0x1ffff
  v_mfma_f32_32x32x16_bf16 a[208:223], v[100:103], v[40:43], a[208:223]
  ds_read_b128 v[160:163], v8 offset:28672
  v_mfma_f32_32x32x16_bf16 a[224:239], v[104:107], v[40:43], a[224:239]
  ds_read_b128 v[164:167], v8 offset:29696
  s_waitcnt lgkmcnt(0)
  v_mfma_f32_32x32x16_bf16 a[0:15], v[108:111], v[44:47], a[0:15]
  v_add_u32 v8, 0x8000, v8
  v_and_b32 v8, 0x1ffff, v8
  s_waitcnt vmcnt(20)
  s_barrier
  ds_read_b128 v[48:51], v8 offset:0
  v_mfma_f32_32x32x16_bf16 a[16:31], v[112:115], v[44:47], a[16:31]
  ds_read_b128 v[52:55], v8 offset:1024
  v_mfma_f32_32x32x16_bf16 a[32:47], v[116:119], v[44:47], a[32:47]
  ds_read_b128 v[56:59], v8 offset:2048
  v_mfma_f32_32x32x16_bf16 a[48:63], v[120:123], v[44:47], a[48:63]
  ds_read_b128 v[60:63], v8 offset:3072
  v_mfma_f32_32x32x16_bf16 a[64:79], v[124:127], v[44:47], a[64:79]
  ds_read_b128 v[64:67], v8 offset:4096
  v_mfma_f32_32x32x16_bf16 a[80:95], v[128:131], v[44:47], a[80:95]
  ds_read_b128 v[68:71], v8 offset:5120
  v_mfma_f32_32x32x16_bf16 a[96:111], v[132:135], v[44:47], a[96:111]
  ds_read_b128 v[72:75], v8 offset:6144
  v_mfma_f32_32x32x16_bf16 a[112:127], v[136:139], v[44:47], a[112:127]
  ds_read_b128 v[76:79], v8 offset:7168
  v_mfma_f32_32x32x16_bf16 a[128:143], v[140:143], v[44:47], a[128:143]
  ds_read_b128 v[80:83], v8 offset:8192
  v_mfma_f32_32x32x16_bf16 a[144:159], v[144:147], v[44:47], a[144:159]
  ds_read_b128 v[84:87], v8 offset:9216
  v_mfma_f32_32x32x16_bf16 a[160:175], v[148:151], v[44:47], a[160:175]
  ds_read_b128 v[88:91], v8 offset:10240
  v_mfma_f32_32x32x16_bf16 a[176:191], v[152:155], v[44:47], a[176:191]
  ds_read_b128 v[92:95], v8 offset:11264
  v_mfma_f32_32x32x16_bf16 a[192:207], v[156:159], v[44:47], a[192:207]
  ds_read_b128 v[96:99], v8 offset:12288
  v_mfma_f32_32x32x16_bf16 a[208:223], v[160:163], v[44:47], a[208:223]
  ds_read_b128 v[100:103], v8 offset:13312
  v_mfma_f32_32x32x16_bf16 a[224:239], v[164:167], v[44:47], a[224:239]
  ds_read_b128 v[104:107], v8 offset:14336
  s_add_u32 s40, s40, 4
  s_cmp_lt_u32 s40, 20
  s_cbranch_scc1 L_ag_57
  s_waitcnt vmcnt(0) lgkmcnt(0)
  s_barrier
  s_lshl_b32 s52, s28, 5
  v_add_u32 v8, s52, v4
  v_mul_u32_u24 v9, 640, v8
  v_mul_u32_u24 v7, 320, v5
  v_add_u32 v9, v9, v7
  v_mul_u32_u24 v10, 400, v8
  v_mul_u32_u24 v7, 192, v5
  s_mov_b32 s42, 81920
  v_add3_u32 v10, v10, v7, s42
  v_accvgpr_read_b32 v40, a80
  v_accvgpr_read_b32 v41, a81
  v_accvgpr_read_b32 v42, a82
  v_accvgpr_read_b32 v43, a83
  v_accvgpr_read_b32 v44, a84
  v_accvgpr_read_b32 v45, a85
  v_accvgpr_read_b32 v46, a86
  v_accvgpr_read_b32 v47, a87
  v_accvgpr_read_b32 v48, a88
  v_accvgpr_read_b32 v49, a89
  v_accvgpr_read_b32 v50, a90
  v_accvgpr_read_b32 v51, a91
  v_accvgpr_read_b32 v52, a92
  v_accvgpr_read_b32 v53, a93
  v_accvgpr_read_b32 v54, a94
  v_accvgpr_read_b32 v55, a95
  v_accvgpr_read_b32 v56, a96
  v_accvgpr_read_b32 v57, a97
  v_accvgpr_read_b32 v58, a98
  v_accvgpr_read_b32 v59, a99
  v_max3_f32 v80, v40, v41, v42
  v_min3_f32 v81, v40, v41, v42
  v_max3_f32 v80, v80, v43, v44
  v_min3_f32 v81, v81, v43, v44
  v_max3_f32 v80, v80, v45, v46
  v_min3_f32 v81, v81, v45, v46
  v_max3_f32 v80, v80, v47, v48
  v_min3_f32 v81, v81, v47, v48
  v_max3_f32 v80, v80, v49, v50
  v_min3_f32 v81, v81, v49, v50
  v_max3_f32 v80, v80, v51, v52
  v_min3_f32 v81, v81, v51, v52
  v_max3_f32 v80, v80, v53, v54
  v_min3_f32 v81, v81, v53, v54
  v_max3_f32 v80, v80, v55, v56
  v_min3_f32 v81, v81, v55, v56
  v_max3_f32 v80, v80, v57, v58
  v_min3_f32 v81, v81, v57, v58
  v_max_f32 v80, v80, v59
  v_min_f32 v81, v81, v59
  v_mul_f32 v80, s41, v80
  v_mul_f32 v81, s41, v81
  v_fma_f32 v60, -v40, s41, v81
  v_fma_f32 v40, v40, s41, -v80
  v_fma_f32 v61, -v41, s41, v81
  v_fma_f32 v41, v41, s41, -v80
  v_fma_f32 v62, -v42, s41, v81
  v_fma_f32 v42, v42, s41, -v80
  v_fma_f32 v63, -v43, s41, v81
  v_fma_f32 v43, v43, s41, -v80
  v_fma_f32 v64, -v44, s41, v81
  v_fma_f32 v44, v44, s41, -v80
  v_fma_f32 v65, -v45, s41, v81
  v_fma_f32 v45, v45, s41, -v80
  v_fma_f32 v66, -v46, s41, v81
  v_fma_f32 v46, v46, s41, -v80
  v_fma_f32 v67, -v47, s41, v81
  v_fma_f32 v47, v47, s41, -v80
  v_fma_f32 v68, -v48, s41, v81
  v_fma_f32 v48, v48, s41, -v80
  v_fma_f32 v69, -v49, s41, v81
  v_fma_f32 v49, v49, s41, -v80
  v_fma_f32 v70, -v50, s41, v81
  v_fma_f32 v50, v50, s41, -v80
  v_fma_f32 v71, -v51, s41, v81
  v_fma_f32 v51, v51, s41, -v80
  v_fma_f32 v72, -v52, s41, v81
  v_fma_f32 v52, v52, s41, -v80
  v_fma_f32 v73, -v53, s41, v81
  v_fma_f32 v53, v53, s41, -v80
  v_fma_f32 v74, -v54, s41, v81
  v_fma_f32 v54, v54, s41, -v80
  v_fma_f32 v75, -v55, s41, v81
  v_fma_f32 v55, v55, s41, -v80
  v_fma_f32 v76, -v56, s41, v81
  v_fma_f32 v56, v56, s41, -v80
  v_fma_f32 v77, -v57, s41, v81
  v_fma_f32 v57, v57, s41, -v80
  v_fma_f32 v78, -v58, s41, v81
  v_fma_f32 v58, v58, s41, -v80
  v_fma_f32 v79, -v59, s41, v81
  v_fma_f32 v59, v59, s41, -v80
  v_exp_f32 v40, v40
  v_exp_f32 v41, v41
  v_exp_f32 v42, v42
  v_exp_f32 v43, v43
  v_exp_f32 v44, v44
  v_exp_f32 v45, v45
  v_exp_f32 v46, v46
  v_exp_f32 v47, v47
  v_exp_f32 v48, v48
  v_exp_f32 v49, v49
  v_exp_f32 v50, v50
  v_exp_f32 v51, v51
  v_exp_f32 v52, v52
  v_exp_f32 v53, v53
  v_exp_f32 v54, v54
  v_exp_f32 v55, v55
  v_exp_f32 v56, v56
  v_exp_f32 v57, v57
  v_exp_f32 v58, v58
  v_exp_f32 v59, v59
  v_exp_f32 v60, v60
  v_exp_f32 v61, v61
  v_exp_f32 v62, v62
  v_exp_f32 v63, v63
  v_exp_f32 v64, v64
  v_exp_f32 v65, v65
  v_exp_f32 v66, v66
  v_exp_f32 v67, v67
  v_exp_f32 v68, v68
  v_exp_f32 v69, v69
  v_exp_f32 v70, v70
  v_exp_f32 v71, v71
  v_exp_f32 v72, v72
  v_exp_f32 v73, v73
  v_exp_f32 v74, v74
  v_exp_f32 v75, v75
  v_exp_f32 v76, v76
  v_exp_f32 v77, v77
  v_exp_f32 v78, v78
  v_exp_f32 v79, v79
  v_add_f32 v82, v40, v41
  v_add_f32 v82, v82, v42
  v_add_f32 v82, v82, v43
  v_add_f32 v82, v82, v44
  v_add_f32 v82, v82, v45
  v_add_f32 v82, v82, v46
  v_add_f32 v82, v82, v47
  v_add_f32 v82, v82, v48
  v_add_f32 v82, v82, v49
  v_add_f32 v82, v82, v50
  v_add_f32 v82, v82, v51
  v_add_f32 v82, v82, v52
  v_add_f32 v82, v82, v53
  v_add_f32 v82, v82, v54
  v_add_f32 v82, v82, v55
  v_add_f32 v82, v82, v56
  v_add_f32 v82, v82, v57
  v_add_f32 v82, v82, v58
  v_add_f32 v82, v82, v59
  v_rcp_f32 v82, v82
  v_add_f32 v83, v60, v61
  v_add_f32 v83, v83, v62
  v_add_f32 v83, v83, v63
  v_add_f32 v83, v83, v64
  v_add_f32 v83, v83, v65
  v_add_f32 v83, v83, v66
  v_add_f32 v83, v83, v67
  v_add_f32 v83, v83, v68
  v_add_f32 v83, v83, v69
  v_add_f32 v83, v83, v70
  v_add_f32 v83, v83, v71
  v_add_f32 v83, v83, v72
  v_add_f32 v83, v83, v73
  v_add_f32 v83, v83, v74
  v_add_f32 v83, v83, v75
  v_add_f32 v83, v83, v76
  v_add_f32 v83, v83, v77
  v_add_f32 v83, v83, v78
  v_add_f32 v83, v83, v79
  v_rcp_f32 v83, v83
  v_mul_f32 v40, v40, v82
  v_mul_f32 v41, v41, v82
  v_mul_f32 v42, v42, v82
  v_mul_f32 v43, v43, v82
  v_mul_f32 v44, v44, v82
  v_mul_f32 v45, v45, v82
  v_mul_f32 v46, v46, v82
  v_mul_f32 v47, v47, v82
  v_mul_f32 v48, v48, v82
  v_mul_f32 v49, v49, v82
  v_mul_f32 v50, v50, v82
  v_mul_f32 v51, v51, v82
  v_mul_f32 v52, v52, v82
  v_mul_f32 v53, v53, v82
  v_mul_f32 v54, v54, v82
  v_mul_f32 v55, v55, v82
  v_mul_f32 v56, v56, v82
  v_mul_f32 v57, v57, v82
  v_mul_f32 v58, v58, v82
  v_mul_f32 v59, v59, v82
  v_mul_f32 v60, v60, v83
  v_mul_f32 v61, v61, v83
  v_mul_f32 v62, v62, v83
  v_mul_f32 v63, v63, v83
  v_mul_f32 v64, v64, v83
  v_mul_f32 v65, v65, v83
  v_mul_f32 v66, v66, v83
  v_mul_f32 v67, v67, v83
  v_mul_f32 v68, v68, v83
  v_mul_f32 v69, v69, v83
  v_mul_f32 v70, v70, v83
  v_mul_f32 v71, v71, v83
  v_mul_f32 v72, v72, v83
  v_mul_f32 v73, v73, v83
  v_mul_f32 v74, v74, v83
  v_mul_f32 v75, v75, v83
  v_mul_f32 v76, v76, v83
  v_mul_f32 v77, v77, v83
  v_mul_f32 v78, v78, v83
  v_mul_f32 v79, v79, v83
  v_cvt_pk_bf16_f32 v16, v40, v41
  v_cvt_pk_bf16_f32 v17, v42, v43
  v_cvt_pk_bf16_f32 v18, v44, v45
  v_cvt_pk_bf16_f32 v19, v46, v47
  v_cvt_pk_bf16_f32 v20, v48, v49
  v_cvt_pk_bf16_f32 v21, v50, v51
  v_cvt_pk_bf16_f32 v22, v52, v53
  v_cvt_pk_bf16_f32 v23, v54, v55
  v_cvt_pk_bf16_f32 v24, v56, v57
  v_cvt_pk_bf16_f32 v25, v58, v59
  v_cvt_pk_bf16_f32 v26, v60, v61
  v_cvt_pk_bf16_f32 v27, v62, v63
  v_cvt_pk_bf16_f32 v28, v64, v65
  v_cvt_pk_bf16_f32 v29, v66, v67
  v_cvt_pk_bf16_f32 v30, v68, v69
  v_cvt_pk_bf16_f32 v31, v70, v71
  v_cvt_pk_bf16_f32 v32, v72, v73
  v_cvt_pk_bf16_f32 v33, v74, v75
  v_cvt_pk_bf16_f32 v34, v76, v77
  v_cvt_pk_bf16_f32 v35, v78, v79
  ds_write_b128 v9, v[16:19] offset:0
  ds_write_b128 v9, v[20:23] offset:16
  ds_write_b128 v9, v[24:27] offset:32
  ds_write_b128 v9, v[28:31] offset:48
  ds_write_b128 v9, v[32:35] offset:64
  v_accvgpr_read_b32 v40, a160
  v_accvgpr_read_b32 v41, a161
  v_accvgpr_read_b32 v42, a162
  v_accvgpr_read_b32 v43, a163
  v_accvgpr_read_b32 v44, a164
  v_accvgpr_read_b32 v45, a165
  v_accvgpr_read_b32 v46, a166
  v_accvgpr_read_b32 v47, a167
  v_accvgpr_read_b32 v48, a168
  v_accvgpr_read_b32 v49, a169
  v_accvgpr_read_b32 v50, a170
  v_accvgpr_read_b32 v51, a171
  v_accvgpr_read_b32 v52, a172
  v_accvgpr_read_b32 v53, a173
  v_accvgpr_read_b32 v54, a174
  v_accvgpr_read_b32 v55, a175
  v_accvgpr_read_b32 v56, a176
  v_accvgpr_read_b32 v57, a177
  v_accvgpr_read_b32 v58, a178
  v_accvgpr_read_b32 v59, a179
  v_cvt_pk_bf16_f32 v64, v40, v41
  v_cvt_pk_bf16_f32 v65, v42, v43
  v_cvt_pk_bf16_f32 v66, v44, v45
  v_cvt_pk_bf16_f32 v67, v46, v47
  v_cvt_pk_bf16_f32 v68, v48, v49
  v_cvt_pk_bf16_f32 v69, v50, v51
  v_cvt_pk_bf16_f32 v70, v52, v53
  v_cvt_pk_bf16_f32 v71, v54, v55
  v_cvt_pk_bf16_f32 v72, v56, v57
  v_cvt_pk_bf16_f32 v73, v58, v59
  v_mov_b32 v74, 0x3f80
  v_mov_b32 v75, 0
  ds_write_b128 v10, v[64:67] offset:0
  ds_write_b128 v10, v[68:71] offset:16
  ds_write_b128 v10, v[72:75] offset:32
  v_accvgpr_read_b32 v40, a100
  v_accvgpr_read_b32 v41, a101
  v_accvgpr_read_b32 v42, a102
  v_accvgpr_read_b32 v43, a103
  v_accvgpr_read_b32 v44, a104
  v_accvgpr_read_b32 v45, a105
  v_accvgpr_read_b32 v46, a106
  v_accvgpr_read_b32 v47, a107
  v_accvgpr_read_b32 v48, a108
  v_accvgpr_read_b32 v49, a109
  v_accvgpr_read_b32 v50, a110
  v_accvgpr_read_b32 v51, a111
  v_accvgpr_read_b32 v52, a112
  v_accvgpr_read_b32 v53, a113
  v_accvgpr_read_b32 v54, a114
  v_accvgpr_read_b32 v55, a115
  v_accvgpr_read_b32 v56, a116
  v_accvgpr_read_b32 v57, a117
  v_accvgpr_read_b32 v58, a118
  v_accvgpr_read_b32 v59, a119
  v_max3_f32 v80, v40, v41, v42
  v_min3_f32 v81, v40, v41, v42
  v_max3_f32 v80, v80, v43, v44
  v_min3_f32 v81, v81, v43, v44
  v_max3_f32 v80, v80, v45, v46
  v_min3_f32 v81, v81, v45, v46
  v_max3_f32 v80, v80, v47, v48
  v_min3_f32 v81, v81, v47, v48
  v_max3_f32 v80, v80, v49, v50
  v_min3_f32 v81, v81, v49, v50
  v_max3_f32 v80, v80, v51, v52
  v_min3_f32 v81, v81, v51, v52
  v_max3_f32 v80, v80, v53, v54
  v_min3_f32 v81, v81, v53, v54
  v_max3_f32 v80, v80, v55, v56
  v_min3_f32 v81, v81, v55, v56
  v_max3_f32 v80, v80, v57, v58
  v_min3_f32 v81, v81, v57, v58
  v_max_f32 v80, v80, v59
  v_min_f32 v81, v81, v59
  v_mul_f32 v80, s41, v80
  v_mul_f32 v81, s41, v81
  v_fma_f32 v60, -v40, s41, v81
  v_fma_f32 v40, v40, s41, -v80
  v_fma_f32 v61, -v41, s41, v81
  v_fma_f32 v41, v41, s41, -v80
  v_fma_f32 v62, -v42, s41, v81
  v_fma_f32 v42, v42, s41, -v80
  v_fma_f32 v63, -v43, s41, v81
  v_fma_f32 v43, v43, s41, -v80
  v_fma_f32 v64, -v44, s41, v81
  v_fma_f32 v44, v44, s41, -v80
  v_fma_f32 v65, -v45, s41, v81
  v_fma_f32 v45, v45, s41, -v80
  v_fma_f32 v66, -v46, s41, v81
  v_fma_f32 v46, v46, s41, -v80
  v_fma_f32 v67, -v47, s41, v81
  v_fma_f32 v47, v47, s41, -v80
  v_fma_f32 v68, -v48, s41, v81
  v_fma_f32 v48, v48, s41, -v80
  v_fma_f32 v69, -v49, s41, v81
  v_fma_f32 v49, v49, s41, -v80
  v_fma_f32 v70, -v50, s41, v81
  v_fma_f32 v50, v50, s41, -v80
  v_fma_f32 v71, -v51, s41, v81
  v_fma_f32 v51, v51, s41, -v80
  v_fma_f32 v72, -v52, s41, v81
  v_fma_f32 v52, v52, s41, -v80
  v_fma_f32 v73, -v53, s41, v81
  v_fma_f32 v53, v53, s41, -v80
  v_fma_f32 v74, -v54, s41, v81
  v_fma_f32 v54, v54, s41, -v80
  v_fma_f32 v75, -v55, s41, v81
  v_fma_f32 v55, v55, s41, -v80
  v_fma_f32 v76, -v56, s41, v81
  v_fma_f32 v56, v56, s41, -v80
  v_fma_f32 v77, -v57, s41, v81
  v_fma_f32 v57, v57, s41, -v80
  v_fma_f32 v78, -v58, s41, v81
  v_fma_f32 v58, v58, s41, -v80
  v_fma_f32 v79, -v59, s41, v81
  v_fma_f32 v59, v59, s41, -v80
  v_exp_f32 v40, v40
  v_exp_f32 v41, v41
  v_exp_f32 v42, v42
  v_exp_f32 v43, v43
  v_exp_f32 v44, v44
  v_exp_f32 v45, v45
  v_exp_f32 v46, v46
  v_exp_f32 v47, v47
  v_exp_f32 v48, v48
  v_exp_f32 v49, v49
  v_exp_f32 v50, v50
  v_exp_f32 v51, v51
  v_exp_f32 v52, v52
  v_exp_f32 v53, v53
  v_exp_f32 v54, v54
  v_exp_f32 v55, v55
  v_exp_f32 v56, v56
  v_exp_f32 v57, v57
  v_exp_f32 v58, v58
  v_exp_f32 v59, v59
  v_exp_f32 v60, v60
  v_exp_f32 v61, v61
  v_exp_f32 v62, v62
  v_exp_f32 v63, v63
  v_exp_f32 v64, v64
  v_exp_f32 v65, v65
  v_exp_f32 v66, v66
  v_exp_f32 v67, v67
  v_exp_f32 v68, v68
  v_exp_f32 v69, v69
  v_exp_f32 v70, v70
  v_exp_f32 v71, v71
  v_exp_f32 v72, v72
  v_exp_f32 v73, v73
  v_exp_f32 v74, v74
  v_exp_f32 v75, v75
  v_exp_f32 v76, v76
  v_exp_f32 v77, v77
  v_exp_f32 v78, v78
  v_exp_f32 v79, v79
  v_add_f32 v82, v40, v41
  v_add_f32 v82, v82, v42
  v_add_f32 v82, v82, v43
  v_add_f32 v82, v82, v44
  v_add_f32 v82, v82, v45
  v_add_f32 v82, v82, v46
  v_add_f32 v82, v82, v47
  v_add_f32 v82, v82, v48
  v_add_f32 v82, v82, v49
  v_add_f32 v82, v82, v50
  v_add_f32 v82, v82, v51
  v_add_f32 v82, v82, v52
  v_add_f32 v82, v82, v53
  v_add_f32 v82, v82, v54
  v_add_f32 v82, v82, v55
  v_add_f32 v82, v82, v56
  v_add_f32 v82, v82, v57
  v_add_f32 v82, v82, v58
  v_add_f32 v82, v82, v59
  v_rcp_f32 v82, v82
  v_add_f32 v83, v60, v61
  v_add_f32 v83, v83, v62
  v_add_f32 v83, v83, v63
  v_add_f32 v83, v83, v64
  v_add_f32 v83, v83, v65
  v_add_f32 v83, v83, v66
  v_add_f32 v83, v83, v67
  v_add_f32 v83, v83, v68
  v_add_f32 v83, v83, v69
  v_add_f32 v83, v83, v70
  v_add_f32 v83, v83, v71
  v_add_f32 v83, v83, v72
  v_add_f32 v83, v83, v73
  v_add_f32 v83, v83, v74
  v_add_f32 v83, v83, v75
  v_add_f32 v83, v83, v76
  v_add_f32 v83, v83, v77
  v_add_f32 v83, v83, v78
  v_add_f32 v83, v83, v79
  v_rcp_f32 v83, v83
  v_mul_f32 v40, v40, v82
  v_mul_f32 v41, v41, v82
  v_mul_f32 v42, v42, v82
  v_mul_f32 v43, v43, v82
  v_mul_f32 v44, v44, v82
  v_mul_f32 v45, v45, v82
  v_mul_f32 v46, v46, v82
  v_mul_f32 v47, v47, v82
  v_mul_f32 v48, v48, v82
  v_mul_f32 v49, v49, v82
  v_mul_f32 v50, v50, v82
  v_mul_f32 v51, v51, v82
  v_mul_f32 v52, v52, v82
  v_mul_f32 v53, v53, v82
  v_mul_f32 v54, v54, v82
  v_mul_f32 v55, v55, v82
  v_mul_f32 v56, v56, v82
  v_mul_f32 v57, v57, v82
  v_mul_f32 v58, v58, v82
  v_mul_f32 v59, v59, v82
  v_mul_f32 v60, v60, v83
  v_mul_f32 v61, v61, v83
  v_mul_f32 v62, v62, v83
  v_mul_f32 v63, v63, v83
  v_mul_f32 v64, v64, v83
  v_mul_f32 v65, v65, v83
  v_mul_f32 v66, v66, v83
  v_mul_f32 v67, v67, v83
  v_mul_f32 v68, v68, v83
  v_mul_f32 v69, v69, v83
  v_mul_f32 v70, v70, v83
  v_mul_f32 v71, v71, v83
  v_mul_f32 v72, v72, v83
  v_mul_f32 v73, v73, v83
  v_mul_f32 v74, v74, v83
  v_mul_f32 v75, v75, v83
  v_mul_f32 v76, v76, v83
  v_mul_f32 v77, v77, v83
  v_mul_f32 v78, v78, v83
  v_mul_f32 v79, v79, v83
  v_cvt_pk_bf16_f32 v16, v40, v41
  v_cvt_pk_bf16_f32 v17, v42, v43
  v_cvt_pk_bf16_f32 v18, v44, v45
  v_cvt_pk_bf16_f32 v19, v46, v47
  v_cvt_pk_bf16_f32 v20, v48, v49
  v_cvt_pk_bf16_f32 v21, v50, v51
  v_cvt_pk_bf16_f32 v22, v52, v53
  v_cvt_pk_bf16_f32 v23, v54, v55
  v_cvt_pk_bf16_f32 v24, v56, v57
  v_cvt_pk_bf16_f32 v25, v58, v59
  v_cvt_pk_bf16_f32 v26, v60, v61
  v_cvt_pk_bf16_f32 v27, v62, v63
  v_cvt_pk_bf16_f32 v28, v64, v65
  v_cvt_pk_bf16_f32 v29, v66, v67
  v_cvt_pk_bf16_f32 v30, v68, v69
  v_cvt_pk_bf16_f32 v31, v70, v71
  v_cvt_pk_bf16_f32 v32, v72, v73
  v_cvt_pk_bf16_f32 v33, v74, v75
  v_cvt_pk_bf16_f32 v34, v76, v77
  v_cvt_pk_bf16_f32 v35, v78, v79
  ds_write_b128 v9, v[16:19] offset:80
  ds_write_b128 v9, v[20:23] offset:96
  ds_write_b128 v9, v[24:27] offset:112
  ds_write_b128 v9, v[28:31] offset:128
  ds_write_b128 v9, v[32:35] offset:144
  v_accvgpr_read_b32 v40, a180
  v_accvgpr_read_b32 v41, a181
  v_accvgpr_read_b32 v42, a182
  v_accvgpr_read_b32 v43, a183
  v_accvgpr_read_b32 v44, a184
  v_accvgpr_read_b32 v45, a185
  v_accvgpr_read_b32 v46, a186
  v_accvgpr_read_b32 v47, a187
  v_accvgpr_read_b32 v48, a188
  v_accvgpr_read_b32 v49, a189
  v_accvgpr_read_b32 v50, a190
  v_accvgpr_read_b32 v51, a191
  v_accvgpr_read_b32 v52, a192
  v_accvgpr_read_b32 v53, a193
  v_accvgpr_read_b32 v54, a194
  v_accvgpr_read_b32 v55, a195
  v_accvgpr_read_b32 v56, a196
  v_accvgpr_read_b32 v57, a197
  v_accvgpr_read_b32 v58, a198
  v_accvgpr_read_b32 v59, a199
  v_cvt_pk_bf16_f32 v64, v40, v41
  v_cvt_pk_bf16_f32 v65, v42, v43
  v_cvt_pk_bf16_f32 v66, v44, v45
  v_cvt_pk_bf16_f32 v67, v46, v47
  v_cvt_pk_bf16_f32 v68, v48, v49
  v_cvt_pk_bf16_f32 v69, v50, v51
  v_cvt_pk_bf16_f32 v70, v52, v53
  v_cvt_pk_bf16_f32 v71, v54, v55
  v_cvt_pk_bf16_f32 v72, v56, v57
  v_cvt_pk_bf16_f32 v73, v58, v59
  v_mov_b32 v74, 0x3f80
  v_mov_b32 v75, 0
  ds_write_b128 v10, v[64:67] offset:48
  ds_write_b128 v10, v[68:71] offset:64
  ds_write_b128 v10, v[72:75] offset:80
  v_accvgpr_read_b32 v40, a120
  v_accvgpr_read_b32 v41, a121
  v_accvgpr_read_b32 v42, a122
  v_accvgpr_read_b32 v43, a123
  v_accvgpr_read_b32 v44, a124
  v_accvgpr_read_b32 v45, a125
  v_accvgpr_read_b32 v46, a126
  v_accvgpr_read_b32 v47, a127
  v_accvgpr_read_b32 v48, a128
  v_accvgpr_read_b32 v49, a129
  v_accvgpr_read_b32 v50, a130
  v_accvgpr_read_b32 v51, a131
  v_accvgpr_read_b32 v52, a132
  v_accvgpr_read_b32 v53, a133
  v_accvgpr_read_b32 v54, a134
  v_accvgpr_read_b32 v55, a135
  v_accvgpr_read_b32 v56, a136
  v_accvgpr_read_b32 v57, a137
  v_accvgpr_read_b32 v58, a138
  v_accvgpr_read_b32 v59, a139
  v_max3_f32 v80, v40, v41, v42
  v_min3_f32 v81, v40, v41, v42
  v_max3_f32 v80, v80, v43, v44
  v_min3_f32 v81, v81, v43, v44
  v_max3_f32 v80, v80, v45, v46
  v_min3_f32 v81, v81, v45, v46
  v_max3_f32 v80, v80, v47, v48
  v_min3_f32 v81, v81, v47, v48
  v_max3_f32 v80, v80, v49, v50
  v_min3_f32 v81, v81, v49, v50
  v_max3_f32 v80, v80, v51, v52
  v_min3_f32 v81, v81, v51, v52
  v_max3_f32 v80, v80, v53, v54
  v_min3_f32 v81, v81, v53, v54
  v_max3_f32 v80, v80, v55, v56
  v_min3_f32 v81, v81, v55, v56
  v_max3_f32 v80, v80, v57, v58
  v_min3_f32 v81, v81, v57, v58
  v_max_f32 v80, v80, v59
  v_min_f32 v81, v81, v59
  v_mul_f32 v80, s41, v80
  v_mul_f32 v81, s41, v81
  v_fma_f32 v60, -v40, s41, v81
  v_fma_f32 v40, v40, s41, -v80
  v_fma_f32 v61, -v41, s41, v81
  v_fma_f32 v41, v41, s41, -v80
  v_fma_f32 v62, -v42, s41, v81
  v_fma_f32 v42, v42, s41, -v80
  v_fma_f32 v63, -v43, s41, v81
  v_fma_f32 v43, v43, s41, -v80
  v_fma_f32 v64, -v44, s41, v81
  v_fma_f32 v44, v44, s41, -v80
  v_fma_f32 v65, -v45, s41, v81
  v_fma_f32 v45, v45, s41, -v80
  v_fma_f32 v66, -v46, s41, v81
  v_fma_f32 v46, v46, s41, -v80
  v_fma_f32 v67, -v47, s41, v81
  v_fma_f32 v47, v47, s41, -v80
  v_fma_f32 v68, -v48, s41, v81
  v_fma_f32 v48, v48, s41, -v80
  v_fma_f32 v69, -v49, s41, v81
  v_fma_f32 v49, v49, s41, -v80
  v_fma_f32 v70, -v50, s41, v81
  v_fma_f32 v50, v50, s41, -v80
  v_fma_f32 v71, -v51, s41, v81
  v_fma_f32 v51, v51, s41, -v80
  v_fma_f32 v72, -v52, s41, v81
  v_fma_f32 v52, v52, s41, -v80
  v_fma_f32 v73, -v53, s41, v81
  v_fma_f32 v53, v53, s41, -v80
  v_fma_f32 v74, -v54, s41, v81
  v_fma_f32 v54, v54, s41, -v80
  v_fma_f32 v75, -v55, s41, v81
  v_fma_f32 v55, v55, s41, -v80
  v_fma_f32 v76, -v56, s41, v81
  v_fma_f32 v56, v56, s41, -v80
  v_fma_f32 v77, -v57, s41, v81
  v_fma_f32 v57, v57, s41, -v80
  v_fma_f32 v78, -v58, s41, v81
  v_fma_f32 v58, v58, s41, -v80
  v_fma_f32 v79, -v59, s41, v81
  v_fma_f32 v59, v59, s41, -v80
  v_exp_f32 v40, v40
  v_exp_f32 v41, v41
  v_exp_f32 v42, v42
  v_exp_f32 v43, v43
  v_exp_f32 v44, v44
  v_exp_f32 v45, v45
  v_exp_f32 v46, v46
  v_exp_f32 v47, v47
  v_exp_f32 v48, v48
  v_exp_f32 v49, v49
  v_exp_f32 v50, v50
  v_exp_f32 v51, v51
  v_exp_f32 v52, v52
  v_exp_f32 v53, v53
  v_exp_f32 v54, v54
  v_exp_f32 v55, v55
  v_exp_f32 v56, v56
  v_exp_f32 v57, v57
  v_exp_f32 v58, v58
  v_exp_f32 v59, v59
  v_exp_f32 v60, v60
  v_exp_f32 v61, v61
  v_exp_f32 v62, v62
  v_exp_f32 v63, v63
  v_exp_f32 v64, v64
  v_exp_f32 v65, v65
  v_exp_f32 v66, v66
  v_exp_f32 v67, v67
  v_exp_f32 v68, v68
  v_exp_f32 v69, v69
  v_exp_f32 v70, v70
  v_exp_f32 v71, v71
  v_exp_f32 v72, v72
  v_exp_f32 v73, v73
  v_exp_f32 v74, v74
  v_exp_f32 v75, v75
  v_exp_f32 v76, v76
  v_exp_f32 v77, v77
  v_exp_f32 v78, v78
  v_exp_f32 v79, v79
  v_add_f32 v82, v40, v41
  v_add_f32 v82, v82, v42
  v_add_f32 v82, v82, v43
  v_add_f32 v82, v82, v44
  v_add_f32 v82, v82, v45
  v_add_f32 v82, v82, v46
  v_add_f32 v82, v82, v47
  v_add_f32 v82, v82, v48
  v_add_f32 v82, v82, v49
  v_add_f32 v82, v82, v50
  v_add_f32 v82, v82, v51
  v_add_f32 v82, v82, v52
  v_add_f32 v82, v82, v53
  v_add_f32 v82, v82, v54
  v_add_f32 v82, v82, v55
  v_add_f32 v82, v82, v56
  v_add_f32 v82, v82, v57
  v_add_f32 v82, v82, v58
  v_add_f32 v82, v82, v59
  v_rcp_f32 v82, v82
  v_add_f32 v83, v60, v61
  v_add_f32 v83, v83, v62
  v_add_f32 v83, v83, v63
  v_add_f32 v83, v83, v64
  v_add_f32 v83, v83, v65
  v_add_f32 v83, v83, v66
  v_add_f32 v83, v83, v67
  v_add_f32 v83, v83, v68
  v_add_f32 v83, v83, v69
  v_add_f32 v83, v83, v70
  v_add_f32 v83, v83, v71
  v_add_f32 v83, v83, v72
  v_add_f32 v83, v83, v73
  v_add_f32 v83, v83, v74
  v_add_f32 v83, v83, v75
  v_add_f32 v83, v83, v76
  v_add_f32 v83, v83, v77
  v_add_f32 v83, v83, v78
  v_add_f32 v83, v83, v79
  v_rcp_f32 v83, v83
  v_mul_f32 v40, v40, v82
  v_mul_f32 v41, v41, v82
  v_mul_f32 v42, v42, v82
  v_mul_f32 v43, v43, v82
  v_mul_f32 v44, v44, v82
  v_mul_f32 v45, v45, v82
  v_mul_f32 v46, v46, v82
  v_mul_f32 v47, v47, v82
  v_mul_f32 v48, v48, v82
  v_mul_f32 v49, v49, v82
  v_mul_f32 v50, v50, v82
  v_mul_f32 v51, v51, v82
  v_mul_f32 v52, v52, v82
  v_mul_f32 v53, v53, v82
  v_mul_f32 v54, v54, v82
  v_mul_f32 v55, v55, v82
  v_mul_f32 v56, v56, v82
  v_mul_f32 v57, v57, v82
  v_mul_f32 v58, v58, v82
  v_mul_f32 v59, v59, v82
  v_mul_f32 v60, v60, v83
  v_mul_f32 v61, v61, v83
  v_mul_f32 v62, v62, v83
  v_mul_f32 v63, v63, v83
  v_mul_f32 v64, v64, v83
  v_mul_f32 v65, v65, v83
  v_mul_f32 v66, v66, v83
  v_mul_f32 v67, v67, v83
  v_mul_f32 v68, v68, v83
  v_mul_f32 v69, v69, v83
  v_mul_f32 v70, v70, v83
  v_mul_f32 v71, v71, v83
  v_mul_f32 v72, v72, v83
  v_mul_f32 v73, v73, v83
  v_mul_f32 v74, v74, v83
  v_mul_f32 v75, v75, v83
  v_mul_f32 v76, v76, v83
  v_mul_f32 v77, v77, v83
  v_mul_f32 v78, v78, v83
  v_mul_f32 v79, v79, v83
  v_cvt_pk_bf16_f32 v16, v40, v41
  v_cvt_pk_bf16_f32 v17, v42, v43
  v_cvt_pk_bf16_f32 v18, v44, v45
  v_cvt_pk_bf16_f32 v19, v46, v47
  v_cvt_pk_bf16_f32 v20, v48, v49
  v_cvt_pk_bf16_f32 v21, v50, v51
  v_cvt_pk_bf16_f32 v22, v52, v53
  v_cvt_pk_bf16_f32 v23, v54, v55
  v_cvt_pk_bf16_f32 v24, v56, v57
  v_cvt_pk_bf16_f32 v25, v58, v59
  v_cvt_pk_bf16_f32 v26, v60, v61
  v_cvt_pk_bf16_f32 v27, v62, v63
  v_cvt_pk_bf16_f32 v28, v64, v65
  v_cvt_pk_bf16_f32 v29, v66, v67
  v_cvt_pk_bf16_f32 v30, v68, v69
  v_cvt_pk_bf16_f32 v31, v70, v71
  v_cvt_pk_bf16_f32 v32, v72, v73
  v_cvt_pk_bf16_f32 v33, v74, v75
  v_cvt_pk_bf16_f32 v34, v76, v77
  v_cvt_pk_bf16_f32 v35, v78, v79
  ds_write_b128 v9, v[16:19] offset:160
  ds_write_b128 v9, v[20:23] offset:176
  ds_write_b128 v9, v[24:27] offset:192
  ds_write_b128 v9, v[28:31] offset:208
  ds_write_b128 v9, v[32:35] offset:224
  v_accvgpr_read_b32 v40, a200
  v_accvgpr_read_b32 v41, a201
  v_accvgpr_read_b32 v42, a202
  v_accvgpr_read_b32 v43, a203
  v_accvgpr_read_b32 v44, a204
  v_accvgpr_read_b32 v45, a205
  v_accvgpr_read_b32 v46, a206
  v_accvgpr_read_b32 v47, a207
  v_accvgpr_read_b32 v48, a208
  v_accvgpr_read_b32 v49, a209
  v_accvgpr_read_b32 v50, a210
  v_accvgpr_read_b32 v51, a211
  v_accvgpr_read_b32 v52, a212
  v_accvgpr_read_b32 v53, a213
  v_accvgpr_read_b32 v54, a214
  v_accvgpr_read_b32 v55, a215
  v_accvgpr_read_b32 v56, a216
  v_accvgpr_read_b32 v57, a217
  v_accvgpr_read_b32 v58, a218
  v_accvgpr_read_b32 v59, a219
  v_cvt_pk_bf16_f32 v64, v40, v41
  v_cvt_pk_bf16_f32 v65, v42, v43
  v_cvt_pk_bf16_f32 v66, v44, v45
  v_cvt_pk_bf16_f32 v67, v46, v47
  v_cvt_pk_bf16_f32 v68, v48, v49
  v_cvt_pk_bf16_f32 v69, v50, v51
  v_cvt_pk_bf16_f32 v70, v52, v53
  v_cvt_pk_bf16_f32 v71, v54, v55
  v_cvt_pk_bf16_f32 v72, v56, v57
  v_cvt_pk_bf16_f32 v73, v58, v59
  v_mov_b32 v74, 0x3f80
  v_mov_b32 v75, 0
  ds_write_b128 v10, v[64:67] offset:96
  ds_write_b128 v10, v[68:71] offset:112
  ds_write_b128 v10, v[72:75] offset:128
  v_accvgpr_read_b32 v40, a140
  v_accvgpr_read_b32 v41, a141
  v_accvgpr_read_b32 v42, a142
  v_accvgpr_read_b32 v43, a143
  v_accvgpr_read_b32 v44, a144
  v_accvgpr_read_b32 v45, a145
  v_accvgpr_read_b32 v46, a146
  v_accvgpr_read_b32 v47, a147
  v_accvgpr_read_b32 v48, a148
  v_accvgpr_read_b32 v49, a149
  v_accvgpr_read_b32 v50, a150
  v_accvgpr_read_b32 v51, a151
  v_accvgpr_read_b32 v52, a152
  v_accvgpr_read_b32 v53, a153
  v_accvgpr_read_b32 v54, a154
  v_accvgpr_read_b32 v55, a155
  v_accvgpr_read_b32 v56, a156
  v_accvgpr_read_b32 v57, a157
  v_accvgpr_read_b32 v58, a158
  v_accvgpr_read_b32 v59, a159
  v_max3_f32 v80, v40, v41, v42
  v_min3_f32 v81, v40, v41, v42
  v_max3_f32 v80, v80, v43, v44
  v_min3_f32 v81, v81, v43, v44
  v_max3_f32 v80, v80, v45, v46
  v_min3_f32 v81, v81, v45, v46
  v_max3_f32 v80, v80, v47, v48
  v_min3_f32 v81, v81, v47, v48
  v_max3_f32 v80, v80, v49, v50
  v_min3_f32 v81, v81, v49, v50
  v_max3_f32 v80, v80, v51, v52
  v_min3_f32 v81, v81, v51, v52
  v_max3_f32 v80, v80, v53, v54
  v_min3_f32 v81, v81, v53, v54
  v_max3_f32 v80, v80, v55, v56
  v_min3_f32 v81, v81, v55, v56
  v_max3_f32 v80, v80, v57, v58
  v_min3_f32 v81, v81, v57, v58
  v_max_f32 v80, v80, v59
  v_min_f32 v81, v81, v59
  v_mul_f32 v80, s41, v80
  v_mul_f32 v81, s41, v81
  v_fma_f32 v60, -v40, s41, v81
  v_fma_f32 v40, v40, s41, -v80
  v_fma_f32 v61, -v41, s41, v81
  v_fma_f32 v41, v41, s41, -v80
  v_fma_f32 v62, -v42, s41, v81
  v_fma_f32 v42, v42, s41, -v80
  v_fma_f32 v63, -v43, s41, v81
  v_fma_f32 v43, v43, s41, -v80
  v_fma_f32 v64, -v44, s41, v81
  v_fma_f32 v44, v44, s41, -v80
  v_fma_f32 v65, -v45, s41, v81
  v_fma_f32 v45, v45, s41, -v80
  v_fma_f32 v66, -v46, s41, v81
  v_fma_f32 v46, v46, s41, -v80
  v_fma_f32 v67, -v47, s41, v81
  v_fma_f32 v47, v47, s41, -v80
  v_fma_f32 v68, -v48, s41, v81
  v_fma_f32 v48, v48, s41, -v80
  v_fma_f32 v69, -v49, s41, v81
  v_fma_f32 v49, v49, s41, -v80
  v_fma_f32 v70, -v50, s41, v81
  v_fma_f32 v50, v50, s41, -v80
  v_fma_f32 v71, -v51, s41, v81
  v_fma_f32 v51, v51, s41, -v80
  v_fma_f32 v72, -v52, s41, v81
  v_fma_f32 v52, v52, s41, -v80
  v_fma_f32 v73, -v53, s41, v81
  v_fma_f32 v53, v53, s41, -v80
  v_fma_f32 v74, -v54, s41, v81
  v_fma_f32 v54, v54, s41, -v80
  v_fma_f32 v75, -v55, s41, v81
  v_fma_f32 v55, v55, s41, -v80
  v_fma_f32 v76, -v56, s41, v81
  v_fma_f32 v56, v56, s41, -v80
  v_fma_f32 v77, -v57, s41, v81
  v_fma_f32 v57, v57, s41, -v80
  v_fma_f32 v78, -v58, s41, v81
  v_fma_f32 v58, v58, s41, -v80
  v_fma_f32 v79, -v59, s41, v81
  v_fma_f32 v59, v59, s41, -v80
  v_exp_f32 v40, v40
  v_exp_f32 v41, v41
  v_exp_f32 v42, v42
  v_exp_f32 v43, v43
  v_exp_f32 v44, v44
  v_exp_f32 v45, v45
  v_exp_f32 v46, v46
  v_exp_f32 v47, v47
  v_exp_f32 v48, v48
  v_exp_f32 v49, v49
  v_exp_f32 v50, v50
  v_exp_f32 v51, v51
  v_exp_f32 v52, v52
  v_exp_f32 v53, v53
  v_exp_f32 v54, v54
  v_exp_f32 v55, v55
  v_exp_f32 v56, v56
  v_exp_f32 v57, v57
  v_exp_f32 v58, v58
  v_exp_f32 v59, v59
  v_exp_f32 v60, v60
  v_exp_f32 v61, v61
  v_exp_f32 v62, v62
  v_exp_f32 v63, v63
  v_exp_f32 v64, v64
  v_exp_f32 v65, v65
  v_exp_f32 v66, v66
  v_exp_f32 v67, v67
  v_exp_f32 v68, v68
  v_exp_f32 v69, v69
  v_exp_f32 v70, v70
  v_exp_f32 v71, v71
  v_exp_f32 v72, v72
  v_exp_f32 v73, v73
  v_exp_f32 v74, v74
  v_exp_f32 v75, v75
  v_exp_f32 v76, v76
  v_exp_f32 v77, v77
  v_exp_f32 v78, v78
  v_exp_f32 v79, v79
  v_add_f32 v82, v40, v41
  v_add_f32 v82, v82, v42
  v_add_f32 v82, v82, v43
  v_add_f32 v82, v82, v44
  v_add_f32 v82, v82, v45
  v_add_f32 v82, v82, v46
  v_add_f32 v82, v82, v47
  v_add_f32 v82, v82, v48
  v_add_f32 v82, v82, v49
  v_add_f32 v82, v82, v50
  v_add_f32 v82, v82, v51
  v_add_f32 v82, v82, v52
  v_add_f32 v82, v82, v53
  v_add_f32 v82, v82, v54
  v_add_f32 v82, v82, v55
  v_add_f32 v82, v82, v56
  v_add_f32 v82, v82, v57
  v_add_f32 v82, v82, v58
  v_add_f32 v82, v82, v59
  v_rcp_f32 v82, v82
  v_add_f32 v83, v60, v61
  v_add_f32 v83, v83, v62
  v_add_f32 v83, v83, v63
  v_add_f32 v83, v83, v64
  v_add_f32 v83, v83, v65
  v_add_f32 v83, v83, v66
  v_add_f32 v83, v83, v67
  v_add_f32 v83, v83, v68
  v_add_f32 v83, v83, v69
  v_add_f32 v83, v83, v70
  v_add_f32 v83, v83, v71
  v_add_f32 v83, v83, v72
  v_add_f32 v83, v83, v73
  v_add_f32 v83, v83, v74
  v_add_f32 v83, v83, v75
  v_add_f32 v83, v83, v76
  v_add_f32 v83, v83, v77
  v_add_f32 v83, v83, v78
  v_add_f32 v83, v83, v79
  v_rcp_f32 v83, v83
  v_mul_f32 v40, v40, v82
  v_mul_f32 v41, v41, v82
  v_mul_f32 v42, v42, v82
  v_mul_f32 v43, v43, v82
  v_mul_f32 v44, v44, v82
  v_mul_f32 v45, v45, v82
  v_mul_f32 v46, v46, v82
  v_mul_f32 v47, v47, v82
  v_mul_f32 v48, v48, v82
  v_mul_f32 v49, v49, v82
  v_mul_f32 v50, v50, v82
  v_mul_f32 v51, v51, v82
  v_mul_f32 v52, v52, v82
  v_mul_f32 v53, v53, v82
  v_mul_f32 v54, v54, v82
  v_mul_f32 v55, v55, v82
  v_mul_f32 v56, v56, v82
  v_mul_f32 v57, v57, v82
  v_mul_f32 v58, v58, v82
  v_mul_f32 v59, v59, v82
  v_mul_f32 v60, v60, v83
  v_mul_f32 v61, v61, v83
  v_mul_f32 v62, v62, v83
  v_mul_f32 v63, v63, v83
  v_mul_f32 v64, v64, v83
  v_mul_f32 v65, v65, v83
  v_mul_f32 v66, v66, v83
  v_mul_f32 v67, v67, v83
  v_mul_f32 v68, v68, v83
  v_mul_f32 v69, v69, v83
  v_mul_f32 v70, v70, v83
  v_mul_f32 v71, v71, v83
  v_mul_f32 v72, v72, v83
  v_mul_f32 v73, v73, v83
  v_mul_f32 v74, v74, v83
  v_mul_f32 v75, v75, v83
  v_mul_f32 v76, v76, v83
  v_mul_f32 v77, v77, v83
  v_mul_f32 v78, v78, v83
  v_mul_f32 v79, v79, v83
  v_cvt_pk_bf16_f32 v16, v40, v41
  v_cvt_pk_bf16_f32 v17, v42, v43
  v_cvt_pk_bf16_f32 v18, v44, v45
  v_cvt_pk_bf16_f32 v19, v46, v47
  v_cvt_pk_bf16_f32 v20, v48, v49
  v_cvt_pk_bf16_f32 v21, v50, v51
  v_cvt_pk_bf16_f32 v22, v52, v53
  v_cvt_pk_bf16_f32 v23, v54, v55
  v_cvt_pk_bf16_f32 v24, v56, v57
  v_cvt_pk_bf16_f32 v25, v58, v59
  v_cvt_pk_bf16_f32 v26, v60, v61
  v_cvt_pk_bf16_f32 v27, v62, v63
  v_cvt_pk_bf16_f32 v28, v64, v65
  v_cvt_pk_bf16_f32 v29, v66, v67
  v_cvt_pk_bf16_f32 v30, v68, v69
  v_cvt_pk_bf16_f32 v31, v70, v71
  v_cvt_pk_bf16_f32 v32, v72, v73
  v_cvt_pk_bf16_f32 v33, v74, v75
  v_cvt_pk_bf16_f32 v34, v76, v77
  v_cvt_pk_bf16_f32 v35, v78, v79
  ds_write_b128 v9, v[16:19] offset:240
  ds_write_b128 v9, v[20:23] offset:256
  ds_write_b128 v9, v[24:27] offset:272
  ds_write_b128 v9, v[28:31] offset:288
  ds_write_b128 v9, v[32:35] offset:304
  v_accvgpr_read_b32 v40, a220
  v_accvgpr_read_b32 v41, a221
  v_accvgpr_read_b32 v42, a222
  v_accvgpr_read_b32 v43, a223
  v_accvgpr_read_b32 v44, a224
  v_accvgpr_read_b32 v45, a225
  v_accvgpr_read_b32 v46, a226
  v_accvgpr_read_b32 v47, a227
  v_accvgpr_read_b32 v48, a228
  v_accvgpr_read_b32 v49, a229
  v_accvgpr_read_b32 v50, a230
  v_accvgpr_read_b32 v51, a231
  v_accvgpr_read_b32 v52, a232
  v_accvgpr_read_b32 v53, a233
  v_accvgpr_read_b32 v54, a234
  v_accvgpr_read_b32 v55, a235
  v_accvgpr_read_b32 v56, a236
  v_accvgpr_read_b32 v57, a237
  v_accvgpr_read_b32 v58, a238
  v_accvgpr_read_b32 v59, a239
  v_cvt_pk_bf16_f32 v64, v40, v41
  v_cvt_pk_bf16_f32 v65, v42, v43
  v_cvt_pk_bf16_f32 v66, v44, v45
  v_cvt_pk_bf16_f32 v67, v46, v47
  v_cvt_pk_bf16_f32 v68, v48, v49
  v_cvt_pk_bf16_f32 v69, v50, v51
  v_cvt_pk_bf16_f32 v70, v52, v53
  v_cvt_pk_bf16_f32 v71, v54, v55
  v_cvt_pk_bf16_f32 v72, v56, v57
  v_cvt_pk_bf16_f32 v73, v58, v59
  v_mov_b32 v74, 0x3f80
  v_mov_b32 v75, 0
  ds_write_b128 v10, v[64:67] offset:144
  ds_write_b128 v10, v[68:71] offset:160
  ds_write_b128 v10, v[72:75] offset:176
  s_waitcnt lgkmcnt(0)
  s_barrier
  v_lshrrev_b32 v7, 4, v0
  v_bfe_u32 v8, v0, 2, 2
  v_lshl_add_u32 v8, v7, 3, v8
  v_and_b32 v11, 3, v0
  s_mul_i32 s52, s28, 160
  v_mul_u32_u24 v12, 640, v8
  v_add_u32 v12, s52, v12
  v_and_b32 v14, 1, v0
  v_lshl_add_u32 v13, v14, 3, v12
  v_lshl_add_u32 v12, v11, 3, v12
  s_mul_i32 s52, s28, 96
  s_add_u32 s52, s52, 81920
  v_mul_u32_u24 v15, 400, v8
  v_add_u32 v15, s52, v15
  v_lshl_add_u32 v14, v14, 3, v15
  v_lshl_add_u32 v15, v11, 3, v15
  s_lshl_b32 s52, s34, 4
  s_add_u32 s52, s52, s35
  s_mul_i32 s52, s52, 49152
  s_mul_i32 s53, s28, 12288
  s_add_u32 s52, s52, s53
  s_add_u32 s38, s52, 0x5400000
  ds_read_b64_tr_b16 v[16:17], v12 offset:0
  ds_read_b64_tr_b16 v[18:19], v12 offset:2560
  ds_read_b64_tr_b16 v[20:21], v12 offset:32
  ds_read_b64_tr_b16 v[22:23], v12 offset:2592
  ds_read_b64_tr_b16 v[24:25], v13 offset:64
  ds_read_b64_tr_b16 v[26:27], v13 offset:2624
  ds_read_b64_tr_b16 v[28:29], v15 offset:0
  ds_read_b64_tr_b16 v[30:31], v15 offset:1600
  ds_read_b64_tr_b16 v[32:33], v14 offset:32
  ds_read_b64_tr_b16 v[34:35], v14 offset:1632
  s_waitcnt lgkmcnt(0)
  v_mfma_f32_16x16x32_bf16 v[40:43], v[16:19], v[28:31], 0
  v_mfma_f32_16x16x32_bf16 v[44:47], v[16:19], v[32:35], 0
  v_mfma_f32_16x16x32_bf16 v[48:51], v[20:23], v[28:31], 0
  v_mfma_f32_16x16x32_bf16 v[52:55], v[20:23], v[32:35], 0
  v_mfma_f32_16x16x32_bf16 v[56:59], v[24:27], v[28:31], 0
  v_mfma_f32_16x16x32_bf16 v[60:63], v[24:27], v[32:35], 0
  ds_read_b64_tr_b16 v[16:17], v12 offset:20480
  ds_read_b64_tr_b16 v[18:19], v12 offset:23040
  ds_read_b64_tr_b16 v[20:21], v12 offset:20512
  ds_read_b64_tr_b16 v[22:23], v12 offset:23072
  ds_read_b64_tr_b16 v[24:25], v13 offset:20544
  ds_read_b64_tr_b16 v[26:27], v13 offset:23104
  ds_read_b64_tr_b16 v[28:29], v15 offset:12800
  ds_read_b64_tr_b16 v[30:31], v15 offset:14400
  ds_read_b64_tr_b16 v[32:33], v14 offset:12832
  ds_read_b64_tr_b16 v[34:35], v14 offset:14432
  s_waitcnt lgkmcnt(0)
  v_mfma_f32_16x16x32_bf16 v[40:43], v[16:19], v[28:31], v[40:43]
  v_mfma_f32_16x16x32_bf16 v[44:47], v[16:19], v[32:35], v[44:47]
  v_mfma_f32_16x16x32_bf16 v[48:51], v[20:23], v[28:31], v[48:51]
  v_mfma_f32_16x16x32_bf16 v[52:55], v[20:23], v[32:35], v[52:55]
  v_mfma_f32_16x16x32_bf16 v[56:59], v[24:27], v[28:31], v[56:59]
  v_mfma_f32_16x16x32_bf16 v[60:63], v[24:27], v[32:35], v[60:63]
  ds_read_b64_tr_b16 v[16:17], v12 offset:40960
  ds_read_b64_tr_b16 v[18:19], v12 offset:43520
  ds_read_b64_tr_b16 v[20:21], v12 offset:40992
  ds_read_b64_tr_b16 v[22:23], v12 offset:43552
  ds_read_b64_tr_b16 v[24:25], v13 offset:41024
  ds_read_b64_tr_b16 v[26:27], v13 offset:43584
  ds_read_b64_tr_b16 v[28:29], v15 offset:25600
  ds_read_b64_tr_b16 v[30:31], v15 offset:27200
  ds_read_b64_tr_b16 v[32:33], v14 offset:25632
  ds_read_b64_tr_b16 v[34:35], v14 offset:27232
  s_waitcnt lgkmcnt(0)
  v_mfma_f32_16x16x32_bf16 v[40:43], v[16:19], v[28:31], v[40:43]
  v_mfma_f32_16x16x32_bf16 v[44:47], v[16:19], v[32:35], v[44:47]
  v_mfma_f32_16x16x32_bf16 v[48:51], v[20:23], v[28:31], v[48:51]
  v_mfma_f32_16x16x32_bf16 v[52:55], v[20:23], v[32:35], v[52:55]
  v_mfma_f32_16x16x32_bf16 v[56:59], v[24:27], v[28:31], v[56:59]
  v_mfma_f32_16x16x32_bf16 v[60:63], v[24:27], v[32:35], v[60:63]
  ds_read_b64_tr_b16 v[16:17], v12 offset:61440
  ds_read_b64_tr_b16 v[18:19], v12 offset:64000
  ds_read_b64_tr_b16 v[20:21], v12 offset:61472
  ds_read_b64_tr_b16 v[22:23], v12 offset:64032
  ds_read_b64_tr_b16 v[24:25], v13 offset:61504
  ds_read_b64_tr_b16 v[26:27], v13 offset:64064
  ds_read_b64_tr_b16 v[28:29], v15 offset:38400
  ds_read_b64_tr_b16 v[30:31], v15 offset:40000
  ds_read_b64_tr_b16 v[32:33], v14 offset:38432
  ds_read_b64_tr_b16 v[34:35], v14 offset:40032
  s_waitcnt lgkmcnt(0)
  v_mfma_f32_16x16x32_bf16 v[40:43], v[16:19], v[28:31], v[40:43]
  v_mfma_f32_16x16x32_bf16 v[44:47], v[16:19], v[32:35], v[44:47]
  v_mfma_f32_16x16x32_bf16 v[48:51], v[20:23], v[28:31], v[48:51]
  v_mfma_f32_16x16x32_bf16 v[52:55], v[20:23], v[32:35], v[52:55]
  v_mfma_f32_16x16x32_bf16 v[56:59], v[24:27], v[28:31], v[56:59]
  v_mfma_f32_16x16x32_bf16 v[60:63], v[24:27], v[32:35], v[60:63]
  ds_read_b64_tr_b16 v[16:17], v12 offset:80
  ds_read_b64_tr_b16 v[18:19], v12 offset:2640
  ds_read_b64_tr_b16 v[20:21], v12 offset:112
  ds_read_b64_tr_b16 v[22:23], v12 offset:2672
  ds_read_b64_tr_b16 v[24:25], v13 offset:144
  ds_read_b64_tr_b16 v[26:27], v13 offset:2704
  ds_read_b64_tr_b16 v[28:29], v15 offset:48
  ds_read_b64_tr_b16 v[30:31], v15 offset:1648
  ds_read_b64_tr_b16 v[32:33], v14 offset:80
  ds_read_b64_tr_b16 v[34:35], v14 offset:1680
  s_waitcnt lgkmcnt(0)
  v_mfma_f32_16x16x32_bf16 v[64:67], v[16:19], v[28:31], 0
  v_mfma_f32_16x16x32_bf16 v[68:71], v[16:19], v[32:35], 0
  v_mfma_f32_16x16x32_bf16 v[72:75], v[20:23], v[28:31], 0
  v_mfma_f32_16x16x32_bf16 v[76:79], v[20:23], v[32:35], 0
  v_mfma_f32_16x16x32_bf16 v[80:83], v[24:27], v[28:31], 0
  v_mfma_f32_16x16x32_bf16 v[84:87], v[24:27], v[32:35], 0
  ds_read_b64_tr_b16 v[16:17], v12 offset:20560
  ds_read_b64_tr_b16 v[18:19], v12 offset:23120
  ds_read_b64_tr_b16 v[20:21], v12 offset:20592
  ds_read_b64_tr_b16 v[22:23], v12 offset:23152
  ds_read_b64_tr_b16 v[24:25], v13 offset:20624
  ds_read_b64_tr_b16 v[26:27], v13 offset:23184
  ds_read_b64_tr_b16 v[28:29], v15 offset:12848
  ds_read_b64_tr_b16 v[30:31], v15 offset:14448
  ds_read_b64_tr_b16 v[32:33], v14 offset:12880
  ds_read_b64_tr_b16 v[34:35], v14 offset:14480
  s_waitcnt lgkmcnt(0)
  v_mfma_f32_16x16x32_bf16 v[64:67], v[16:19], v[28:31], v[64:67]
  v_mfma_f32_16x16x32_bf16 v[68:71], v[16:19], v[32:35], v[68:71]
  v_mfma_f32_16x16x32_bf16 v[72:75], v[20:23], v[28:31], v[72:75]
  v_mfma_f32_16x16x32_bf16 v[76:79], v[20:23], v[32:35], v[76:79]
  v_mfma_f32_16x16x32_bf16 v[80:83], v[24:27], v[28:31], v[80:83]
  v_mfma_f32_16x16x32_bf16 v[84:87], v[24:27], v[32:35], v[84:87]
  ds_read_b64_tr_b16 v[16:17], v12 offset:41040
  ds_read_b64_tr_b16 v[18:19], v12 offset:43600
  ds_read_b64_tr_b16 v[20:21], v12 offset:41072
  ds_read_b64_tr_b16 v[22:23], v12 offset:43632
  ds_read_b64_tr_b16 v[24:25], v13 offset:41104
  ds_read_b64_tr_b16 v[26:27], v13 offset:43664
  ds_read_b64_tr_b16 v[28:29], v15 offset:25648
  ds_read_b64_tr_b16 v[30:31], v15 offset:27248
  ds_read_b64_tr_b16 v[32:33], v14 offset:25680
  ds_read_b64_tr_b16 v[34:35], v14 offset:27280
  s_waitcnt lgkmcnt(0)
  v_mfma_f32_16x16x32_bf16 v[64:67], v[16:19], v[28:31], v[64:67]
  v_mfma_f32_16x16x32_bf16 v[68:71], v[16:19], v[32:35], v[68:71]
  v_mfma_f32_16x16x32_bf16 v[72:75], v[20:23], v[28:31], v[72:75]
  v_mfma_f32_16x16x32_bf16 v[76:79], v[20:23], v[32:35], v[76:79]
  v_mfma_f32_16x16x32_bf16 v[80:83], v[24:27], v[28:31], v[80:83]
  v_mfma_f32_16x16x32_bf16 v[84:87], v[24:27], v[32:35], v[84:87]
  ds_read_b64_tr_b16 v[16:17], v12 offset:61520
  ds_read_b64_tr_b16 v[18:19], v12 offset:64080
  ds_read_b64_tr_b16 v[20:21], v12 offset:61552
  ds_read_b64_tr_b16 v[22:23], v12 offset:64112
  ds_read_b64_tr_b16 v[24:25], v13 offset:61584
  ds_read_b64_tr_b16 v[26:27], v13 offset:64144
  ds_read_b64_tr_b16 v[28:29], v15 offset:38448
  ds_read_b64_tr_b16 v[30:31], v15 offset:40048
  ds_read_b64_tr_b16 v[32:33], v14 offset:38480
  ds_read_b64_tr_b16 v[34:35], v14 offset:40080
  s_waitcnt lgkmcnt(0)
  v_mfma_f32_16x16x32_bf16 v[64:67], v[16:19], v[28:31], v[64:67]
  v_mfma_f32_16x16x32_bf16 v[68:71], v[16:19], v[32:35], v[68:71]
  v_mfma_f32_16x16x32_bf16 v[72:75], v[20:23], v[28:31], v[72:75]
  v_mfma_f32_16x16x32_bf16 v[76:79], v[20:23], v[32:35], v[76:79]
  v_mfma_f32_16x16x32_bf16 v[80:83], v[24:27], v[28:31], v[80:83]
  v_mfma_f32_16x16x32_bf16 v[84:87], v[24:27], v[32:35], v[84:87]
  buffer_store_dwordx4 v[40:43], v1, s[4:7], s38 offen offset:0 sc1
  buffer_store_dwordx4 v[44:47], v1, s[4:7], s38 offen offset:1024 sc1
  buffer_store_dwordx4 v[48:51], v1, s[4:7], s38 offen offset:2048 sc1
  buffer_store_dwordx4 v[52:55], v1, s[4:7], s38 offen offset:3072 sc1
  s_add_u32 s38, s38, 4096
  buffer_store_dwordx4 v[56:59], v1, s[4:7], s38 offen offset:0 sc1
  buffer_store_dwordx4 v[60:63], v1, s[4:7], s38 offen offset:1024 sc1
  buffer_store_dwordx4 v[64:67], v1, s[4:7], s38 offen offset:2048 sc1
  buffer_store_dwordx4 v[68:71], v1, s[4:7], s38 offen offset:3072 sc1
  s_add_u32 s38, s38, 4096
  buffer_store_dwordx4 v[72:75], v1, s[4:7], s38 offen offset:0 sc1
  buffer_store_dwordx4 v[76:79], v1, s[4:7], s38 offen offset:1024 sc1
  buffer_store_dwordx4 v[80:83], v1, s[4:7], s38 offen offset:2048 sc1
  buffer_store_dwordx4 v[84:87], v1, s[4:7], s38 offen offset:3072 sc1
  s_add_u32 s38, s38, 4096
  s_lshl_b32 s53, s34, 2
  s_add_u32 s53, s53, 196
  s_waitcnt vmcnt(0)
  s_barrier
  s_cmp_lg_u32 s28, 0
  s_cbranch_scc1 L_sig_58
  s_mov_b64 exec, 1
  v_mov_b32 v2, 1
  buffer_atomic_add v2, off, s[8:11], s53 sc1
  s_mov_b64 exec, -1
L_sig_58:
  v_accvgpr_read_b32 v40, a0
  v_accvgpr_read_b32 v41, a1
  v_accvgpr_read_b32 v42, a2
  v_accvgpr_read_b32 v43, a3
  v_accvgpr_read_b32 v44, a4
  v_accvgpr_read_b32 v45, a5
  v_accvgpr_read_b32 v46, a6
  v_accvgpr_read_b32 v47, a7
  v_accvgpr_read_b32 v48, a8
  v_accvgpr_read_b32 v49, a9
  v_accvgpr_read_b32 v50, a10
  v_accvgpr_read_b32 v51, a11
  v_accvgpr_read_b32 v52, a12
  v_accvgpr_read_b32 v53, a13
  v_accvgpr_read_b32 v54, a14
  v_accvgpr_read_b32 v55, a15
  v_accvgpr_read_b32 v56, a16
  v_accvgpr_read_b32 v57, a17
  v_accvgpr_read_b32 v58, a18
  v_accvgpr_read_b32 v59, a19
  v_max3_f32 v80, v40, v41, v42
  v_min3_f32 v81, v40, v41, v42
  v_max3_f32 v80, v80, v43, v44
  v_min3_f32 v81, v81, v43, v44
  v_max3_f32 v80, v80, v45, v46
  v_min3_f32 v81, v81, v45, v46
  v_max3_f32 v80, v80, v47, v48
  v_min3_f32 v81, v81, v47, v48
  v_max3_f32 v80, v80, v49, v50
  v_min3_f32 v81, v81, v49, v50
  v_max3_f32 v80, v80, v51, v52
  v_min3_f32 v81, v81, v51, v52
  v_max3_f32 v80, v80, v53, v54
  v_min3_f32 v81, v81, v53, v54
  v_max3_f32 v80, v80, v55, v56
  v_min3_f32 v81, v81, v55, v56
  v_max3_f32 v80, v80, v57, v58
  v_min3_f32 v81, v81, v57, v58
  v_max_f32 v80, v80, v59
  v_min_f32 v81, v81, v59
  v_mul_f32 v80, s41, v80
  v_mul_f32 v81, s41, v81
  v_fma_f32 v60, -v40, s41, v81
  v_fma_f32 v40, v40, s41, -v80
  v_fma_f32 v61, -v41, s41, v81
  v_fma_f32 v41, v41, s41, -v80
  v_fma_f32 v62, -v42, s41, v81
  v_fma_f32 v42, v42, s41, -v80
  v_fma_f32 v63, -v43, s41, v81
  v_fma_f32 v43, v43, s41, -v80
  v_fma_f32 v64, -v44, s41, v81
  v_fma_f32 v44, v44, s41, -v80
  v_fma_f32 v65, -v45, s41, v81
  v_fma_f32 v45, v45, s41, -v80
  v_fma_f32 v66, -v46, s41, v81
  v_fma_f32 v46, v46, s41, -v80
  v_fma_f32 v67, -v47, s41, v81
  v_fma_f32 v47, v47, s41, -v80
  v_fma_f32 v68, -v48, s41, v81
  v_fma_f32 v48, v48, s41, -v80
  v_fma_f32 v69, -v49, s41, v81
  v_fma_f32 v49, v49, s41, -v80
  v_fma_f32 v70, -v50, s41, v81
  v_fma_f32 v50, v50, s41, -v80
  v_fma_f32 v71, -v51, s41, v81
  v_fma_f32 v51, v51, s41, -v80
  v_fma_f32 v72, -v52, s41, v81
  v_fma_f32 v52, v52, s41, -v80
  v_fma_f32 v73, -v53, s41, v81
  v_fma_f32 v53, v53, s41, -v80
  v_fma_f32 v74, -v54, s41, v81
  v_fma_f32 v54, v54, s41, -v80
  v_fma_f32 v75, -v55, s41, v81
  v_fma_f32 v55, v55, s41, -v80
  v_fma_f32 v76, -v56, s41, v81
  v_fma_f32 v56, v56, s41, -v80
  v_fma_f32 v77, -v57, s41, v81
  v_fma_f32 v57, v57, s41, -v80
  v_fma_f32 v78, -v58, s41, v81
  v_fma_f32 v58, v58, s41, -v80
  v_fma_f32 v79, -v59, s41, v81
  v_fma_f32 v59, v59, s41, -v80
  v_exp_f32 v40, v40
  v_exp_f32 v41, v41
  v_exp_f32 v42, v42
  v_exp_f32 v43, v43
  v_exp_f32 v44, v44
  v_exp_f32 v45, v45
  v_exp_f32 v46, v46
  v_exp_f32 v47, v47
  v_exp_f32 v48, v48
  v_exp_f32 v49, v49
  v_exp_f32 v50, v50
  v_exp_f32 v51, v51
  v_exp_f32 v52, v52
  v_exp_f32 v53, v53
  v_exp_f32 v54, v54
  v_exp_f32 v55, v55
  v_exp_f32 v56, v56
  v_exp_f32 v57, v57
  v_exp_f32 v58, v58
  v_exp_f32 v59, v59
  v_exp_f32 v60, v60
  v_exp_f32 v61, v61
  v_exp_f32 v62, v62
  v_exp_f32 v63, v63
  v_exp_f32 v64, v64
  v_exp_f32 v65, v65
  v_exp_f32 v66, v66
  v_exp_f32 v67, v67
  v_exp_f32 v68, v68
  v_exp_f32 v69, v69
  v_exp_f32 v70, v70
  v_exp_f32 v71, v71
  v_exp_f32 v72, v72
  v_exp_f32 v73, v73
  v_exp_f32 v74, v74
  v_exp_f32 v75, v75
  v_exp_f32 v76, v76
  v_exp_f32 v77, v77
  v_exp_f32 v78, v78
  v_exp_f32 v79, v79
  v_add_f32 v82, v40, v41
  v_add_f32 v82, v82, v42
  v_add_f32 v82, v82, v43
  v_add_f32 v82, v82, v44
  v_add_f32 v82, v82, v45
  v_add_f32 v82, v82, v46
  v_add_f32 v82, v82, v47
  v_add_f32 v82, v82, v48
  v_add_f32 v82, v82, v49
  v_add_f32 v82, v82, v50
  v_add_f32 v82, v82, v51
  v_add_f32 v82, v82, v52
  v_add_f32 v82, v82, v53
  v_add_f32 v82, v82, v54
  v_add_f32 v82, v82, v55
  v_add_f32 v82, v82, v56
  v_add_f32 v82, v82, v57
  v_add_f32 v82, v82, v58
  v_add_f32 v82, v82, v59
  v_rcp_f32 v82, v82
  v_add_f32 v83, v60, v61
  v_add_f32 v83, v83, v62
  v_add_f32 v83, v83, v63
  v_add_f32 v83, v83, v64
  v_add_f32 v83, v83, v65
  v_add_f32 v83, v83, v66
  v_add_f32 v83, v83, v67
  v_add_f32 v83, v83, v68
  v_add_f32 v83, v83, v69
  v_add_f32 v83, v83, v70
  v_add_f32 v83, v83, v71
  v_add_f32 v83, v83, v72
  v_add_f32 v83, v83, v73
  v_add_f32 v83, v83, v74
  v_add_f32 v83, v83, v75
  v_add_f32 v83, v83, v76
  v_add_f32 v83, v83, v77
  v_add_f32 v83, v83, v78
  v_add_f32 v83, v83, v79
  v_rcp_f32 v83, v83
  v_mul_f32 v40, v40, v82
  v_mul_f32 v41, v41, v82
  v_mul_f32 v42, v42, v82
  v_mul_f32 v43, v43, v82
  v_mul_f32 v44, v44, v82
  v_mul_f32 v45, v45, v82
  v_mul_f32 v46, v46, v82
  v_mul_f32 v47, v47, v82
  v_mul_f32 v48, v48, v82
  v_mul_f32 v49, v49, v82
  v_mul_f32 v50, v50, v82
  v_mul_f32 v51, v51, v82
  v_mul_f32 v52, v52, v82
  v_mul_f32 v53, v53, v82
  v_mul_f32 v54, v54, v82
  v_mul_f32 v55, v55, v82
  v_mul_f32 v56, v56, v82
  v_mul_f32 v57, v57, v82
  v_mul_f32 v58, v58, v82
  v_mul_f32 v59, v59, v82
  v_mul_f32 v60, v60, v83
  v_mul_f32 v61, v61, v83
  v_mul_f32 v62, v62, v83
  v_mul_f32 v63, v63, v83
  v_mul_f32 v64, v64, v83
  v_mul_f32 v65, v65, v83
  v_mul_f32 v66, v66, v83
  v_mul_f32 v67, v67, v83
  v_mul_f32 v68, v68, v83
  v_mul_f32 v69, v69, v83
  v_mul_f32 v70, v70, v83
  v_mul_f32 v71, v71, v83
  v_mul_f32 v72, v72, v83
  v_mul_f32 v73, v73, v83
  v_mul_f32 v74, v74, v83
  v_mul_f32 v75, v75, v83
  v_mul_f32 v76, v76, v83
  v_mul_f32 v77, v77, v83
  v_mul_f32 v78, v78, v83
  v_mul_f32 v79, v79, v83
  v_cvt_pk_bf16_f32 v160, v40, v41
  v_cvt_pk_bf16_f32 v161, v42, v43
  v_cvt_pk_bf16_f32 v162, v44, v45
  v_cvt_pk_bf16_f32 v163, v46, v47
  v_cvt_pk_bf16_f32 v164, v48, v49
  v_cvt_pk_bf16_f32 v165, v50, v51
  v_cvt_pk_bf16_f32 v166, v52, v53
  v_cvt_pk_bf16_f32 v167, v54, v55
  v_cvt_pk_bf16_f32 v168, v56, v57
  v_cvt_pk_bf16_f32 v169, v58, v59
  v_cvt_pk_bf16_f32 v170, v60, v61
  v_cvt_pk_bf16_f32 v171, v62, v63
  v_cvt_pk_bf16_f32 v172, v64, v65
  v_cvt_pk_bf16_f32 v173, v66, v67
  v_cvt_pk_bf16_f32 v174, v68, v69
  v_cvt_pk_bf16_f32 v175, v70, v71
  v_cvt_pk_bf16_f32 v176, v72, v73
  v_cvt_pk_bf16_f32 v177, v74, v75
  v_cvt_pk_bf16_f32 v178, v76, v77
  v_cvt_pk_bf16_f32 v179, v78, v79
  v_accvgpr_read_b32 v40, a20
  v_accvgpr_read_b32 v41, a21
  v_accvgpr_read_b32 v42, a22
  v_accvgpr_read_b32 v43, a23
  v_accvgpr_read_b32 v44, a24
  v_accvgpr_read_b32 v45, a25
  v_accvgpr_read_b32 v46, a26
  v_accvgpr_read_b32 v47, a27
  v_accvgpr_read_b32 v48, a28
  v_accvgpr_read_b32 v49, a29
  v_accvgpr_read_b32 v50, a30
  v_accvgpr_read_b32 v51, a31
  v_accvgpr_read_b32 v52, a32
  v_accvgpr_read_b32 v53, a33
  v_accvgpr_read_b32 v54, a34
  v_accvgpr_read_b32 v55, a35
  v_accvgpr_read_b32 v56, a36
  v_accvgpr_read_b32 v57, a37
  v_accvgpr_read_b32 v58, a38
  v_accvgpr_read_b32 v59, a39
  v_max3_f32 v80, v40, v41, v42
  v_min3_f32 v81, v40, v41, v42
  v_max3_f32 v80, v80, v43, v44
  v_min3_f32 v81, v81, v43, v44
  v_max3_f32 v80, v80, v45, v46
  v_min3_f32 v81, v81, v45, v46
  v_max3_f32 v80, v80, v47, v48
  v_min3_f32 v81, v81, v47, v48
  v_max3_f32 v80, v80, v49, v50
  v_min3_f32 v81, v81, v49, v50
  v_max3_f32 v80, v80, v51, v52
  v_min3_f32 v81, v81, v51, v52
  v_max3_f32 v80, v80, v53, v54
  v_min3_f32 v81, v81, v53, v54
  v_max3_f32 v80, v80, v55, v56
  v_min3_f32 v81, v81, v55, v56
  v_max3_f32 v80, v80, v57, v58
  v_min3_f32 v81, v81, v57, v58
  v_max_f32 v80, v80, v59
  v_min_f32 v81, v81, v59
  v_mul_f32 v80, s41, v80
  v_mul_f32 v81, s41, v81
  v_fma_f32 v60, -v40, s41, v81
  v_fma_f32 v40, v40, s41, -v80
  v_fma_f32 v61, -v41, s41, v81
  v_fma_f32 v41, v41, s41, -v80
  v_fma_f32 v62, -v42, s41, v81
  v_fma_f32 v42, v42, s41, -v80
  v_fma_f32 v63, -v43, s41, v81
  v_fma_f32 v43, v43, s41, -v80
  v_fma_f32 v64, -v44, s41, v81
  v_fma_f32 v44, v44, s41, -v80
  v_fma_f32 v65, -v45, s41, v81
  v_fma_f32 v45, v45, s41, -v80
  v_fma_f32 v66, -v46, s41, v81
  v_fma_f32 v46, v46, s41, -v80
  v_fma_f32 v67, -v47, s41, v81
  v_fma_f32 v47, v47, s41, -v80
  v_fma_f32 v68, -v48, s41, v81
  v_fma_f32 v48, v48, s41, -v80
  v_fma_f32 v69, -v49, s41, v81
  v_fma_f32 v49, v49, s41, -v80
  v_fma_f32 v70, -v50, s41, v81
  v_fma_f32 v50, v50, s41, -v80
  v_fma_f32 v71, -v51, s41, v81
  v_fma_f32 v51, v51, s41, -v80
  v_fma_f32 v72, -v52, s41, v81
  v_fma_f32 v52, v52, s41, -v80
  v_fma_f32 v73, -v53, s41, v81
  v_fma_f32 v53, v53, s41, -v80
  v_fma_f32 v74, -v54, s41, v81
  v_fma_f32 v54, v54, s41, -v80
  v_fma_f32 v75, -v55, s41, v81
  v_fma_f32 v55, v55, s41, -v80
  v_fma_f32 v76, -v56, s41, v81
  v_fma_f32 v56, v56, s41, -v80
  v_fma_f32 v77, -v57, s41, v81
  v_fma_f32 v57, v57, s41, -v80
  v_fma_f32 v78, -v58, s41, v81
  v_fma_f32 v58, v58, s41, -v80
  v_fma_f32 v79, -v59, s41, v81
  v_fma_f32 v59, v59, s41, -v80
  v_exp_f32 v40, v40
  v_exp_f32 v41, v41
  v_exp_f32 v42, v42
  v_exp_f32 v43, v43
  v_exp_f32 v44, v44
  v_exp_f32 v45, v45
  v_exp_f32 v46, v46
  v_exp_f32 v47, v47
  v_exp_f32 v48, v48
  v_exp_f32 v49, v49
  v_exp_f32 v50, v50
  v_exp_f32 v51, v51
  v_exp_f32 v52, v52
  v_exp_f32 v53, v53
  v_exp_f32 v54, v54
  v_exp_f32 v55, v55
  v_exp_f32 v56, v56
  v_exp_f32 v57, v57
  v_exp_f32 v58, v58
  v_exp_f32 v59, v59
  v_exp_f32 v60, v60
  v_exp_f32 v61, v61
  v_exp_f32 v62, v62
  v_exp_f32 v63, v63
  v_exp_f32 v64, v64
  v_exp_f32 v65, v65
  v_exp_f32 v66, v66
  v_exp_f32 v67, v67
  v_exp_f32 v68, v68
  v_exp_f32 v69, v69
  v_exp_f32 v70, v70
  v_exp_f32 v71, v71
  v_exp_f32 v72, v72
  v_exp_f32 v73, v73
  v_exp_f32 v74, v74
  v_exp_f32 v75, v75
  v_exp_f32 v76, v76
  v_exp_f32 v77, v77
  v_exp_f32 v78, v78
  v_exp_f32 v79, v79
  v_add_f32 v82, v40, v41
  v_add_f32 v82, v82, v42
  v_add_f32 v82, v82, v43
  v_add_f32 v82, v82, v44
  v_add_f32 v82, v82, v45
  v_add_f32 v82, v82, v46
  v_add_f32 v82, v82, v47
  v_add_f32 v82, v82, v48
  v_add_f32 v82, v82, v49
  v_add_f32 v82, v82, v50
  v_add_f32 v82, v82, v51
  v_add_f32 v82, v82, v52
  v_add_f32 v82, v82, v53
  v_add_f32 v82, v82, v54
  v_add_f32 v82, v82, v55
  v_add_f32 v82, v82, v56
  v_add_f32 v82, v82, v57
  v_add_f32 v82, v82, v58
  v_add_f32 v82, v82, v59
  v_rcp_f32 v82, v82
  v_add_f32 v83, v60, v61
  v_add_f32 v83, v83, v62
  v_add_f32 v83, v83, v63
  v_add_f32 v83, v83, v64
  v_add_f32 v83, v83, v65
  v_add_f32 v83, v83, v66
  v_add_f32 v83, v83, v67
  v_add_f32 v83, v83, v68
  v_add_f32 v83, v83, v69
  v_add_f32 v83, v83, v70
  v_add_f32 v83, v83, v71
  v_add_f32 v83, v83, v72
  v_add_f32 v83, v83, v73
  v_add_f32 v83, v83, v74
  v_add_f32 v83, v83, v75
  v_add_f32 v83, v83, v76
  v_add_f32 v83, v83, v77
  v_add_f32 v83, v83, v78
  v_add_f32 v83, v83, v79
  v_rcp_f32 v83, v83
  v_mul_f32 v40, v40, v82
  v_mul_f32 v41, v41, v82
  v_mul_f32 v42, v42, v82
  v_mul_f32 v43, v43, v82
  v_mul_f32 v44, v44, v82
  v_mul_f32 v45, v45, v82
  v_mul_f32 v46, v46, v82
  v_mul_f32 v47, v47, v82
  v_mul_f32 v48, v48, v82
  v_mul_f32 v49, v49, v82
  v_mul_f32 v50, v50, v82
  v_mul_f32 v51, v51, v82
  v_mul_f32 v52, v52, v82
  v_mul_f32 v53, v53, v82
  v_mul_f32 v54, v54, v82
  v_mul_f32 v55, v55, v82
  v_mul_f32 v56, v56, v82
  v_mul_f32 v57, v57, v82
  v_mul_f32 v58, v58, v82
  v_mul_f32 v59, v59, v82
  v_mul_f32 v60, v60, v83
  v_mul_f32 v61, v61, v83
  v_mul_f32 v62, v62, v83
  v_mul_f32 v63, v63, v83
  v_mul_f32 v64, v64, v83
  v_mul_f32 v65, v65, v83
  v_mul_f32 v66, v66, v83
  v_mul_f32 v67, v67, v83
  v_mul_f32 v68, v68, v83
  v_mul_f32 v69, v69, v83
  v_mul_f32 v70, v70, v83
  v_mul_f32 v71, v71, v83
  v_mul_f32 v72, v72, v83
  v_mul_f32 v73, v73, v83
  v_mul_f32 v74, v74, v83
  v_mul_f32 v75, v75, v83
  v_mul_f32 v76, v76, v83
  v_mul_f32 v77, v77, v83
  v_mul_f32 v78, v78, v83
  v_mul_f32 v79, v79, v83
  v_cvt_pk_bf16_f32 v180, v40, v41
  v_cvt_pk_bf16_f32 v181, v42, v43
  v_cvt_pk_bf16_f32 v182, v44, v45
  v_cvt_pk_bf16_f32 v183, v46, v47
  v_cvt_pk_bf16_f32 v184, v48, v49
  v_cvt_pk_bf16_f32 v185, v50, v51
  v_cvt_pk_bf16_f32 v186, v52, v53
  v_cvt_pk_bf16_f32 v187, v54, v55
  v_cvt_pk_bf16_f32 v188, v56, v57
  v_cvt_pk_bf16_f32 v189, v58, v59
  v_cvt_pk_bf16_f32 v190, v60, v61
  v_cvt_pk_bf16_f32 v191, v62, v63
  v_cvt_pk_bf16_f32 v192, v64, v65
  v_cvt_pk_bf16_f32 v193, v66, v67
  v_cvt_pk_bf16_f32 v194, v68, v69
  v_cvt_pk_bf16_f32 v195, v70, v71
  v_cvt_pk_bf16_f32 v196, v72, v73
  v_cvt_pk_bf16_f32 v197, v74, v75
  v_cvt_pk_bf16_f32 v198, v76, v77
  v_cvt_pk_bf16_f32 v199, v78, v79
  v_accvgpr_read_b32 v40, a40
  v_accvgpr_read_b32 v41, a41
  v_accvgpr_read_b32 v42, a42
  v_accvgpr_read_b32 v43, a43
  v_accvgpr_read_b32 v44, a44
  v_accvgpr_read_b32 v45, a45
  v_accvgpr_read_b32 v46, a46
  v_accvgpr_read_b32 v47, a47
  v_accvgpr_read_b32 v48, a48
  v_accvgpr_read_b32 v49, a49
  v_accvgpr_read_b32 v50, a50
  v_accvgpr_read_b32 v51, a51
  v_accvgpr_read_b32 v52, a52
  v_accvgpr_read_b32 v53, a53
  v_accvgpr_read_b32 v54, a54
  v_accvgpr_read_b32 v55, a55
  v_accvgpr_read_b32 v56, a56
  v_accvgpr_read_b32 v57, a57
  v_accvgpr_read_b32 v58, a58
  v_accvgpr_read_b32 v59, a59
  v_max3_f32 v80, v40, v41, v42
  v_min3_f32 v81, v40, v41, v42
  v_max3_f32 v80, v80, v43, v44
  v_min3_f32 v81, v81, v43, v44
  v_max3_f32 v80, v80, v45, v46
  v_min3_f32 v81, v81, v45, v46
  v_max3_f32 v80, v80, v47, v48
  v_min3_f32 v81, v81, v47, v48
  v_max3_f32 v80, v80, v49, v50
  v_min3_f32 v81, v81, v49, v50
  v_max3_f32 v80, v80, v51, v52
  v_min3_f32 v81, v81, v51, v52
  v_max3_f32 v80, v80, v53, v54
  v_min3_f32 v81, v81, v53, v54
  v_max3_f32 v80, v80, v55, v56
  v_min3_f32 v81, v81, v55, v56
  v_max3_f32 v80, v80, v57, v58
  v_min3_f32 v81, v81, v57, v58
  v_max_f32 v80, v80, v59
  v_min_f32 v81, v81, v59
  v_mul_f32 v80, s41, v80
  v_mul_f32 v81, s41, v81
  v_fma_f32 v60, -v40, s41, v81
  v_fma_f32 v40, v40, s41, -v80
  v_fma_f32 v61, -v41, s41, v81
  v_fma_f32 v41, v41, s41, -v80
  v_fma_f32 v62, -v42, s41, v81
  v_fma_f32 v42, v42, s41, -v80
  v_fma_f32 v63, -v43, s41, v81
  v_fma_f32 v43, v43, s41, -v80
  v_fma_f32 v64, -v44, s41, v81
  v_fma_f32 v44, v44, s41, -v80
  v_fma_f32 v65, -v45, s41, v81
  v_fma_f32 v45, v45, s41, -v80
  v_fma_f32 v66, -v46, s41, v81
  v_fma_f32 v46, v46, s41, -v80
  v_fma_f32 v67, -v47, s41, v81
  v_fma_f32 v47, v47, s41, -v80
  v_fma_f32 v68, -v48, s41, v81
  v_fma_f32 v48, v48, s41, -v80
  v_fma_f32 v69, -v49, s41, v81
  v_fma_f32 v49, v49, s41, -v80
  v_fma_f32 v70, -v50, s41, v81
  v_fma_f32 v50, v50, s41, -v80
  v_fma_f32 v71, -v51, s41, v81
  v_fma_f32 v51, v51, s41, -v80
  v_fma_f32 v72, -v52, s41, v81
  v_fma_f32 v52, v52, s41, -v80
  v_fma_f32 v73, -v53, s41, v81
  v_fma_f32 v53, v53, s41, -v80
  v_fma_f32 v74, -v54, s41, v81
  v_fma_f32 v54, v54, s41, -v80
  v_fma_f32 v75, -v55, s41, v81
  v_fma_f32 v55, v55, s41, -v80
  v_fma_f32 v76, -v56, s41, v81
  v_fma_f32 v56, v56, s41, -v80
  v_fma_f32 v77, -v57, s41, v81
  v_fma_f32 v57, v57, s41, -v80
  v_fma_f32 v78, -v58, s41, v81
  v_fma_f32 v58, v58, s41, -v80
  v_fma_f32 v79, -v59, s41, v81
  v_fma_f32 v59, v59, s41, -v80
  v_exp_f32 v40, v40
  v_exp_f32 v41, v41
  v_exp_f32 v42, v42
  v_exp_f32 v43, v43
  v_exp_f32 v44, v44
  v_exp_f32 v45, v45
  v_exp_f32 v46, v46
  v_exp_f32 v47, v47
  v_exp_f32 v48, v48
  v_exp_f32 v49, v49
  v_exp_f32 v50, v50
  v_exp_f32 v51, v51
  v_exp_f32 v52, v52
  v_exp_f32 v53, v53
  v_exp_f32 v54, v54
  v_exp_f32 v55, v55
  v_exp_f32 v56, v56
  v_exp_f32 v57, v57
  v_exp_f32 v58, v58
  v_exp_f32 v59, v59
  v_exp_f32 v60, v60
  v_exp_f32 v61, v61
  v_exp_f32 v62, v62
  v_exp_f32 v63, v63
  v_exp_f32 v64, v64
  v_exp_f32 v65, v65
  v_exp_f32 v66, v66
  v_exp_f32 v67, v67
  v_exp_f32 v68, v68
  v_exp_f32 v69, v69
  v_exp_f32 v70, v70
  v_exp_f32 v71, v71
  v_exp_f32 v72, v72
  v_exp_f32 v73, v73
  v_exp_f32 v74, v74
  v_exp_f32 v75, v75
  v_exp_f32 v76, v76
  v_exp_f32 v77, v77
  v_exp_f32 v78, v78
  v_exp_f32 v79, v79
  v_add_f32 v82, v40, v41
  v_add_f32 v82, v82, v42
  v_add_f32 v82, v82, v43
  v_add_f32 v82, v82, v44
  v_add_f32 v82, v82, v45
  v_add_f32 v82, v82, v46
  v_add_f32 v82, v82, v47
  v_add_f32 v82, v82, v48
  v_add_f32 v82, v82, v49
  v_add_f32 v82, v82, v50
  v_add_f32 v82, v82, v51
  v_add_f32 v82, v82, v52
  v_add_f32 v82, v82, v53
  v_add_f32 v82, v82, v54
  v_add_f32 v82, v82, v55
  v_add_f32 v82, v82, v56
  v_add_f32 v82, v82, v57
  v_add_f32 v82, v82, v58
  v_add_f32 v82, v82, v59
  v_rcp_f32 v82, v82
  v_add_f32 v83, v60, v61
  v_add_f32 v83, v83, v62
  v_add_f32 v83, v83, v63
  v_add_f32 v83, v83, v64
  v_add_f32 v83, v83, v65
  v_add_f32 v83, v83, v66
  v_add_f32 v83, v83, v67
  v_add_f32 v83, v83, v68
  v_add_f32 v83, v83, v69
  v_add_f32 v83, v83, v70
  v_add_f32 v83, v83, v71
  v_add_f32 v83, v83, v72
  v_add_f32 v83, v83, v73
  v_add_f32 v83, v83, v74
  v_add_f32 v83, v83, v75
  v_add_f32 v83, v83, v76
  v_add_f32 v83, v83, v77
  v_add_f32 v83, v83, v78
  v_add_f32 v83, v83, v79
  v_rcp_f32 v83, v83
  v_mul_f32 v40, v40, v82
  v_mul_f32 v41, v41, v82
  v_mul_f32 v42, v42, v82
  v_mul_f32 v43, v43, v82
  v_mul_f32 v44, v44, v82
  v_mul_f32 v45, v45, v82
  v_mul_f32 v46, v46, v82
  v_mul_f32 v47, v47, v82
  v_mul_f32 v48, v48, v82
  v_mul_f32 v49, v49, v82
  v_mul_f32 v50, v50, v82
  v_mul_f32 v51, v51, v82
  v_mul_f32 v52, v52, v82
  v_mul_f32 v53, v53, v82
  v_mul_f32 v54, v54, v82
  v_mul_f32 v55, v55, v82
  v_mul_f32 v56, v56, v82
  v_mul_f32 v57, v57, v82
  v_mul_f32 v58, v58, v82
  v_mul_f32 v59, v59, v82
  v_mul_f32 v60, v60, v83
  v_mul_f32 v61, v61, v83
  v_mul_f32 v62, v62, v83
  v_mul_f32 v63, v63, v83
  v_mul_f32 v64, v64, v83
  v_mul_f32 v65, v65, v83
  v_mul_f32 v66, v66, v83
  v_mul_f32 v67, v67, v83
  v_mul_f32 v68, v68, v83
  v_mul_f32 v69, v69, v83
  v_mul_f32 v70, v70, v83
  v_mul_f32 v71, v71, v83
  v_mul_f32 v72, v72, v83
  v_mul_f32 v73, v73, v83
  v_mul_f32 v74, v74, v83
  v_mul_f32 v75, v75, v83
  v_mul_f32 v76, v76, v83
  v_mul_f32 v77, v77, v83
  v_mul_f32 v78, v78, v83
  v_mul_f32 v79, v79, v83
  v_cvt_pk_bf16_f32 v200, v40, v41
  v_cvt_pk_bf16_f32 v201, v42, v43
  v_cvt_pk_bf16_f32 v202, v44, v45
  v_cvt_pk_bf16_f32 v203, v46, v47
  v_cvt_pk_bf16_f32 v204, v48, v49
  v_cvt_pk_bf16_f32 v205, v50, v51
  v_cvt_pk_bf16_f32 v206, v52, v53
  v_cvt_pk_bf16_f32 v207, v54, v55
  v_cvt_pk_bf16_f32 v208, v56, v57
  v_cvt_pk_bf16_f32 v209, v58, v59
  v_cvt_pk_bf16_f32 v210, v60, v61
  v_cvt_pk_bf16_f32 v211, v62, v63
  v_cvt_pk_bf16_f32 v212, v64, v65
  v_cvt_pk_bf16_f32 v213, v66, v67
  v_cvt_pk_bf16_f32 v214, v68, v69
  v_cvt_pk_bf16_f32 v215, v70, v71
  v_cvt_pk_bf16_f32 v216, v72, v73
  v_cvt_pk_bf16_f32 v217, v74, v75
  v_cvt_pk_bf16_f32 v218, v76, v77
  v_cvt_pk_bf16_f32 v219, v78, v79
  v_accvgpr_read_b32 v40, a60
  v_accvgpr_read_b32 v41, a61
  v_accvgpr_read_b32 v42, a62
  v_accvgpr_read_b32 v43, a63
  v_accvgpr_read_b32 v44, a64
  v_accvgpr_read_b32 v45, a65
  v_accvgpr_read_b32 v46, a66
  v_accvgpr_read_b32 v47, a67
  v_accvgpr_read_b32 v48, a68
  v_accvgpr_read_b32 v49, a69
  v_accvgpr_read_b32 v50, a70
  v_accvgpr_read_b32 v51, a71
  v_accvgpr_read_b32 v52, a72
  v_accvgpr_read_b32 v53, a73
  v_accvgpr_read_b32 v54, a74
  v_accvgpr_read_b32 v55, a75
  v_accvgpr_read_b32 v56, a76
  v_accvgpr_read_b32 v57, a77
  v_accvgpr_read_b32 v58, a78
  v_accvgpr_read_b32 v59, a79
  v_max3_f32 v80, v40, v41, v42
  v_min3_f32 v81, v40, v41, v42
  v_max3_f32 v80, v80, v43, v44
  v_min3_f32 v81, v81, v43, v44
  v_max3_f32 v80, v80, v45, v46
  v_min3_f32 v81, v81, v45, v46
  v_max3_f32 v80, v80, v47, v48
  v_min3_f32 v81, v81, v47, v48
  v_max3_f32 v80, v80, v49, v50
  v_min3_f32 v81, v81, v49, v50
  v_max3_f32 v80, v80, v51, v52
  v_min3_f32 v81, v81, v51, v52
  v_max3_f32 v80, v80, v53, v54
  v_min3_f32 v81, v81, v53, v54
  v_max3_f32 v80, v80, v55, v56
  v_min3_f32 v81, v81, v55, v56
  v_max3_f32 v80, v80, v57, v58
  v_min3_f32 v81, v81, v57, v58
  v_max_f32 v80, v80, v59
  v_min_f32 v81, v81, v59
  v_mul_f32 v80, s41, v80
  v_mul_f32 v81, s41, v81
  v_fma_f32 v60, -v40, s41, v81
  v_fma_f32 v40, v40, s41, -v80
  v_fma_f32 v61, -v41, s41, v81
  v_fma_f32 v41, v41, s41, -v80
  v_fma_f32 v62, -v42, s41, v81
  v_fma_f32 v42, v42, s41, -v80
  v_fma_f32 v63, -v43, s41, v81
  v_fma_f32 v43, v43, s41, -v80
  v_fma_f32 v64, -v44, s41, v81
  v_fma_f32 v44, v44, s41, -v80
  v_fma_f32 v65, -v45, s41, v81
  v_fma_f32 v45, v45, s41, -v80
  v_fma_f32 v66, -v46, s41, v81
  v_fma_f32 v46, v46, s41, -v80
  v_fma_f32 v67, -v47, s41, v81
  v_fma_f32 v47, v47, s41, -v80
  v_fma_f32 v68, -v48, s41, v81
  v_fma_f32 v48, v48, s41, -v80
  v_fma_f32 v69, -v49, s41, v81
  v_fma_f32 v49, v49, s41, -v80
  v_fma_f32 v70, -v50, s41, v81
  v_fma_f32 v50, v50, s41, -v80
  v_fma_f32 v71, -v51, s41, v81
  v_fma_f32 v51, v51, s41, -v80
  v_fma_f32 v72, -v52, s41, v81
  v_fma_f32 v52, v52, s41, -v80
  v_fma_f32 v73, -v53, s41, v81
  v_fma_f32 v53, v53, s41, -v80
  v_fma_f32 v74, -v54, s41, v81
  v_fma_f32 v54, v54, s41, -v80
  v_fma_f32 v75, -v55, s41, v81
  v_fma_f32 v55, v55, s41, -v80
  v_fma_f32 v76, -v56, s41, v81
  v_fma_f32 v56, v56, s41, -v80
  v_fma_f32 v77, -v57, s41, v81
  v_fma_f32 v57, v57, s41, -v80
  v_fma_f32 v78, -v58, s41, v81
  v_fma_f32 v58, v58, s41, -v80
  v_fma_f32 v79, -v59, s41, v81
  v_fma_f32 v59, v59, s41, -v80
  v_exp_f32 v40, v40
  v_exp_f32 v41, v41
  v_exp_f32 v42, v42
  v_exp_f32 v43, v43
  v_exp_f32 v44, v44
  v_exp_f32 v45, v45
  v_exp_f32 v46, v46
  v_exp_f32 v47, v47
  v_exp_f32 v48, v48
  v_exp_f32 v49, v49
  v_exp_f32 v50, v50
  v_exp_f32 v51, v51
  v_exp_f32 v52, v52
  v_exp_f32 v53, v53
  v_exp_f32 v54, v54
  v_exp_f32 v55, v55
  v_exp_f32 v56, v56
  v_exp_f32 v57, v57
  v_exp_f32 v58, v58
  v_exp_f32 v59, v59
  v_exp_f32 v60, v60
  v_exp_f32 v61, v61
  v_exp_f32 v62, v62
  v_exp_f32 v63, v63
  v_exp_f32 v64, v64
  v_exp_f32 v65, v65
  v_exp_f32 v66, v66
  v_exp_f32 v67, v67
  v_exp_f32 v68, v68
  v_exp_f32 v69, v69
  v_exp_f32 v70, v70
  v_exp_f32 v71, v71
  v_exp_f32 v72, v72
  v_exp_f32 v73, v73
  v_exp_f32 v74, v74
  v_exp_f32 v75, v75
  v_exp_f32 v76, v76
  v_exp_f32 v77, v77
  v_exp_f32 v78, v78
  v_exp_f32 v79, v79
  v_add_f32 v82, v40, v41
  v_add_f32 v82, v82, v42
  v_add_f32 v82, v82, v43
  v_add_f32 v82, v82, v44
  v_add_f32 v82, v82, v45
  v_add_f32 v82, v82, v46
  v_add_f32 v82, v82, v47
  v_add_f32 v82, v82, v48
  v_add_f32 v82, v82, v49
  v_add_f32 v82, v82, v50
  v_add_f32 v82, v82, v51
  v_add_f32 v82, v82, v52
  v_add_f32 v82, v82, v53
  v_add_f32 v82, v82, v54
  v_add_f32 v82, v82, v55
  v_add_f32 v82, v82, v56
  v_add_f32 v82, v82, v57
  v_add_f32 v82, v82, v58
  v_add_f32 v82, v82, v59
  v_rcp_f32 v82, v82
  v_add_f32 v83, v60, v61
  v_add_f32 v83, v83, v62
  v_add_f32 v83, v83, v63
  v_add_f32 v83, v83, v64
  v_add_f32 v83, v83, v65
  v_add_f32 v83, v83, v66
  v_add_f32 v83, v83, v67
  v_add_f32 v83, v83, v68
  v_add_f32 v83, v83, v69
  v_add_f32 v83, v83, v70
  v_add_f32 v83, v83, v71
  v_add_f32 v83, v83, v72
  v_add_f32 v83, v83, v73
  v_add_f32 v83, v83, v74
  v_add_f32 v83, v83, v75
  v_add_f32 v83, v83, v76
  v_add_f32 v83, v83, v77
  v_add_f32 v83, v83, v78
  v_add_f32 v83, v83, v79
  v_rcp_f32 v83, v83
  v_mul_f32 v40, v40, v82
  v_mul_f32 v41, v41, v82
  v_mul_f32 v42, v42, v82
  v_mul_f32 v43, v43, v82
  v_mul_f32 v44, v44, v82
  v_mul_f32 v45, v45, v82
  v_mul_f32 v46, v46, v82
  v_mul_f32 v47, v47, v82
  v_mul_f32 v48, v48, v82
  v_mul_f32 v49, v49, v82
  v_mul_f32 v50, v50, v82
  v_mul_f32 v51, v51, v82
  v_mul_f32 v52, v52, v82
  v_mul_f32 v53, v53, v82
  v_mul_f32 v54, v54, v82
  v_mul_f32 v55, v55, v82
  v_mul_f32 v56, v56, v82
  v_mul_f32 v57, v57, v82
  v_mul_f32 v58, v58, v82
  v_mul_f32 v59, v59, v82
  v_mul_f32 v60, v60, v83
  v_mul_f32 v61, v61, v83
  v_mul_f32 v62, v62, v83
  v_mul_f32 v63, v63, v83
  v_mul_f32 v64, v64, v83
  v_mul_f32 v65, v65, v83
  v_mul_f32 v66, v66, v83
  v_mul_f32 v67, v67, v83
  v_mul_f32 v68, v68, v83
  v_mul_f32 v69, v69, v83
  v_mul_f32 v70, v70, v83
  v_mul_f32 v71, v71, v83
  v_mul_f32 v72, v72, v83
  v_mul_f32 v73, v73, v83
  v_mul_f32 v74, v74, v83
  v_mul_f32 v75, v75, v83
  v_mul_f32 v76, v76, v83
  v_mul_f32 v77, v77, v83
  v_mul_f32 v78, v78, v83
  v_mul_f32 v79, v79, v83
  v_cvt_pk_bf16_f32 v220, v40, v41
  v_cvt_pk_bf16_f32 v221, v42, v43
  v_cvt_pk_bf16_f32 v222, v44, v45
  v_cvt_pk_bf16_f32 v223, v46, v47
  v_cvt_pk_bf16_f32 v224, v48, v49
  v_cvt_pk_bf16_f32 v225, v50, v51
  v_cvt_pk_bf16_f32 v226, v52, v53
  v_cvt_pk_bf16_f32 v227, v54, v55
  v_cvt_pk_bf16_f32 v228, v56, v57
  v_cvt_pk_bf16_f32 v229, v58, v59
  v_cvt_pk_bf16_f32 v230, v60, v61
  v_cvt_pk_bf16_f32 v231, v62, v63
  v_cvt_pk_bf16_f32 v232, v64, v65
  v_cvt_pk_bf16_f32 v233, v66, v67
  v_cvt_pk_bf16_f32 v234, v68, v69
  v_cvt_pk_bf16_f32 v235, v70, v71
  v_cvt_pk_bf16_f32 v236, v72, v73
  v_cvt_pk_bf16_f32 v237, v74, v75
  v_cvt_pk_bf16_f32 v238, v76, v77
  v_cvt_pk_bf16_f32 v239, v78, v79
  s_add_u32 s54, s34, 49
  s_mov_b32 s51, 0
  s_branch L_wd_59a
L_wd_59:
  s_sleep 8
L_wd_59a:
  v_lshlrev_b32 v2, 2, v0
  buffer_load_dword v2, v2, s[8:11], 0 offen sc1
  s_add_u32 s51, s51, 1
  s_cmp_gt_u32 s51, 131072
  s_cbranch_scc1 L_end
  s_waitcnt vmcnt(0)
  v_readlane_b32 s52, v2, s54
  s_nop 0
  s_cmp_lg_u32 s52, 16
  s_cbranch_scc1 L_wd_59
  s_cmp_eq_u32 s28, 3
  s_cbranch_scc1 L_nored_60
  s_mul_i32 s52, s35, 3
  s_add_u32 s52, s52, s28
  s_mul_i32 s53, s34, 786432
  s_lshl_b32 s54, s52, 10
  s_add_u32 s53, s53, s54
  s_add_u32 s38, s53, 0x5400000
  buffer_load_dwordx4 v[16:19], v1, s[4:7], s38 offen sc1
  s_add_u32 s38, s38, 49152
  buffer_load_dwordx4 v[20:23], v1, s[4:7], s38 offen sc1
  s_add_u32 s38, s38, 49152
  buffer_load_dwordx4 v[24:27], v1, s[4:7], s38 offen sc1
  s_add_u32 s38, s38, 49152
  buffer_load_dwordx4 v[28:31], v1, s[4:7], s38 offen sc1
  s_add_u32 s38, s38, 49152
  buffer_load_dwordx4 v[32:35], v1, s[4:7], s38 offen sc1
  s_add_u32 s38, s38, 49152
  buffer_load_dwordx4 v[36:39], v1, s[4:7], s38 offen sc1
  s_add_u32 s38, s38, 49152
  buffer_load_dwordx4 v[40:43], v1, s[4:7], s38 offen sc1
  s_add_u32 s38, s38, 49152
  buffer_load_dwordx4 v[44:47], v1, s[4:7], s38 offen sc1
  s_add_u32 s38, s38, 49152
  buffer_load_dwordx4 v[48:51], v1, s[4:7], s38 offen sc1
  s_add_u32 s38, s38, 49152
  buffer_load_dwordx4 v[52:55], v1, s[4:7], s38 offen sc1
  s_add_u32 s38, s38, 49152
  buffer_load_dwordx4 v[56:59], v1, s[4:7], s38 offen sc1
  s_add_u32 s38, s38, 49152
  buffer_load_dwordx4 v[60:63], v1, s[4:7], s38 offen sc1
  s_add_u32 s38, s38, 49152
  buffer_load_dwordx4 v[64:67], v1, s[4:7], s38 offen sc1
  s_add_u32 s38, s38, 49152
  buffer_load_dwordx4 v[68:71], v1, s[4:7], s38 offen sc1
  s_add_u32 s38, s38, 49152
  buffer_load_dwordx4 v[72:75], v1, s[4:7], s38 offen sc1
  s_add_u32 s38, s38, 49152
  buffer_load_dwordx4 v[76:79], v1, s[4:7], s38 offen sc1
  s_add_u32 s38, s38, 49152
  s_mul_i32 s53, s52, 43
  s_lshr_b32 s53, s53, 8
  s_mul_i32 s54, s53, 6
  s_sub_u32 s52, s52, s54
  s_lshr_b32 s54, s52, 1
  s_and_b32 s52, s52, 1
  s_and_b32 s55, s53, 3
  s_lshl_b32 s55, s55, 1
  s_add_u32 s55, s55, s52
  s_mul_i32 s55, s55, 5120
  s_lshr_b32 s53, s53, 2
  s_mul_i32 s53, s53, 576
  s_add_u32 s55, s55, s53
  s_mul_i32 s53, s34, 40960
  s_add_u32 s55, s55, s53
  s_add_u32 s55, s55, 0x5800000
  s_lshl_b32 s54, s54, 1
  v_lshrrev_b32 v8, 1, v7
  v_add_u32 v8, s54, v8
  v_cmp_gt_u32 vcc, 5, v8
  v_lshlrev_b32 v8, 10, v8
  v_bfe_u32 v11, v0, 2, 2
  v_lshl_add_u32 v8, v11, 7, v8
  v_and_b32 v11, 3, v0
  v_lshl_add_u32 v8, v11, 4, v8
  v_and_b32 v11, 1, v7
  v_lshl_add_u32 v8, v11, 3, v8
  v_mov_b32 v11, 0x80000000
  v_cndmask_b32 v8, v11, v8, vcc
  s_waitcnt vmcnt(14)
  v_add_f32 v16, v16, v20
  v_add_f32 v17, v17, v21
  v_add_f32 v18, v18, v22
  v_add_f32 v19, v19, v23
  s_waitcnt vmcnt(13)
  v_add_f32 v16, v16, v24
  v_add_f32 v17, v17, v25
  v_add_f32 v18, v18, v26
  v_add_f32 v19, v19, v27
  s_waitcnt vmcnt(12)
  v_add_f32 v16, v16, v28
  v_add_f32 v17, v17, v29
  v_add_f32 v18, v18, v30
  v_add_f32 v19, v19, v31
  s_waitcnt vmcnt(11)
  v_add_f32 v16, v16, v32
  v_add_f32 v17, v17, v33
  v_add_f32 v18, v18, v34
  v_add_f32 v19, v19, v35
  s_waitcnt vmcnt(10)
  v_add_f32 v16, v16, v36
  v_add_f32 v17, v17, v37
  v_add_f32 v18, v18, v38
  v_add_f32 v19, v19, v39
  s_waitcnt vmcnt(9)
  v_add_f32 v16, v16, v40
  v_add_f32 v17, v17, v41
  v_add_f32 v18, v18, v42
  v_add_f32 v19, v19, v43
  s_waitcnt vmcnt(8)
  v_add_f32 v16, v16, v44
  v_add_f32 v17, v17, v45
  v_add_f32 v18, v18, v46
  v_add_f32 v19, v19, v47
  s_waitcnt vmcnt(7)
  v_add_f32 v16, v16, v48
  v_add_f32 v17, v17, v49
  v_add_f32 v18, v18, v50
  v_add_f32 v19, v19, v51
  s_waitcnt vmcnt(6)
  v_add_f32 v16, v16, v52
  v_add_f32 v17, v17, v53
  v_add_f32 v18, v18, v54
  v_add_f32 v19, v19, v55
  s_waitcnt vmcnt(5)
  v_add_f32 v16, v16, v56
  v_add_f32 v17, v17, v57
  v_add_f32 v18, v18, v58
  v_add_f32 v19, v19, v59
  s_waitcnt vmcnt(4)
  v_add_f32 v16, v16, v60
  v_add_f32 v17, v17, v61
  v_add_f32 v18, v18, v62
  v_add_f32 v19, v19, v63
  s_waitcnt vmcnt(3)
  v_add_f32 v16, v16, v64
  v_add_f32 v17, v17, v65
  v_add_f32 v18, v18, v66
  v_add_f32 v19, v19, v67
  s_waitcnt vmcnt(2)
  v_add_f32 v16, v16, v68
  v_add_f32 v17, v17, v69
  v_add_f32 v18, v18, v70
  v_add_f32 v19, v19, v71
  s_waitcnt vmcnt(1)
  v_add_f32 v16, v16, v72
  v_add_f32 v17, v17, v73
  v_add_f32 v18, v18, v74
  v_add_f32 v19, v19, v75
  s_waitcnt vmcnt(0)
  v_add_f32 v16, v16, v76
  v_add_f32 v17, v17, v77
  v_add_f32 v18, v18, v78
  v_add_f32 v19, v19, v79
  v_cvt_pk_bf16_f32 v16, v16, v17
  v_cvt_pk_bf16_f32 v17, v18, v19
  buffer_store_dwordx2 v[16:17], v8, s[4:7], s55 offen sc1
L_nored_60:
  s_lshl_b32 s53, s34, 2
  s_add_u32 s53, s53, 212
  s_waitcnt vmcnt(0)
  s_barrier
  s_cmp_lg_u32 s28, 0
  s_cbranch_scc1 L_sig_61
  s_mov_b64 exec, 1
  v_mov_b32 v2, 1
  buffer_atomic_add v2, off, s[8:11], s53 sc1
  s_mov_b64 exec, -1
L_sig_61:
  v_bfe_u32 v8, v0, 2, 1
  v_cmp_eq_u32 vcc, v8, v5
  v_mov_b32 v11, 0x80000000
  s_nop 0
  v_cndmask_b32 v8, v11, v1, vcc
  s_mul_i32 s38, s34, 40960
  s_add_u32 s38, s38, 0x5800000
  s_mov_b32 s39, 0x358637bd
  s_add_u32 s54, s34, 53
  s_mov_b32 s51, 0
  s_branch L_wd_62a
L_wd_62:
  s_sleep 8
L_wd_62a:
  v_lshlrev_b32 v2, 2, v0
  buffer_load_dword v2, v2, s[8:11], 0 offen sc1
  s_add_u32 s51, s51, 1
  s_cmp_gt_u32 s51, 131072
  s_cbranch_scc1 L_end
  s_waitcnt vmcnt(0)
  v_readlane_b32 s52, v2, s54
  s_nop 0
  s_cmp_lg_u32 s52, 16
  s_cbranch_scc1 L_wd_62
  buffer_load_dwordx4 v[16:19], v8, s[4:7], s38 offen sc1
  s_add_u32 s38, s38, 1024
  buffer_load_dwordx4 v[20:23], v8, s[4:7], s38 offen sc1
  s_add_u32 s38, s38, 1024
  buffer_load_dwordx4 v[24:27], v8, s[4:7], s38 offen sc1
  s_add_u32 s38, s38, 1024
  buffer_load_dwordx4 v[28:31], v8, s[4:7], s38 offen sc1
  s_add_u32 s38, s38, 1024
  buffer_load_dwordx4 v[32:35], v8, s[4:7], s38 offen sc1
  s_add_u32 s38, s38, 1024
  buffer_load_dwordx4 v[36:39], v8, s[4:7], s38 offen sc1
  s_add_u32 s38, s38, 1024
  buffer_load_dwordx4 v[40:43], v8, s[4:7], s38 offen sc1
  s_add_u32 s38, s38, 1024
  buffer_load_dwordx4 v[44:47], v8, s[4:7], s38 offen sc1
  s_add_u32 s38, s38, 1024
  buffer_load_dwordx4 v[48:51], v8, s[4:7], s38 offen sc1
  s_add_u32 s38, s38, 1024
  buffer_load_dwordx4 v[52:55], v8, s[4:7], s38 offen sc1
  s_add_u32 s38, s38, 1024
  s_waitcnt vmcnt(9)
  v_mfma_f32_32x32x16_bf16 v[64:79], v[16:19], v[160:163], 0
  s_waitcnt vmcnt(8)
  v_mfma_f32_32x32x16_bf16 v[64:79], v[20:23], v[164:167], v[64:79]
  s_waitcnt vmcnt(7)
  v_mfma_f32_32x32x16_bf16 v[64:79], v[24:27], v[168:171], v[64:79]
  s_waitcnt vmcnt(6)
  v_mfma_f32_32x32x16_bf16 v[64:79], v[28:31], v[172:175], v[64:79]
  s_waitcnt vmcnt(5)
  v_mfma_f32_32x32x16_bf16 v[64:79], v[32:35], v[176:179], v[64:79]
  s_waitcnt vmcnt(4)
  v_mfma_f32_32x32x16_bf16 v[80:95], v[36:39], v[160:163], 0
  s_waitcnt vmcnt(3)
  v_mfma_f32_32x32x16_bf16 v[80:95], v[40:43], v[164:167], v[80:95]
  s_waitcnt vmcnt(2)
  v_mfma_f32_32x32x16_bf16 v[80:95], v[44:47], v[168:171], v[80:95]
  s_waitcnt vmcnt(1)
  v_mfma_f32_32x32x16_bf16 v[80:95], v[48:51], v[172:175], v[80:95]
  s_waitcnt vmcnt(0)
  v_mfma_f32_32x32x16_bf16 v[80:95], v[52:55], v[176:179], v[80:95]
  s_nop 11
  v_add_f32 v84, s39, v84
  v_rcp_f32 v84, v84
  s_nop 0
  v_mul_f32 v64, v64, v84
  v_mul_f32 v65, v65, v84
  v_mul_f32 v66, v66, v84
  v_mul_f32 v67, v67, v84
  v_mul_f32 v68, v68, v84
  v_mul_f32 v69, v69, v84
  v_mul_f32 v70, v70, v84
  v_mul_f32 v71, v71, v84
  v_mul_f32 v72, v72, v84
  v_mul_f32 v73, v73, v84
  v_mul_f32 v74, v74, v84
  v_mul_f32 v75, v75, v84
  v_mul_f32 v76, v76, v84
  v_mul_f32 v77, v77, v84
  v_mul_f32 v78, v78, v84
  v_mul_f32 v79, v79, v84
  v_mul_f32 v80, v80, v84
  v_mul_f32 v81, v81, v84
  v_mul_f32 v82, v82, v84
  v_mul_f32 v83, v83, v84
  v_cvt_pk_bf16_f32 v100, v64, v65
  v_cvt_pk_bf16_f32 v101, v66, v67
  v_cvt_pk_bf16_f32 v102, v68, v69
  v_cvt_pk_bf16_f32 v103, v70, v71
  v_cvt_pk_bf16_f32 v104, v72, v73
  v_cvt_pk_bf16_f32 v105, v74, v75
  v_cvt_pk_bf16_f32 v106, v76, v77
  v_cvt_pk_bf16_f32 v107, v78, v79
  v_cvt_pk_bf16_f32 v108, v80, v81
  v_cvt_pk_bf16_f32 v109, v82, v83
  buffer_load_dwordx4 v[16:19], v8, s[4:7], s38 offen sc1
  s_add_u32 s38, s38, 1024
  buffer_load_dwordx4 v[20:23], v8, s[4:7], s38 offen sc1
  s_add_u32 s38, s38, 1024
  buffer_load_dwordx4 v[24:27], v8, s[4:7], s38 offen sc1
  s_add_u32 s38, s38, 1024
  buffer_load_dwordx4 v[28:31], v8, s[4:7], s38 offen sc1
  s_add_u32 s38, s38, 1024
  buffer_load_dwordx4 v[32:35], v8, s[4:7], s38 offen sc1
  s_add_u32 s38, s38, 1024
  buffer_load_dwordx4 v[36:39], v8, s[4:7], s38 offen sc1
  s_add_u32 s38, s38, 1024
  buffer_load_dwordx4 v[40:43], v8, s[4:7], s38 offen sc1
  s_add_u32 s38, s38, 1024
  buffer_load_dwordx4 v[44:47], v8, s[4:7], s38 offen sc1
  s_add_u32 s38, s38, 1024
  buffer_load_dwordx4 v[48:51], v8, s[4:7], s38 offen sc1
  s_add_u32 s38, s38, 1024
  buffer_load_dwordx4 v[52:55], v8, s[4:7], s38 offen sc1
  s_add_u32 s38, s38, 1024
  s_waitcnt vmcnt(9)
  v_mfma_f32_32x32x16_bf16 v[64:79], v[16:19], v[180:183], 0
  s_waitcnt vmcnt(8)
  v_mfma_f32_32x32x16_bf16 v[64:79], v[20:23], v[184:187], v[64:79]
  s_waitcnt vmcnt(7)
  v_mfma_f32_32x32x16_bf16 v[64:79], v[24:27], v[188:191], v[64:79]
  s_waitcnt vmcnt(6)
  v_mfma_f32_32x32x16_bf16 v[64:79], v[28:31], v[192:195], v[64:79]
  s_waitcnt vmcnt(5)
  v_mfma_f32_32x32x16_bf16 v[64:79], v[32:35], v[196:199], v[64:79]
  s_waitcnt vmcnt(4)
  v_mfma_f32_32x32x16_bf16 v[80:95], v[36:39], v[180:183], 0
  s_waitcnt vmcnt(3)
  v_mfma_f32_32x32x16_bf16 v[80:95], v[40:43], v[184:187], v[80:95]
  s_waitcnt vmcnt(2)
  v_mfma_f32_32x32x16_bf16 v[80:95], v[44:47], v[188:191], v[80:95]
  s_waitcnt vmcnt(1)
  v_mfma_f32_32x32x16_bf16 v[80:95], v[48:51], v[192:195], v[80:95]
  s_waitcnt vmcnt(0)
  v_mfma_f32_32x32x16_bf16 v[80:95], v[52:55], v[196:199], v[80:95]
  s_nop 11
  v_add_f32 v84, s39, v84
  v_rcp_f32 v84, v84
  s_nop 0
  v_mul_f32 v64, v64, v84
  v_mul_f32 v65, v65, v84
  v_mul_f32 v66, v66, v84
  v_mul_f32 v67, v67, v84
  v_mul_f32 v68, v68, v84
  v_mul_f32 v69, v69, v84
  v_mul_f32 v70, v70, v84
  v_mul_f32 v71, v71, v84
  v_mul_f32 v72, v72, v84
  v_mul_f32 v73, v73, v84
  v_mul_f32 v74, v74, v84
  v_mul_f32 v75, v75, v84
  v_mul_f32 v76, v76, v84
  v_mul_f32 v77, v77, v84
  v_mul_f32 v78, v78, v84
  v_mul_f32 v79, v79, v84
  v_mul_f32 v80, v80, v84
  v_mul_f32 v81, v81, v84
  v_mul_f32 v82, v82, v84
  v_mul_f32 v83, v83, v84
  v_cvt_pk_bf16_f32 v110, v64, v65
  v_cvt_pk_bf16_f32 v111, v66, v67
  v_cvt_pk_bf16_f32 v112, v68, v69
  v_cvt_pk_bf16_f32 v113, v70, v71
  v_cvt_pk_bf16_f32 v114, v72, v73
  v_cvt_pk_bf16_f32 v115, v74, v75
  v_cvt_pk_bf16_f32 v116, v76, v77
  v_cvt_pk_bf16_f32 v117, v78, v79
  v_cvt_pk_bf16_f32 v118, v80, v81
  v_cvt_pk_bf16_f32 v119, v82, v83
  buffer_load_dwordx4 v[16:19], v8, s[4:7], s38 offen sc1
  s_add_u32 s38, s38, 1024
  buffer_load_dwordx4 v[20:23], v8, s[4:7], s38 offen sc1
  s_add_u32 s38, s38, 1024
  buffer_load_dwordx4 v[24:27], v8, s[4:7], s38 offen sc1
  s_add_u32 s38, s38, 1024
  buffer_load_dwordx4 v[28:31], v8, s[4:7], s38 offen sc1
  s_add_u32 s38, s38, 1024
  buffer_load_dwordx4 v[32:35], v8, s[4:7], s38 offen sc1
  s_add_u32 s38, s38, 1024
  buffer_load_dwordx4 v[36:39], v8, s[4:7], s38 offen sc1
  s_add_u32 s38, s38, 1024
  buffer_load_dwordx4 v[40:43], v8, s[4:7], s38 offen sc1
  s_add_u32 s38, s38, 1024
  buffer_load_dwordx4 v[44:47], v8, s[4:7], s38 offen sc1
  s_add_u32 s38, s38, 1024
  buffer_load_dwordx4 v[48:51], v8, s[4:7], s38 offen sc1
  s_add_u32 s38, s38, 1024
  buffer_load_dwordx4 v[52:55], v8, s[4:7], s38 offen sc1
  s_add_u32 s38, s38, 1024
  s_waitcnt vmcnt(9)
  v_mfma_f32_32x32x16_bf16 v[64:79], v[16:19], v[200:203], 0
  s_waitcnt vmcnt(8)
  v_mfma_f32_32x32x16_bf16 v[64:79], v[20:23], v[204:207], v[64:79]
  s_waitcnt vmcnt(7)
  v_mfma_f32_32x32x16_bf16 v[64:79], v[24:27], v[208:211], v[64:79]
  s_waitcnt vmcnt(6)
  v_mfma_f32_32x32x16_bf16 v[64:79], v[28:31], v[212:215], v[64:79]
  s_waitcnt vmcnt(5)
  v_mfma_f32_32x32x16_bf16 v[64:79], v[32:35], v[216:219], v[64:79]
  s_waitcnt vmcnt(4)
  v_mfma_f32_32x32x16_bf16 v[80:95], v[36:39], v[200:203], 0
  s_waitcnt vmcnt(3)
  v_mfma_f32_32x32x16_bf16 v[80:95], v[40:43], v[204:207], v[80:95]
  s_waitcnt vmcnt(2)
  v_mfma_f32_32x32x16_bf16 v[80:95], v[44:47], v[208:211], v[80:95]
  s_waitcnt vmcnt(1)
  v_mfma_f32_32x32x16_bf16 v[80:95], v[48:51], v[212:215], v[80:95]
  s_waitcnt vmcnt(0)
  v_mfma_f32_32x32x16_bf16 v[80:95], v[52:55], v[216:219], v[80:95]
  s_nop 11
  v_add_f32 v84, s39, v84
  v_rcp_f32 v84, v84
  s_nop 0
  v_mul_f32 v64, v64, v84
  v_mul_f32 v65, v65, v84
  v_mul_f32 v66, v66, v84
  v_mul_f32 v67, v67, v84
  v_mul_f32 v68, v68, v84
  v_mul_f32 v69, v69, v84
  v_mul_f32 v70, v70, v84
  v_mul_f32 v71, v71, v84
  v_mul_f32 v72, v72, v84
  v_mul_f32 v73, v73, v84
  v_mul_f32 v74, v74, v84
  v_mul_f32 v75, v75, v84
  v_mul_f32 v76, v76, v84
  v_mul_f32 v77, v77, v84
  v_mul_f32 v78, v78, v84
  v_mul_f32 v79, v79, v84
  v_mul_f32 v80, v80, v84
  v_mul_f32 v81, v81, v84
  v_mul_f32 v82, v82, v84
  v_mul_f32 v83, v83, v84
  v_cvt_pk_bf16_f32 v120, v64, v65
  v_cvt_pk_bf16_f32 v121, v66, v67
  v_cvt_pk_bf16_f32 v122, v68, v69
  v_cvt_pk_bf16_f32 v123, v70, v71
  v_cvt_pk_bf16_f32 v124, v72, v73
  v_cvt_pk_bf16_f32 v125, v74, v75
  v_cvt_pk_bf16_f32 v126, v76, v77
  v_cvt_pk_bf16_f32 v127, v78, v79
  v_cvt_pk_bf16_f32 v128, v80, v81
  v_cvt_pk_bf16_f32 v129, v82, v83
  buffer_load_dwordx4 v[16:19], v8, s[4:7], s38 offen sc1
  s_add_u32 s38, s38, 1024
  buffer_load_dwordx4 v[20:23], v8, s[4:7], s38 offen sc1
  s_add_u32 s38, s38, 1024
  buffer_load_dwordx4 v[24:27], v8, s[4:7], s38 offen sc1
  s_add_u32 s38, s38, 1024
  buffer_load_dwordx4 v[28:31], v8, s[4:7], s38 offen sc1
  s_add_u32 s38, s38, 1024
  buffer_load_dwordx4 v[32:35], v8, s[4:7], s38 offen sc1
  s_add_u32 s38, s38, 1024
  buffer_load_dwordx4 v[36:39], v8, s[4:7], s38 offen sc1
  s_add_u32 s38, s38, 1024
  buffer_load_dwordx4 v[40:43], v8, s[4:7], s38 offen sc1
  s_add_u32 s38, s38, 1024
  buffer_load_dwordx4 v[44:47], v8, s[4:7], s38 offen sc1
  s_add_u32 s38, s38, 1024
  buffer_load_dwordx4 v[48:51], v8, s[4:7], s38 offen sc1
  s_add_u32 s38, s38, 1024
  buffer_load_dwordx4 v[52:55], v8, s[4:7], s38 offen sc1
  s_add_u32 s38, s38, 1024
  s_waitcnt vmcnt(9)
  v_mfma_f32_32x32x16_bf16 v[64:79], v[16:19], v[220:223], 0
  s_waitcnt vmcnt(8)
  v_mfma_f32_32x32x16_bf16 v[64:79], v[20:23], v[224:227], v[64:79]
  s_waitcnt vmcnt(7)
  v_mfma_f32_32x32x16_bf16 v[64:79], v[24:27], v[228:231], v[64:79]
  s_waitcnt vmcnt(6)
  v_mfma_f32_32x32x16_bf16 v[64:79], v[28:31], v[232:235], v[64:79]
  s_waitcnt vmcnt(5)
  v_mfma_f32_32x32x16_bf16 v[64:79], v[32:35], v[236:239], v[64:79]
  s_waitcnt vmcnt(4)
  v_mfma_f32_32x32x16_bf16 v[80:95], v[36:39], v[220:223], 0
  s_waitcnt vmcnt(3)
  v_mfma_f32_32x32x16_bf16 v[80:95], v[40:43], v[224:227], v[80:95]
  s_waitcnt vmcnt(2)
  v_mfma_f32_32x32x16_bf16 v[80:95], v[44:47], v[228:231], v[80:95]
  s_waitcnt vmcnt(1)
  v_mfma_f32_32x32x16_bf16 v[80:95], v[48:51], v[232:235], v[80:95]
  s_waitcnt vmcnt(0)
  v_mfma_f32_32x32x16_bf16 v[80:95], v[52:55], v[236:239], v[80:95]
  s_nop 11
  v_add_f32 v84, s39, v84
  v_rcp_f32 v84, v84
  s_nop 0
  v_mul_f32 v64, v64, v84
  v_mul_f32 v65, v65, v84
  v_mul_f32 v66, v66, v84
  v_mul_f32 v67, v67, v84
  v_mul_f32 v68, v68, v84
  v_mul_f32 v69, v69, v84
  v_mul_f32 v70, v70, v84
  v_mul_f32 v71, v71, v84
  v_mul_f32 v72, v72, v84
  v_mul_f32 v73, v73, v84
  v_mul_f32 v74, v74, v84
  v_mul_f32 v75, v75, v84
  v_mul_f32 v76, v76, v84
  v_mul_f32 v77, v77, v84
  v_mul_f32 v78, v78, v84
  v_mul_f32 v79, v79, v84
  v_mul_f32 v80, v80, v84
  v_mul_f32 v81, v81, v84
  v_mul_f32 v82, v82, v84
  v_mul_f32 v83, v83, v84
  v_cvt_pk_bf16_f32 v130, v64, v65
  v_cvt_pk_bf16_f32 v131, v66, v67
  v_cvt_pk_bf16_f32 v132, v68, v69
  v_cvt_pk_bf16_f32 v133, v70, v71
  v_cvt_pk_bf16_f32 v134, v72, v73
  v_cvt_pk_bf16_f32 v135, v74, v75
  v_cvt_pk_bf16_f32 v136, v76, v77
  v_cvt_pk_bf16_f32 v137, v78, v79
  v_cvt_pk_bf16_f32 v138, v80, v81
  v_cvt_pk_bf16_f32 v139, v82, v83
  s_lshl_b32 s52, s35, 2
  s_add_u32 s52, s52, s28
  s_mul_i32 s52, s52, 40960
  s_add_u32 s36, s52, 0x5900000
  s_mul_i32 s53, s34, 10240
  s_add_u32 s38, s36, s53
  buffer_store_dwordx4 v[100:103], v1, s[4:7], s38 offen sc1
  s_add_u32 s38, s38, 1024
  buffer_store_dwordx4 v[104:107], v1, s[4:7], s38 offen sc1
  s_add_u32 s38, s38, 1024
  buffer_store_dwordx4 v[108:111], v1, s[4:7], s38 offen sc1
  s_add_u32 s38, s38, 1024
  buffer_store_dwordx4 v[112:115], v1, s[4:7], s38 offen sc1
  s_add_u32 s38, s38, 1024
  buffer_store_dwordx4 v[116:119], v1, s[4:7], s38 offen sc1
  s_add_u32 s38, s38, 1024
  buffer_store_dwordx4 v[120:123], v1, s[4:7], s38 offen sc1
  s_add_u32 s38, s38, 1024
  buffer_store_dwordx4 v[124:127], v1, s[4:7], s38 offen sc1
  s_add_u32 s38, s38, 1024
  buffer_store_dwordx4 v[128:131], v1, s[4:7], s38 offen sc1
  s_add_u32 s38, s38, 1024
  buffer_store_dwordx4 v[132:135], v1, s[4:7], s38 offen sc1
  s_add_u32 s38, s38, 1024
  buffer_store_dwordx4 v[136:139], v1, s[4:7], s38 offen sc1
  s_add_u32 s38, s38, 1024
  s_and_b32 s37, s35, 3
  s_lshl_b32 s37, s37, 3
  s_lshr_b32 s54, s35, 2
  s_add_u32 s54, s54, 57
  s_lshl_b32 s53, s54, 2
  s_lshl_b32 s52, 1, s37
  s_waitcnt vmcnt(0)
  s_barrier
  s_cmp_lg_u32 s28, 0
  s_cbranch_scc1 L_sig3_63
  s_mov_b64 exec, 1
  v_mov_b32 v2, s52
  buffer_atomic_add v2, off, s[8:11], s53 sc1
  s_mov_b64 exec, -1
L_sig3_63:
  s_mov_b32 s51, 0
L_w3_64:
  s_sleep 4
  buffer_load_dword v2, off, s[8:11], s53 sc1
  s_add_u32 s51, s51, 1
  s_cmp_gt_u32 s51, 131072
  s_cbranch_scc1 L_end
  s_waitcnt vmcnt(0)
  v_bfe_u32 v2, v2, s37, 8
  v_cmp_ne_u32 vcc, 4, v2
  s_nop 0
  s_cbranch_vccnz L_w3_64
  s_mul_i32 s52, s34, 204800
  s_add_u32 s44, s52, 0x5300000
  s_mul_i32 s48, s28, 3072
  v_add_u32 v3, s48, v1
  v_mov_b32 v8, v1
  s_mov_b32 s47, 0
  s_mov_b32 s40, 0
  buffer_load_dwordx4 v[16:19], v1, s[4:7], s36 offen sc1
  s_add_u32 s36, s36, 1024
  buffer_load_dwordx4 v[20:23], v1, s[4:7], s36 offen sc1
  s_add_u32 s36, s36, 1024
  s_add_u32 m0, s48, s47
  s_add_u32 s53, s44, 0
  buffer_load_dwordx4 v3, s[4:7], s53 offen offset:0 sc1 lds
  buffer_load_dwordx4 v3, s[4:7], s53 offen offset:1024 sc1 lds
  buffer_load_dwordx4 v3, s[4:7], s53 offen offset:2048 sc1 lds
  s_add_u32 s44, s44, 10240
  s_add_u32 s47, s47, 0x8000
  s_and_b32 s47, s47, 0x1ffff
  buffer_load_dwordx4 v[24:27], v1, s[4:7], s36 offen sc1
  s_add_u32 s36, s36, 1024
  buffer_load_dwordx4 v[28:31], v1, s[4:7], s36 offen sc1
  s_add_u32 s36, s36, 1024
  s_add_u32 m0, s48, s47
  s_add_u32 s53, s44, 0
  buffer_load_dwordx4 v3, s[4:7], s53 offen offset:0 sc1 lds
  buffer_load_dwordx4 v3, s[4:7], s53 offen offset:1024 sc1 lds
  buffer_load_dwordx4 v3, s[4:7], s53 offen offset:2048 sc1 lds
  s_add_u32 s44, s44, 10240
  s_add_u32 s47, s47, 0x8000
  s_and_b32 s47, s47, 0x1ffff
  buffer_load_dwordx4 v[32:35], v1, s[4:7], s36 offen sc1
  s_add_u32 s36, s36, 1024
  buffer_load_dwordx4 v[36:39], v1, s[4:7], s36 offen sc1
  s_add_u32 s36, s36, 1024
  s_add_u32 m0, s48, s47
  s_add_u32 s53, s44, 0
  buffer_load_dwordx4 v3, s[4:7], s53 offen offset:0 sc1 lds
  buffer_load_dwordx4 v3, s[4:7], s53 offen offset:1024 sc1 lds
  buffer_load_dwordx4 v3, s[4:7], s53 offen offset:2048 sc1 lds
  s_add_u32 s44, s44, 10240
  s_add_u32 s47, s47, 0x8000
  s_and_b32 s47, s47, 0x1ffff
  v_accvgpr_write_b32 a0, 0
  v_accvgpr_write_b32 a1, 0
  v_accvgpr_write_b32 a2, 0
  v_accvgpr_write_b32 a3, 0
  v_accvgpr_write_b32 a4, 0
  v_accvgpr_write_b32 a5, 0
  v_accvgpr_write_b32 a6, 0
  v_accvgpr_write_b32 a7, 0
  v_accvgpr_write_b32 a8, 0
  v_accvgpr_write_b32 a9, 0
  v_accvgpr_write_b32 a10, 0
  v_accvgpr_write_b32 a11, 0
  v_accvgpr_write_b32 a12, 0
  v_accvgpr_write_b32 a13, 0
  v_accvgpr_write_b32 a14, 0
  v_accvgpr_write_b32 a15, 0
  v_accvgpr_write_b32 a16, 0
  v_accvgpr_write_b32 a17, 0
  v_accvgpr_write_b32 a18, 0
  v_accvgpr_write_b32 a19, 0
  v_accvgpr_write_b32 a20, 0
  v_accvgpr_write_b32 a21, 0
  v_accvgpr_write_b32 a22, 0
  v_accvgpr_write_b32 a23, 0
  v_accvgpr_write_b32 a24, 0
  v_accvgpr_write_b32 a25, 0
  v_accvgpr_write_b32 a26, 0
  v_accvgpr_write_b32 a27, 0
  v_accvgpr_write_b32 a28, 0
  v_accvgpr_write_b32 a29, 0
  v_accvgpr_write_b32 a30, 0
  v_accvgpr_write_b32 a31, 0
  v_accvgpr_write_b32 a32, 0
  v_accvgpr_write_b32 a33, 0
  v_accvgpr_write_b32 a34, 0
  v_accvgpr_write_b32 a35, 0
  v_accvgpr_write_b32 a36, 0
  v_accvgpr_write_b32 a37, 0
  v_accvgpr_write_b32 a38, 0
  v_accvgpr_write_b32 a39, 0
  v_accvgpr_write_b32 a40, 0
  v_accvgpr_write_b32 a41, 0
  v_accvgpr_write_b32 a42, 0
  v_accvgpr_write_b32 a43, 0
  v_accvgpr_write_b32 a44, 0
  v_accvgpr_write_b32 a45, 0
  v_accvgpr_write_b32 a46, 0
  v_accvgpr_write_b32 a47, 0
  v_accvgpr_write_b32 a48, 0
  v_accvgpr_write_b32 a49, 0
  v_accvgpr_write_b32 a50, 0
  v_accvgpr_write_b32 a51, 0
  v_accvgpr_write_b32 a52, 0
  v_accvgpr_write_b32 a53, 0
  v_accvgpr_write_b32 a54, 0
  v_accvgpr_write_b32 a55, 0
  v_accvgpr_write_b32 a56, 0
  v_accvgpr_write_b32 a57, 0
  v_accvgpr_write_b32 a58, 0
  v_accvgpr_write_b32 a59, 0
  v_accvgpr_write_b32 a60, 0
  v_accvgpr_write_b32 a61, 0
  v_accvgpr_write_b32 a62, 0
  v_accvgpr_write_b32 a63, 0
  v_accvgpr_write_b32 a64, 0
  v_accvgpr_write_b32 a65, 0
  v_accvgpr_write_b32 a66, 0
  v_accvgpr_write_b32 a67, 0
  v_accvgpr_write_b32 a68, 0
  v_accvgpr_write_b32 a69, 0
  v_accvgpr_write_b32 a70, 0
  v_accvgpr_write_b32 a71, 0
  v_accvgpr_write_b32 a72, 0
  v_accvgpr_write_b32 a73, 0
  v_accvgpr_write_b32 a74, 0
  v_accvgpr_write_b32 a75, 0
  v_accvgpr_write_b32 a76, 0
  v_accvgpr_write_b32 a77, 0
  v_accvgpr_write_b32 a78, 0
  v_accvgpr_write_b32 a79, 0
  s_waitcnt vmcnt(10)
  s_barrier
  ds_read_b128 v[48:51], v8 offset:0
  ds_read_b128 v[52:55], v8 offset:1024
  ds_read_b128 v[56:59], v8 offset:2048
  ds_read_b128 v[60:63], v8 offset:3072
  ds_read_b128 v[64:67], v8 offset:4096
L_ag_65:
  s_waitcnt lgkmcnt(0)
  v_mfma_f32_32x32x16_bf16 a[0:15], v[48:51], v[16:19], a[0:15]
  ds_read_b128 v[68:71], v8 offset:5120
  buffer_load_dwordx4 v[40:43], v1, s[4:7], s36 offen sc1
  s_add_u32 s36, s36, 1024
  buffer_load_dwordx4 v[44:47], v1, s[4:7], s36 offen sc1
  s_add_u32 s36, s36, 1024
  v_mfma_f32_32x32x16_bf16 a[16:31], v[52:55], v[16:19], a[16:31]
  ds_read_b128 v[72:75], v8 offset:6144
  s_add_u32 m0, s48, s47
  s_add_u32 s53, s44, 0
  buffer_load_dwordx4 v3, s[4:7], s53 offen offset:0 sc1 lds
  v_mfma_f32_32x32x16_bf16 a[32:47], v[56:59], v[16:19], a[32:47]
  ds_read_b128 v[76:79], v8 offset:7168
  buffer_load_dwordx4 v3, s[4:7], s53 offen offset:1024 sc1 lds
  v_mfma_f32_32x32x16_bf16 a[48:63], v[60:63], v[16:19], a[48:63]
  ds_read_b128 v[80:83], v8 offset:8192
  buffer_load_dwordx4 v3, s[4:7], s53 offen offset:2048 sc1 lds
  v_mfma_f32_32x32x16_bf16 a[64:79], v[64:67], v[16:19], a[64:79]
  ds_read_b128 v[84:87], v8 offset:9216
  s_add_u32 s44, s44, 10240
  s_add_u32 s47, s47, 0x8000
  s_and_b32 s47, s47, 0x1ffff
  s_waitcnt lgkmcnt(0)
  v_mfma_f32_32x32x16_bf16 a[0:15], v[68:71], v[20:23], a[0:15]
  v_add_u32 v8, 0x8000, v8
  v_and_b32 v8, 0x1ffff, v8
  s_waitcnt vmcnt(10)
  s_barrier
  ds_read_b128 v[48:51], v8 offset:0
  v_mfma_f32_32x32x16_bf16 a[16:31], v[72:75], v[20:23], a[16:31]
  ds_read_b128 v[52:55], v8 offset:1024
  v_mfma_f32_32x32x16_bf16 a[32:47], v[76:79], v[20:23], a[32:47]
  ds_read_b128 v[56:59], v8 offset:2048
  v_mfma_f32_32x32x16_bf16 a[48:63], v[80:83], v[20:23], a[48:63]
  ds_read_b128 v[60:63], v8 offset:3072
  v_mfma_f32_32x32x16_bf16 a[64:79], v[84:87], v[20:23], a[64:79]
  ds_read_b128 v[64:67], v8 offset:4096
  s_waitcnt lgkmcnt(0)
  v_mfma_f32_32x32x16_bf16 a[0:15], v[48:51], v[24:27], a[0:15]
  ds_read_b128 v[68:71], v8 offset:5120
  buffer_load_dwordx4 v[16:19], v1, s[4:7], s36 offen sc1
  s_add_u32 s36, s36, 1024
  buffer_load_dwordx4 v[20:23], v1, s[4:7], s36 offen sc1
  s_add_u32 s36, s36, 1024
  v_mfma_f32_32x32x16_bf16 a[16:31], v[52:55], v[24:27], a[16:31]
  ds_read_b128 v[72:75], v8 offset:6144
  s_add_u32 m0, s48, s47
  s_add_u32 s53, s44, 0
  buffer_load_dwordx4 v3, s[4:7], s53 offen offset:0 sc1 lds
  v_mfma_f32_32x32x16_bf16 a[32:47], v[56:59], v[24:27], a[32:47]
  ds_read_b128 v[76:79], v8 offset:7168
  buffer_load_dwordx4 v3, s[4:7], s53 offen offset:1024 sc1 lds
  v_mfma_f32_32x32x16_bf16 a[48:63], v[60:63], v[24:27], a[48:63]
  ds_read_b128 v[80:83], v8 offset:8192
  buffer_load_dwordx4 v3, s[4:7], s53 offen offset:2048 sc1 lds
  v_mfma_f32_32x32x16_bf16 a[64:79], v[64:67], v[24:27], a[64:79]
  ds_read_b128 v[84:87], v8 offset:9216
  s_add_u32 s44, s44, 10240
  s_add_u32 s47, s47, 0x8000
  s_and_b32 s47, s47, 0x1ffff
  s_waitcnt lgkmcnt(0)
  v_mfma_f32_32x32x16_bf16 a[0:15], v[68:71], v[28:31], a[0:15]
  v_add_u32 v8, 0x8000, v8
  v_and_b32 v8, 0x1ffff, v8
  s_waitcnt vmcnt(10)
  s_barrier
  ds_read_b128 v[48:51], v8 offset:0
  v_mfma_f32_32x32x16_bf16 a[16:31], v[72:75], v[28:31], a[16:31]
  ds_read_b128 v[52:55], v8 offset:1024
  v_mfma_f32_32x32x16_bf16 a[32:47], v[76:79], v[28:31], a[32:47]
  ds_read_b128 v[56:59], v8 offset:2048
  v_mfma_f32_32x32x16_bf16 a[48:63], v[80:83], v[28:31], a[48:63]
  ds_read_b128 v[60:63], v8 offset:3072
  v_mfma_f32_32x32x16_bf16 a[64:79], v[84:87], v[28:31], a[64:79]
  ds_read_b128 v[64:67], v8 offset:4096
  s_waitcnt lgkmcnt(0)
  v_mfma_f32_32x32x16_bf16 a[0:15], v[48:51], v[32:35], a[0:15]
  ds_read_b128 v[68:71], v8 offset:5120
  buffer_load_dwordx4 v[24:27], v1, s[4:7], s36 offen sc1
  s_add_u32 s36, s36, 1024
  buffer_load_dwordx4 v[28:31], v1, s[4:7], s36 offen sc1
  s_add_u32 s36, s36, 1024
  v_mfma_f32_32x32x16_bf16 a[16:31], v[52:55], v[32:35], a[16:31]
  ds_read_b128 v[72:75], v8 offset:6144
  s_add_u32 m0, s48, s47
  s_add_u32 s53, s44, 0
  buffer_load_dwordx4 v3, s[4:7], s53 offen offset:0 sc1 lds
  v_mfma_f32_32x32x16_bf16 a[32:47], v[56:59], v[32:35], a[32:47]
  ds_read_b128 v[76:79], v8 offset:7168
  buffer_load_dwordx4 v3, s[4:7], s53 offen offset:1024 sc1 lds
  v_mfma_f32_32x32x16_bf16 a[48:63], v[60:63], v[32:35], a[48:63]
  ds_read_b128 v[80:83], v8 offset:8192
  buffer_load_dwordx4 v3, s[4:7], s53 offen offset:2048 sc1 lds
  v_mfma_f32_32x32x16_bf16 a[64:79], v[64:67], v[32:35], a[64:79]
  ds_read_b128 v[84:87], v8 offset:9216
  s_add_u32 s44, s44, 10240
  s_add_u32 s47, s47, 0x8000
  s_and_b32 s47, s47, 0x1ffff
  s_waitcnt lgkmcnt(0)
  v_mfma_f32_32x32x16_bf16 a[0:15], v[68:71], v[36:39], a[0:15]
  v_add_u32 v8, 0x8000, v8
  v_and_b32 v8, 0x1ffff, v8
  s_waitcnt vmcnt(10)
  s_barrier
  ds_read_b128 v[48:51], v8 offset:0
  v_mfma_f32_32x32x16_bf16 a[16:31], v[72:75], v[36:39], a[16:31]
  ds_read_b128 v[52:55], v8 offset:1024
  v_mfma_f32_32x32x16_bf16 a[32:47], v[76:79], v[36:39], a[32:47]
  ds_read_b128 v[56:59], v8 offset:2048
  v_mfma_f32_32x32x16_bf16 a[48:63], v[80:83], v[36:39], a[48:63]
  ds_read_b128 v[60:63], v8 offset:3072
  v_mfma_f32_32x32x16_bf16 a[64:79], v[84:87], v[36:39], a[64:79]
  ds_read_b128 v[64:67], v8 offset:4096
  s_waitcnt lgkmcnt(0)
  v_mfma_f32_32x32x16_bf16 a[0:15], v[48:51], v[40:43], a[0:15]
  ds_read_b128 v[68:71], v8 offset:5120
  buffer_load_dwordx4 v[32:35], v1, s[4:7], s36 offen sc1
  s_add_u32 s36, s36, 1024
  buffer_load_dwordx4 v[36:39], v1, s[4:7], s36 offen sc1
  s_add_u32 s36, s36, 1024
  v_mfma_f32_32x32x16_bf16 a[16:31], v[52:55], v[40:43], a[16:31]
  ds_read_b128 v[72:75], v8 offset:6144
  s_add_u32 m0, s48, s47
  s_add_u32 s53, s44, 0
  buffer_load_dwordx4 v3, s[4:7], s53 offen offset:0 sc1 lds
  v_mfma_f32_32x32x16_bf16 a[32:47], v[56:59], v[40:43], a[32:47]
  ds_read_b128 v[76:79], v8 offset:7168
  buffer_load_dwordx4 v3, s[4:7], s53 offen offset:1024 sc1 lds
  v_mfma_f32_32x32x16_bf16 a[48:63], v[60:63], v[40:43], a[48:63]
  ds_read_b128 v[80:83], v8 offset:8192
  buffer_load_dwordx4 v3, s[4:7], s53 offen offset:2048 sc1 lds
  v_mfma_f32_32x32x16_bf16 a[64:79], v[64:67], v[40:43], a[64:79]
  ds_read_b128 v[84:87], v8 offset:9216
  s_add_u32 s44, s44, 10240
  s_add_u32 s47, s47, 0x8000
  s_and_b32 s47, s47, 0x1ffff
  s_waitcnt lgkmcnt(0)
  v_mfma_f32_32x32x16_bf16 a[0:15], v[68:71], v[44:47], a[0:15]
  v_add_u32 v8, 0x8000, v8
  v_and_b32 v8, 0x1ffff, v8
  s_waitcnt vmcnt(10)
  s_barrier
  ds_read_b128 v[48:51], v8 offset:0
  v_mfma_f32_32x32x16_bf16 a[16:31], v[72:75], v[44:47], a[16:31]
  ds_read_b128 v[52:55], v8 offset:1024
  v_mfma_f32_32x32x16_bf16 a[32:47], v[76:79], v[44:47], a[32:47]
  ds_read_b128 v[56:59], v8 offset:2048
  v_mfma_f32_32x32x16_bf16 a[48:63], v[80:83], v[44:47], a[48:63]
  ds_read_b128 v[60:63], v8 offset:3072
  v_mfma_f32_32x32x16_bf16 a[64:79], v[84:87], v[44:47], a[64:79]
  ds_read_b128 v[64:67], v8 offset:4096
  s_add_u32 s40, s40, 4
  s_cmp_lt_u32 s40, 20
  s_cbranch_scc1 L_ag_65
  s_waitcnt vmcnt(0) lgkmcnt(0)
  s_barrier
  s_mov_b32 s12, s86
  s_and_b32 s13, s87, 0xffff
  s_mov_b32 s14, 0x500000
  s_mov_b32 s15, 0x20000
  v_mul_u32_u24 v6, 2560, v4
  v_mul_u32_u24 v7, 160, v5
  v_add_u32 v6, v6, v7
  s_lshl_b32 s52, s35, 2
  s_add_u32 s52, s52, s28
  s_mul_i32 s52, s52, 81920
  s_mul_i32 s53, s34, 320
  s_add_u32 s52, s52, s53
  v_accvgpr_read_b32 v20, a0
  v_accvgpr_read_b32 v21, a1
  v_accvgpr_read_b32 v22, a2
  v_accvgpr_read_b32 v23, a3
  v_accvgpr_read_b32 v24, a4
  v_accvgpr_read_b32 v25, a5
  v_accvgpr_read_b32 v26, a6
  v_accvgpr_read_b32 v27, a7
  v_cvt_pk_bf16_f32 v16, v20, v21
  v_cvt_pk_bf16_f32 v17, v22, v23
  v_cvt_pk_bf16_f32 v18, v24, v25
  v_cvt_pk_bf16_f32 v19, v26, v27
  buffer_store_dwordx4 v[16:19], v6, s[12:15], s52 offen offset:0
  v_accvgpr_read_b32 v32, a8
  v_accvgpr_read_b32 v33, a9
  v_accvgpr_read_b32 v34, a10
  v_accvgpr_read_b32 v35, a11
  v_accvgpr_read_b32 v36, a12
  v_accvgpr_read_b32 v37, a13
  v_accvgpr_read_b32 v38, a14
  v_accvgpr_read_b32 v39, a15
  v_cvt_pk_bf16_f32 v28, v32, v33
  v_cvt_pk_bf16_f32 v29, v34, v35
  v_cvt_pk_bf16_f32 v30, v36, v37
  v_cvt_pk_bf16_f32 v31, v38, v39
  buffer_store_dwordx4 v[28:31], v6, s[12:15], s52 offen offset:16
  v_accvgpr_read_b32 v44, a16
  v_accvgpr_read_b32 v45, a17
  v_accvgpr_read_b32 v46, a18
  v_accvgpr_read_b32 v47, a19
  v_accvgpr_read_b32 v48, a20
  v_accvgpr_read_b32 v49, a21
  v_accvgpr_read_b32 v50, a22
  v_accvgpr_read_b32 v51, a23
  v_cvt_pk_bf16_f32 v40, v44, v45
  v_cvt_pk_bf16_f32 v41, v46, v47
  v_cvt_pk_bf16_f32 v42, v48, v49
  v_cvt_pk_bf16_f32 v43, v50, v51
  buffer_store_dwordx4 v[40:43], v6, s[12:15], s52 offen offset:32
  v_accvgpr_read_b32 v56, a24
  v_accvgpr_read_b32 v57, a25
  v_accvgpr_read_b32 v58, a26
  v_accvgpr_read_b32 v59, a27
  v_accvgpr_read_b32 v60, a28
  v_accvgpr_read_b32 v61, a29
  v_accvgpr_read_b32 v62, a30
  v_accvgpr_read_b32 v63, a31
  v_cvt_pk_bf16_f32 v52, v56, v57
  v_cvt_pk_bf16_f32 v53, v58, v59
  v_cvt_pk_bf16_f32 v54, v60, v61
  v_cvt_pk_bf16_f32 v55, v62, v63
  buffer_store_dwordx4 v[52:55], v6, s[12:15], s52 offen offset:48
  v_accvgpr_read_b32 v20, a32
  v_accvgpr_read_b32 v21, a33
  v_accvgpr_read_b32 v22, a34
  v_accvgpr_read_b32 v23, a35
  v_accvgpr_read_b32 v24, a36
  v_accvgpr_read_b32 v25, a37
  v_accvgpr_read_b32 v26, a38
  v_accvgpr_read_b32 v27, a39
  v_cvt_pk_bf16_f32 v16, v20, v21
  v_cvt_pk_bf16_f32 v17, v22, v23
  v_cvt_pk_bf16_f32 v18, v24, v25
  v_cvt_pk_bf16_f32 v19, v26, v27
  buffer_store_dwordx4 v[16:19], v6, s[12:15], s52 offen offset:64
  v_accvgpr_read_b32 v32, a40
  v_accvgpr_read_b32 v33, a41
  v_accvgpr_read_b32 v34, a42
  v_accvgpr_read_b32 v35, a43
  v_accvgpr_read_b32 v36, a44
  v_accvgpr_read_b32 v37, a45
  v_accvgpr_read_b32 v38, a46
  v_accvgpr_read_b32 v39, a47
  v_cvt_pk_bf16_f32 v28, v32, v33
  v_cvt_pk_bf16_f32 v29, v34, v35
  v_cvt_pk_bf16_f32 v30, v36, v37
  v_cvt_pk_bf16_f32 v31, v38, v39
  buffer_store_dwordx4 v[28:31], v6, s[12:15], s52 offen offset:80
  v_accvgpr_read_b32 v44, a48
  v_accvgpr_read_b32 v45, a49
  v_accvgpr_read_b32 v46, a50
  v_accvgpr_read_b32 v47, a51
  v_accvgpr_read_b32 v48, a52
  v_accvgpr_read_b32 v49, a53
  v_accvgpr_read_b32 v50, a54
  v_accvgpr_read_b32 v51, a55
  v_cvt_pk_bf16_f32 v40, v44, v45
  v_cvt_pk_bf16_f32 v41, v46, v47
  v_cvt_pk_bf16_f32 v42, v48, v49
  v_cvt_pk_bf16_f32 v43, v50, v51
  buffer_store_dwordx4 v[40:43], v6, s[12:15], s52 offen offset:96
  v_accvgpr_read_b32 v56, a56
  v_accvgpr_read_b32 v57, a57
  v_accvgpr_read_b32 v58, a58
  v_accvgpr_read_b32 v59, a59
  v_accvgpr_read_b32 v60, a60
  v_accvgpr_read_b32 v61, a61
  v_accvgpr_read_b32 v62, a62
  v_accvgpr_read_b32 v63, a63
  v_cvt_pk_bf16_f32 v52, v56, v57
  v_cvt_pk_bf16_f32 v53, v58, v59
  v_cvt_pk_bf16_f32 v54, v60, v61
  v_cvt_pk_bf16_f32 v55, v62, v63
  buffer_store_dwordx4 v[52:55], v6, s[12:15], s52 offen offset:112
  v_accvgpr_read_b32 v20, a64
  v_accvgpr_read_b32 v21, a65
  v_accvgpr_read_b32 v22, a66
  v_accvgpr_read_b32 v23, a67
  v_accvgpr_read_b32 v24, a68
  v_accvgpr_read_b32 v25, a69
  v_accvgpr_read_b32 v26, a70
  v_accvgpr_read_b32 v27, a71
  v_cvt_pk_bf16_f32 v16, v20, v21
  v_cvt_pk_bf16_f32 v17, v22, v23
  v_cvt_pk_bf16_f32 v18, v24, v25
  v_cvt_pk_bf16_f32 v19, v26, v27
  buffer_store_dwordx4 v[16:19], v6, s[12:15], s52 offen offset:128
  v_accvgpr_read_b32 v32, a72
  v_accvgpr_read_b32 v33, a73
  v_accvgpr_read_b32 v34, a74
  v_accvgpr_read_b32 v35, a75
  v_accvgpr_read_b32 v36, a76
  v_accvgpr_read_b32 v37, a77
  v_accvgpr_read_b32 v38, a78
  v_accvgpr_read_b32 v39, a79
  v_cvt_pk_bf16_f32 v28, v32, v33
  v_cvt_pk_bf16_f32 v29, v34, v35
  v_cvt_pk_bf16_f32 v30, v36, v37
  v_cvt_pk_bf16_f32 v31, v38, v39
  buffer_store_dwordx4 v[28:31], v6, s[12:15], s52 offen offset:144
  s_branch L_end
L_end0:
  s_endpgm
L_chain:
  s_mov_b32 s12, s76
  s_and_b32 s13, s77, 0xffff
  s_mov_b32 s14, 0x500000
  s_mov_b32 s15, 0x20000
  s_mov_b32 s16, s78
  s_and_b32 s17, s79, 0xffff
  s_mov_b32 s18, 0x500000
  s_mov_b32 s19, 0x20000
  s_mov_b32 s20, s80
  s_and_b32 s21, s81, 0xffff
  s_mov_b32 s22, 0x500000
  s_mov_b32 s23, 0x20000
  s_mov_b32 s92, s82
  s_and_b32 s93, s83, 0xffff
  s_mov_b32 s94, 0x500000
  s_mov_b32 s95, 0x20000
  v_lshrrev_b32 v66, 5, v0
  v_bfe_u32 v67, v0, 4, 1
  v_lshl_add_u32 v66, v66, 3, v67
  v_lshlrev_b32 v66, 13, v66
  s_lshl_b32 s52, s30, 8
  s_lshl_b32 s53, s28, 17
  s_add_u32 s52, s52, s53
  v_lshrrev_b32 v67, 4, v0
  v_and_b32 v68, 15, v0
  v_add_u32 v56, 0, v67
  v_lshlrev_b32 v56, 1, v56
  v_xor_b32 v56, v56, v68
  v_lshl_add_u32 v56, v56, 4, v66
  v_add_u32 v56, s52, v56
  v_add_u32 v57, 4, v67
  v_lshlrev_b32 v57, 1, v57
  v_xor_b32 v57, v57, v68
  v_lshl_add_u32 v57, v57, 4, v66
  v_add_u32 v57, s52, v57
  s_mul_i32 s52, s30, 163840
  s_mul_i32 s53, s29, 640
  s_add_u32 s52, s52, s53
  s_mul_i32 s53, s28, 40960
  s_add_u32 s52, s52, s53
  v_bfe_u32 v66, v0, 4, 1
  v_lshlrev_b32 v67, 3, v66
  v_lshrrev_b32 v68, 5, v0
  v_lshl_add_u32 v67, v68, 1, v67
  v_bfe_u32 v68, v0, 3, 1
  v_add_u32 v67, v67, v68
  v_mul_u32_u24 v67, 1280, v67
  v_and_b32 v68, 7, v0
  v_add_u32 v58, 0, v66
  v_lshlrev_b32 v58, 1, v58
  v_xor_b32 v58, v58, v68
  v_lshl_add_u32 v58, v58, 4, v67
  v_add_u32 v58, s52, v58
  v_add_u32 v59, 2, v66
  v_lshlrev_b32 v59, 1, v59
  v_xor_b32 v59, v59, v68
  v_lshl_add_u32 v59, v59, 4, v67
  v_add_u32 v59, s52, v59
  s_mul_i32 s61, s29, 2621440
  s_lshl_b32 s60, s28, 12
  s_add_u32 s60, s60, 0x8000
  s_add_u32 m0, s60, 0
  s_add_u32 s52, s61, 0x0
  buffer_load_dwordx4 v56, s[12:15], s52 offen offset:0 lds
  s_add_u32 s52, s61, 0x3c00
  buffer_load_dwordx4 v56, s[12:15], s52 offen offset:1024 lds
  s_add_u32 s52, s61, 0x7800
  buffer_load_dwordx4 v57, s[12:15], s52 offen offset:2048 lds
  s_add_u32 s52, s61, 0xb400
  buffer_load_dwordx4 v57, s[12:15], s52 offen offset:3072 lds
  s_add_u32 m0, s60, 16384
  s_add_u32 s52, s61, 0x80000
  buffer_load_dwordx4 v56, s[12:15], s52 offen offset:0 lds
  s_add_u32 s52, s61, 0x83c00
  buffer_load_dwordx4 v56, s[12:15], s52 offen offset:1024 lds
  s_add_u32 s52, s61, 0x87800
  buffer_load_dwordx4 v57, s[12:15], s52 offen offset:2048 lds
  s_add_u32 s52, s61, 0x8b400
  buffer_load_dwordx4 v57, s[12:15], s52 offen offset:3072 lds
  s_add_u32 m0, s60, 32768
  s_add_u32 s52, s61, 0x100000
  buffer_load_dwordx4 v56, s[12:15], s52 offen offset:0 lds
  s_add_u32 s52, s61, 0x103c00
  buffer_load_dwordx4 v56, s[12:15], s52 offen offset:1024 lds
  s_add_u32 s52, s61, 0x107800
  buffer_load_dwordx4 v57, s[12:15], s52 offen offset:2048 lds
  s_add_u32 s52, s61, 0x10b400
  buffer_load_dwordx4 v57, s[12:15], s52 offen offset:3072 lds
  s_add_u32 m0, s60, 49152
  s_add_u32 s52, s61, 0x180000
  buffer_load_dwordx4 v56, s[12:15], s52 offen offset:0 lds
  s_add_u32 s52, s61, 0x183c00
  buffer_load_dwordx4 v56, s[12:15], s52 offen offset:1024 lds
  s_add_u32 s52, s61, 0x187800
  buffer_load_dwordx4 v57, s[12:15], s52 offen offset:2048 lds
  s_add_u32 s52, s61, 0x18b400
  buffer_load_dwordx4 v57, s[12:15], s52 offen offset:3072 lds
  s_add_u32 m0, s60, 65536
  s_add_u32 s52, s61, 0x200000
  buffer_load_dwordx4 v56, s[12:15], s52 offen offset:0 lds
  s_add_u32 s52, s61, 0x203c00
  buffer_load_dwordx4 v56, s[12:15], s52 offen offset:1024 lds
  s_add_u32 s52, s61, 0x207800
  buffer_load_dwordx4 v57, s[12:15], s52 offen offset:2048 lds
  s_add_u32 s52, s61, 0x20b400
  buffer_load_dwordx4 v57, s[12:15], s52 offen offset:3072 lds
  s_add_u32 m0, s60, 81920
  s_sub_u32 s52, 0x280000, s61
  buffer_load_dwordx4 v56, s[12:15], s52 offen offset:0 lds
  s_sub_u32 s52, 0x283c00, s61
  buffer_load_dwordx4 v56, s[12:15], s52 offen offset:1024 lds
  s_sub_u32 s52, 0x287800, s61
  buffer_load_dwordx4 v57, s[12:15], s52 offen offset:2048 lds
  s_sub_u32 s52, 0x28b400, s61
  buffer_load_dwordx4 v57, s[12:15], s52 offen offset:3072 lds
  s_add_u32 m0, s60, 98304
  s_sub_u32 s52, 0x300000, s61
  buffer_load_dwordx4 v56, s[12:15], s52 offen offset:0 lds
  s_sub_u32 s52, 0x303c00, s61
  buffer_load_dwordx4 v56, s[12:15], s52 offen offset:1024 lds
  s_sub_u32 s52, 0x307800, s61
  buffer_load_dwordx4 v57, s[12:15], s52 offen offset:2048 lds
  s_sub_u32 s52, 0x30b400, s61
  buffer_load_dwordx4 v57, s[12:15], s52 offen offset:3072 lds
  v_lshrrev_b32 v66, 4, v0
  v_bfe_u32 v67, v0, 2, 2
  v_lshl_add_u32 v68, v66, 3, v67
  v_and_b32 v66, 1, v66
  v_lshl_add_u32 v69, v66, 2, v67
  v_lshlrev_b32 v69, 1, v69
  v_bfe_u32 v70, v0, 1, 1
  v_and_b32 v71, 1, v0
  v_lshlrev_b32 v71, 3, v71
  s_lshl_b32 s52, s28, 2
  v_add3_u32 v60, v70, 0, s52
  v_xor_b32 v60, v60, v69
  v_lshl_add_u32 v60, v60, 4, v71
  v_lshl_add_u32 v60, v68, 8, v60
  v_add3_u32 v61, v70, 2, s52
  v_xor_b32 v61, v61, v69
  v_lshl_add_u32 v61, v61, 4, v71
  v_lshl_add_u32 v61, v68, 8, v61
  v_lshrrev_b32 v67, 1, v67
  v_lshl_add_u32 v67, v66, 1, v67
  v_xor_b32 v67, s28, v67
  v_lshl_add_u32 v67, v67, 1, v70
  v_lshl_add_u32 v67, v67, 4, v71
  v_lshl_add_u32 v62, v68, 7, v67
  s_lshl_b32 s52, s28, 1
  v_add3_u32 v76, v70, 0, s52
  v_xor_b32 v76, v76, v69
  v_lshl_add_u32 v76, v76, 4, v71
  v_lshl_add_u32 v76, v68, 8, v76
  v_add3_u32 v77, v70, 8, s52
  v_xor_b32 v77, v77, v69
  v_lshl_add_u32 v77, v77, 4, v71
  v_lshl_add_u32 v77, v68, 8, v77
  v_add_u32 v60, 0x8000, v60
  v_add_u32 v72, 0x10000, v60
  v_add_u32 v61, 0x8000, v61
  v_add_u32 v73, 0x10000, v61
  v_add_u32 v62, 0x8000, v62
  v_add_u32 v74, 0x10000, v62
  v_add_u32 v76, 0x8000, v76
  v_add_u32 v78, 0x10000, v76
  v_add_u32 v77, 0x8000, v77
  v_add_u32 v79, 0x10000, v77
  v_lshlrev_b32 v1, 4, v0
  v_add_u32 v2, s60, v1
  v_add_u32 v3, 0x10000, v2
  v_lshrrev_b32 v16, 4, v0
  v_and_b32 v17, 15, v0
  v_mov_b32 v4, 0x4444
  v_mov_b32 v66, 0xeeee
  v_and_b32 v67, 2, v0
  v_cmp_ne_u32 vcc, 0, v67
  s_nop 1
  v_cndmask_b32 v4, v4, v66, vcc
  v_bfe_u32 v66, v0, 2, 2
  v_and_b32 v18, 1, v0
  v_lshl_add_u32 v18, v66, 1, v18
  v_and_b32 v19, 1, v16
  v_lshrrev_b32 v20, 1, v16
  v_mul_u32_u24 v5, 576, v16
  v_bfe_u32 v66, v0, 2, 1
  v_lshl_add_u32 v5, v66, 4, v5
  v_bfe_u32 v66, v0, 3, 1
  v_lshl_add_u32 v5, v66, 3, v5
  v_and_b32 v66, 3, v0
  v_lshl_add_u32 v5, v66, 1, v5
  s_lshl_b32 s52, s28, 6
  v_add_u32 v5, s52, v5
  v_mul_u32_u24 v6, 288, v18
  v_lshl_add_u32 v6, v16, 4, v6
  s_lshl_b32 s52, s28, 8
  s_add_u32 s52, s52, 0x3800
  v_and_b32 v67, 13, v0
  v_lshl_add_u32 v67, v20, 1, v67
  v_and_b32 v68, 2, v0
  v_lshl_add_u32 v67, v68, 5, v67
  v_lshlrev_b32 v67, 4, v67
  v_lshl_add_u32 v7, v19, 3, v67
  v_add_u32 v7, s52, v7
  s_lshl_b32 s52, s30, 8
  s_lshl_b32 s53, s28, 13
  s_add_u32 s52, s52, s53
  v_lshl_add_u32 v8, v0, 2, s52
  s_lshl_b32 s52, s28, 10
  v_add_u32 v11, s52, v1
  s_lshl_b32 s52, s28, 8
  s_add_u32 s52, s52, 4096
  v_lshl_add_u32 v9, v0, 2, s52
  v_and_b32 v67, 8, v0
  v_and_b32 v68, 1, v0
  v_lshl_add_u32 v67, v68, 2, v67
  v_bfe_u32 v68, v0, 1, 2
  v_add_u32 v67, v67, v68
  v_lshl_add_u32 v67, v16, 4, v67
  v_lshlrev_b32 v10, 4, v67
  s_mov_b32 s32, 0
  s_lshl_b32 s53, s29, 19
  s_add_u32 s35, s53, 0x4a02000
  s_add_u32 s33, s53, 0x4a00000
  s_add_u32 s37, s53, 0x4b00000
  s_add_u32 s38, s53, 0x4b08000
  s_add_u32 s39, s53, 0x4b10000
  s_add_u32 s40, s53, 0x4b18000
  s_add_u32 s41, s53, 0x4b20000
  s_add_u32 s42, s53, 0x4b00000
  s_add_u32 s43, s53, 0x4b01000
  s_lshl_b32 s53, s29, 20
  s_add_u32 s36, s53, 0x4804000
  s_xor_b32 s53, s53, 0x100000
  s_add_u32 s34, s53, 0x4800000
  s_lshl_b32 s45, s30, 14
  s_lshl_b32 s54, s28, 11
  s_add_u32 s54, s54, 8192
  s_add_u32 s44, s45, s54
  s_add_u32 s46, s54, 0x4000
  s_lshl_b32 s54, s28, 12
  s_add_u32 s54, s54, s45
  s_add_u32 s56, s54, 0x80000
  s_lshl_b32 s47, s30, 12
  s_lshl_b32 s53, s29, 11
  s_add_u32 s47, s47, s53
  s_lshl_b32 s53, s28, 9
  s_add_u32 s47, s47, s53
  s_add_u32 s47, s47, 0x3fe0000
  s_and_b32 s53, s30, 7
  s_add_u32 s53, s53, 32
  s_bitcmp1_b32 s28, 0
  s_cselect_b32 s53, s53, s30
  s_lshl_b32 s96, s53, 7
  s_lshl_b32 s53, s29, 5
  s_add_u32 s53, s53, s30
  s_lshl_b32 s53, s53, 7
  s_add_u32 s48, s53, 0x4c00000
  s_mov_b32 s50, 0x3e0293ee
  s_mov_b32 s58, 0xcccccccc
  s_mov_b32 s59, 0xcccccccc
  s_mov_b32 s63, 0
  s_lshl_b32 s57, s28, 4
  s_sub_u32 s53, 3, s28
  s_lshl_b32 s53, s53, 5
  s_add_u32 s53, s53, s30
  s_cmp_lt_u32 s53, 40
  s_cselect_b32 s49, 1, 0
  s_cselect_b32 s53, s53, 0
  s_and_b32 s54, s53, 1
  s_lshl_b32 s54, s54, 7
  s_lshr_b32 s53, s53, 1
  s_lshl_b32 s55, s53, 13
  s_add_u32 s55, s55, s54
  v_bfe_u32 v67, v0, 3, 1
  v_lshl_add_u32 v67, v67, 2, v16
  v_lshlrev_b32 v67, 8, v67
  v_and_b32 v68, 7, v0
  v_lshl_add_u32 v12, v68, 4, v67
  v_add_u32 v12, s55, v12
  s_lshl_b32 s55, s53, 8
  s_add_u32 s55, s55, s54
  v_lshlrev_b32 v68, 3, v68
  v_lshl_add_u32 v13, v19, 6, v68
  v_add_u32 v13, s55, v13
  s_sub_u32 s45, s44, 8192
  s_waitcnt vmcnt(24)
  s_barrier
  s_or_b32 s52, s28, s27
  s_mov_b32 s27, 1
  s_cmp_lg_u32 s52, 0
  s_cbranch_scc1 L_cens_66
  s_lshl_b32 s52, 1, s30
  s_lshl_b32 s53, s29, 3
  s_cmp_lt_u32 s29, 8
  s_cselect_b32 s52, s52, 0
  s_cselect_b32 s53, s53, 0
  s_mov_b64 exec, 1
  v_mov_b32 v14, 1
  v_mov_b32 v15, s52
  buffer_atomic_add_x2 v[14:15], off, s[8:11], s53 sc1
  s_mov_b64 exec, -1
L_cens_66:
  s_add_u32 m0, s60, 114688
  s_sub_u32 s52, 0x380000, s61
  buffer_load_dwordx4 v56, s[12:15], s52 offen offset:0 lds
  s_sub_u32 s52, 0x383c00, s61
  buffer_load_dwordx4 v56, s[12:15], s52 offen offset:1024 lds
  s_sub_u32 s52, 0x387800, s61
  buffer_load_dwordx4 v57, s[12:15], s52 offen offset:2048 lds
  s_sub_u32 s52, 0x38b400, s61
  buffer_load_dwordx4 v57, s[12:15], s52 offen offset:3072 lds
  ds_read_b64_tr_b16 a[0:1], v60 offset:0
  ds_read_b64_tr_b16 a[2:3], v60 offset:1024
  ds_read_b64_tr_b16 a[4:5], v60 offset:8192
  ds_read_b64_tr_b16 a[6:7], v60 offset:9216
  ds_read_b64_tr_b16 a[8:9], v61 offset:0
  ds_read_b64_tr_b16 a[10:11], v61 offset:1024
  ds_read_b64_tr_b16 a[12:13], v61 offset:8192
  ds_read_b64_tr_b16 a[14:15], v61 offset:9216
  s_waitcnt vmcnt(24) lgkmcnt(0)
  s_barrier
  s_add_u32 m0, s60, 0
  s_sub_u32 s52, 0x400000, s61
  buffer_load_dwordx4 v56, s[12:15], s52 offen offset:0 lds
  s_sub_u32 s52, 0x403c00, s61
  buffer_load_dwordx4 v56, s[12:15], s52 offen offset:1024 lds
  s_sub_u32 s52, 0x407800, s61
  buffer_load_dwordx4 v57, s[12:15], s52 offen offset:2048 lds
  s_sub_u32 s52, 0x40b400, s61
  buffer_load_dwordx4 v57, s[12:15], s52 offen offset:3072 lds
  ds_read_b64_tr_b16 a[16:17], v60 offset:16384
  ds_read_b64_tr_b16 a[18:19], v60 offset:17408
  ds_read_b64_tr_b16 a[20:21], v60 offset:24576
  ds_read_b64_tr_b16 a[22:23], v60 offset:25600
  ds_read_b64_tr_b16 a[24:25], v61 offset:16384
  ds_read_b64_tr_b16 a[26:27], v61 offset:17408
  ds_read_b64_tr_b16 a[28:29], v61 offset:24576
  ds_read_b64_tr_b16 a[30:31], v61 offset:25600
  s_waitcnt vmcnt(24) lgkmcnt(0)
  s_barrier
  s_add_u32 m0, s60, 16384
  s_add_u32 s52, s61, 0x0
  buffer_load_dwordx4 v56, s[16:19], s52 offen offset:0 lds
  s_add_u32 s52, s61, 0x3c00
  buffer_load_dwordx4 v56, s[16:19], s52 offen offset:1024 lds
  s_add_u32 s52, s61, 0x7800
  buffer_load_dwordx4 v57, s[16:19], s52 offen offset:2048 lds
  s_add_u32 s52, s61, 0xb400
  buffer_load_dwordx4 v57, s[16:19], s52 offen offset:3072 lds
  ds_read_b64_tr_b16 a[32:33], v60 offset:32768
  ds_read_b64_tr_b16 a[34:35], v60 offset:33792
  ds_read_b64_tr_b16 a[36:37], v60 offset:40960
  ds_read_b64_tr_b16 a[38:39], v60 offset:41984
  ds_read_b64_tr_b16 a[40:41], v61 offset:32768
  ds_read_b64_tr_b16 a[42:43], v61 offset:33792
  ds_read_b64_tr_b16 a[44:45], v61 offset:40960
  ds_read_b64_tr_b16 a[46:47], v61 offset:41984
  s_waitcnt vmcnt(24) lgkmcnt(0)
  s_barrier
  s_add_u32 m0, s60, 32768
  s_add_u32 s52, s61, 0x80000
  buffer_load_dwordx4 v56, s[16:19], s52 offen offset:0 lds
  s_add_u32 s52, s61, 0x83c00
  buffer_load_dwordx4 v56, s[16:19], s52 offen offset:1024 lds
  s_add_u32 s52, s61, 0x87800
  buffer_load_dwordx4 v57, s[16:19], s52 offen offset:2048 lds
  s_add_u32 s52, s61, 0x8b400
  buffer_load_dwordx4 v57, s[16:19], s52 offen offset:3072 lds
  ds_read_b64_tr_b16 a[48:49], v60 offset:49152
  ds_read_b64_tr_b16 a[50:51], v60 offset:50176
  ds_read_b64_tr_b16 a[52:53], v60 offset:57344
  ds_read_b64_tr_b16 a[54:55], v60 offset:58368
  ds_read_b64_tr_b16 a[56:57], v61 offset:49152
  ds_read_b64_tr_b16 a[58:59], v61 offset:50176
  ds_read_b64_tr_b16 a[60:61], v61 offset:57344
  ds_read_b64_tr_b16 a[62:63], v61 offset:58368
  s_waitcnt vmcnt(24) lgkmcnt(0)
  s_barrier
  s_add_u32 m0, s60, 49152
  s_add_u32 s52, s61, 0x100000
  buffer_load_dwordx4 v56, s[16:19], s52 offen offset:0 lds
  s_add_u32 s52, s61, 0x103c00
  buffer_load_dwordx4 v56, s[16:19], s52 offen offset:1024 lds
  s_add_u32 s52, s61, 0x107800
  buffer_load_dwordx4 v57, s[16:19], s52 offen offset:2048 lds
  s_add_u32 s52, s61, 0x10b400
  buffer_load_dwordx4 v57, s[16:19], s52 offen offset:3072 lds
  ds_read_b64_tr_b16 a[64:65], v72 offset:0
  ds_read_b64_tr_b16 a[66:67], v72 offset:1024
  ds_read_b64_tr_b16 a[68:69], v72 offset:8192
  ds_read_b64_tr_b16 a[70:71], v72 offset:9216
  ds_read_b64_tr_b16 a[72:73], v73 offset:0
  ds_read_b64_tr_b16 a[74:75], v73 offset:1024
  ds_read_b64_tr_b16 a[76:77], v73 offset:8192
  ds_read_b64_tr_b16 a[78:79], v73 offset:9216
  s_waitcnt vmcnt(24) lgkmcnt(0)
  s_barrier
  s_add_u32 m0, s60, 65536
  s_add_u32 s52, s61, 0x180000
  buffer_load_dwordx4 v56, s[16:19], s52 offen offset:0 lds
  s_add_u32 s52, s61, 0x183c00
  buffer_load_dwordx4 v56, s[16:19], s52 offen offset:1024 lds
  s_add_u32 s52, s61, 0x187800
  buffer_load_dwordx4 v57, s[16:19], s52 offen offset:2048 lds
  s_add_u32 s52, s61, 0x18b400
  buffer_load_dwordx4 v57, s[16:19], s52 offen offset:3072 lds
  ds_read_b64_tr_b16 a[80:81], v72 offset:16384
  ds_read_b64_tr_b16 a[82:83], v72 offset:17408
  ds_read_b64_tr_b16 a[84:85], v72 offset:24576
  ds_read_b64_tr_b16 a[86:87], v72 offset:25600
  ds_read_b64_tr_b16 a[88:89], v73 offset:16384
  ds_read_b64_tr_b16 a[90:91], v73 offset:17408
  ds_read_b64_tr_b16 a[92:93], v73 offset:24576
  ds_read_b64_tr_b16 a[94:95], v73 offset:25600
  s_waitcnt vmcnt(24) lgkmcnt(0)
  s_barrier
  s_add_u32 m0, s60, 81920
  s_add_u32 s52, s61, 0x200000
  buffer_load_dwordx4 v56, s[16:19], s52 offen offset:0 lds
  s_add_u32 s52, s61, 0x203c00
  buffer_load_dwordx4 v56, s[16:19], s52 offen offset:1024 lds
  s_add_u32 s52, s61, 0x207800
  buffer_load_dwordx4 v57, s[16:19], s52 offen offset:2048 lds
  s_add_u32 s52, s61, 0x20b400
  buffer_load_dwordx4 v57, s[16:19], s52 offen offset:3072 lds
  ds_read_b64_tr_b16 a[96:97], v72 offset:32768
  ds_read_b64_tr_b16 a[98:99], v72 offset:33792
  ds_read_b64_tr_b16 a[100:101], v72 offset:40960
  ds_read_b64_tr_b16 a[102:103], v72 offset:41984
  ds_read_b64_tr_b16 a[104:105], v73 offset:32768
  ds_read_b64_tr_b16 a[106:107], v73 offset:33792
  ds_read_b64_tr_b16 a[108:109], v73 offset:40960
  ds_read_b64_tr_b16 a[110:111], v73 offset:41984
  s_waitcnt vmcnt(24) lgkmcnt(0)
  s_barrier
  s_add_u32 m0, s60, 98304
  s_sub_u32 s52, 0x280000, s61
  buffer_load_dwordx4 v56, s[16:19], s52 offen offset:0 lds
  s_sub_u32 s52, 0x283c00, s61
  buffer_load_dwordx4 v56, s[16:19], s52 offen offset:1024 lds
  s_sub_u32 s52, 0x287800, s61
  buffer_load_dwordx4 v57, s[16:19], s52 offen offset:2048 lds
  s_sub_u32 s52, 0x28b400, s61
  buffer_load_dwordx4 v57, s[16:19], s52 offen offset:3072 lds
  ds_read_b64_tr_b16 a[112:113], v72 offset:49152
  ds_read_b64_tr_b16 a[114:115], v72 offset:50176
  ds_read_b64_tr_b16 a[116:117], v72 offset:57344
  ds_read_b64_tr_b16 a[118:119], v72 offset:58368
  ds_read_b64_tr_b16 a[120:121], v73 offset:49152
  ds_read_b64_tr_b16 a[122:123], v73 offset:50176
  ds_read_b64_tr_b16 a[124:125], v73 offset:57344
  ds_read_b64_tr_b16 a[126:127], v73 offset:58368
  s_waitcnt vmcnt(24) lgkmcnt(0)
  s_barrier
  s_add_u32 m0, s60, 114688
  s_sub_u32 s52, 0x300000, s61
  buffer_load_dwordx4 v56, s[16:19], s52 offen offset:0 lds
  s_sub_u32 s52, 0x303c00, s61
  buffer_load_dwordx4 v56, s[16:19], s52 offen offset:1024 lds
  s_sub_u32 s52, 0x307800, s61
  buffer_load_dwordx4 v57, s[16:19], s52 offen offset:2048 lds
  s_sub_u32 s52, 0x30b400, s61
  buffer_load_dwordx4 v57, s[16:19], s52 offen offset:3072 lds
  ds_read_b64_tr_b16 a[128:129], v60 offset:0
  ds_read_b64_tr_b16 a[130:131], v60 offset:1024
  ds_read_b64_tr_b16 a[132:133], v60 offset:8192
  ds_read_b64_tr_b16 a[134:135], v60 offset:9216
  ds_read_b64_tr_b16 a[136:137], v61 offset:0
  ds_read_b64_tr_b16 a[138:139], v61 offset:1024
  ds_read_b64_tr_b16 a[140:141], v61 offset:8192
  ds_read_b64_tr_b16 a[142:143], v61 offset:9216
  s_waitcnt vmcnt(24) lgkmcnt(0)
  s_barrier
  s_add_u32 m0, s60, 0
  s_sub_u32 s52, 0x380000, s61
  buffer_load_dwordx4 v56, s[16:19], s52 offen offset:0 lds
  s_sub_u32 s52, 0x383c00, s61
  buffer_load_dwordx4 v56, s[16:19], s52 offen offset:1024 lds
  s_sub_u32 s52, 0x387800, s61
  buffer_load_dwordx4 v57, s[16:19], s52 offen offset:2048 lds
  s_sub_u32 s52, 0x38b400, s61
  buffer_load_dwordx4 v57, s[16:19], s52 offen offset:3072 lds
  ds_read_b64_tr_b16 a[144:145], v60 offset:16384
  ds_read_b64_tr_b16 a[146:147], v60 offset:17408
  ds_read_b64_tr_b16 a[148:149], v60 offset:24576
  ds_read_b64_tr_b16 a[150:151], v60 offset:25600
  ds_read_b64_tr_b16 a[152:153], v61 offset:16384
  ds_read_b64_tr_b16 a[154:155], v61 offset:17408
  ds_read_b64_tr_b16 a[156:157], v61 offset:24576
  ds_read_b64_tr_b16 a[158:159], v61 offset:25600
  s_waitcnt vmcnt(24) lgkmcnt(0)
  s_barrier
  s_add_u32 m0, s60, 16384
  s_sub_u32 s52, 0x400000, s61
  buffer_load_dwordx4 v56, s[16:19], s52 offen offset:0 lds
  s_sub_u32 s52, 0x403c00, s61
  buffer_load_dwordx4 v56, s[16:19], s52 offen offset:1024 lds
  s_sub_u32 s52, 0x407800, s61
  buffer_load_dwordx4 v57, s[16:19], s52 offen offset:2048 lds
  s_sub_u32 s52, 0x40b400, s61
  buffer_load_dwordx4 v57, s[16:19], s52 offen offset:3072 lds
  ds_read_b64_tr_b16 a[160:161], v60 offset:32768
  ds_read_b64_tr_b16 a[162:163], v60 offset:33792
  ds_read_b64_tr_b16 a[164:165], v60 offset:40960
  ds_read_b64_tr_b16 a[166:167], v60 offset:41984
  ds_read_b64_tr_b16 a[168:169], v61 offset:32768
  ds_read_b64_tr_b16 a[170:171], v61 offset:33792
  ds_read_b64_tr_b16 a[172:173], v61 offset:40960
  ds_read_b64_tr_b16 a[174:175], v61 offset:41984
  s_waitcnt vmcnt(24) lgkmcnt(0)
  s_barrier
  s_add_u32 m0, s60, 32768
  s_sub_u32 s52, 0x480000, s61
  buffer_load_dwordx4 v56, s[16:19], s52 offen offset:0 lds
  s_sub_u32 s52, 0x483c00, s61
  buffer_load_dwordx4 v56, s[16:19], s52 offen offset:1024 lds
  s_sub_u32 s52, 0x487800, s61
  buffer_load_dwordx4 v57, s[16:19], s52 offen offset:2048 lds
  s_sub_u32 s52, 0x48b400, s61
  buffer_load_dwordx4 v57, s[16:19], s52 offen offset:3072 lds
  ds_read_b64_tr_b16 a[176:177], v60 offset:49152
  ds_read_b64_tr_b16 a[178:179], v60 offset:50176
  ds_read_b64_tr_b16 a[180:181], v60 offset:57344
  ds_read_b64_tr_b16 a[182:183], v60 offset:58368
  ds_read_b64_tr_b16 a[184:185], v61 offset:49152
  ds_read_b64_tr_b16 a[186:187], v61 offset:50176
  ds_read_b64_tr_b16 a[188:189], v61 offset:57344
  ds_read_b64_tr_b16 a[190:191], v61 offset:58368
  s_waitcnt vmcnt(24) lgkmcnt(0)
  s_barrier
  s_add_u32 m0, s60, 49152
  s_sub_u32 s52, 0x280000, s61
  buffer_load_dwordx4 v56, s[20:23], s52 offen offset:0 lds
  s_sub_u32 s52, 0x283c00, s61
  buffer_load_dwordx4 v56, s[20:23], s52 offen offset:1024 lds
  s_sub_u32 s52, 0x287800, s61
  buffer_load_dwordx4 v57, s[20:23], s52 offen offset:2048 lds
  s_sub_u32 s52, 0x28b400, s61
  buffer_load_dwordx4 v57, s[20:23], s52 offen offset:3072 lds
  ds_read_b64_tr_b16 a[192:193], v72 offset:0
  ds_read_b64_tr_b16 a[194:195], v72 offset:1024
  ds_read_b64_tr_b16 a[196:197], v72 offset:8192
  ds_read_b64_tr_b16 a[198:199], v72 offset:9216
  ds_read_b64_tr_b16 a[200:201], v73 offset:0
  ds_read_b64_tr_b16 a[202:203], v73 offset:1024
  ds_read_b64_tr_b16 a[204:205], v73 offset:8192
  ds_read_b64_tr_b16 a[206:207], v73 offset:9216
  s_waitcnt vmcnt(24) lgkmcnt(0)
  s_barrier
  s_add_u32 m0, s60, 65536
  s_sub_u32 s52, 0x300000, s61
  buffer_load_dwordx4 v56, s[20:23], s52 offen offset:0 lds
  s_sub_u32 s52, 0x303c00, s61
  buffer_load_dwordx4 v56, s[20:23], s52 offen offset:1024 lds
  s_sub_u32 s52, 0x307800, s61
  buffer_load_dwordx4 v57, s[20:23], s52 offen offset:2048 lds
  s_sub_u32 s52, 0x30b400, s61
  buffer_load_dwordx4 v57, s[20:23], s52 offen offset:3072 lds
  ds_read_b64_tr_b16 a[208:209], v72 offset:16384
  ds_read_b64_tr_b16 a[210:211], v72 offset:17408
  ds_read_b64_tr_b16 a[212:213], v72 offset:24576
  ds_read_b64_tr_b16 a[214:215], v72 offset:25600
  ds_read_b64_tr_b16 a[216:217], v73 offset:16384
  ds_read_b64_tr_b16 a[218:219], v73 offset:17408
  ds_read_b64_tr_b16 a[220:221], v73 offset:24576
  ds_read_b64_tr_b16 a[222:223], v73 offset:25600
  s_waitcnt vmcnt(24) lgkmcnt(0)
  s_barrier
  s_add_u32 m0, s60, 81920
  s_sub_u32 s52, 0x380000, s61
  buffer_load_dwordx4 v56, s[20:23], s52 offen offset:0 lds
  s_sub_u32 s52, 0x383c00, s61
  buffer_load_dwordx4 v56, s[20:23], s52 offen offset:1024 lds
  s_sub_u32 s52, 0x387800, s61
  buffer_load_dwordx4 v57, s[20:23], s52 offen offset:2048 lds
  s_sub_u32 s52, 0x38b400, s61
  buffer_load_dwordx4 v57, s[20:23], s52 offen offset:3072 lds
  ds_read_b64_tr_b16 a[224:225], v72 offset:32768
  ds_read_b64_tr_b16 a[226:227], v72 offset:33792
  ds_read_b64_tr_b16 a[228:229], v72 offset:40960
  ds_read_b64_tr_b16 a[230:231], v72 offset:41984
  ds_read_b64_tr_b16 a[232:233], v73 offset:32768
  ds_read_b64_tr_b16 a[234:235], v73 offset:33792
  ds_read_b64_tr_b16 a[236:237], v73 offset:40960
  ds_read_b64_tr_b16 a[238:239], v73 offset:41984
  s_waitcnt vmcnt(24) lgkmcnt(0)
  s_barrier
  s_add_u32 m0, s60, 98304
  s_sub_u32 s52, 0x400000, s61
  buffer_load_dwordx4 v56, s[20:23], s52 offen offset:0 lds
  s_sub_u32 s52, 0x403c00, s61
  buffer_load_dwordx4 v56, s[20:23], s52 offen offset:1024 lds
  s_sub_u32 s52, 0x407800, s61
  buffer_load_dwordx4 v57, s[20:23], s52 offen offset:2048 lds
  s_sub_u32 s52, 0x40b400, s61
  buffer_load_dwordx4 v57, s[20:23], s52 offen offset:3072 lds
  ds_read_b64_tr_b16 a[240:241], v72 offset:49152
  ds_read_b64_tr_b16 a[242:243], v72 offset:50176
  ds_read_b64_tr_b16 a[244:245], v72 offset:57344
  ds_read_b64_tr_b16 a[246:247], v72 offset:58368
  ds_read_b64_tr_b16 a[248:249], v73 offset:49152
  ds_read_b64_tr_b16 a[250:251], v73 offset:50176
  ds_read_b64_tr_b16 a[252:253], v73 offset:57344
  ds_read_b64_tr_b16 a[254:255], v73 offset:58368
  s_waitcnt vmcnt(24) lgkmcnt(0)
  s_barrier
  s_add_u32 m0, s60, 114688
  s_sub_u32 s52, 0x480000, s61
  buffer_load_dwordx4 v56, s[20:23], s52 offen offset:0 lds
  s_sub_u32 s52, 0x483c00, s61
  buffer_load_dwordx4 v56, s[20:23], s52 offen offset:1024 lds
  s_sub_u32 s52, 0x487800, s61
  buffer_load_dwordx4 v57, s[20:23], s52 offen offset:2048 lds
  s_sub_u32 s52, 0x48b400, s61
  buffer_load_dwordx4 v57, s[20:23], s52 offen offset:3072 lds
  ds_read_b64_tr_b16 v[80:81], v60 offset:0
  ds_read_b64_tr_b16 v[82:83], v60 offset:1024
  ds_read_b64_tr_b16 v[84:85], v60 offset:8192
  ds_read_b64_tr_b16 v[86:87], v60 offset:9216
  ds_read_b64_tr_b16 v[88:89], v61 offset:0
  ds_read_b64_tr_b16 v[90:91], v61 offset:1024
  ds_read_b64_tr_b16 v[92:93], v61 offset:8192
  ds_read_b64_tr_b16 v[94:95], v61 offset:9216
  s_waitcnt vmcnt(24) lgkmcnt(0)
  s_barrier
  s_add_u32 m0, s60, 0
  s_mov_b32 s52, 0x0
  buffer_load_dwordx4 v58, s[92:95], s52 offen offset:0 lds
  s_mov_b32 s52, 0x1000
  buffer_load_dwordx4 v59, s[92:95], s52 offen offset:1024 lds
  s_mov_b32 s52, 0x4800
  buffer_load_dwordx4 v58, s[92:95], s52 offen offset:2048 lds
  s_mov_b32 s52, 0x5800
  buffer_load_dwordx4 v59, s[92:95], s52 offen offset:3072 lds
  ds_read_b64_tr_b16 v[96:97], v60 offset:16384
  ds_read_b64_tr_b16 v[98:99], v60 offset:17408
  ds_read_b64_tr_b16 v[100:101], v60 offset:24576
  ds_read_b64_tr_b16 v[102:103], v60 offset:25600
  ds_read_b64_tr_b16 v[104:105], v61 offset:16384
  ds_read_b64_tr_b16 v[106:107], v61 offset:17408
  ds_read_b64_tr_b16 v[108:109], v61 offset:24576
  ds_read_b64_tr_b16 v[110:111], v61 offset:25600
  s_waitcnt vmcnt(24) lgkmcnt(0)
  s_barrier
  s_add_u32 m0, s60, 16384
  s_mov_b32 s52, 0x80
  buffer_load_dwordx4 v58, s[92:95], s52 offen offset:0 lds
  s_mov_b32 s52, 0x1080
  buffer_load_dwordx4 v59, s[92:95], s52 offen offset:1024 lds
  s_mov_b32 s52, 0x4880
  buffer_load_dwordx4 v58, s[92:95], s52 offen offset:2048 lds
  s_mov_b32 s52, 0x5880
  buffer_load_dwordx4 v59, s[92:95], s52 offen offset:3072 lds
  ds_read_b64_tr_b16 v[112:113], v60 offset:32768
  ds_read_b64_tr_b16 v[114:115], v60 offset:33792
  ds_read_b64_tr_b16 v[116:117], v60 offset:40960
  ds_read_b64_tr_b16 v[118:119], v60 offset:41984
  ds_read_b64_tr_b16 v[120:121], v61 offset:32768
  ds_read_b64_tr_b16 v[122:123], v61 offset:33792
  ds_read_b64_tr_b16 v[124:125], v61 offset:40960
  ds_read_b64_tr_b16 v[126:127], v61 offset:41984
  s_waitcnt vmcnt(24) lgkmcnt(0)
  s_barrier
  s_add_u32 m0, s60, 32768
  s_mov_b32 s52, 0x100
  buffer_load_dwordx4 v58, s[92:95], s52 offen offset:0 lds
  s_mov_b32 s52, 0x1100
  buffer_load_dwordx4 v59, s[92:95], s52 offen offset:1024 lds
  s_mov_b32 s52, 0x4900
  buffer_load_dwordx4 v58, s[92:95], s52 offen offset:2048 lds
  s_mov_b32 s52, 0x5900
  buffer_load_dwordx4 v59, s[92:95], s52 offen offset:3072 lds
  ds_read_b64_tr_b16 v[128:129], v76 offset:49152
  ds_read_b64_tr_b16 v[130:131], v76 offset:50176
  ds_read_b64_tr_b16 v[132:133], v76 offset:57344
  ds_read_b64_tr_b16 v[134:135], v76 offset:58368
  ds_read_b64_tr_b16 v[136:137], v77 offset:49152
  ds_read_b64_tr_b16 v[138:139], v77 offset:50176
  ds_read_b64_tr_b16 v[140:141], v77 offset:57344
  ds_read_b64_tr_b16 v[142:143], v77 offset:58368
  s_waitcnt vmcnt(24) lgkmcnt(0)
  s_barrier
  s_add_u32 m0, s60, 49152
  s_add_u32 s52, s61, 0x0
  buffer_load_dwordx4 v56, s[20:23], s52 offen offset:0 lds
  s_add_u32 s52, s61, 0x3c00
  buffer_load_dwordx4 v56, s[20:23], s52 offen offset:1024 lds
  s_add_u32 s52, s61, 0x7800
  buffer_load_dwordx4 v57, s[20:23], s52 offen offset:2048 lds
  s_add_u32 s52, s61, 0xb400
  buffer_load_dwordx4 v57, s[20:23], s52 offen offset:3072 lds
  ds_read_b64_tr_b16 v[144:145], v78 offset:0
  ds_read_b64_tr_b16 v[146:147], v78 offset:1024
  ds_read_b64_tr_b16 v[148:149], v78 offset:8192
  ds_read_b64_tr_b16 v[150:151], v78 offset:9216
  ds_read_b64_tr_b16 v[152:153], v79 offset:0
  ds_read_b64_tr_b16 v[154:155], v79 offset:1024
  ds_read_b64_tr_b16 v[156:157], v79 offset:8192
  ds_read_b64_tr_b16 v[158:159], v79 offset:9216
  s_waitcnt vmcnt(24) lgkmcnt(0)
  s_barrier
  s_add_u32 m0, s60, 65536
  s_add_u32 s52, s61, 0x80000
  buffer_load_dwordx4 v56, s[20:23], s52 offen offset:0 lds
  s_add_u32 s52, s61, 0x83c00
  buffer_load_dwordx4 v56, s[20:23], s52 offen offset:1024 lds
  s_add_u32 s52, s61, 0x87800
  buffer_load_dwordx4 v57, s[20:23], s52 offen offset:2048 lds
  s_add_u32 s52, s61, 0x8b400
  buffer_load_dwordx4 v57, s[20:23], s52 offen offset:3072 lds
  ds_read_b64_tr_b16 v[160:161], v78 offset:16384
  ds_read_b64_tr_b16 v[162:163], v78 offset:17408
  ds_read_b64_tr_b16 v[164:165], v78 offset:24576
  ds_read_b64_tr_b16 v[166:167], v78 offset:25600
  ds_read_b64_tr_b16 v[168:169], v79 offset:16384
  ds_read_b64_tr_b16 v[170:171], v79 offset:17408
  ds_read_b64_tr_b16 v[172:173], v79 offset:24576
  ds_read_b64_tr_b16 v[174:175], v79 offset:25600
  s_waitcnt vmcnt(24) lgkmcnt(0)
  s_barrier
  s_add_u32 m0, s60, 81920
  s_add_u32 s52, s61, 0x100000
  buffer_load_dwordx4 v56, s[20:23], s52 offen offset:0 lds
  s_add_u32 s52, s61, 0x103c00
  buffer_load_dwordx4 v56, s[20:23], s52 offen offset:1024 lds
  s_add_u32 s52, s61, 0x107800
  buffer_load_dwordx4 v57, s[20:23], s52 offen offset:2048 lds
  s_add_u32 s52, s61, 0x10b400
  buffer_load_dwordx4 v57, s[20:23], s52 offen offset:3072 lds
  ds_read_b64_tr_b16 v[176:177], v78 offset:32768
  ds_read_b64_tr_b16 v[178:179], v78 offset:33792
  ds_read_b64_tr_b16 v[180:181], v78 offset:40960
  ds_read_b64_tr_b16 v[182:183], v78 offset:41984
  ds_read_b64_tr_b16 v[184:185], v79 offset:32768
  ds_read_b64_tr_b16 v[186:187], v79 offset:33792
  ds_read_b64_tr_b16 v[188:189], v79 offset:40960
  ds_read_b64_tr_b16 v[190:191], v79 offset:41984
  s_waitcnt vmcnt(24) lgkmcnt(0)
  s_barrier
  s_add_u32 m0, s60, 98304
  s_add_u32 s52, s61, 0x180000
  buffer_load_dwordx4 v56, s[20:23], s52 offen offset:0 lds
  s_add_u32 s52, s61, 0x183c00
  buffer_load_dwordx4 v56, s[20:23], s52 offen offset:1024 lds
  s_add_u32 s52, s61, 0x187800
  buffer_load_dwordx4 v57, s[20:23], s52 offen offset:2048 lds
  s_add_u32 s52, s61, 0x18b400
  buffer_load_dwordx4 v57, s[20:23], s52 offen offset:3072 lds
  ds_read_b64_tr_b16 v[192:193], v78 offset:49152
  ds_read_b64_tr_b16 v[194:195], v78 offset:50176
  ds_read_b64_tr_b16 v[196:197], v78 offset:57344
  ds_read_b64_tr_b16 v[198:199], v78 offset:58368
  ds_read_b64_tr_b16 v[200:201], v79 offset:49152
  ds_read_b64_tr_b16 v[202:203], v79 offset:50176
  ds_read_b64_tr_b16 v[204:205], v79 offset:57344
  ds_read_b64_tr_b16 v[206:207], v79 offset:58368
  s_waitcnt vmcnt(24) lgkmcnt(0)
  s_barrier
  s_add_u32 m0, s60, 114688
  s_add_u32 s52, s61, 0x200000
  buffer_load_dwordx4 v56, s[20:23], s52 offen offset:0 lds
  s_add_u32 s52, s61, 0x203c00
  buffer_load_dwordx4 v56, s[20:23], s52 offen offset:1024 lds
  s_add_u32 s52, s61, 0x207800
  buffer_load_dwordx4 v57, s[20:23], s52 offen offset:2048 lds
  s_add_u32 s52, s61, 0x20b400
  buffer_load_dwordx4 v57, s[20:23], s52 offen offset:3072 lds
  ds_read_b64_tr_b16 v[208:209], v62 offset:0
  ds_read_b64_tr_b16 v[210:211], v62 offset:512
  ds_read_b64_tr_b16 v[212:213], v62 offset:4096
  ds_read_b64_tr_b16 v[214:215], v62 offset:4608
  ds_read_b64_tr_b16 v[216:217], v62 offset:8192
  ds_read_b64_tr_b16 v[218:219], v62 offset:8704
  ds_read_b64_tr_b16 v[220:221], v62 offset:12288
  ds_read_b64_tr_b16 v[222:223], v62 offset:12800
  s_waitcnt vmcnt(24) lgkmcnt(0)
  s_barrier
  s_add_u32 m0, s60, 0
  s_sub_u32 s52, 0x480000, s61
  buffer_load_dwordx4 v56, s[12:15], s52 offen offset:0 lds
  s_sub_u32 s52, 0x483c00, s61
  buffer_load_dwordx4 v56, s[12:15], s52 offen offset:1024 lds
  s_sub_u32 s52, 0x487800, s61
  buffer_load_dwordx4 v57, s[12:15], s52 offen offset:2048 lds
  s_sub_u32 s52, 0x48b400, s61
  buffer_load_dwordx4 v57, s[12:15], s52 offen offset:3072 lds
  ds_read_b64_tr_b16 v[224:225], v62 offset:16384
  ds_read_b64_tr_b16 v[226:227], v62 offset:16896
  ds_read_b64_tr_b16 v[228:229], v62 offset:20480
  ds_read_b64_tr_b16 v[230:231], v62 offset:20992
  ds_read_b64_tr_b16 v[232:233], v62 offset:24576
  ds_read_b64_tr_b16 v[234:235], v62 offset:25088
  ds_read_b64_tr_b16 v[236:237], v62 offset:28672
  ds_read_b64_tr_b16 v[238:239], v62 offset:29184
  s_waitcnt vmcnt(24) lgkmcnt(0)
  s_barrier
  s_add_u32 m0, s60, 16384
  s_mov_b32 s52, 0x180
  buffer_load_dwordx4 v58, s[92:95], s52 offen offset:0 lds
  s_mov_b32 s52, 0x1180
  buffer_load_dwordx4 v59, s[92:95], s52 offen offset:1024 lds
  s_mov_b32 s52, 0x4980
  buffer_load_dwordx4 v58, s[92:95], s52 offen offset:2048 lds
  s_mov_b32 s52, 0x5980
  buffer_load_dwordx4 v59, s[92:95], s52 offen offset:3072 lds
  ds_read_b64_tr_b16 v[240:241], v62 offset:32768
  ds_read_b64_tr_b16 v[242:243], v62 offset:33280
  ds_read_b64_tr_b16 v[244:245], v62 offset:36864
  ds_read_b64_tr_b16 v[246:247], v62 offset:37376
  ds_read_b64_tr_b16 v[248:249], v62 offset:40960
  ds_read_b64_tr_b16 v[250:251], v62 offset:41472
  ds_read_b64_tr_b16 v[252:253], v62 offset:45056
  ds_read_b64_tr_b16 v[254:255], v62 offset:45568
  s_waitcnt lgkmcnt(0)
  s_mov_b32 s12, s74
  s_and_b32 s13, s75, 0xffff
  s_mov_b32 s14, 0x2800
  s_mov_b32 s15, 0x20000
  v_bfe_u32 v66, v0, 3, 1
  v_and_b32 v67, 2, v0
  v_lshl_add_u32 v66, v66, 2, v67
  v_bfe_u32 v67, v0, 2, 1
  v_add_u32 v66, v66, v67
  v_mul_u32_u24 v66, 1280, v66
  v_lshrrev_b32 v67, 4, v0
  v_lshl_add_u32 v66, v67, 5, v66
  v_and_b32 v67, 1, v0
  v_lshl_add_u32 v66, v67, 4, v66
  s_add_u32 s52, s28, 0
  s_lshl_b32 s53, s52, 10
  s_add_u32 m0, s53, 0x0
  s_mul_i32 s53, s29, 5
  s_add_u32 s52, s52, s53
  s_sub_u32 s53, s52, 10
  s_cmp_ge_u32 s52, 10
  s_cselect_b32 s52, s53, s52
  s_lshl_b32 s52, s52, 7
  buffer_load_dwordx4 v66, s[12:15], s52 offen lds
  s_add_u32 s52, s28, 4
  s_lshl_b32 s53, s52, 10
  s_add_u32 m0, s53, 0x0
  s_mul_i32 s53, s29, 5
  s_add_u32 s52, s52, s53
  s_sub_u32 s53, s52, 10
  s_cmp_ge_u32 s52, 10
  s_cselect_b32 s52, s53, s52
  s_lshl_b32 s52, s52, 7
  buffer_load_dwordx4 v66, s[12:15], s52 offen lds
  s_add_u32 s52, s28, 8
  s_and_b32 s52, s52, 9
  s_lshl_b32 s53, s52, 10
  s_add_u32 m0, s53, 0x0
  s_mul_i32 s53, s29, 5
  s_add_u32 s52, s52, s53
  s_sub_u32 s53, s52, 10
  s_cmp_ge_u32 s52, 10
  s_cselect_b32 s52, s53, s52
  s_lshl_b32 s52, s52, 7
  buffer_load_dwordx4 v66, s[12:15], s52 offen lds
  s_waitcnt vmcnt(27)
  s_barrier
  s_add_u32 m0, s60, 32768
  s_mov_b32 s52, 0x200
  buffer_load_dwordx4 v58, s[92:95], s52 offen offset:0 lds
  s_mov_b32 s52, 0x1200
  buffer_load_dwordx4 v59, s[92:95], s52 offen offset:1024 lds
  s_mov_b32 s52, 0x4a00
  buffer_load_dwordx4 v58, s[92:95], s52 offen offset:2048 lds
  s_mov_b32 s52, 0x5a00
  buffer_load_dwordx4 v59, s[92:95], s52 offen offset:3072 lds
  ds_read_b64_tr_b16 v[16:17], v76 offset:49152
  ds_read_b64_tr_b16 v[18:19], v76 offset:50176
  ds_read_b64_tr_b16 v[20:21], v76 offset:57344
  ds_read_b64_tr_b16 v[22:23], v76 offset:58368
  ds_read_b64_tr_b16 v[24:25], v77 offset:49152
  ds_read_b64_tr_b16 v[26:27], v77 offset:50176
  ds_read_b64_tr_b16 v[28:29], v77 offset:57344
  ds_read_b64_tr_b16 v[30:31], v77 offset:58368
  s_waitcnt lgkmcnt(0)
  s_barrier
  ds_write_b128 v2, v[16:19] offset:49152
  ds_write_b128 v2, v[20:23] offset:50176
  ds_write_b128 v2, v[24:27] offset:51200
  ds_write_b128 v2, v[28:31] offset:52224
  s_waitcnt vmcnt(27)
  s_barrier
  ds_read_b64_tr_b16 v[16:17], v78 offset:0
  ds_read_b64_tr_b16 v[18:19], v78 offset:1024
  ds_read_b64_tr_b16 v[20:21], v78 offset:8192
  ds_read_b64_tr_b16 v[22:23], v78 offset:9216
  ds_read_b64_tr_b16 v[24:25], v79 offset:0
  ds_read_b64_tr_b16 v[26:27], v79 offset:1024
  ds_read_b64_tr_b16 v[28:29], v79 offset:8192
  ds_read_b64_tr_b16 v[30:31], v79 offset:9216
  s_waitcnt lgkmcnt(0)
  s_barrier
  ds_write_b128 v3, v[16:19] offset:0
  ds_write_b128 v3, v[20:23] offset:1024
  ds_write_b128 v3, v[24:27] offset:2048
  ds_write_b128 v3, v[28:31] offset:3072
  s_waitcnt vmcnt(23)
  s_barrier
  ds_read_b64_tr_b16 v[16:17], v78 offset:16384
  ds_read_b64_tr_b16 v[18:19], v78 offset:17408
  ds_read_b64_tr_b16 v[20:21], v78 offset:24576
  ds_read_b64_tr_b16 v[22:23], v78 offset:25600
  ds_read_b64_tr_b16 v[24:25], v79 offset:16384
  ds_read_b64_tr_b16 v[26:27], v79 offset:17408
  ds_read_b64_tr_b16 v[28:29], v79 offset:24576
  ds_read_b64_tr_b16 v[30:31], v79 offset:25600
  s_waitcnt lgkmcnt(0)
  s_barrier
  ds_write_b128 v3, v[16:19] offset:16384
  ds_write_b128 v3, v[20:23] offset:17408
  ds_write_b128 v3, v[24:27] offset:18432
  ds_write_b128 v3, v[28:31] offset:19456
  s_waitcnt vmcnt(19)
  s_barrier
  ds_read_b64_tr_b16 v[16:17], v78 offset:32768
  ds_read_b64_tr_b16 v[18:19], v78 offset:33792
  ds_read_b64_tr_b16 v[20:21], v78 offset:40960
  ds_read_b64_tr_b16 v[22:23], v78 offset:41984
  ds_read_b64_tr_b16 v[24:25], v79 offset:32768
  ds_read_b64_tr_b16 v[26:27], v79 offset:33792
  ds_read_b64_tr_b16 v[28:29], v79 offset:40960
  ds_read_b64_tr_b16 v[30:31], v79 offset:41984
  s_waitcnt lgkmcnt(0)
  s_barrier
  ds_write_b128 v3, v[16:19] offset:32768
  ds_write_b128 v3, v[20:23] offset:33792
  ds_write_b128 v3, v[24:27] offset:34816
  ds_write_b128 v3, v[28:31] offset:35840
  s_waitcnt vmcnt(15)
  s_barrier
  ds_read_b64_tr_b16 v[16:17], v78 offset:49152
  ds_read_b64_tr_b16 v[18:19], v78 offset:50176
  ds_read_b64_tr_b16 v[20:21], v78 offset:57344
  ds_read_b64_tr_b16 v[22:23], v78 offset:58368
  ds_read_b64_tr_b16 v[24:25], v79 offset:49152
  ds_read_b64_tr_b16 v[26:27], v79 offset:50176
  ds_read_b64_tr_b16 v[28:29], v79 offset:57344
  ds_read_b64_tr_b16 v[30:31], v79 offset:58368
  s_waitcnt lgkmcnt(0)
  s_barrier
  ds_write_b128 v3, v[16:19] offset:49152
  ds_write_b128 v3, v[20:23] offset:50176
  ds_write_b128 v3, v[24:27] offset:51200
  ds_write_b128 v3, v[28:31] offset:52224
  s_waitcnt vmcnt(11)
  s_barrier
  ds_read_b64_tr_b16 v[16:17], v60 offset:0
  ds_read_b64_tr_b16 v[18:19], v60 offset:1024
  ds_read_b64_tr_b16 v[20:21], v60 offset:8192
  ds_read_b64_tr_b16 v[22:23], v60 offset:9216
  ds_read_b64_tr_b16 v[24:25], v61 offset:0
  ds_read_b64_tr_b16 v[26:27], v61 offset:1024
  ds_read_b64_tr_b16 v[28:29], v61 offset:8192
  ds_read_b64_tr_b16 v[30:31], v61 offset:9216
  s_waitcnt lgkmcnt(0)
  s_barrier
  ds_write_b128 v2, v[16:19] offset:0
  ds_write_b128 v2, v[20:23] offset:1024
  ds_write_b128 v2, v[24:27] offset:2048
  ds_write_b128 v2, v[28:31] offset:3072
  v_lshlrev_b32 v66, 2, v0
  buffer_load_dword v66, v66, s[8:11], 0 offen sc1
  s_waitcnt vmcnt(8)
  s_barrier
  ds_read_b64_tr_b16 v[16:17], v62 offset:16384
  ds_read_b64_tr_b16 v[18:19], v62 offset:16896
  ds_read_b64_tr_b16 v[20:21], v62 offset:20480
  ds_read_b64_tr_b16 v[22:23], v62 offset:20992
  ds_read_b64_tr_b16 v[24:25], v62 offset:24576
  ds_read_b64_tr_b16 v[26:27], v62 offset:25088
  ds_read_b64_tr_b16 v[28:29], v62 offset:28672
  ds_read_b64_tr_b16 v[30:31], v62 offset:29184
  s_waitcnt lgkmcnt(0)
  s_barrier
  ds_write_b128 v2, v[16:19] offset:16384
  ds_write_b128 v2, v[20:23] offset:17408
  ds_write_b128 v2, v[24:27] offset:18432
  ds_write_b128 v2, v[28:31] offset:19456
  s_waitcnt vmcnt(0)
  s_barrier
  s_mov_b32 s51, 0
  s_branch L_start_70g
L_start_70:
  v_lshlrev_b32 v66, 2, v0
  buffer_load_dword v66, v66, s[8:11], 0 offen sc1
  s_add_u32 s51, s51, 1
  s_cmp_gt_u32 s51, 131072
  s_cbranch_scc1 L_end
  s_waitcnt vmcnt(0)
L_start_70g:
  s_mov_b32 s55, s51
  s_mov_b32 s51, 0
L_vagain_72:
  v_cmp_eq_u32 vcc, -1, v66
  s_and_b32 s52, vcc_lo, 0xaaaa
  s_cmp_eq_u32 s52, 0xaaaa
  s_cbranch_scc1 L_vok_71
  s_mov_b32 s52, 0
  v_readlane_b32 s53, v66, 0
  s_nop 0
  s_add_u32 s52, s52, s53
  v_readlane_b32 s53, v66, 2
  s_nop 0
  s_add_u32 s52, s52, s53
  v_readlane_b32 s53, v66, 4
  s_nop 0
  s_add_u32 s52, s52, s53
  v_readlane_b32 s53, v66, 6
  s_nop 0
  s_add_u32 s52, s52, s53
  v_readlane_b32 s53, v66, 8
  s_nop 0
  s_add_u32 s52, s52, s53
  v_readlane_b32 s53, v66, 10
  s_nop 0
  s_add_u32 s52, s52, s53
  v_readlane_b32 s53, v66, 12
  s_nop 0
  s_add_u32 s52, s52, s53
  v_readlane_b32 s53, v66, 14
  s_nop 0
  s_add_u32 s52, s52, s53
  s_cmp_lt_u32 s52, 256
  s_cbranch_scc1 L_vagain_72w
  s_cmp_lg_u32 s31, 0
  s_cbranch_scc1 L_vok_71
  s_branch L_fallback
L_vagain_72w:
  s_add_u32 s51, s51, 1
  s_cmp_gt_u32 s51, 131072
  s_cbranch_scc1 L_end
  v_lshlrev_b32 v66, 2, v0
  buffer_load_dword v66, v66, s[8:11], 0 offen sc1
  s_waitcnt vmcnt(0)
  s_branch L_vagain_72
L_vok_71:
  s_mov_b32 s51, s55
  v_readlane_b32 s53, v66, 17
  s_nop 0
  s_cmp_eq_u32 s53, 0
  s_cbranch_scc1 L_start_70
  v_readlane_b32 s54, v66, 32
  s_nop 0
  s_cmp_lg_u32 s54, 0x20202020
  s_cbranch_scc1 L_start_70
  s_and_b32 s53, s53, 1
  s_lshl_b32 s53, s53, 13
  s_add_u32 s36, s36, s53
  s_add_u32 s34, s34, s53
  s_sub_u32 m0, s46, 8192
  s_nop 0
  buffer_load_dwordx4 v1, s[4:7], s45 offen offset:0 sc1 lds
  buffer_load_dwordx4 v1, s[4:7], s45 offen offset:1024 sc1 lds
  s_add_u32 s45, s45, 0x80000
  ds_read_b64_tr_b16 v[16:17], v62 offset:32768
  ds_read_b64_tr_b16 v[18:19], v62 offset:33280
  ds_read_b64_tr_b16 v[20:21], v62 offset:36864
  ds_read_b64_tr_b16 v[22:23], v62 offset:37376
  ds_read_b64_tr_b16 v[24:25], v62 offset:40960
  ds_read_b64_tr_b16 v[26:27], v62 offset:41472
  ds_read_b64_tr_b16 v[28:29], v62 offset:45056
  ds_read_b64_tr_b16 v[30:31], v62 offset:45568
  s_waitcnt lgkmcnt(0)
  s_barrier
  ds_write_b128 v2, v[16:19] offset:32768
  ds_write_b128 v2, v[20:23] offset:33792
  ds_write_b128 v2, v[24:27] offset:34816
  ds_write_b128 v2, v[28:31] offset:35840
  s_mov_b32 s19, 0x436b430f
  s_mov_b32 s21, 0xf0000000
  s_cmp_eq_u32 s28, 3
  s_cselect_b32 s20, s48, s21
  s_mov_b32 s62, s20
  s_mov_b32 s22, 0x3f803f80
  s_mov_b32 s23, 0x3f803f80
  s_waitcnt vmcnt(0)
  s_cmp_lg_u32 s31, 0
  s_cbranch_scc1 L_loopsafe_74
L_loopfast_73:
  v_mov_b64 v[16:17], 0
  v_mov_b64 v[18:19], 0
  v_mov_b64 v[20:21], 0
  v_mov_b64 v[22:23], 0
  v_mov_b64 v[24:25], 0
  v_mov_b64 v[26:27], 0
  v_mov_b64 v[28:29], 0
  v_mov_b64 v[30:31], 0
  v_mov_b64 v[32:33], 0
  v_mov_b64 v[34:35], 0
  v_mov_b64 v[36:37], 0
  v_mov_b64 v[38:39], 0
  s_and_b32 s52, s32, 15
  s_or_b32 s52, s52, s57
  s_add_u32 s97, s32, 516
  s_lshr_b32 s97, s97, 2
  s_cmp_eq_u32 s52, 12
  s_cselect_b32 s97, s97, 0
  s_cmp_lt_u32 s32, 48
  s_cselect_b32 s97, s97, 0
  ds_read_b128 v[40:43], v2 offset:49152
  ds_read_b128 v[44:47], v2 offset:50176
  ds_read_b128 v[48:51], v2 offset:51200
  ds_read_b128 v[52:55], v2 offset:52224
  s_barrier
  ds_read_b128 v[68:71], v11 offset:5120
  ds_read_b32 v76, v9 offset:5120
  s_branch L_b1_76
.p2align 8
L_loopfast_73_top:
  s_nop 15
  s_nop 15
  s_nop 15
  s_nop 1
  buffer_load_dwordx4 v[72:75], v11, s[4:7], s33 offen sc1
  buffer_load_dword v77, v9, s[4:7], s33 offen sc1
  s_nop 14
  buffer_load_dwordx4 v[68:71], v11, s[4:7], s33 offen sc1
  buffer_load_dword v78, v9, s[4:7], s33 offen sc1
  s_waitcnt vmcnt(11)
  ds_read_b128 v[40:43], v2 offset:49152
  ds_read_b128 v[44:47], v2 offset:50176
  ds_read_b128 v[48:51], v2 offset:51200
  ds_read_b128 v[52:55], v2 offset:52224
  s_cmp_lg_u32 s29, 0
  s_cbranch_scc1 L_stage_79
  s_lshl_b32 s52, s28, 6
  v_bfe_u32 v14, v0, 1, 3
  v_mul_u32_u24 v14, 288, v14
  v_lshrrev_b32 v15, 4, v0
  v_lshl_add_u32 v14, v15, 4, v14
  v_and_b32 v15, 1, v0
  v_lshl_add_u32 v14, v15, 3, v14
  v_add_u32 v14, s52, v14
  ds_read_b64 v[14:15], v14 offset:10240
L_stage_79:
  s_cmp_lt_u32 s32, 62
  s_cbranch_scc1 L_flush_80
  v_lshrrev_b32 v79, 1, v1
  s_waitcnt lgkmcnt(0)
  buffer_store_dwordx2 v[14:15], v79, s[4:7], s47 offen sc1
L_flush_80:
  s_mov_b32 s51, 0
L_gag_77:
  s_waitcnt vmcnt(2)
  ds_write_b128 v11, v[72:75] offset:0
  ds_write_b32 v9, v77 offset:0
  v_max3_u32 v79, v72, v73, v74
  v_max3_u32 v79, v79, v75, v77
  v_cmp_eq_u32 vcc, -1, v79
  s_nop 0
  s_cbranch_vccnz L_gag_77b
L_got_78:
  buffer_load_dwordx4 v[68:71], v11, s[4:7], s34 offen sc1
  buffer_load_dword v76, v9, s[4:7], s34 offen sc1
L_b1_76:
  s_waitcnt lgkmcnt(0)
  s_barrier
  ds_read_b128 v[56:59], v10 offset:0
  ds_read_b128 v[60:63], v10 offset:1024
  ds_read_b128 v[64:67], v10 offset:2048
  s_mov_b32 m0, s46
  s_nop 0
  buffer_load_dwordx4 v1, s[4:7], s44 offen offset:0 sc1 lds
  buffer_load_dwordx4 v1, s[4:7], s44 offen offset:1024 sc1 lds
  s_cmp_ge_u32 s32, 62
  s_cbranch_scc1 L_nlast_81
L_nlast_81b:
  s_waitcnt lgkmcnt(2)
  v_smfmac_f32_16x16x64_bf16 v[32:35], v[56:59], v[40:47], v4
  ds_read_b128 v[40:43], v3 offset:0
  ds_read_b128 v[44:47], v3 offset:1024
  v_smfmac_f32_16x16x64_bf16 v[16:19], v[56:59], a[0:7], v4
  v_smfmac_f32_16x16x64_bf16 v[20:23], v[56:59], a[8:15], v4
  v_smfmac_f32_16x16x64_bf16 v[36:39], v[56:59], v[48:55], v4
  ds_read_b128 v[48:51], v3 offset:2048
  ds_read_b128 v[52:55], v3 offset:3072
  v_smfmac_f32_16x16x64_bf16 v[24:27], v[56:59], a[144:151], v4
  v_smfmac_f32_16x16x64_bf16 v[28:31], v[56:59], a[152:159], v4
  ds_read_b128 v[56:59], v10 offset:3072
  s_waitcnt lgkmcnt(3)
  v_smfmac_f32_16x16x64_bf16 v[32:35], v[60:63], v[40:47], v4
  ds_read_b128 v[40:43], v3 offset:16384
  ds_read_b128 v[44:47], v3 offset:17408
  v_smfmac_f32_16x16x64_bf16 v[16:19], v[60:63], a[16:23], v4
  v_smfmac_f32_16x16x64_bf16 v[20:23], v[60:63], a[24:31], v4
  s_waitcnt lgkmcnt(3)
  v_smfmac_f32_16x16x64_bf16 v[36:39], v[60:63], v[48:55], v4
  ds_read_b128 v[48:51], v3 offset:18432
  ds_read_b128 v[52:55], v3 offset:19456
  v_smfmac_f32_16x16x64_bf16 v[24:27], v[60:63], a[160:167], v4
  v_smfmac_f32_16x16x64_bf16 v[28:31], v[60:63], a[168:175], v4
  ds_read_b128 v[60:63], v10 offset:4096
  s_waitcnt lgkmcnt(3)
  v_smfmac_f32_16x16x64_bf16 v[32:35], v[64:67], v[40:47], v4
  ds_read_b128 v[40:43], v3 offset:32768
  ds_read_b128 v[44:47], v3 offset:33792
  v_smfmac_f32_16x16x64_bf16 v[16:19], v[64:67], a[32:39], v4
  v_smfmac_f32_16x16x64_bf16 v[20:23], v[64:67], a[40:47], v4
  s_waitcnt lgkmcnt(3)
  v_smfmac_f32_16x16x64_bf16 v[36:39], v[64:67], v[48:55], v4
  ds_read_b128 v[48:51], v3 offset:34816
  ds_read_b128 v[52:55], v3 offset:35840
  v_smfmac_f32_16x16x64_bf16 v[24:27], v[64:67], a[176:183], v4
  v_smfmac_f32_16x16x64_bf16 v[28:31], v[64:67], a[184:191], v4
  s_waitcnt lgkmcnt(2)
  v_smfmac_f32_16x16x64_bf16 v[32:35], v[56:59], v[40:47], v4
  ds_read_b128 v[40:43], v3 offset:49152
  ds_read_b128 v[44:47], v3 offset:50176
  v_smfmac_f32_16x16x64_bf16 v[16:19], v[56:59], a[48:55], v4
  v_smfmac_f32_16x16x64_bf16 v[20:23], v[56:59], a[56:63], v4
  s_waitcnt lgkmcnt(2)
  v_smfmac_f32_16x16x64_bf16 v[36:39], v[56:59], v[48:55], v4
  ds_read_b128 v[48:51], v3 offset:51200
  ds_read_b128 v[52:55], v3 offset:52224
  v_smfmac_f32_16x16x64_bf16 v[24:27], v[56:59], a[192:199], v4
  s_waitcnt vmcnt(2)
  v_max3_u32 v79, v68, v69, v70
  v_max3_u32 v79, v79, v71, v76
  v_smfmac_f32_16x16x64_bf16 v[28:31], v[56:59], a[200:207], v4
  v_cmp_eq_u32 vcc, -1, v79
  s_waitcnt lgkmcnt(2)
  v_smfmac_f32_16x16x64_bf16 v[32:35], v[60:63], v[40:47], v4
  ds_read_b128 v[40:43], v2 offset:0
  ds_read_b128 v[44:47], v2 offset:1024
  s_cbranch_vccnz L_late_85
  ds_write_b128 v11, v[68:71] offset:5120
  ds_write_b32 v9, v76 offset:5120
  v_smfmac_f32_16x16x64_bf16 v[16:19], v[60:63], a[64:71], v4
  v_smfmac_f32_16x16x64_bf16 v[20:23], v[60:63], a[72:79], v4
  s_waitcnt lgkmcnt(4)
  v_smfmac_f32_16x16x64_bf16 v[36:39], v[60:63], v[48:55], v4
  ds_read_b128 v[48:51], v2 offset:2048
  ds_read_b128 v[52:55], v2 offset:3072
  v_smfmac_f32_16x16x64_bf16 v[24:27], v[60:63], a[208:215], v4
  v_smfmac_f32_16x16x64_bf16 v[28:31], v[60:63], a[216:223], v4
L_rok_83:
  v_lshrrev_b32 v77, 1, v1
  s_waitcnt lgkmcnt(0)
  s_barrier
  ds_read_b128 v[64:67], v10 offset:5120
  ds_read_b128 v[68:71], v10 offset:6144
  ds_read_b128 v[72:75], v10 offset:7168
  ds_read_b128 v[56:59], v10 offset:8192
  ds_read_b128 v[60:63], v10 offset:9216
  buffer_store_dwordx2 v[14:15], v77, s[4:7], s47 offen sc1
  s_mov_b32 m0, 0x3400
  s_sub_u32 s52, s32, 1
  s_max_i32 s52, s52, 0
  v_lshlrev_b32 v79, 3, v1
  s_waitcnt lgkmcnt(4)
  v_smfmac_f32_16x16x64_bf16 v[16:19], v[64:67], a[80:87], v4
  s_mov_b32 exec_hi, 0
  buffer_load_dword v79, s[4:7], s56 offen sc1 lds
  s_mov_b32 exec_hi, -1
  s_waitcnt lgkmcnt(3)
  v_smfmac_f32_16x16x64_bf16 v[16:19], v[68:71], a[96:103], v4
  s_waitcnt lgkmcnt(2)
  v_smfmac_f32_16x16x64_bf16 v[16:19], v[72:75], a[112:119], v4
  s_waitcnt lgkmcnt(1)
  v_smfmac_f32_16x16x64_bf16 v[16:19], v[56:59], a[128:135], v4
  v_smfmac_f32_16x16x64_bf16 v[20:23], v[64:67], a[88:95], v4
  v_smfmac_f32_16x16x64_bf16 v[20:23], v[68:71], a[104:111], v4
  ds_read_b128 v[76:79], v1 offset:16384
  s_waitcnt lgkmcnt(1)
  v_smfmac_f32_16x16x64_bf16 v[16:19], v[60:63], v[40:47], v4
  v_smfmac_f32_16x16x64_bf16 v[20:23], v[72:75], a[120:127], v4
  v_smfmac_f32_16x16x64_bf16 v[20:23], v[56:59], a[136:143], v4
  v_add_f32 v18, v16, v18
  v_smfmac_f32_16x16x64_bf16 v[20:23], v[60:63], v[48:55], v4
  v_add_f32 v19, v17, v19
  v_smfmac_f32_16x16x64_bf16 v[24:27], v[64:67], a[224:231], v4
  v_cvt_pk_bf16_f32 v16, v18, v19
  v_smfmac_f32_16x16x64_bf16 v[24:27], v[68:71], a[240:247], v4
  ds_write_b16 v5, v16 offset:0
  ds_write_b16_d16_hi v5, v16 offset:288
  v_smfmac_f32_16x16x64_bf16 v[24:27], v[72:75], v[80:87], v4
  v_add_f32 v22, v20, v22
  v_smfmac_f32_16x16x64_bf16 v[24:27], v[56:59], v[96:103], v4
  ds_read_b128 v[16:19], v1 offset:20480
  v_add_f32 v23, v21, v23
  v_smfmac_f32_16x16x64_bf16 v[24:27], v[60:63], v[112:119], v4
  v_cvt_pk_bf16_f32 v20, v22, v23
  v_smfmac_f32_16x16x64_bf16 v[28:31], v[64:67], a[232:239], v4
  ds_write_b16 v5, v20 offset:32
  ds_write_b16_d16_hi v5, v20 offset:320
  v_smfmac_f32_16x16x64_bf16 v[28:31], v[68:71], a[248:255], v4
  v_add_f32 v26, v24, v26
  v_smfmac_f32_16x16x64_bf16 v[28:31], v[72:75], v[88:95], v4
  ds_read_b128 v[20:23], v1 offset:17408
  v_add_f32 v27, v25, v27
  v_smfmac_f32_16x16x64_bf16 v[28:31], v[56:59], v[104:111], v4
  v_cvt_pk_bf16_f32 v24, v26, v27
  v_smfmac_f32_16x16x64_bf16 v[28:31], v[60:63], v[120:127], v4
  ds_write_b16 v5, v24 offset:10240
  ds_write_b16_d16_hi v5, v24 offset:10528
  v_smfmac_f32_16x16x64_bf16 v[32:35], v[64:67], v[128:135], v4
  v_smfmac_f32_16x16x64_bf16 v[36:39], v[64:67], v[136:143], v4
  v_add_f32 v30, v28, v30
  v_add_f32 v31, v29, v31
  v_cvt_pk_bf16_f32 v28, v30, v31
  v_smfmac_f32_16x16x64_bf16 v[32:35], v[68:71], v[144:151], v4
  ds_write_b16 v5, v28 offset:10272
  ds_write_b16_d16_hi v5, v28 offset:10560
  v_smfmac_f32_16x16x64_bf16 v[36:39], v[68:71], v[152:159], v4
  ds_read_b128 v[64:67], v1 offset:21504
  ds_read_b128 v[68:71], v1 offset:18432
  v_smfmac_f32_16x16x64_bf16 v[32:35], v[72:75], v[160:167], v4
  s_waitcnt vmcnt(2) lgkmcnt(2)
  s_barrier
  ds_read_b128 v[40:43], v6 offset:0
  v_smfmac_f32_16x16x64_bf16 v[36:39], v[72:75], v[168:175], v4
  ds_read_b128 v[44:47], v6 offset:64
  ds_read_b128 v[72:75], v1 offset:22528
  v_smfmac_f32_16x16x64_bf16 v[32:35], v[56:59], v[176:183], v4
  ds_read_b128 v[48:51], v6 offset:128
  v_mov_b32 v14, s52
  v_smfmac_f32_16x16x64_bf16 v[36:39], v[56:59], v[184:191], v4
  ds_read_b128 v[56:59], v1 offset:19456
  ds_read_b128 v[52:55], v6 offset:192
  s_cmp_lg_u32 s97, 0
  s_cbranch_scc1 L_ns_87
L_ns_87b:
  v_smfmac_f32_16x16x64_bf16 v[32:35], v[60:63], v[192:199], v4
  buffer_store_dword v14, off, s[4:7], s62 sc1
  v_smfmac_f32_16x16x64_bf16 v[36:39], v[60:63], v[200:207], v4
  ds_read_b128 v[60:63], v1 offset:23552
  s_waitcnt lgkmcnt(6)
  v_mfma_f32_16x16x32_bf16 v[24:27], v[76:79], v[40:43], 0
  v_mfma_f32_16x16x32_bf16 v[28:31], v[16:19], v[40:43], 0
  ds_read_b128 v[16:19], v6 offset:10240
  v_add_f32 v34, v32, v34
  s_waitcnt lgkmcnt(6)
  v_mfma_f32_16x16x32_bf16 v[24:27], v[20:23], v[44:47], v[24:27]
  ds_read_b128 v[20:23], v6 offset:10304
  v_add_f32 v35, v33, v35
  v_mfma_f32_16x16x32_bf16 v[28:31], v[64:67], v[44:47], v[28:31]
  ds_read_b128 v[64:67], v6 offset:10368
  v_add_f32 v38, v36, v38
  s_waitcnt lgkmcnt(6)
  v_mfma_f32_16x16x32_bf16 v[24:27], v[68:71], v[48:51], v[24:27]
  ds_read_b128 v[68:71], v6 offset:10432
  v_add_f32 v39, v37, v39
  v_mfma_f32_16x16x32_bf16 v[28:31], v[72:75], v[48:51], v[28:31]
  ds_read_b128 v[72:75], v11 offset:24576
  s_waitcnt lgkmcnt(6)
  v_mfma_f32_16x16x32_bf16 v[24:27], v[56:59], v[52:55], v[24:27]
  ds_read_b128 v[56:59], v11 offset:28672
  v_cvt_pk_bf16_f32 v15, v38, v39
  s_waitcnt lgkmcnt(6)
  v_mfma_f32_16x16x32_bf16 v[28:31], v[60:63], v[52:55], v[28:31]
  v_cvt_pk_bf16_f32 v14, v34, v35
  s_waitcnt lgkmcnt(5)
  v_mfma_f32_16x16x32_bf16 v[76:79], v[16:19], v[40:43], 0
  v_mov_b64 v[36:37], s[22:23]
  v_max3_f32 v32, |v24|, |v25|, |v26|
  s_waitcnt lgkmcnt(4)
  v_mfma_f32_16x16x32_bf16 v[76:79], v[20:23], v[44:47], v[76:79]
  v_max3_f32 v32, v32, |v27|, |v28|
  v_max3_f32 v32, v32, |v29|, |v30|
  s_waitcnt lgkmcnt(3)
  v_mfma_f32_16x16x32_bf16 v[76:79], v[64:67], v[48:51], v[76:79]
  v_mov_b64 v[38:39], s[22:23]
  v_mov_b32 v22, 0
  s_waitcnt lgkmcnt(2)
  v_mfma_f32_16x16x32_bf16 v[76:79], v[68:71], v[52:55], v[76:79]
  ds_read_b128 v[40:43], v2 offset:16384
  ds_read_b128 v[44:47], v2 offset:17408
  ds_read_b128 v[48:51], v2 offset:18432
  ds_read_b128 v[52:55], v2 offset:19456
  s_cmp_eq_u32 s32, 63
  s_cbranch_scc1 L_chainfin_75
  v_max_f32 v32, v32, |v31|
  v_mov_b32 v21, 0
  v_max3_f32 v32, v32, |v76|, |v77|
  v_cmp_nge_f32 vcc, s19, v32
  v_mul_f32 v24, s50, v24
  v_mul_f32 v25, s50, v25
  v_mul_f32 v26, s50, v26
  v_mul_f32 v27, s50, v27
  v_mul_f32 v28, s50, v28
  v_mul_f32 v29, s50, v29
  v_mul_f32 v30, s50, v30
  v_mul_f32 v31, s50, v31
  v_mul_f32 v76, s50, v76
  v_mul_f32 v77, s50, v77
  s_cbranch_vccnz L_big_88
L_big_88b:
  v_exp_f32 v24, v24
  v_exp_f32 v25, v25
  v_exp_f32 v26, v26
  v_exp_f32 v27, v27
  v_exp_f32 v28, v28
  v_exp_f32 v29, v29
  v_exp_f32 v30, v30
  v_exp_f32 v31, v31
  v_exp_f32 v76, v76
  v_cvt_pk_bf16_f32 v16, v24, v25
  v_cvt_pk_bf16_f32 v17, v26, v27
  v_cvt_pk_bf16_f32 v18, v28, v29
  v_cvt_pk_bf16_f32 v19, v30, v31
  v_exp_f32 v77, v77
  v_mov_b64 v[60:61], 0
  v_mfma_f32_16x16x32_bf16 v[24:27], v[36:39], v[16:19], 0
  v_cvt_pk_bf16_f32 v20, v76, v77
  s_waitcnt lgkmcnt(4)
  v_mfma_f32_16x16x32_bf16 v[28:31], v[72:75], v[16:19], 0
  v_cvt_pk_bf16_f32 v23, v76, v77
  v_mov_b64 v[62:63], 0
  v_mfma_f32_16x16x32_bf16 v[32:35], v[56:59], v[16:19], 0
  v_mov_b64 v[64:65], 0
  v_mov_b64 v[66:67], 0
  v_mfma_f32_16x16x16_bf16 v[24:27], v[36:37], v[20:21], v[24:27]
  v_mov_b64 v[68:69], 0
  v_mov_b64 v[70:71], 0
  v_mfma_f32_16x16x16_bf16 v[28:31], v[14:15], v[20:21], v[28:31]
  v_mov_b64 v[72:73], 0
  v_mov_b64 v[74:75], 0
  v_mfma_f32_16x16x16_bf16 v[32:35], v[14:15], v[22:23], v[32:35]
  v_mov_b64 v[56:57], 0
  v_mov_b64 v[58:59], 0
  v_rcp_f32 v24, v24
  s_mov_b64 exec, s[58:59]
  s_nop 3
  v_mov_b64 v[28:29], v[32:33]
  v_mov_b64 v[30:31], v[34:35]
  s_mov_b64 exec, -1
  v_pk_mul_f32 v[28:29], v[28:29], v[24:25] op_sel_hi:[1,0]
  v_pk_mul_f32 v[30:31], v[30:31], v[24:25] op_sel_hi:[1,0]
  v_cvt_pk_bf16_f32 v28, v28, v29
  v_cvt_pk_bf16_f32 v29, v30, v31
  ds_write_b64 v7, v[28:29]
  s_add_u32 s32, s32, 1
  s_add_u32 s34, s34, 0x4000
  s_add_u32 s47, s47, 0x20000
  s_add_u32 s44, s44, 0x80000
  s_add_u32 s56, s56, 0x80000
  s_xor_b32 s33, s33, 8192
  s_waitcnt lgkmcnt(0)
  s_barrier
  ds_read_b128 v[32:35], v1 offset:14336
  ds_read_b128 v[36:39], v1 offset:15360
  s_sub_u32 m0, s46, 8192
  s_waitcnt lgkmcnt(1)
  v_smfmac_f32_16x16x64_bf16 v[56:59], v[32:35], v[208:215], v4
  ds_read_b128 v[16:19], v2 offset:32768
  ds_read_b128 v[20:23], v2 offset:33792
  s_waitcnt lgkmcnt(2)
  v_smfmac_f32_16x16x64_bf16 v[56:59], v[36:39], v[216:223], v4
  ds_read_b128 v[24:27], v2 offset:34816
  ds_read_b128 v[28:31], v2 offset:35840
  v_smfmac_f32_16x16x64_bf16 v[60:63], v[32:35], v[224:231], v4
  buffer_load_dwordx4 v1, s[4:7], s45 offen offset:0 sc1 lds
  v_smfmac_f32_16x16x64_bf16 v[60:63], v[36:39], v[232:239], v4
  buffer_load_dwordx4 v1, s[4:7], s45 offen offset:1024 sc1 lds
  v_add_f32 v58, v56, v58
  v_add_f32 v59, v57, v59
  v_smfmac_f32_16x16x64_bf16 v[64:67], v[32:35], v[240:247], v4
  v_cvt_pk_bf16_f32 v56, v58, v59
  v_smfmac_f32_16x16x64_bf16 v[64:67], v[36:39], v[248:255], v4
  buffer_store_dword v56, v8, s[4:7], s37 offen
  v_add_f32 v62, v60, v62
  v_add_f32 v63, v61, v63
  v_smfmac_f32_16x16x64_bf16 v[68:71], v[32:35], v[40:47], v4
  v_cvt_pk_bf16_f32 v60, v62, v63
  v_smfmac_f32_16x16x64_bf16 v[68:71], v[36:39], v[48:55], v4
  buffer_store_dword v60, v8, s[4:7], s38 offen
  v_add_f32 v66, v64, v66
  v_add_f32 v67, v65, v67
  s_waitcnt lgkmcnt(2)
  v_smfmac_f32_16x16x64_bf16 v[72:75], v[32:35], v[16:23], v4
  v_cvt_pk_bf16_f32 v64, v66, v67
  s_waitcnt lgkmcnt(0)
  v_smfmac_f32_16x16x64_bf16 v[72:75], v[36:39], v[24:31], v4
  buffer_store_dword v64, v8, s[4:7], s39 offen
  s_add_u32 s45, s45, 0x80000
  v_add_f32 v70, v68, v70
  v_add_f32 v71, v69, v71
  v_cvt_pk_bf16_f32 v68, v70, v71
  s_nop 2
  v_add_f32 v74, v72, v74
  v_add_f32 v75, v73, v75
  v_cvt_pk_bf16_f32 v72, v74, v75
  buffer_store_dword v68, v8, s[4:7], s40 offen
  buffer_store_dword v72, v8, s[4:7], s41 offen
  s_xor_b32 s37, s37, 0x40000
  s_xor_b32 s38, s38, 0x40000
  s_xor_b32 s39, s39, 0x40000
  s_xor_b32 s40, s40, 0x40000
  s_xor_b32 s41, s41, 0x40000
  s_cmp_eq_u32 s49, 0
  s_cbranch_scc1 L_noown_89
  v_and_b32 v76, 3, v0
  v_bfe_u32 v77, v0, 2, 1
  v_lshlrev_b32 v77, 4, v77
  v_mov_b32 v78, 0x3f80
  v_lshlrev_b32 v77, v77, v78
  v_cmp_eq_u32 vcc, 0, v76
  s_nop 1
  v_cndmask_b32 v56, 0, v77, vcc
  v_cmp_eq_u32 vcc, 1, v76
  s_nop 1
  v_cndmask_b32 v57, 0, v77, vcc
  v_cmp_eq_u32 vcc, 2, v76
  s_nop 1
  v_cndmask_b32 v58, 0, v77, vcc
  v_cmp_eq_u32 vcc, 3, v76
  s_nop 1
  v_cndmask_b32 v59, 0, v77, vcc
  s_mov_b32 s51, 0
  s_nop 4
  buffer_load_dwordx4 v[60:63], v12, s[4:7], s42 offen offset:0 sc1
  buffer_load_dwordx4 v[64:67], v12, s[4:7], s42 offen offset:2048 sc1
  buffer_load_dwordx4 v[68:71], v12, s[4:7], s43 offen offset:0 sc1
  buffer_load_dwordx4 v[72:75], v12, s[4:7], s43 offen offset:2048 sc1
  v_mov_b64 v[16:17], 0
  v_mov_b64 v[18:19], 0
  v_mov_b64 v[20:21], 0
  v_mov_b64 v[22:23], 0
  v_mov_b64 v[24:25], 0
  v_mov_b64 v[26:27], 0
  v_mov_b64 v[28:29], 0
  v_mov_b64 v[30:31], 0
  v_mov_b64 v[32:33], 0
  v_mov_b64 v[34:35], 0
  v_mov_b64 v[36:37], 0
  v_mov_b64 v[38:39], 0
  s_and_b32 s52, s32, 15
  s_or_b32 s52, s52, s57
  s_add_u32 s97, s32, 516
  s_lshr_b32 s97, s97, 2
  s_cmp_eq_u32 s52, 12
  s_cselect_b32 s97, s97, 0
  s_cmp_lt_u32 s32, 48
  s_cselect_b32 s97, s97, 0
  buffer_load_dwordx4 v[40:43], v12, s[4:7], s42 offen offset:0 sc1
  buffer_load_dwordx4 v[44:47], v12, s[4:7], s42 offen offset:2048 sc1
  buffer_load_dwordx4 v[48:51], v12, s[4:7], s43 offen offset:0 sc1
  buffer_load_dwordx4 v[52:55], v12, s[4:7], s43 offen offset:2048 sc1
L_oag_90:
  s_waitcnt vmcnt(7)
  v_mfma_f32_16x16x32_bf16 v[76:79], v[56:59], v[60:63], 0
  v_max3_u32 v39, v60, v61, v62
  v_max_u32 v39, v39, v63
  s_waitcnt vmcnt(6)
  v_mfma_f32_16x16x32_bf16 v[76:79], v[56:59], v[64:67], v[76:79]
  v_max3_u32 v39, v39, v64, v65
  v_max3_u32 v39, v39, v66, v67
  s_waitcnt vmcnt(5)
  v_mfma_f32_16x16x32_bf16 v[76:79], v[56:59], v[68:71], v[76:79]
  v_max3_u32 v39, v39, v68, v69
  v_max3_u32 v39, v39, v70, v71
  s_waitcnt vmcnt(4)
  v_mfma_f32_16x16x32_bf16 v[76:79], v[56:59], v[72:75], v[76:79]
  v_max3_u32 v39, v39, v72, v73
  v_max3_u32 v39, v39, v74, v75
  v_cmp_eq_u32 vcc, -1, v39
  v_mov_b32 v39, 0
  s_nop 3
  v_add_f32_dpp v76, v76, v76 row_ror:8 row_mask:0xf bank_mask:0xf
  v_add_f32_dpp v77, v77, v77 row_ror:8 row_mask:0xf bank_mask:0xf
  v_add_f32_dpp v78, v78, v78 row_ror:8 row_mask:0xf bank_mask:0xf
  v_add_f32_dpp v79, v79, v79 row_ror:8 row_mask:0xf bank_mask:0xf
  v_cvt_pk_bf16_f32 v76, v76, v77
  v_cvt_pk_bf16_f32 v77, v78, v79
  s_cbranch_vccnz L_oag_90b
L_ook_91:
  s_mov_b64 exec, 0x00ff00ff
  buffer_store_dwordx2 v[76:77], v13, s[4:7], s35 offen
  s_barrier
  buffer_store_dwordx2 v[76:77], v13, s[4:7], s36 offen sc1
  s_mov_b64 exec, -1
  v_mov_b64 v[56:57], -1
  v_mov_b64 v[58:59], -1
  s_xor_b32 s35, s35, 8192
  s_mov_b64 exec, 0x00ff00ff
  buffer_store_dwordx2 v[56:57], v13, s[4:7], s35 offen
  s_mov_b64 exec, -1
  buffer_store_dwordx4 v[56:59], v12, s[4:7], s42 offen offset:0
  buffer_store_dwordx4 v[56:59], v12, s[4:7], s42 offen offset:2048
  buffer_store_dwordx4 v[56:59], v12, s[4:7], s43 offen offset:0
  buffer_store_dwordx4 v[56:59], v12, s[4:7], s43 offen offset:2048
  s_xor_b32 s42, s42, 0x40000
  s_xor_b32 s43, s43, 0x40000
  s_add_u32 s36, s36, 16384
  s_branch L_loopfast_73_top
L_noown_89:
  s_cmp_eq_u32 s97, 0
  s_cbranch_scc1 L_nochk_93
  v_mov_b32 v16, 0x3600
  s_waitcnt vmcnt(7)
  ds_read_b32 v16, v16
  s_mov_b32 s51, 0
  s_waitcnt lgkmcnt(0)
L_kvag_94:
  v_cmp_ne_u32 vcc, 0x20202020, v16
  s_nop 0
  s_cbranch_vccz L_nochk_93
  buffer_load_dword v16, off, s[8:11], s97 sc1
  s_add_u32 s51, s51, 1
  s_cmp_gt_u32 s51, 131072
  s_cbranch_scc1 L_end
  s_waitcnt vmcnt(0)
  s_branch L_kvag_94
L_nochk_93:
  v_mov_b64 v[16:17], 0
  v_mov_b64 v[18:19], 0
  v_mov_b64 v[20:21], 0
  v_mov_b64 v[22:23], 0
  v_mov_b64 v[24:25], 0
  v_mov_b64 v[26:27], 0
  v_mov_b64 v[28:29], 0
  v_mov_b64 v[30:31], 0
  v_mov_b64 v[32:33], 0
  v_mov_b64 v[34:35], 0
  v_mov_b64 v[36:37], 0
  v_mov_b64 v[38:39], 0
  s_and_b32 s52, s32, 15
  s_or_b32 s52, s52, s57
  s_add_u32 s97, s32, 516
  s_lshr_b32 s97, s97, 2
  s_cmp_eq_u32 s52, 12
  s_cselect_b32 s97, s97, 0
  s_cmp_lt_u32 s32, 48
  s_cselect_b32 s97, s97, 0
  s_barrier
  s_nop 15
  s_nop 8
  s_branch L_loopfast_73_top
L_gag_77b:
  buffer_load_dwordx4 v[72:75], v11, s[4:7], s33 offen sc1
  buffer_load_dword v77, v9, s[4:7], s33 offen sc1
  s_waitcnt vmcnt(2)
  ds_write_b128 v11, v[68:71] offset:0
  ds_write_b32 v9, v78 offset:0
  v_max3_u32 v79, v68, v69, v70
  v_max3_u32 v79, v79, v71, v78
  v_cmp_eq_u32 vcc, -1, v79
  s_nop 0
  s_cbranch_vccz L_got_78
  buffer_load_dwordx4 v[68:71], v11, s[4:7], s33 offen sc1
  buffer_load_dword v78, v9, s[4:7], s33 offen sc1
  s_add_u32 s51, s51, 1
  s_cmp_gt_u32 s51, 131072
  s_cbranch_scc1 L_end
  s_branch L_gag_77
L_nlast_81:
  v_mov_b32 v79, s32
  buffer_store_dword v79, off, s[4:7], s20 sc1
  s_mov_b32 s62, s21
  s_branch L_nlast_81b
L_ns_87:
  s_movk_i32 m0, 0x3600
  s_nop 0
  buffer_load_dword off, s[8:11], s97 sc1 lds
  s_branch L_ns_87b
L_big_88:
  v_max3_f32 v32, v24, v25, v26
  v_max3_f32 v32, v32, v27, v28
  v_max3_f32 v32, v32, v29, v30
  v_max3_f32 v32, v32, v31, v76
  v_max_f32 v32, v32, v77
  v_mov_b32 v33, v32
  s_nop 1
  v_permlane32_swap_b32 v32, v33
  v_max_f32 v32, v32, v33
  v_mov_b32 v33, v32
  s_nop 1
  v_permlane16_swap_b32 v32, v33
  v_max_f32 v32, v32, v33
  v_sub_f32 v24, v24, v32
  v_sub_f32 v25, v25, v32
  v_sub_f32 v26, v26, v32
  v_sub_f32 v27, v27, v32
  v_sub_f32 v28, v28, v32
  v_sub_f32 v29, v29, v32
  v_sub_f32 v30, v30, v32
  v_sub_f32 v31, v31, v32
  v_sub_f32 v76, v76, v32
  v_sub_f32 v77, v77, v32
  s_branch L_big_88b
L_oag_90b:
  buffer_load_dwordx4 v[60:63], v12, s[4:7], s42 offen offset:0 sc1
  buffer_load_dwordx4 v[64:67], v12, s[4:7], s42 offen offset:2048 sc1
  buffer_load_dwordx4 v[68:71], v12, s[4:7], s43 offen offset:0 sc1
  buffer_load_dwordx4 v[72:75], v12, s[4:7], s43 offen offset:2048 sc1
  s_waitcnt vmcnt(7)
  v_mfma_f32_16x16x32_bf16 v[76:79], v[56:59], v[40:43], 0
  v_max3_u32 v39, v40, v41, v42
  v_max_u32 v39, v39, v43
  s_waitcnt vmcnt(6)
  v_mfma_f32_16x16x32_bf16 v[76:79], v[56:59], v[44:47], v[76:79]
  v_max3_u32 v39, v39, v44, v45
  v_max3_u32 v39, v39, v46, v47
  s_waitcnt vmcnt(5)
  v_mfma_f32_16x16x32_bf16 v[76:79], v[56:59], v[48:51], v[76:79]
  v_max3_u32 v39, v39, v48, v49
  v_max3_u32 v39, v39, v50, v51
  s_waitcnt vmcnt(4)
  v_mfma_f32_16x16x32_bf16 v[76:79], v[56:59], v[52:55], v[76:79]
  v_max3_u32 v39, v39, v52, v53
  v_max3_u32 v39, v39, v54, v55
  v_cmp_eq_u32 vcc, -1, v39
  v_mov_b32 v39, 0
  s_nop 3
  v_add_f32_dpp v76, v76, v76 row_ror:8 row_mask:0xf bank_mask:0xf
  v_add_f32_dpp v77, v77, v77 row_ror:8 row_mask:0xf bank_mask:0xf
  v_add_f32_dpp v78, v78, v78 row_ror:8 row_mask:0xf bank_mask:0xf
  v_add_f32_dpp v79, v79, v79 row_ror:8 row_mask:0xf bank_mask:0xf
  v_cvt_pk_bf16_f32 v76, v76, v77
  v_cvt_pk_bf16_f32 v77, v78, v79
  s_cbranch_vccz L_ook_91
  buffer_load_dwordx4 v[40:43], v12, s[4:7], s42 offen offset:0 sc1
  buffer_load_dwordx4 v[44:47], v12, s[4:7], s42 offen offset:2048 sc1
  buffer_load_dwordx4 v[48:51], v12, s[4:7], s43 offen offset:0 sc1
  buffer_load_dwordx4 v[52:55], v12, s[4:7], s43 offen offset:2048 sc1
  s_add_u32 s51, s51, 1
  s_cmp_gt_u32 s51, 131072
  s_cbranch_scc1 L_end
  s_branch L_oag_90
L_late_85:
  s_waitcnt lgkmcnt(0)
  v_smfmac_f32_16x16x64_bf16 v[16:19], v[60:63], a[64:71], v4
  s_waitcnt lgkmcnt(0)
  v_smfmac_f32_16x16x64_bf16 v[20:23], v[60:63], a[72:79], v4
  s_waitcnt lgkmcnt(0)
  v_smfmac_f32_16x16x64_bf16 v[36:39], v[60:63], v[48:55], v4
  ds_read_b128 v[48:51], v2 offset:2048
  ds_read_b128 v[52:55], v2 offset:3072
  s_waitcnt lgkmcnt(0)
  v_smfmac_f32_16x16x64_bf16 v[24:27], v[60:63], a[208:215], v4
  s_waitcnt lgkmcnt(0)
  v_smfmac_f32_16x16x64_bf16 v[28:31], v[60:63], a[216:223], v4
  s_mov_b32 s51, 0
  s_add_u32 s52, s34, s96
  s_branch L_rag_84
L_watch_86:
  buffer_load_dword v79, off, s[4:7], s52 sc1
  s_add_u32 s51, s51, 1
  s_cmp_gt_u32 s51, 131072
  s_cbranch_scc1 L_end
  s_waitcnt vmcnt(0)
  v_cmp_eq_u32 vcc, -1, v79
  s_nop 0
  s_cbranch_vccnz L_watch_86
  s_nop 14
L_rag_84:
  buffer_load_dwordx4 v[68:71], v11, s[4:7], s34 offen sc1
  buffer_load_dword v76, v9, s[4:7], s34 offen sc1
  s_add_u32 s51, s51, 1
  s_cmp_gt_u32 s51, 131072
  s_cbranch_scc1 L_end
  s_waitcnt vmcnt(0)
  v_max3_u32 v79, v68, v69, v70
  v_max3_u32 v79, v79, v71, v76
  v_cmp_eq_u32 vcc, -1, v79
  s_nop 0
  s_cbranch_vccnz L_watch_86
  ds_write_b128 v11, v[68:71] offset:5120
  ds_write_b32 v9, v76 offset:5120
  s_branch L_rok_83
L_loopsafe_74:
  v_mov_b64 v[16:17], 0
  v_mov_b64 v[18:19], 0
  v_mov_b64 v[20:21], 0
  v_mov_b64 v[22:23], 0
  v_mov_b64 v[24:25], 0
  v_mov_b64 v[26:27], 0
  v_mov_b64 v[28:29], 0
  v_mov_b64 v[30:31], 0
  v_mov_b64 v[32:33], 0
  v_mov_b64 v[34:35], 0
  v_mov_b64 v[36:37], 0
  v_mov_b64 v[38:39], 0
  s_and_b32 s52, s32, 15
  s_or_b32 s52, s52, s57
  s_add_u32 s97, s32, 516
  s_lshr_b32 s97, s97, 2
  s_cmp_eq_u32 s52, 12
  s_cselect_b32 s97, s97, 0
  s_cmp_lt_u32 s32, 48
  s_cselect_b32 s97, s97, 0
  ds_read_b128 v[40:43], v2 offset:49152
  ds_read_b128 v[44:47], v2 offset:50176
  ds_read_b128 v[48:51], v2 offset:51200
  ds_read_b128 v[52:55], v2 offset:52224
  s_barrier
  ds_read_b128 v[68:71], v11 offset:5120
  ds_read_b32 v76, v9 offset:5120
  s_branch L_b1_95
.p2align 8
L_loopsafe_74_top:
  s_nop 15
  s_nop 15
  s_nop 15
  s_nop 1
  buffer_load_dwordx4 v[72:75], v11, s[4:7], s33 offen sc1
  buffer_load_dword v77, v9, s[4:7], s33 offen sc1
  s_nop 14
  buffer_load_dwordx4 v[68:71], v11, s[4:7], s33 offen sc1
  buffer_load_dword v78, v9, s[4:7], s33 offen sc1
  s_waitcnt vmcnt(11)
  ds_read_b128 v[40:43], v2 offset:49152
  ds_read_b128 v[44:47], v2 offset:50176
  ds_read_b128 v[48:51], v2 offset:51200
  ds_read_b128 v[52:55], v2 offset:52224
  s_cmp_lg_u32 s29, 0
  s_cbranch_scc1 L_stage_98
  s_lshl_b32 s52, s28, 6
  v_bfe_u32 v14, v0, 1, 3
  v_mul_u32_u24 v14, 288, v14
  v_lshrrev_b32 v15, 4, v0
  v_lshl_add_u32 v14, v15, 4, v14
  v_and_b32 v15, 1, v0
  v_lshl_add_u32 v14, v15, 3, v14
  v_add_u32 v14, s52, v14
  ds_read_b64 v[14:15], v14 offset:10240
L_stage_98:
  s_cmp_lt_u32 s32, 62
  s_cbranch_scc1 L_flush_99
  v_lshrrev_b32 v79, 1, v1
  s_waitcnt lgkmcnt(0)
  buffer_store_dwordx2 v[14:15], v79, s[4:7], s47 offen sc1
L_flush_99:
  s_mov_b32 s51, 0
L_gag_96:
  s_waitcnt vmcnt(2)
  ds_write_b128 v11, v[72:75] offset:0
  ds_write_b32 v9, v77 offset:0
  v_max3_u32 v79, v72, v73, v74
  v_max3_u32 v79, v79, v75, v77
  v_cmp_eq_u32 vcc, -1, v79
  s_nop 0
  s_cbranch_vccnz L_gag_96b
L_got_97:
  buffer_load_dwordx4 v[68:71], v11, s[4:7], s34 offen sc1
  buffer_load_dword v76, v9, s[4:7], s34 offen sc1
L_b1_95:
  s_waitcnt lgkmcnt(0)
  s_barrier
  ds_read_b128 v[56:59], v10 offset:0
  ds_read_b128 v[60:63], v10 offset:1024
  ds_read_b128 v[64:67], v10 offset:2048
  s_mov_b32 m0, s46
  s_nop 0
  buffer_load_dwordx4 v1, s[4:7], s44 offen offset:0 sc1 lds
  buffer_load_dwordx4 v1, s[4:7], s44 offen offset:1024 sc1 lds
  s_cmp_ge_u32 s32, 62
  s_cbranch_scc1 L_nlast_100
L_nlast_100b:
  s_waitcnt lgkmcnt(2)
  v_smfmac_f32_16x16x64_bf16 v[32:35], v[56:59], v[40:47], v4
  ds_read_b128 v[40:43], v3 offset:0
  ds_read_b128 v[44:47], v3 offset:1024
  v_smfmac_f32_16x16x64_bf16 v[16:19], v[56:59], a[0:7], v4
  v_smfmac_f32_16x16x64_bf16 v[20:23], v[56:59], a[8:15], v4
  v_smfmac_f32_16x16x64_bf16 v[36:39], v[56:59], v[48:55], v4
  ds_read_b128 v[48:51], v3 offset:2048
  ds_read_b128 v[52:55], v3 offset:3072
  v_smfmac_f32_16x16x64_bf16 v[24:27], v[56:59], a[144:151], v4
  v_smfmac_f32_16x16x64_bf16 v[28:31], v[56:59], a[152:159], v4
  ds_read_b128 v[56:59], v10 offset:3072
  s_waitcnt lgkmcnt(3)
  v_smfmac_f32_16x16x64_bf16 v[32:35], v[60:63], v[40:47], v4
  ds_read_b128 v[40:43], v3 offset:16384
  ds_read_b128 v[44:47], v3 offset:17408
  v_smfmac_f32_16x16x64_bf16 v[16:19], v[60:63], a[16:23], v4
  v_smfmac_f32_16x16x64_bf16 v[20:23], v[60:63], a[24:31], v4
  s_waitcnt lgkmcnt(3)
  v_smfmac_f32_16x16x64_bf16 v[36:39], v[60:63], v[48:55], v4
  ds_read_b128 v[48:51], v3 offset:18432
  ds_read_b128 v[52:55], v3 offset:19456
  v_smfmac_f32_16x16x64_bf16 v[24:27], v[60:63], a[160:167], v4
  v_smfmac_f32_16x16x64_bf16 v[28:31], v[60:63], a[168:175], v4
  ds_read_b128 v[60:63], v10 offset:4096
  s_waitcnt lgkmcnt(3)
  v_smfmac_f32_16x16x64_bf16 v[32:35], v[64:67], v[40:47], v4
  ds_read_b128 v[40:43], v3 offset:32768
  ds_read_b128 v[44:47], v3 offset:33792
  v_smfmac_f32_16x16x64_bf16 v[16:19], v[64:67], a[32:39], v4
  v_smfmac_f32_16x16x64_bf16 v[20:23], v[64:67], a[40:47], v4
  s_waitcnt lgkmcnt(3)
  v_smfmac_f32_16x16x64_bf16 v[36:39], v[64:67], v[48:55], v4
  ds_read_b128 v[48:51], v3 offset:34816
  ds_read_b128 v[52:55], v3 offset:35840
  v_smfmac_f32_16x16x64_bf16 v[24:27], v[64:67], a[176:183], v4
  v_smfmac_f32_16x16x64_bf16 v[28:31], v[64:67], a[184:191], v4
  s_waitcnt lgkmcnt(2)
  v_smfmac_f32_16x16x64_bf16 v[32:35], v[56:59], v[40:47], v4
  ds_read_b128 v[40:43], v3 offset:49152
  ds_read_b128 v[44:47], v3 offset:50176
  v_smfmac_f32_16x16x64_bf16 v[16:19], v[56:59], a[48:55], v4
  v_smfmac_f32_16x16x64_bf16 v[20:23], v[56:59], a[56:63], v4
  s_waitcnt lgkmcnt(2)
  v_smfmac_f32_16x16x64_bf16 v[36:39], v[56:59], v[48:55], v4
  ds_read_b128 v[48:51], v3 offset:51200
  ds_read_b128 v[52:55], v3 offset:52224
  v_smfmac_f32_16x16x64_bf16 v[24:27], v[56:59], a[192:199], v4
  s_waitcnt vmcnt(2)
  v_max3_u32 v79, v68, v69, v70
  v_max3_u32 v79, v79, v71, v76
  v_smfmac_f32_16x16x64_bf16 v[28:31], v[56:59], a[200:207], v4
  v_cmp_eq_u32 vcc, -1, v79
  s_waitcnt lgkmcnt(2)
  v_smfmac_f32_16x16x64_bf16 v[32:35], v[60:63], v[40:47], v4
  ds_read_b128 v[40:43], v2 offset:0
  ds_read_b128 v[44:47], v2 offset:1024
  s_cbranch_vccnz L_late_104
  ds_write_b128 v11, v[68:71] offset:5120
  ds_write_b32 v9, v76 offset:5120
  v_smfmac_f32_16x16x64_bf16 v[16:19], v[60:63], a[64:71], v4
  v_smfmac_f32_16x16x64_bf16 v[20:23], v[60:63], a[72:79], v4
  s_waitcnt lgkmcnt(4)
  v_smfmac_f32_16x16x64_bf16 v[36:39], v[60:63], v[48:55], v4
  ds_read_b128 v[48:51], v2 offset:2048
  ds_read_b128 v[52:55], v2 offset:3072
  v_smfmac_f32_16x16x64_bf16 v[24:27], v[60:63], a[208:215], v4
  v_smfmac_f32_16x16x64_bf16 v[28:31], v[60:63], a[216:223], v4
L_rok_102:
  v_lshrrev_b32 v77, 1, v1
  s_waitcnt lgkmcnt(0)
  s_barrier
  ds_read_b128 v[64:67], v10 offset:5120
  ds_read_b128 v[68:71], v10 offset:6144
  ds_read_b128 v[72:75], v10 offset:7168
  ds_read_b128 v[56:59], v10 offset:8192
  ds_read_b128 v[60:63], v10 offset:9216
  buffer_store_dwordx2 v[14:15], v77, s[4:7], s47 offen sc1
  s_mov_b32 m0, 0x3400
  s_sub_u32 s52, s32, 1
  s_max_i32 s52, s52, 0
  v_lshlrev_b32 v79, 3, v1
  s_waitcnt lgkmcnt(4)
  v_smfmac_f32_16x16x64_bf16 v[16:19], v[64:67], a[80:87], v4
  s_mov_b32 exec_hi, 0
  buffer_load_dword v79, s[4:7], s56 offen sc1 lds
  s_mov_b32 exec_hi, -1
  s_waitcnt lgkmcnt(3)
  v_smfmac_f32_16x16x64_bf16 v[16:19], v[68:71], a[96:103], v4
  s_waitcnt lgkmcnt(2)
  v_smfmac_f32_16x16x64_bf16 v[16:19], v[72:75], a[112:119], v4
  s_waitcnt lgkmcnt(1)
  v_smfmac_f32_16x16x64_bf16 v[16:19], v[56:59], a[128:135], v4
  v_smfmac_f32_16x16x64_bf16 v[20:23], v[64:67], a[88:95], v4
  v_smfmac_f32_16x16x64_bf16 v[20:23], v[68:71], a[104:111], v4
  ds_read_b128 v[76:79], v1 offset:16384
  s_waitcnt lgkmcnt(1)
  v_smfmac_f32_16x16x64_bf16 v[16:19], v[60:63], v[40:47], v4
  v_smfmac_f32_16x16x64_bf16 v[20:23], v[72:75], a[120:127], v4
  v_smfmac_f32_16x16x64_bf16 v[20:23], v[56:59], a[136:143], v4
  v_add_f32 v18, v16, v18
  v_smfmac_f32_16x16x64_bf16 v[20:23], v[60:63], v[48:55], v4
  v_add_f32 v19, v17, v19
  v_smfmac_f32_16x16x64_bf16 v[24:27], v[64:67], a[224:231], v4
  v_cvt_pk_bf16_f32 v16, v18, v19
  v_smfmac_f32_16x16x64_bf16 v[24:27], v[68:71], a[240:247], v4
  ds_write_b16 v5, v16 offset:0
  ds_write_b16_d16_hi v5, v16 offset:288
  v_smfmac_f32_16x16x64_bf16 v[24:27], v[72:75], v[80:87], v4
  v_add_f32 v22, v20, v22
  v_smfmac_f32_16x16x64_bf16 v[24:27], v[56:59], v[96:103], v4
  ds_read_b128 v[16:19], v1 offset:20480
  v_add_f32 v23, v21, v23
  v_smfmac_f32_16x16x64_bf16 v[24:27], v[60:63], v[112:119], v4
  v_cvt_pk_bf16_f32 v20, v22, v23
  v_smfmac_f32_16x16x64_bf16 v[28:31], v[64:67], a[232:239], v4
  ds_write_b16 v5, v20 offset:32
  ds_write_b16_d16_hi v5, v20 offset:320
  v_smfmac_f32_16x16x64_bf16 v[28:31], v[68:71], a[248:255], v4
  v_add_f32 v26, v24, v26
  v_smfmac_f32_16x16x64_bf16 v[28:31], v[72:75], v[88:95], v4
  ds_read_b128 v[20:23], v1 offset:17408
  v_add_f32 v27, v25, v27
  v_smfmac_f32_16x16x64_bf16 v[28:31], v[56:59], v[104:111], v4
  v_cvt_pk_bf16_f32 v24, v26, v27
  v_smfmac_f32_16x16x64_bf16 v[28:31], v[60:63], v[120:127], v4
  ds_write_b16 v5, v24 offset:10240
  ds_write_b16_d16_hi v5, v24 offset:10528
  v_smfmac_f32_16x16x64_bf16 v[32:35], v[64:67], v[128:135], v4
  v_smfmac_f32_16x16x64_bf16 v[36:39], v[64:67], v[136:143], v4
  v_add_f32 v30, v28, v30
  v_add_f32 v31, v29, v31
  v_cvt_pk_bf16_f32 v28, v30, v31
  v_smfmac_f32_16x16x64_bf16 v[32:35], v[68:71], v[144:151], v4
  ds_write_b16 v5, v28 offset:10272
  ds_write_b16_d16_hi v5, v28 offset:10560
  v_smfmac_f32_16x16x64_bf16 v[36:39], v[68:71], v[152:159], v4
  ds_read_b128 v[64:67], v1 offset:21504
  ds_read_b128 v[68:71], v1 offset:18432
  v_smfmac_f32_16x16x64_bf16 v[32:35], v[72:75], v[160:167], v4
  s_waitcnt vmcnt(2) lgkmcnt(2)
  s_barrier
  ds_read_b128 v[40:43], v6 offset:0
  v_smfmac_f32_16x16x64_bf16 v[36:39], v[72:75], v[168:175], v4
  ds_read_b128 v[44:47], v6 offset:64
  ds_read_b128 v[72:75], v1 offset:22528
  v_smfmac_f32_16x16x64_bf16 v[32:35], v[56:59], v[176:183], v4
  ds_read_b128 v[48:51], v6 offset:128
  v_mov_b32 v14, s52
  v_smfmac_f32_16x16x64_bf16 v[36:39], v[56:59], v[184:191], v4
  ds_read_b128 v[56:59], v1 offset:19456
  ds_read_b128 v[52:55], v6 offset:192
  s_cmp_lg_u32 s97, 0
  s_cbranch_scc1 L_ns_106
L_ns_106b:
  v_smfmac_f32_16x16x64_bf16 v[32:35], v[60:63], v[192:199], v4
  buffer_store_dword v14, off, s[4:7], s62 sc1
  v_smfmac_f32_16x16x64_bf16 v[36:39], v[60:63], v[200:207], v4
  ds_read_b128 v[60:63], v1 offset:23552
  s_waitcnt lgkmcnt(6)
  v_mfma_f32_16x16x32_bf16 v[24:27], v[76:79], v[40:43], 0
  v_mfma_f32_16x16x32_bf16 v[28:31], v[16:19], v[40:43], 0
  ds_read_b128 v[16:19], v6 offset:10240
  v_add_f32 v34, v32, v34
  s_waitcnt lgkmcnt(6)
  v_mfma_f32_16x16x32_bf16 v[24:27], v[20:23], v[44:47], v[24:27]
  ds_read_b128 v[20:23], v6 offset:10304
  v_add_f32 v35, v33, v35
  v_mfma_f32_16x16x32_bf16 v[28:31], v[64:67], v[44:47], v[28:31]
  ds_read_b128 v[64:67], v6 offset:10368
  v_add_f32 v38, v36, v38
  s_waitcnt lgkmcnt(6)
  v_mfma_f32_16x16x32_bf16 v[24:27], v[68:71], v[48:51], v[24:27]
  ds_read_b128 v[68:71], v6 offset:10432
  v_add_f32 v39, v37, v39
  v_mfma_f32_16x16x32_bf16 v[28:31], v[72:75], v[48:51], v[28:31]
  ds_read_b128 v[72:75], v11 offset:24576
  s_waitcnt lgkmcnt(6)
  v_mfma_f32_16x16x32_bf16 v[24:27], v[56:59], v[52:55], v[24:27]
  ds_read_b128 v[56:59], v11 offset:28672
  v_cvt_pk_bf16_f32 v15, v38, v39
  s_waitcnt lgkmcnt(6)
  v_mfma_f32_16x16x32_bf16 v[28:31], v[60:63], v[52:55], v[28:31]
  v_cvt_pk_bf16_f32 v14, v34, v35
  s_waitcnt lgkmcnt(5)
  v_mfma_f32_16x16x32_bf16 v[76:79], v[16:19], v[40:43], 0
  v_mov_b64 v[36:37], s[22:23]
  v_max3_f32 v32, |v24|, |v25|, |v26|
  s_waitcnt lgkmcnt(4)
  v_mfma_f32_16x16x32_bf16 v[76:79], v[20:23], v[44:47], v[76:79]
  v_max3_f32 v32, v32, |v27|, |v28|
  v_max3_f32 v32, v32, |v29|, |v30|
  s_waitcnt lgkmcnt(3)
  v_mfma_f32_16x16x32_bf16 v[76:79], v[64:67], v[48:51], v[76:79]
  v_mov_b64 v[38:39], s[22:23]
  v_mov_b32 v22, 0
  s_waitcnt lgkmcnt(2)
  v_mfma_f32_16x16x32_bf16 v[76:79], v[68:71], v[52:55], v[76:79]
  ds_read_b128 v[40:43], v2 offset:16384
  ds_read_b128 v[44:47], v2 offset:17408
  ds_read_b128 v[48:51], v2 offset:18432
  ds_read_b128 v[52:55], v2 offset:19456
  s_cmp_eq_u32 s32, 63
  s_cbranch_scc1 L_chainfin_75
  v_max_f32 v32, v32, |v31|
  v_mov_b32 v21, 0
  v_max3_f32 v32, v32, |v76|, |v77|
  v_cmp_nge_f32 vcc, s19, v32
  v_mul_f32 v24, s50, v24
  v_mul_f32 v25, s50, v25
  v_mul_f32 v26, s50, v26
  v_mul_f32 v27, s50, v27
  v_mul_f32 v28, s50, v28
  v_mul_f32 v29, s50, v29
  v_mul_f32 v30, s50, v30
  v_mul_f32 v31, s50, v31
  v_mul_f32 v76, s50, v76
  v_mul_f32 v77, s50, v77
  s_cbranch_vccnz L_big_107
L_big_107b:
  v_exp_f32 v24, v24
  v_exp_f32 v25, v25
  v_exp_f32 v26, v26
  v_exp_f32 v27, v27
  v_exp_f32 v28, v28
  v_exp_f32 v29, v29
  v_exp_f32 v30, v30
  v_exp_f32 v31, v31
  v_exp_f32 v76, v76
  v_cvt_pk_bf16_f32 v16, v24, v25
  v_cvt_pk_bf16_f32 v17, v26, v27
  v_cvt_pk_bf16_f32 v18, v28, v29
  v_cvt_pk_bf16_f32 v19, v30, v31
  v_exp_f32 v77, v77
  v_mov_b64 v[60:61], 0
  v_mfma_f32_16x16x32_bf16 v[24:27], v[36:39], v[16:19], 0
  v_cvt_pk_bf16_f32 v20, v76, v77
  s_waitcnt lgkmcnt(4)
  v_mfma_f32_16x16x32_bf16 v[28:31], v[72:75], v[16:19], 0
  v_cvt_pk_bf16_f32 v23, v76, v77
  v_mov_b64 v[62:63], 0
  v_mfma_f32_16x16x32_bf16 v[32:35], v[56:59], v[16:19], 0
  v_mov_b64 v[64:65], 0
  v_mov_b64 v[66:67], 0
  v_mfma_f32_16x16x16_bf16 v[24:27], v[36:37], v[20:21], v[24:27]
  v_mov_b64 v[68:69], 0
  v_mov_b64 v[70:71], 0
  v_mfma_f32_16x16x16_bf16 v[28:31], v[14:15], v[20:21], v[28:31]
  v_mov_b64 v[72:73], 0
  v_mov_b64 v[74:75], 0
  v_mfma_f32_16x16x16_bf16 v[32:35], v[14:15], v[22:23], v[32:35]
  v_mov_b64 v[56:57], 0
  v_mov_b64 v[58:59], 0
  v_rcp_f32 v24, v24
  s_mov_b64 exec, s[58:59]
  s_nop 3
  v_mov_b64 v[28:29], v[32:33]
  v_mov_b64 v[30:31], v[34:35]
  s_mov_b64 exec, -1
  v_pk_mul_f32 v[28:29], v[28:29], v[24:25] op_sel_hi:[1,0]
  v_pk_mul_f32 v[30:31], v[30:31], v[24:25] op_sel_hi:[1,0]
  v_cvt_pk_bf16_f32 v28, v28, v29
  v_cvt_pk_bf16_f32 v29, v30, v31
  ds_write_b64 v7, v[28:29]
  s_add_u32 s32, s32, 1
  s_add_u32 s34, s34, 0x4000
  s_add_u32 s47, s47, 0x20000
  s_add_u32 s44, s44, 0x80000
  s_add_u32 s56, s56, 0x80000
  s_xor_b32 s33, s33, 8192
  s_waitcnt lgkmcnt(0)
  s_barrier
  ds_read_b128 v[32:35], v1 offset:14336
  ds_read_b128 v[36:39], v1 offset:15360
  s_sub_u32 m0, s46, 8192
  s_waitcnt lgkmcnt(1)
  v_smfmac_f32_16x16x64_bf16 v[56:59], v[32:35], v[208:215], v4
  ds_read_b128 v[16:19], v2 offset:32768
  ds_read_b128 v[20:23], v2 offset:33792
  s_waitcnt lgkmcnt(2)
  v_smfmac_f32_16x16x64_bf16 v[56:59], v[36:39], v[216:223], v4
  ds_read_b128 v[24:27], v2 offset:34816
  ds_read_b128 v[28:31], v2 offset:35840
  v_smfmac_f32_16x16x64_bf16 v[60:63], v[32:35], v[224:231], v4
  buffer_load_dwordx4 v1, s[4:7], s45 offen offset:0 sc1 lds
  v_smfmac_f32_16x16x64_bf16 v[60:63], v[36:39], v[232:239], v4
  buffer_load_dwordx4 v1, s[4:7], s45 offen offset:1024 sc1 lds
  v_add_f32 v58, v56, v58
  v_add_f32 v59, v57, v59
  v_smfmac_f32_16x16x64_bf16 v[64:67], v[32:35], v[240:247], v4
  v_cvt_pk_bf16_f32 v56, v58, v59
  v_smfmac_f32_16x16x64_bf16 v[64:67], v[36:39], v[248:255], v4
  buffer_store_dword v56, v8, s[4:7], s37 offen sc1
  v_add_f32 v62, v60, v62
  v_add_f32 v63, v61, v63
  v_smfmac_f32_16x16x64_bf16 v[68:71], v[32:35], v[40:47], v4
  v_cvt_pk_bf16_f32 v60, v62, v63
  v_smfmac_f32_16x16x64_bf16 v[68:71], v[36:39], v[48:55], v4
  buffer_store_dword v60, v8, s[4:7], s38 offen sc1
  v_add_f32 v66, v64, v66
  v_add_f32 v67, v65, v67
  s_waitcnt lgkmcnt(2)
  v_smfmac_f32_16x16x64_bf16 v[72:75], v[32:35], v[16:23], v4
  v_cvt_pk_bf16_f32 v64, v66, v67
  s_waitcnt lgkmcnt(0)
  v_smfmac_f32_16x16x64_bf16 v[72:75], v[36:39], v[24:31], v4
  buffer_store_dword v64, v8, s[4:7], s39 offen sc1
  s_add_u32 s45, s45, 0x80000
  v_add_f32 v70, v68, v70
  v_add_f32 v71, v69, v71
  v_cvt_pk_bf16_f32 v68, v70, v71
  s_nop 2
  v_add_f32 v74, v72, v74
  v_add_f32 v75, v73, v75
  v_cvt_pk_bf16_f32 v72, v74, v75
  buffer_store_dword v68, v8, s[4:7], s40 offen sc1
  buffer_store_dword v72, v8, s[4:7], s41 offen sc1
  s_xor_b32 s37, s37, 0x40000
  s_xor_b32 s38, s38, 0x40000
  s_xor_b32 s39, s39, 0x40000
  s_xor_b32 s40, s40, 0x40000
  s_xor_b32 s41, s41, 0x40000
  s_cmp_eq_u32 s49, 0
  s_cbranch_scc1 L_noown_108
  v_and_b32 v76, 3, v0
  v_bfe_u32 v77, v0, 2, 1
  v_lshlrev_b32 v77, 4, v77
  v_mov_b32 v78, 0x3f80
  v_lshlrev_b32 v77, v77, v78
  v_cmp_eq_u32 vcc, 0, v76
  s_nop 1
  v_cndmask_b32 v56, 0, v77, vcc
  v_cmp_eq_u32 vcc, 1, v76
  s_nop 1
  v_cndmask_b32 v57, 0, v77, vcc
  v_cmp_eq_u32 vcc, 2, v76
  s_nop 1
  v_cndmask_b32 v58, 0, v77, vcc
  v_cmp_eq_u32 vcc, 3, v76
  s_nop 1
  v_cndmask_b32 v59, 0, v77, vcc
  s_mov_b32 s51, 0
  s_nop 4
  buffer_load_dwordx4 v[60:63], v12, s[4:7], s42 offen offset:0 sc1
  buffer_load_dwordx4 v[64:67], v12, s[4:7], s42 offen offset:2048 sc1
  buffer_load_dwordx4 v[68:71], v12, s[4:7], s43 offen offset:0 sc1
  buffer_load_dwordx4 v[72:75], v12, s[4:7], s43 offen offset:2048 sc1
  v_mov_b64 v[16:17], 0
  v_mov_b64 v[18:19], 0
  v_mov_b64 v[20:21], 0
  v_mov_b64 v[22:23], 0
  v_mov_b64 v[24:25], 0
  v_mov_b64 v[26:27], 0
  v_mov_b64 v[28:29], 0
  v_mov_b64 v[30:31], 0
  v_mov_b64 v[32:33], 0
  v_mov_b64 v[34:35], 0
  v_mov_b64 v[36:37], 0
  v_mov_b64 v[38:39], 0
  s_and_b32 s52, s32, 15
  s_or_b32 s52, s52, s57
  s_add_u32 s97, s32, 516
  s_lshr_b32 s97, s97, 2
  s_cmp_eq_u32 s52, 12
  s_cselect_b32 s97, s97, 0
  s_cmp_lt_u32 s32, 48
  s_cselect_b32 s97, s97, 0
  buffer_load_dwordx4 v[40:43], v12, s[4:7], s42 offen offset:0 sc1
  buffer_load_dwordx4 v[44:47], v12, s[4:7], s42 offen offset:2048 sc1
  buffer_load_dwordx4 v[48:51], v12, s[4:7], s43 offen offset:0 sc1
  buffer_load_dwordx4 v[52:55], v12, s[4:7], s43 offen offset:2048 sc1
L_oag_109:
  s_waitcnt vmcnt(7)
  v_mfma_f32_16x16x32_bf16 v[76:79], v[56:59], v[60:63], 0
  v_max3_u32 v39, v60, v61, v62
  v_max_u32 v39, v39, v63
  s_waitcnt vmcnt(6)
  v_mfma_f32_16x16x32_bf16 v[76:79], v[56:59], v[64:67], v[76:79]
  v_max3_u32 v39, v39, v64, v65
  v_max3_u32 v39, v39, v66, v67
  s_waitcnt vmcnt(5)
  v_mfma_f32_16x16x32_bf16 v[76:79], v[56:59], v[68:71], v[76:79]
  v_max3_u32 v39, v39, v68, v69
  v_max3_u32 v39, v39, v70, v71
  s_waitcnt vmcnt(4)
  v_mfma_f32_16x16x32_bf16 v[76:79], v[56:59], v[72:75], v[76:79]
  v_max3_u32 v39, v39, v72, v73
  v_max3_u32 v39, v39, v74, v75
  v_cmp_eq_u32 vcc, -1, v39
  v_mov_b32 v39, 0
  s_nop 3
  v_add_f32_dpp v76, v76, v76 row_ror:8 row_mask:0xf bank_mask:0xf
  v_add_f32_dpp v77, v77, v77 row_ror:8 row_mask:0xf bank_mask:0xf
  v_add_f32_dpp v78, v78, v78 row_ror:8 row_mask:0xf bank_mask:0xf
  v_add_f32_dpp v79, v79, v79 row_ror:8 row_mask:0xf bank_mask:0xf
  v_cvt_pk_bf16_f32 v76, v76, v77
  v_cvt_pk_bf16_f32 v77, v78, v79
  s_cbranch_vccnz L_oag_109b
L_ook_110:
  s_mov_b64 exec, 0x00ff00ff
  buffer_store_dwordx2 v[76:77], v13, s[4:7], s35 offen sc1
  s_barrier
  buffer_store_dwordx2 v[76:77], v13, s[4:7], s36 offen sc1
  s_mov_b64 exec, -1
  v_mov_b64 v[56:57], -1
  v_mov_b64 v[58:59], -1
  s_xor_b32 s35, s35, 8192
  s_mov_b64 exec, 0x00ff00ff
  buffer_store_dwordx2 v[56:57], v13, s[4:7], s35 offen sc1
  s_mov_b64 exec, -1
  buffer_store_dwordx4 v[56:59], v12, s[4:7], s42 offen offset:0 sc1
  buffer_store_dwordx4 v[56:59], v12, s[4:7], s42 offen offset:2048 sc1
  buffer_store_dwordx4 v[56:59], v12, s[4:7], s43 offen offset:0 sc1
  buffer_store_dwordx4 v[56:59], v12, s[4:7], s43 offen offset:2048 sc1
  s_xor_b32 s42, s42, 0x40000
  s_xor_b32 s43, s43, 0x40000
  s_add_u32 s36, s36, 16384
  s_branch L_loopsafe_74_top
L_noown_108:
  s_cmp_eq_u32 s97, 0
  s_cbranch_scc1 L_nochk_112
  v_mov_b32 v16, 0x3600
  s_waitcnt vmcnt(7)
  ds_read_b32 v16, v16
  s_mov_b32 s51, 0
  s_waitcnt lgkmcnt(0)
L_kvag_113:
  v_cmp_ne_u32 vcc, 0x20202020, v16
  s_nop 0
  s_cbranch_vccz L_nochk_112
  buffer_load_dword v16, off, s[8:11], s97 sc1
  s_add_u32 s51, s51, 1
  s_cmp_gt_u32 s51, 131072
  s_cbranch_scc1 L_end
  s_waitcnt vmcnt(0)
  s_branch L_kvag_113
L_nochk_112:
  v_mov_b64 v[16:17], 0
  v_mov_b64 v[18:19], 0
  v_mov_b64 v[20:21], 0
  v_mov_b64 v[22:23], 0
  v_mov_b64 v[24:25], 0
  v_mov_b64 v[26:27], 0
  v_mov_b64 v[28:29], 0
  v_mov_b64 v[30:31], 0
  v_mov_b64 v[32:33], 0
  v_mov_b64 v[34:35], 0
  v_mov_b64 v[36:37], 0
  v_mov_b64 v[38:39], 0
  s_and_b32 s52, s32, 15
  s_or_b32 s52, s52, s57
  s_add_u32 s97, s32, 516
  s_lshr_b32 s97, s97, 2
  s_cmp_eq_u32 s52, 12
  s_cselect_b32 s97, s97, 0
  s_cmp_lt_u32 s32, 48
  s_cselect_b32 s97, s97, 0
  s_barrier
  s_nop 15
  s_nop 8
  s_branch L_loopsafe_74_top
L_gag_96b:
  buffer_load_dwordx4 v[72:75], v11, s[4:7], s33 offen sc1
  buffer_load_dword v77, v9, s[4:7], s33 offen sc1
  s_waitcnt vmcnt(2)
  ds_write_b128 v11, v[68:71] offset:0
  ds_write_b32 v9, v78 offset:0
  v_max3_u32 v79, v68, v69, v70
  v_max3_u32 v79, v79, v71, v78
  v_cmp_eq_u32 vcc, -1, v79
  s_nop 0
  s_cbranch_vccz L_got_97
  buffer_load_dwordx4 v[68:71], v11, s[4:7], s33 offen sc1
  buffer_load_dword v78, v9, s[4:7], s33 offen sc1
  s_add_u32 s51, s51, 1
  s_cmp_gt_u32 s51, 131072
  s_cbranch_scc1 L_end
  s_branch L_gag_96
L_nlast_100:
  v_mov_b32 v79, s32
  buffer_store_dword v79, off, s[4:7], s20 sc1
  s_mov_b32 s62, s21
  s_branch L_nlast_100b
L_ns_106:
  s_movk_i32 m0, 0x3600
  s_nop 0
  buffer_load_dword off, s[8:11], s97 sc1 lds
  s_branch L_ns_106b
L_big_107:
  v_max3_f32 v32, v24, v25, v26
  v_max3_f32 v32, v32, v27, v28
  v_max3_f32 v32, v32, v29, v30
  v_max3_f32 v32, v32, v31, v76
  v_max_f32 v32, v32, v77
  v_mov_b32 v33, v32
  s_nop 1
  v_permlane32_swap_b32 v32, v33
  v_max_f32 v32, v32, v33
  v_mov_b32 v33, v32
  s_nop 1
  v_permlane16_swap_b32 v32, v33
  v_max_f32 v32, v32, v33
  v_sub_f32 v24, v24, v32
  v_sub_f32 v25, v25, v32
  v_sub_f32 v26, v26, v32
  v_sub_f32 v27, v27, v32
  v_sub_f32 v28, v28, v32
  v_sub_f32 v29, v29, v32
  v_sub_f32 v30, v30, v32
  v_sub_f32 v31, v31, v32
  v_sub_f32 v76, v76, v32
  v_sub_f32 v77, v77, v32
  s_branch L_big_107b
L_oag_109b:
  buffer_load_dwordx4 v[60:63], v12, s[4:7], s42 offen offset:0 sc1
  buffer_load_dwordx4 v[64:67], v12, s[4:7], s42 offen offset:2048 sc1
  buffer_load_dwordx4 v[68:71], v12, s[4:7], s43 offen offset:0 sc1
  buffer_load_dwordx4 v[72:75], v12, s[4:7], s43 offen offset:2048 sc1
  s_waitcnt vmcnt(7)
  v_mfma_f32_16x16x32_bf16 v[76:79], v[56:59], v[40:43], 0
  v_max3_u32 v39, v40, v41, v42
  v_max_u32 v39, v39, v43
  s_waitcnt vmcnt(6)
  v_mfma_f32_16x16x32_bf16 v[76:79], v[56:59], v[44:47], v[76:79]
  v_max3_u32 v39, v39, v44, v45
  v_max3_u32 v39, v39, v46, v47
  s_waitcnt vmcnt(5)
  v_mfma_f32_16x16x32_bf16 v[76:79], v[56:59], v[48:51], v[76:79]
  v_max3_u32 v39, v39, v48, v49
  v_max3_u32 v39, v39, v50, v51
  s_waitcnt vmcnt(4)
  v_mfma_f32_16x16x32_bf16 v[76:79], v[56:59], v[52:55], v[76:79]
  v_max3_u32 v39, v39, v52, v53
  v_max3_u32 v39, v39, v54, v55
  v_cmp_eq_u32 vcc, -1, v39
  v_mov_b32 v39, 0
  s_nop 3
  v_add_f32_dpp v76, v76, v76 row_ror:8 row_mask:0xf bank_mask:0xf
  v_add_f32_dpp v77, v77, v77 row_ror:8 row_mask:0xf bank_mask:0xf
  v_add_f32_dpp v78, v78, v78 row_ror:8 row_mask:0xf bank_mask:0xf
  v_add_f32_dpp v79, v79, v79 row_ror:8 row_mask:0xf bank_mask:0xf
  v_cvt_pk_bf16_f32 v76, v76, v77
  v_cvt_pk_bf16_f32 v77, v78, v79
  s_cbranch_vccz L_ook_110
  buffer_load_dwordx4 v[40:43], v12, s[4:7], s42 offen offset:0 sc1
  buffer_load_dwordx4 v[44:47], v12, s[4:7], s42 offen offset:2048 sc1
  buffer_load_dwordx4 v[48:51], v12, s[4:7], s43 offen offset:0 sc1
  buffer_load_dwordx4 v[52:55], v12, s[4:7], s43 offen offset:2048 sc1
  s_add_u32 s51, s51, 1
  s_cmp_gt_u32 s51, 131072
  s_cbranch_scc1 L_end
  s_branch L_oag_109
L_late_104:
  s_waitcnt lgkmcnt(0)
  v_smfmac_f32_16x16x64_bf16 v[16:19], v[60:63], a[64:71], v4
  s_waitcnt lgkmcnt(0)
  v_smfmac_f32_16x16x64_bf16 v[20:23], v[60:63], a[72:79], v4
  s_waitcnt lgkmcnt(0)
  v_smfmac_f32_16x16x64_bf16 v[36:39], v[60:63], v[48:55], v4
  ds_read_b128 v[48:51], v2 offset:2048
  ds_read_b128 v[52:55], v2 offset:3072
  s_waitcnt lgkmcnt(0)
  v_smfmac_f32_16x16x64_bf16 v[24:27], v[60:63], a[208:215], v4
  s_waitcnt lgkmcnt(0)
  v_smfmac_f32_16x16x64_bf16 v[28:31], v[60:63], a[216:223], v4
  s_mov_b32 s51, 0
  s_add_u32 s52, s34, s96
  s_branch L_rag_103
L_watch_105:
  buffer_load_dword v79, off, s[4:7], s52 sc1
  s_add_u32 s51, s51, 1
  s_cmp_gt_u32 s51, 131072
  s_cbranch_scc1 L_end
  s_waitcnt vmcnt(0)
  v_cmp_eq_u32 vcc, -1, v79
  s_nop 0
  s_cbranch_vccnz L_watch_105
  s_nop 14
L_rag_103:
  buffer_load_dwordx4 v[68:71], v11, s[4:7], s34 offen sc1
  buffer_load_dword v76, v9, s[4:7], s34 offen sc1
  s_add_u32 s51, s51, 1
  s_cmp_gt_u32 s51, 131072
  s_cbranch_scc1 L_end
  s_waitcnt vmcnt(0)
  v_max3_u32 v79, v68, v69, v70
  v_max3_u32 v79, v79, v71, v76
  v_cmp_eq_u32 vcc, -1, v79
  s_nop 0
  s_cbranch_vccnz L_watch_105
  ds_write_b128 v11, v[68:71] offset:5120
  ds_write_b32 v9, v76 offset:5120
  s_branch L_rok_102
L_chainfin_75:
  s_waitcnt lgkmcnt(0)
  s_barrier
  s_cmp_lg_u32 s29, 0
  s_cbranch_scc1 L_stage_114
  s_lshl_b32 s52, s28, 6
  v_bfe_u32 v14, v0, 1, 3
  v_mul_u32_u24 v14, 288, v14
  v_lshrrev_b32 v15, 4, v0
  v_lshl_add_u32 v14, v15, 4, v14
  v_and_b32 v15, 1, v0
  v_lshl_add_u32 v14, v15, 3, v14
  v_add_u32 v14, s52, v14
  ds_read_b64 v[14:15], v14 offset:10240
L_stage_114:
  s_add_u32 s47, s47, 0x20000
  v_lshrrev_b32 v78, 1, v1
  s_waitcnt lgkmcnt(0)
  buffer_store_dwordx2 v[14:15], v78, s[4:7], s47 offen sc1
  s_waitcnt vmcnt(0)
  s_barrier
  s_cmp_lg_u32 s28, 0
  s_cbranch_scc1 L_end
  v_mov_b32 v14, 64
  buffer_store_dword v14, off, s[4:7], s48 sc1
  s_branch L_end
L_end:
  s_endpgm
.section .rodata,"a"
.p2align 6
.amdhsa_kernel concat_heads__linear_kernel_hedgehog__memory_aug_recurrent_mem_tr__prompt_kernel
  .amdhsa_next_free_vgpr 512
  .amdhsa_next_free_sgpr 102
  .amdhsa_accum_offset 256
  .amdhsa_group_segment_fixed_size 0
  .amdhsa_kernarg_size 112
  .amdhsa_user_sgpr_count 2
  .amdhsa_user_sgpr_kernarg_segment_ptr 1
  .amdhsa_system_sgpr_workgroup_id_x 1
  .amdhsa_float_denorm_mode_32 3
.end_amdhsa_kernel
```
